```python
import torch

def _softmax(x, axis=-1):
    return torch.softmax(x, dim=axis)
def _gelu(x):
    return torch.nn.functional.gelu(x, approximate="tanh")
def _silu(x):
    return torch.nn.functional.silu(x)
def _sigmoid(x):
    return torch.sigmoid(x)
def _layernorm(x, axis=-1, eps=1e-5):
    m = x.mean(dim=axis, keepdim=True)
    v = x.var(dim=axis, keepdim=True, unbiased=False)
    return (x - m) / torch.sqrt(v + eps)
def _scatter_add(tgt, idx, src, axis=0):
    return tgt.clone().index_add_(axis, idx, src)
def _segment_sum(src, seg, n):
    out = torch.zeros((n,) + src.shape[1:], dtype=src.dtype)
    return out.index_add_(0, seg, src)
def _pad(x, pw):
    flat = tuple(v for pair in reversed(pw) for v in pair)
    return torch.nn.functional.pad(x, flat)

kernel_name = 'recurrent_scan__ssm_conv_s5__glu_gated_swiglu__prompt'

def setup_inputs():

    _w = (lambda a: (lambda t: t.to(torch.bfloat16) if t.is_floating_point() else t)(torch.as_tensor(a)))
    def _A_setup():
        B, S, D = 1, 2048, 640
        P = D
        Lambda_re = -0.5 * (lambda _x: torch.exp(torch.as_tensor(_x)))((lambda *s: torch.randn(*s, dtype=torch.bfloat16) * 0.8)(P))
        Lambda_im = (lambda *s: torch.randn(*s, dtype=torch.bfloat16) * 0.8)(P) * 1.0
        B_re = (lambda *s: torch.randn(*s, dtype=torch.bfloat16) * 0.8)(P, D) * (D ** -0.5)
        B_im = (lambda *s: torch.randn(*s, dtype=torch.bfloat16) * 0.8)(P, D) * (D ** -0.5)
        C_re = (lambda *s: torch.randn(*s, dtype=torch.bfloat16) * 0.8)(D, P) * (P ** -0.5)
        C_im = (lambda *s: torch.randn(*s, dtype=torch.bfloat16) * 0.8)(D, P) * (P ** -0.5)
        log_dt = (lambda *s: torch.randn(*s, dtype=torch.bfloat16) * 0.8)(P) * 0.3 - 2.0
        Dskip = (lambda *s: torch.randn(*s, dtype=torch.bfloat16) * 0.8)(D)
        return {
            "x": _w((lambda *s: torch.randn(*s, dtype=torch.bfloat16) * 0.05)(B, S, D)),
            "Lambda_re": _w(Lambda_re),
            "Lambda_im": _w(Lambda_im),
            "B_re": _w(B_re),
            "B_im": _w(B_im),
            "C_re": _w(C_re),
            "C_im": _w(C_im),
            "log_dt": _w(log_dt),
            "Dskip": _w(Dskip),
        }
    _A_in = _A_setup()

    def _B_setup():
        B, S, D, F = 1, 2048, 640, 1728
        return {
            "x": _w((lambda *s: torch.randn(*s, dtype=torch.bfloat16) * 0.05)(B, S, D)),
            "w1": _w((lambda *s: torch.randn(*s, dtype=torch.bfloat16) * 0.2)(D, F) * (2.0 / D) ** 0.5),
            "w3": _w((lambda *s: torch.randn(*s, dtype=torch.bfloat16) * 0.2)(D, F) * (2.0 / D) ** 0.5),
            "w2": _w((lambda *s: torch.randn(*s, dtype=torch.bfloat16) * 0.2)(F, D) * (2.0 / F) ** 0.5),
        }
    _B_in = _B_setup()

    return {
        "A_x": _A_in["x"],
        "A_Lambda_re": _A_in["Lambda_re"],
        "A_Lambda_im": _A_in["Lambda_im"],
        "A_B_re": _A_in["B_re"],
        "A_B_im": _A_in["B_im"],
        "A_C_re": _A_in["C_re"],
        "A_C_im": _A_in["C_im"],
        "A_log_dt": _A_in["log_dt"],
        "A_Dskip": _A_in["Dskip"],
        "B_x": _B_in["x"],
        "B_w1": _B_in["w1"],
        "B_w3": _B_in["w3"],
        "B_w2": _B_in["w2"],
    }

def reference(A_x, A_Lambda_re, A_Lambda_im, A_B_re, A_B_im, A_C_re, A_C_im, A_log_dt, A_Dskip, B_x, B_w1, B_w3, B_w2):
    def _A_ref(x, Lambda_re, Lambda_im, B_re, B_im, C_re, C_im, log_dt, Dskip):
        Bsz, L, H = x.shape
        Lam = Lambda_re + 1j * Lambda_im
        Bmat = B_re + 1j * B_im
        Cmat = C_re + 1j * C_im
        dt = torch.exp(log_dt)
        Lam_bar = torch.exp(dt * Lam)
        B_bar = ((Lam_bar - 1.0) / Lam)[:, None] * Bmat
        Bu = torch.einsum("bld,pd->blp", x + 0j, B_bar)
        h = torch.zeros_like(Bu[:, 0, :])
        hs = []
        for t in range(L):
            h = Lam_bar[None, :] * h + Bu[:, t, :]
            hs.append(h)
        hseq = torch.stack(hs, 1)
        y = 2.0 * torch.einsum("blp,dp->bld", hseq, Cmat).real + x * Dskip[None, None, :]
        return y

    def _B_ref(x, w1, w3, w2):
        gate = torch.einsum("bsd,df->bsf", x, w1)
        up = torch.einsum("bsd,df->bsf", x, w3)
        h = _silu(gate) * up
        out = torch.einsum("bsf,fd->bsd", h, w2)
        return out

    x = A_x
    xn = _layernorm(x, axis=-1)
    s = _A_ref(xn, A_Lambda_re, A_Lambda_im, A_B_re, A_B_im, A_C_re, A_C_im, A_log_dt, A_Dskip)
    g = _silu(_B_ref(xn, B_w1, B_w3, B_w2))
    return x + s * g
```

```asm
; @launch grid=(256,1,1) block=(512,1,1) lds=163840
.amdgcn_target "amdgcn-amd-amdhsa--gfx950"
.text
.globl recurrent_scan__ssm_conv_s5__glu_gated_swiglu__prompt_kernel
.p2align 8
.type recurrent_scan__ssm_conv_s5__glu_gated_swiglu__prompt_kernel,@function
recurrent_scan__ssm_conv_s5__glu_gated_swiglu__prompt_kernel:
    s_cmp_ge_u32 s2, 256
    s_cbranch_scc1 L_done
    s_load_dwordx16 s[4:19], s[0:1], 0
    s_load_dwordx16 s[20:35], s[0:1], 64
    v_lshrrev_b32 v1, 6, v0
    v_and_b32 v0, 63, v0
    v_readfirstlane_b32 s3, v1
    s_and_b32 s68, s2, 7
    s_lshr_b32 s69, s2, 3
    s_and_b32 s60, s68, 1
    s_lshl_b32 s60, s60, 2
    s_and_b32 s70, s69, 3
    s_add_u32 s60, s60, s70
    s_lshr_b32 s70, s68, 1
    s_lshr_b32 s71, s69, 2
    s_lshl_b32 s63, s70, 3
    s_and_b32 s72, s69, 7
    s_add_u32 s63, s63, s72
    s_and_b32 s64, s68, 1
    s_lshl_b32 s64, s64, 2
    s_lshr_b32 s72, s69, 3
    s_add_u32 s64, s64, s72
    s_mul_i32 s72, s70, 3
    s_lshl_b32 s73, s70, 1
    s_add_u32 s73, s73, 2
    s_cmp_lt_u32 s70, 2
    s_cselect_b32 s72, s72, s73
    s_cselect_b32 s73, 3, 2
    s_lshl_b32 s68, s70, 3
    s_sub_u32 s68, s68, s72
    s_add_u32 s68, s68, s71
    s_sub_u32 s68, s68, s73
    s_add_u32 s68, s68, 10
    s_add_u32 s72, s72, s71
    s_cmp_lt_u32 s71, s73
    s_cselect_b32 s61, s72, s68
    s_cselect_b32 s90, 12, 13
    s_cselect_b32 s91, 4608, 0
    s_sub_u32 s91, 162816, s91
    s_lshl_b32 s90, s90, 12
    s_and_b32 s65, s3, 3
    s_mov_b32 s67, 0
    v_lshlrev_b32 v1, 4, v0
    s_waitcnt lgkmcnt(0)
    s_add_u32 s68, s34, 0xf80000
    s_addc_u32 s69, s35, 0
    s_load_dword s66, s[68:69], 0
    s_cmp_ge_u32 s3, 4
    s_cbranch_scc1 L_helper
    s_cmp_ge_u32 s61, 10
    s_cbranch_scc1 L_c_nossm
    s_mov_b32 s62, s61
    s_mov_b32 s48, s6
    s_mov_b32 s49, s7
    s_mov_b32 s50, 1280
    s_mov_b32 s51, 0x00020000
    s_mov_b32 s52, s8
    s_mov_b32 s53, s9
    s_mov_b32 s54, 1280
    s_mov_b32 s55, 0x00020000
    s_mov_b32 s56, s18
    s_mov_b32 s57, s19
    s_mov_b32 s58, 1280
    s_mov_b32 s59, 0x00020000
    v_lshlrev_b32 v2, 1, v0
    s_lshl_b32 s68, s62, 7
    buffer_load_ushort v100, v2, s[48:51], s68 offen
    buffer_load_ushort v101, v2, s[52:55], s68 offen
    buffer_load_ushort v102, v2, s[56:59], s68 offen
L_c_nossm:
    s_mov_b32 s89, 0x7000000
    s_cmp_ge_u32 s3, 2
    s_cbranch_scc1 L_relay
    s_mov_b32 s36, s4
    s_mov_b32 s37, s5
    s_mov_b32 s38, 2621440
    s_mov_b32 s39, 0x00020000
    s_lshl_b32 s68, s60, 8
    s_lshl_b32 s69, s61, 3
    s_add_u32 s68, s68, s69
    s_lshl_b32 s69, s3, 2
    s_add_u32 s68, s68, s69
    s_mul_i32 s69, s68, 1280
    v_lshrrev_b32 v2, 4, v0
    v_and_b32 v3, 15, v0
    v_mul_u32_u24 v4, 1280, v2
    v_lshl_add_u32 v4, v3, 4, v4
    buffer_load_dwordx4 v[8:11], v4, s[36:39], s69 offen offset:0
    buffer_load_dwordx4 v[12:15], v4, s[36:39], s69 offen offset:256
    buffer_load_dwordx4 v[16:19], v4, s[36:39], s69 offen offset:512
    buffer_load_dwordx4 v[20:23], v4, s[36:39], s69 offen offset:768
    buffer_load_dwordx4 v[24:27], v4, s[36:39], s69 offen offset:1024
    s_add_u32 s44, s34, 0xf00000
    s_addc_u32 s45, s35, 0
    s_mov_b32 s46, 65536
    s_mov_b32 s47, 0x00020000
    s_lshl_b32 s68, s68, 5
    v_lshlrev_b32 v5, 5, v2
    v_lshl_add_u32 v5, v3, 4, v5
    s_mov_b32 s70, 0xffff0000
    s_waitcnt vmcnt(4)
    v_lshlrev_b32 v32, 16, v8
    v_and_b32 v33, s70, v8
    v_lshlrev_b32 v34, 16, v9
    v_and_b32 v35, s70, v9
    v_lshlrev_b32 v36, 16, v10
    v_and_b32 v37, s70, v10
    v_lshlrev_b32 v38, 16, v11
    v_and_b32 v39, s70, v11
    s_waitcnt vmcnt(3)
    v_lshlrev_b32 v40, 16, v12
    v_and_b32 v41, s70, v12
    v_lshlrev_b32 v42, 16, v13
    v_and_b32 v43, s70, v13
    v_lshlrev_b32 v44, 16, v14
    v_and_b32 v45, s70, v14
    v_lshlrev_b32 v46, 16, v15
    v_and_b32 v47, s70, v15
    s_waitcnt vmcnt(2)
    v_lshlrev_b32 v48, 16, v16
    v_and_b32 v49, s70, v16
    v_lshlrev_b32 v50, 16, v17
    v_and_b32 v51, s70, v17
    v_lshlrev_b32 v52, 16, v18
    v_and_b32 v53, s70, v18
    v_lshlrev_b32 v54, 16, v19
    v_and_b32 v55, s70, v19
    s_waitcnt vmcnt(1)
    v_lshlrev_b32 v56, 16, v20
    v_and_b32 v57, s70, v20
    v_lshlrev_b32 v58, 16, v21
    v_and_b32 v59, s70, v21
    v_lshlrev_b32 v60, 16, v22
    v_and_b32 v61, s70, v22
    v_lshlrev_b32 v62, 16, v23
    v_and_b32 v63, s70, v23
    s_waitcnt vmcnt(0)
    v_lshlrev_b32 v64, 16, v24
    v_and_b32 v65, s70, v24
    v_lshlrev_b32 v66, 16, v25
    v_and_b32 v67, s70, v25
    v_lshlrev_b32 v68, 16, v26
    v_and_b32 v69, s70, v26
    v_lshlrev_b32 v70, 16, v27
    v_and_b32 v71, s70, v27
    v_pk_add_f32 v[72:73], v[32:33], v[34:35]
    v_pk_add_f32 v[74:75], v[36:37], v[38:39]
    v_pk_add_f32 v[72:73], v[72:73], v[40:41]
    v_pk_add_f32 v[74:75], v[74:75], v[42:43]
    v_pk_add_f32 v[72:73], v[72:73], v[44:45]
    v_pk_add_f32 v[74:75], v[74:75], v[46:47]
    v_pk_add_f32 v[72:73], v[72:73], v[48:49]
    v_pk_add_f32 v[74:75], v[74:75], v[50:51]
    v_pk_add_f32 v[72:73], v[72:73], v[52:53]
    v_pk_add_f32 v[74:75], v[74:75], v[54:55]
    v_pk_add_f32 v[72:73], v[72:73], v[56:57]
    v_pk_add_f32 v[74:75], v[74:75], v[58:59]
    v_pk_add_f32 v[72:73], v[72:73], v[60:61]
    v_pk_add_f32 v[74:75], v[74:75], v[62:63]
    v_pk_add_f32 v[72:73], v[72:73], v[64:65]
    v_pk_add_f32 v[74:75], v[74:75], v[66:67]
    v_pk_add_f32 v[72:73], v[72:73], v[68:69]
    v_pk_add_f32 v[74:75], v[74:75], v[70:71]
    s_nop 0
    v_pk_add_f32 v[72:73], v[72:73], v[74:75]
    s_nop 0
    v_add_f32 v72, v72, v73
    s_nop 1
    v_add_f32_dpp v72, v72, v72 quad_perm:[1,0,3,2] row_mask:0xf bank_mask:0xf
    s_nop 1
    v_add_f32_dpp v72, v72, v72 quad_perm:[2,3,0,1] row_mask:0xf bank_mask:0xf
    s_nop 1
    v_add_f32_dpp v72, v72, v72 row_half_mirror row_mask:0xf bank_mask:0xf
    s_nop 1
    v_add_f32_dpp v72, v72, v72 row_mirror row_mask:0xf bank_mask:0xf
    v_mul_f32 v72, 0x3acccccd, v72
    v_cvt_pk_bf16_f32 v74, v72, v72
    v_lshlrev_b32 v74, 16, v74
    v_sub_f32 v73, v72, v74
    v_pk_add_f32 v[32:33], v[32:33], v[74:75] op_sel_hi:[1,0] neg_lo:[0,1] neg_hi:[0,1]
    v_pk_add_f32 v[34:35], v[34:35], v[74:75] op_sel_hi:[1,0] neg_lo:[0,1] neg_hi:[0,1]
    v_pk_add_f32 v[36:37], v[36:37], v[74:75] op_sel_hi:[1,0] neg_lo:[0,1] neg_hi:[0,1]
    v_pk_add_f32 v[38:39], v[38:39], v[74:75] op_sel_hi:[1,0] neg_lo:[0,1] neg_hi:[0,1]
    v_pk_add_f32 v[40:41], v[40:41], v[74:75] op_sel_hi:[1,0] neg_lo:[0,1] neg_hi:[0,1]
    v_pk_add_f32 v[42:43], v[42:43], v[74:75] op_sel_hi:[1,0] neg_lo:[0,1] neg_hi:[0,1]
    v_pk_add_f32 v[44:45], v[44:45], v[74:75] op_sel_hi:[1,0] neg_lo:[0,1] neg_hi:[0,1]
    v_pk_add_f32 v[46:47], v[46:47], v[74:75] op_sel_hi:[1,0] neg_lo:[0,1] neg_hi:[0,1]
    v_pk_add_f32 v[48:49], v[48:49], v[74:75] op_sel_hi:[1,0] neg_lo:[0,1] neg_hi:[0,1]
    v_pk_add_f32 v[50:51], v[50:51], v[74:75] op_sel_hi:[1,0] neg_lo:[0,1] neg_hi:[0,1]
    v_pk_add_f32 v[52:53], v[52:53], v[74:75] op_sel_hi:[1,0] neg_lo:[0,1] neg_hi:[0,1]
    v_pk_add_f32 v[54:55], v[54:55], v[74:75] op_sel_hi:[1,0] neg_lo:[0,1] neg_hi:[0,1]
    v_pk_add_f32 v[56:57], v[56:57], v[74:75] op_sel_hi:[1,0] neg_lo:[0,1] neg_hi:[0,1]
    v_pk_add_f32 v[58:59], v[58:59], v[74:75] op_sel_hi:[1,0] neg_lo:[0,1] neg_hi:[0,1]
    v_pk_add_f32 v[60:61], v[60:61], v[74:75] op_sel_hi:[1,0] neg_lo:[0,1] neg_hi:[0,1]
    v_pk_add_f32 v[62:63], v[62:63], v[74:75] op_sel_hi:[1,0] neg_lo:[0,1] neg_hi:[0,1]
    v_pk_add_f32 v[64:65], v[64:65], v[74:75] op_sel_hi:[1,0] neg_lo:[0,1] neg_hi:[0,1]
    v_pk_add_f32 v[66:67], v[66:67], v[74:75] op_sel_hi:[1,0] neg_lo:[0,1] neg_hi:[0,1]
    v_pk_add_f32 v[68:69], v[68:69], v[74:75] op_sel_hi:[1,0] neg_lo:[0,1] neg_hi:[0,1]
    v_pk_add_f32 v[70:71], v[70:71], v[74:75] op_sel_hi:[1,0] neg_lo:[0,1] neg_hi:[0,1]
    v_pk_mul_f32 v[76:77], v[32:33], v[32:33]
    v_pk_mul_f32 v[78:79], v[34:35], v[34:35]
    v_pk_fma_f32 v[76:77], v[36:37], v[36:37], v[76:77]
    v_pk_fma_f32 v[78:79], v[38:39], v[38:39], v[78:79]
    v_pk_fma_f32 v[76:77], v[40:41], v[40:41], v[76:77]
    v_pk_fma_f32 v[78:79], v[42:43], v[42:43], v[78:79]
    v_pk_fma_f32 v[76:77], v[44:45], v[44:45], v[76:77]
    v_pk_fma_f32 v[78:79], v[46:47], v[46:47], v[78:79]
    v_pk_fma_f32 v[76:77], v[48:49], v[48:49], v[76:77]
    v_pk_fma_f32 v[78:79], v[50:51], v[50:51], v[78:79]
    v_pk_fma_f32 v[76:77], v[52:53], v[52:53], v[76:77]
    v_pk_fma_f32 v[78:79], v[54:55], v[54:55], v[78:79]
    v_pk_fma_f32 v[76:77], v[56:57], v[56:57], v[76:77]
    v_pk_fma_f32 v[78:79], v[58:59], v[58:59], v[78:79]
    v_pk_fma_f32 v[76:77], v[60:61], v[60:61], v[76:77]
    v_pk_fma_f32 v[78:79], v[62:63], v[62:63], v[78:79]
    v_pk_fma_f32 v[76:77], v[64:65], v[64:65], v[76:77]
    v_pk_fma_f32 v[78:79], v[66:67], v[66:67], v[78:79]
    v_pk_fma_f32 v[76:77], v[68:69], v[68:69], v[76:77]
    v_pk_fma_f32 v[78:79], v[70:71], v[70:71], v[78:79]
    s_nop 0
    v_pk_add_f32 v[76:77], v[76:77], v[78:79]
    s_nop 0
    v_add_f32 v76, v76, v77
    s_nop 1
    v_add_f32_dpp v76, v76, v76 quad_perm:[1,0,3,2] row_mask:0xf bank_mask:0xf
    s_nop 1
    v_add_f32_dpp v76, v76, v76 quad_perm:[2,3,0,1] row_mask:0xf bank_mask:0xf
    s_nop 1
    v_add_f32_dpp v76, v76, v76 row_half_mirror row_mask:0xf bank_mask:0xf
    s_nop 1
    v_add_f32_dpp v76, v76, v76 row_mirror row_mask:0xf bank_mask:0xf
    v_mul_f32 v76, 0x3acccccd, v76
    v_fma_f32 v76, -v73, v73, v76
    v_max_f32 v76, 0, v76
    v_cvt_pk_bf16_f32 v76, v76, v76
    v_lshlrev_b32 v76, 16, v76
    v_add_f32 v76, 0x3727c5ac, v76
    v_cvt_pk_bf16_f32 v76, v76, v76
    v_lshlrev_b32 v76, 16, v76
    v_sqrt_f32 v76, v76
    s_nop 0
    v_cvt_pk_bf16_f32 v76, v76, v76
    v_lshlrev_b32 v76, 16, v76
    s_waitcnt lgkmcnt(0)
    s_add_u32 s69, s66, 0x9E3779B1
    v_mov_b32 v75, s69
    v_mov_b32 v77, s69
    v_cmp_gt_u32 vcc, 2, v3
    s_and_saveexec_b64 s[70:71], vcc
    buffer_store_dwordx4 v[74:77], v5, s[44:47], s68 offen sc1
    s_mov_b64 exec, s[70:71]
    s_branch L_roles_done
L_relay:
    s_cmp_lt_u32 s61, 10
    s_cbranch_scc1 L_tssm
    s_cmp_eq_u32 s3, 2
    s_cselect_b32 s36, s24, s26
    s_cselect_b32 s37, s25, s27
    s_mov_b32 s38, 2211840
    s_mov_b32 s39, 0x00020000
    s_sub_u32 s68, s61, 10
    s_mul_i32 s68, s68, 160
    s_min_u32 s68, s68, 3296
    s_mul_i32 s69, s60, 55296
    s_add_u32 s68, s68, s69
    v_lshrrev_b32 v2, 1, v0
    v_min_u32 v2, 15, v2
    v_mul_u32_u24 v2, 3456, v2
    v_and_b32 v3, 1, v0
    v_mul_u32_u24 v3, 156, v3
    v_add_u32 v2, v2, v3
    s_branch L_tgo
L_tssm:
    s_cmp_eq_u32 s3, 2
    s_cselect_b32 s36, s10, s12
    s_cselect_b32 s37, s11, s13
    s_mov_b32 s38, 819200
    s_mov_b32 s39, 0x00020000
    s_lshl_b32 s68, s61, 3
    s_add_u32 s68, s68, s60
    s_mul_i32 s68, s68, 10240
    v_bfe_u32 v2, v0, 2, 3
    v_mul_u32_u24 v2, 1280, v2
    v_and_b32 v3, 3, v0
    v_min_u32 v3, 1, v3
    v_lshl_add_u32 v2, v3, 7, v2
L_tgo:
    buffer_load_dword v4, v2, s[36:39], s68 offen
    s_waitcnt vmcnt(0)
L_roles_done:
    s_waitcnt lgkmcnt(0)
    s_add_u32 s66, s66, 0x9E3779B1
    s_cmp_lt_u32 s61, 10
    s_cbranch_scc1 L_c_ssm
    s_sub_u32 s62, s61, 10
    v_and_b32 v8, 15, v0
    v_lshrrev_b32 v9, 4, v0
    v_bfe_u32 v10, v0, 1, 3
    v_xor_b32 v10, v10, v9
    v_lshlrev_b32 v10, 4, v10
    v_lshl_add_u32 v10, v8, 7, v10
    v_and_b32 v11, 1, v9
    v_lshl_add_u32 v10, v11, 3, v10
    s_lshl_b32 s68, s3, 13
    v_add_u32 v10, s68, v10
    v_mov_b32 v2, v10
    v_xor_b32 v3, 8, v10
    v_xor_b32 v4, 64, v10
    v_xor_b32 v5, 0x48, v10
    v_add_u32 v248, 106496, v2
    v_add_u32 v249, 106496, v3
    v_add_u32 v250, 106496, v4
    v_add_u32 v251, 106496, v5
    v_bfe_u32 v12, v0, 2, 2
    v_lshl_add_u32 v12, v9, 3, v12
    v_lshl_add_u32 v13, v11, 2, v12
    v_xor_b32 v11, 1, v11
    v_lshl_add_u32 v14, v11, 2, v12
    v_and_b32 v12, 3, v0
    v_lshlrev_b32 v12, 3, v12
    v_add_u32 v12, 32768, v12
    v_mul_u32_u24 v13, 160, v13
    v_mul_u32_u24 v14, 160, v14
    v_add_u32 v6, v13, v12
    v_add_u32 v7, v14, v12
    v_add_u32 v13, 53248, v6
    v_add_u32 v14, 53248, v7
    v_add_u32 v252, 106496, v6
    v_add_u32 v253, 106496, v7
    v_mov_b32 v12, s91
    s_lshl_b32 s68, s3, 2
    v_add_u32 v254, s68, v12
    s_setprio 3
    s_add_u32 s56, s34, 0xf60000
    s_addc_u32 s57, s35, 0
    s_mov_b32 s58, 65536
    s_mov_b32 s59, 0x00020000
    s_barrier
    ds_read_b64 v[56:57], v2 offset:0
    ds_read_b64 v[58:59], v3 offset:0
    ds_read_b64 v[60:61], v2 offset:2048
    ds_read_b64 v[62:63], v3 offset:2048
    ds_read_b64 v[64:65], v2 offset:4096
    ds_read_b64 v[66:67], v3 offset:4096
    ds_read_b64 v[68:69], v2 offset:6144
    ds_read_b64 v[70:71], v3 offset:6144
    ds_read_b64_tr_b16 v[16:17], v6 offset:0
    ds_read_b64_tr_b16 v[18:19], v7 offset:0
    ds_read_b64_tr_b16 v[20:21], v6 offset:10240
    ds_read_b64_tr_b16 v[22:23], v7 offset:10240
    ds_read_b64_tr_b16 v[24:25], v6 offset:32
    ds_read_b64_tr_b16 v[26:27], v7 offset:32
    s_waitcnt lgkmcnt(4)
    v_mfma_f32_16x16x32_bf16 v[88:91], v[16:19], v[56:59], 0
    ds_read_b64_tr_b16 v[28:29], v6 offset:10272
    v_mfma_f32_16x16x32_bf16 v[128:131], v[16:19], v[60:63], 0
    ds_read_b64_tr_b16 v[30:31], v7 offset:10272
    v_mfma_f32_16x16x32_bf16 v[168:171], v[16:19], v[64:67], 0
    ds_read_b64_tr_b16 v[32:33], v6 offset:64
    v_mfma_f32_16x16x32_bf16 v[208:211], v[16:19], v[68:71], 0
    ds_read_b64_tr_b16 v[34:35], v7 offset:64
    ds_read_b64_tr_b16 v[36:37], v6 offset:10304
    s_waitcnt lgkmcnt(7)
    v_mfma_f32_16x16x32_bf16 v[92:95], v[20:23], v[56:59], 0
    ds_read_b64_tr_b16 v[38:39], v7 offset:10304
    v_mfma_f32_16x16x32_bf16 v[132:135], v[20:23], v[60:63], 0
    ds_read_b64_tr_b16 v[40:41], v6 offset:96
    v_mfma_f32_16x16x32_bf16 v[172:175], v[20:23], v[64:67], 0
    ds_read_b64_tr_b16 v[42:43], v7 offset:96
    v_mfma_f32_16x16x32_bf16 v[212:215], v[20:23], v[68:71], 0
    ds_read_b64_tr_b16 v[44:45], v6 offset:10336
    ds_read_b64_tr_b16 v[46:47], v7 offset:10336
    s_waitcnt lgkmcnt(10)
    v_mfma_f32_16x16x32_bf16 v[96:99], v[24:27], v[56:59], 0
    ds_read_b64_tr_b16 v[48:49], v6 offset:128
    v_mfma_f32_16x16x32_bf16 v[136:139], v[24:27], v[60:63], 0
    ds_read_b64_tr_b16 v[50:51], v7 offset:128
    v_mfma_f32_16x16x32_bf16 v[176:179], v[24:27], v[64:67], 0
    ds_read_b64_tr_b16 v[52:53], v6 offset:10368
    v_mfma_f32_16x16x32_bf16 v[216:219], v[24:27], v[68:71], 0
    ds_read_b64_tr_b16 v[54:55], v7 offset:10368
    ds_read_b64 v[72:73], v4 offset:0
    s_waitcnt lgkmcnt(13)
    v_mfma_f32_16x16x32_bf16 v[100:103], v[28:31], v[56:59], 0
    ds_read_b64 v[74:75], v5 offset:0
    v_mfma_f32_16x16x32_bf16 v[140:143], v[28:31], v[60:63], 0
    ds_read_b64 v[76:77], v4 offset:2048
    v_mfma_f32_16x16x32_bf16 v[180:183], v[28:31], v[64:67], 0
    ds_read_b64 v[78:79], v5 offset:2048
    v_mfma_f32_16x16x32_bf16 v[220:223], v[28:31], v[68:71], 0
    ds_read_b64 v[80:81], v4 offset:4096
    ds_read_b64 v[82:83], v5 offset:4096
    s_waitcnt lgkmcnt(15)
    v_mfma_f32_16x16x32_bf16 v[104:107], v[32:35], v[56:59], 0
    ds_read_b64 v[84:85], v4 offset:6144
    v_mfma_f32_16x16x32_bf16 v[144:147], v[32:35], v[60:63], 0
    ds_read_b64 v[86:87], v5 offset:6144
    v_mfma_f32_16x16x32_bf16 v[184:187], v[32:35], v[64:67], 0
    ds_read_b64_tr_b16 v[16:17], v6 offset:5120
    v_mfma_f32_16x16x32_bf16 v[224:227], v[32:35], v[68:71], 0
    ds_read_b64_tr_b16 v[18:19], v7 offset:5120
    ds_read_b64_tr_b16 v[20:21], v6 offset:15360
    s_waitcnt lgkmcnt(15)
    v_mfma_f32_16x16x32_bf16 v[108:111], v[36:39], v[56:59], 0
    ds_read_b64_tr_b16 v[22:23], v7 offset:15360
    v_mfma_f32_16x16x32_bf16 v[148:151], v[36:39], v[60:63], 0
    ds_read_b64_tr_b16 v[24:25], v6 offset:5152
    v_mfma_f32_16x16x32_bf16 v[188:191], v[36:39], v[64:67], 0
    ds_read_b64_tr_b16 v[26:27], v7 offset:5152
    v_mfma_f32_16x16x32_bf16 v[228:231], v[36:39], v[68:71], 0
    ds_read_b64_tr_b16 v[28:29], v6 offset:15392
    ds_read_b64_tr_b16 v[30:31], v7 offset:15392
    v_mfma_f32_16x16x32_bf16 v[112:115], v[40:43], v[56:59], 0
    v_mfma_f32_16x16x32_bf16 v[152:155], v[40:43], v[60:63], 0
    v_mfma_f32_16x16x32_bf16 v[192:195], v[40:43], v[64:67], 0
    v_mfma_f32_16x16x32_bf16 v[232:235], v[40:43], v[68:71], 0
    ds_read_b64_tr_b16 v[32:33], v6 offset:5184
    ds_read_b64_tr_b16 v[34:35], v7 offset:5184
    v_mfma_f32_16x16x32_bf16 v[116:119], v[44:47], v[56:59], 0
    v_mfma_f32_16x16x32_bf16 v[156:159], v[44:47], v[60:63], 0
    v_mfma_f32_16x16x32_bf16 v[196:199], v[44:47], v[64:67], 0
    v_mfma_f32_16x16x32_bf16 v[236:239], v[44:47], v[68:71], 0
    ds_read_b64_tr_b16 v[36:37], v6 offset:15424
    ds_read_b64_tr_b16 v[38:39], v7 offset:15424
    s_waitcnt lgkmcnt(15)
    v_mfma_f32_16x16x32_bf16 v[120:123], v[48:51], v[56:59], 0
    v_mfma_f32_16x16x32_bf16 v[160:163], v[48:51], v[60:63], 0
    v_mfma_f32_16x16x32_bf16 v[200:203], v[48:51], v[64:67], 0
    v_mfma_f32_16x16x32_bf16 v[240:243], v[48:51], v[68:71], 0
    ds_read_b64_tr_b16 v[40:41], v6 offset:5216
    ds_read_b64_tr_b16 v[42:43], v7 offset:5216
    v_mfma_f32_16x16x32_bf16 v[124:127], v[52:55], v[56:59], 0
    v_mfma_f32_16x16x32_bf16 v[164:167], v[52:55], v[60:63], 0
    v_mfma_f32_16x16x32_bf16 v[204:207], v[52:55], v[64:67], 0
    v_mfma_f32_16x16x32_bf16 v[244:247], v[52:55], v[68:71], 0
    ds_read_b64_tr_b16 v[44:45], v6 offset:15456
    ds_read_b64_tr_b16 v[46:47], v7 offset:15456
    s_waitcnt lgkmcnt(14)
    v_mfma_f32_16x16x32_bf16 v[88:91], v[16:19], v[72:75], v[88:91]
    v_mfma_f32_16x16x32_bf16 v[128:131], v[16:19], v[76:79], v[128:131]
    v_mfma_f32_16x16x32_bf16 v[168:171], v[16:19], v[80:83], v[168:171]
    v_mfma_f32_16x16x32_bf16 v[208:211], v[16:19], v[84:87], v[208:211]
    ds_read_b64_tr_b16 v[48:49], v6 offset:5248
    ds_read_b64_tr_b16 v[50:51], v7 offset:5248
    s_waitcnt lgkmcnt(14)
    v_mfma_f32_16x16x32_bf16 v[92:95], v[20:23], v[72:75], v[92:95]
    v_mfma_f32_16x16x32_bf16 v[132:135], v[20:23], v[76:79], v[132:135]
    v_mfma_f32_16x16x32_bf16 v[172:175], v[20:23], v[80:83], v[172:175]
    v_mfma_f32_16x16x32_bf16 v[212:215], v[20:23], v[84:87], v[212:215]
    ds_read_b64_tr_b16 v[52:53], v6 offset:15488
    ds_read_b64_tr_b16 v[54:55], v7 offset:15488
    s_waitcnt lgkmcnt(14)
    v_mfma_f32_16x16x32_bf16 v[96:99], v[24:27], v[72:75], v[96:99]
    v_mfma_f32_16x16x32_bf16 v[136:139], v[24:27], v[76:79], v[136:139]
    v_mfma_f32_16x16x32_bf16 v[176:179], v[24:27], v[80:83], v[176:179]
    v_mfma_f32_16x16x32_bf16 v[216:219], v[24:27], v[84:87], v[216:219]
    s_waitcnt lgkmcnt(12)
    v_mfma_f32_16x16x32_bf16 v[100:103], v[28:31], v[72:75], v[100:103]
    ds_read_b128 v[8:11], v12 offset:32
    v_mfma_f32_16x16x32_bf16 v[140:143], v[28:31], v[76:79], v[140:143]
    v_mfma_f32_16x16x32_bf16 v[180:183], v[28:31], v[80:83], v[180:183]
    v_mfma_f32_16x16x32_bf16 v[220:223], v[28:31], v[84:87], v[220:223]
    s_waitcnt lgkmcnt(11)
    v_mfma_f32_16x16x32_bf16 v[104:107], v[32:35], v[72:75], v[104:107]
    v_mfma_f32_16x16x32_bf16 v[144:147], v[32:35], v[76:79], v[144:147]
    v_mfma_f32_16x16x32_bf16 v[184:187], v[32:35], v[80:83], v[184:187]
    v_mfma_f32_16x16x32_bf16 v[224:227], v[32:35], v[84:87], v[224:227]
    s_waitcnt lgkmcnt(0)
    v_mfma_f32_16x16x32_bf16 v[108:111], v[36:39], v[72:75], v[108:111]
    v_mov_b32 v15, 1
    v_min3_u32 v8, v8, v9, v10
    v_mfma_f32_16x16x32_bf16 v[148:151], v[36:39], v[76:79], v[148:151]
    ds_write_b32 v254, v15 offset:48
    v_min_u32 v8, v8, v11
    v_mfma_f32_16x16x32_bf16 v[188:191], v[36:39], v[80:83], v[188:191]
    v_cmp_gt_u32 vcc, 2, v8
    v_mfma_f32_16x16x32_bf16 v[228:231], v[36:39], v[84:87], v[228:231]
    s_cbranch_vccnz L_ffn_s1a
L_ffn_s1b:
    ds_read_b64 v[56:57], v2 offset:53248
    ds_read_b64 v[58:59], v3 offset:53248
    v_mfma_f32_16x16x32_bf16 v[112:115], v[40:43], v[72:75], v[112:115]
    ds_read_b64 v[60:61], v2 offset:55296
    v_mfma_f32_16x16x32_bf16 v[152:155], v[40:43], v[76:79], v[152:155]
    ds_read_b64 v[62:63], v3 offset:55296
    v_mfma_f32_16x16x32_bf16 v[192:195], v[40:43], v[80:83], v[192:195]
    ds_read_b64 v[64:65], v2 offset:57344
    v_mfma_f32_16x16x32_bf16 v[232:235], v[40:43], v[84:87], v[232:235]
    ds_read_b64 v[66:67], v3 offset:57344
    ds_read_b64 v[68:69], v2 offset:59392
    v_mfma_f32_16x16x32_bf16 v[116:119], v[44:47], v[72:75], v[116:119]
    ds_read_b64 v[70:71], v3 offset:59392
    v_mfma_f32_16x16x32_bf16 v[156:159], v[44:47], v[76:79], v[156:159]
    ds_read_b64_tr_b16 v[16:17], v13 offset:0
    v_mfma_f32_16x16x32_bf16 v[196:199], v[44:47], v[80:83], v[196:199]
    ds_read_b64_tr_b16 v[18:19], v14 offset:0
    v_mfma_f32_16x16x32_bf16 v[236:239], v[44:47], v[84:87], v[236:239]
    ds_read_b64_tr_b16 v[20:21], v13 offset:10240
    ds_read_b64_tr_b16 v[22:23], v14 offset:10240
    v_mfma_f32_16x16x32_bf16 v[120:123], v[48:51], v[72:75], v[120:123]
    ds_read_b64_tr_b16 v[24:25], v13 offset:32
    v_mfma_f32_16x16x32_bf16 v[160:163], v[48:51], v[76:79], v[160:163]
    ds_read_b64_tr_b16 v[26:27], v14 offset:32
    v_mfma_f32_16x16x32_bf16 v[200:203], v[48:51], v[80:83], v[200:203]
    ds_read_b64_tr_b16 v[28:29], v13 offset:10272
    v_mfma_f32_16x16x32_bf16 v[240:243], v[48:51], v[84:87], v[240:243]
    ds_read_b64_tr_b16 v[30:31], v14 offset:10272
    ds_read_b64_tr_b16 v[32:33], v13 offset:64
    v_mfma_f32_16x16x32_bf16 v[124:127], v[52:55], v[72:75], v[124:127]
    ds_read_b64_tr_b16 v[34:35], v14 offset:64
    v_mfma_f32_16x16x32_bf16 v[164:167], v[52:55], v[76:79], v[164:167]
    ds_read_b64_tr_b16 v[36:37], v13 offset:10304
    v_mfma_f32_16x16x32_bf16 v[204:207], v[52:55], v[80:83], v[204:207]
    ds_read_b64_tr_b16 v[38:39], v14 offset:10304
    v_mfma_f32_16x16x32_bf16 v[244:247], v[52:55], v[84:87], v[244:247]
    ds_read_b64_tr_b16 v[40:41], v13 offset:96
    ds_read_b64_tr_b16 v[42:43], v14 offset:96
    s_waitcnt lgkmcnt(12)
    v_mfma_f32_16x16x32_bf16 v[88:91], v[16:19], v[56:59], v[88:91]
    ds_read_b64_tr_b16 v[44:45], v13 offset:10336
    v_mfma_f32_16x16x32_bf16 v[128:131], v[16:19], v[60:63], v[128:131]
    ds_read_b64_tr_b16 v[46:47], v14 offset:10336
    v_mfma_f32_16x16x32_bf16 v[168:171], v[16:19], v[64:67], v[168:171]
    v_mfma_f32_16x16x32_bf16 v[208:211], v[16:19], v[68:71], v[208:211]
    ds_read_b64_tr_b16 v[48:49], v13 offset:128
    ds_read_b64_tr_b16 v[50:51], v14 offset:128
    s_waitcnt lgkmcnt(14)
    v_mfma_f32_16x16x32_bf16 v[92:95], v[20:23], v[56:59], v[92:95]
    v_mfma_f32_16x16x32_bf16 v[132:135], v[20:23], v[60:63], v[132:135]
    v_mfma_f32_16x16x32_bf16 v[172:175], v[20:23], v[64:67], v[172:175]
    v_mfma_f32_16x16x32_bf16 v[212:215], v[20:23], v[68:71], v[212:215]
    ds_read_b64_tr_b16 v[52:53], v13 offset:10368
    ds_read_b64_tr_b16 v[54:55], v14 offset:10368
    s_waitcnt lgkmcnt(14)
    v_mfma_f32_16x16x32_bf16 v[96:99], v[24:27], v[56:59], v[96:99]
    ds_read_b64 v[72:73], v4 offset:53248
    v_mfma_f32_16x16x32_bf16 v[136:139], v[24:27], v[60:63], v[136:139]
    ds_read_b64 v[74:75], v5 offset:53248
    v_mfma_f32_16x16x32_bf16 v[176:179], v[24:27], v[64:67], v[176:179]
    ds_read_b64 v[76:77], v4 offset:55296
    v_mfma_f32_16x16x32_bf16 v[216:219], v[24:27], v[68:71], v[216:219]
    ds_read_b64 v[78:79], v5 offset:55296
    ds_read_b64 v[80:81], v4 offset:57344
    s_waitcnt lgkmcnt(15)
    v_mfma_f32_16x16x32_bf16 v[100:103], v[28:31], v[56:59], v[100:103]
    ds_read_b64 v[82:83], v5 offset:57344
    v_mfma_f32_16x16x32_bf16 v[140:143], v[28:31], v[60:63], v[140:143]
    ds_read_b64 v[84:85], v4 offset:59392
    v_mfma_f32_16x16x32_bf16 v[180:183], v[28:31], v[64:67], v[180:183]
    ds_read_b64 v[86:87], v5 offset:59392
    v_mfma_f32_16x16x32_bf16 v[220:223], v[28:31], v[68:71], v[220:223]
    ds_read_b64_tr_b16 v[16:17], v13 offset:5120
    ds_read_b64_tr_b16 v[18:19], v14 offset:5120
    v_mfma_f32_16x16x32_bf16 v[104:107], v[32:35], v[56:59], v[104:107]
    ds_read_b64_tr_b16 v[20:21], v13 offset:15360
    v_mfma_f32_16x16x32_bf16 v[144:147], v[32:35], v[60:63], v[144:147]
    ds_read_b64_tr_b16 v[22:23], v14 offset:15360
    v_mfma_f32_16x16x32_bf16 v[184:187], v[32:35], v[64:67], v[184:187]
    v_mfma_f32_16x16x32_bf16 v[224:227], v[32:35], v[68:71], v[224:227]
    ds_read_b64_tr_b16 v[24:25], v13 offset:5152
    ds_read_b64_tr_b16 v[26:27], v14 offset:5152
    s_waitcnt lgkmcnt(15)
    v_mfma_f32_16x16x32_bf16 v[108:111], v[36:39], v[56:59], v[108:111]
    v_mfma_f32_16x16x32_bf16 v[148:151], v[36:39], v[60:63], v[148:151]
    v_mfma_f32_16x16x32_bf16 v[188:191], v[36:39], v[64:67], v[188:191]
    v_mfma_f32_16x16x32_bf16 v[228:231], v[36:39], v[68:71], v[228:231]
    ds_read_b64_tr_b16 v[28:29], v13 offset:15392
    ds_read_b64_tr_b16 v[30:31], v14 offset:15392
    v_mfma_f32_16x16x32_bf16 v[112:115], v[40:43], v[56:59], v[112:115]
    v_mfma_f32_16x16x32_bf16 v[152:155], v[40:43], v[60:63], v[152:155]
    v_mfma_f32_16x16x32_bf16 v[192:195], v[40:43], v[64:67], v[192:195]
    v_mfma_f32_16x16x32_bf16 v[232:235], v[40:43], v[68:71], v[232:235]
    ds_read_b64_tr_b16 v[32:33], v13 offset:5184
    ds_read_b64_tr_b16 v[34:35], v14 offset:5184
    v_mfma_f32_16x16x32_bf16 v[116:119], v[44:47], v[56:59], v[116:119]
    v_mfma_f32_16x16x32_bf16 v[156:159], v[44:47], v[60:63], v[156:159]
    v_mfma_f32_16x16x32_bf16 v[196:199], v[44:47], v[64:67], v[196:199]
    v_mfma_f32_16x16x32_bf16 v[236:239], v[44:47], v[68:71], v[236:239]
    ds_read_b64_tr_b16 v[36:37], v13 offset:15424
    ds_read_b64_tr_b16 v[38:39], v14 offset:15424
    v_mfma_f32_16x16x32_bf16 v[120:123], v[48:51], v[56:59], v[120:123]
    v_mfma_f32_16x16x32_bf16 v[160:163], v[48:51], v[60:63], v[160:163]
    v_mfma_f32_16x16x32_bf16 v[200:203], v[48:51], v[64:67], v[200:203]
    v_mfma_f32_16x16x32_bf16 v[240:243], v[48:51], v[68:71], v[240:243]
    ds_read_b64_tr_b16 v[40:41], v13 offset:5216
    ds_read_b64_tr_b16 v[42:43], v14 offset:5216
    s_waitcnt lgkmcnt(15)
    v_mfma_f32_16x16x32_bf16 v[124:127], v[52:55], v[56:59], v[124:127]
    v_mfma_f32_16x16x32_bf16 v[164:167], v[52:55], v[60:63], v[164:167]
    v_mfma_f32_16x16x32_bf16 v[204:207], v[52:55], v[64:67], v[204:207]
    v_mfma_f32_16x16x32_bf16 v[244:247], v[52:55], v[68:71], v[244:247]
    ds_read_b64_tr_b16 v[44:45], v13 offset:15456
    ds_read_b64_tr_b16 v[46:47], v14 offset:15456
    s_waitcnt lgkmcnt(14)
    v_mfma_f32_16x16x32_bf16 v[88:91], v[16:19], v[72:75], v[88:91]
    v_mfma_f32_16x16x32_bf16 v[128:131], v[16:19], v[76:79], v[128:131]
    v_mfma_f32_16x16x32_bf16 v[168:171], v[16:19], v[80:83], v[168:171]
    v_mfma_f32_16x16x32_bf16 v[208:211], v[16:19], v[84:87], v[208:211]
    ds_read_b64_tr_b16 v[48:49], v13 offset:5248
    ds_read_b64_tr_b16 v[50:51], v14 offset:5248
    s_waitcnt lgkmcnt(14)
    v_mfma_f32_16x16x32_bf16 v[92:95], v[20:23], v[72:75], v[92:95]
    v_mfma_f32_16x16x32_bf16 v[132:135], v[20:23], v[76:79], v[132:135]
    v_mfma_f32_16x16x32_bf16 v[172:175], v[20:23], v[80:83], v[172:175]
    v_mfma_f32_16x16x32_bf16 v[212:215], v[20:23], v[84:87], v[212:215]
    ds_read_b64_tr_b16 v[52:53], v13 offset:15488
    ds_read_b64_tr_b16 v[54:55], v14 offset:15488
    s_waitcnt lgkmcnt(14)
    v_mfma_f32_16x16x32_bf16 v[96:99], v[24:27], v[72:75], v[96:99]
    v_mfma_f32_16x16x32_bf16 v[136:139], v[24:27], v[76:79], v[136:139]
    v_mfma_f32_16x16x32_bf16 v[176:179], v[24:27], v[80:83], v[176:179]
    v_mfma_f32_16x16x32_bf16 v[216:219], v[24:27], v[84:87], v[216:219]
    s_waitcnt lgkmcnt(12)
    v_mfma_f32_16x16x32_bf16 v[100:103], v[28:31], v[72:75], v[100:103]
    ds_read_b128 v[8:11], v12 offset:32
    v_mfma_f32_16x16x32_bf16 v[140:143], v[28:31], v[76:79], v[140:143]
    v_mfma_f32_16x16x32_bf16 v[180:183], v[28:31], v[80:83], v[180:183]
    v_mfma_f32_16x16x32_bf16 v[220:223], v[28:31], v[84:87], v[220:223]
    s_waitcnt lgkmcnt(11)
    v_mfma_f32_16x16x32_bf16 v[104:107], v[32:35], v[72:75], v[104:107]
    v_mfma_f32_16x16x32_bf16 v[144:147], v[32:35], v[76:79], v[144:147]
    v_mfma_f32_16x16x32_bf16 v[184:187], v[32:35], v[80:83], v[184:187]
    v_mfma_f32_16x16x32_bf16 v[224:227], v[32:35], v[84:87], v[224:227]
    s_waitcnt lgkmcnt(0)
    v_mfma_f32_16x16x32_bf16 v[108:111], v[36:39], v[72:75], v[108:111]
    v_mov_b32 v15, 2
    v_min3_u32 v8, v8, v9, v10
    v_mfma_f32_16x16x32_bf16 v[148:151], v[36:39], v[76:79], v[148:151]
    ds_write_b32 v254, v15 offset:48
    v_min_u32 v8, v8, v11
    v_mfma_f32_16x16x32_bf16 v[188:191], v[36:39], v[80:83], v[188:191]
    v_cmp_gt_u32 vcc, 3, v8
    v_mfma_f32_16x16x32_bf16 v[228:231], v[36:39], v[84:87], v[228:231]
    s_cbranch_vccnz L_ffn_s2a
L_ffn_s2b:
    ds_read_b64 v[56:57], v248 offset:0
    ds_read_b64 v[58:59], v249 offset:0
    v_mfma_f32_16x16x32_bf16 v[112:115], v[40:43], v[72:75], v[112:115]
    ds_read_b64 v[60:61], v248 offset:2048
    v_mfma_f32_16x16x32_bf16 v[152:155], v[40:43], v[76:79], v[152:155]
    ds_read_b64 v[62:63], v249 offset:2048
    v_mfma_f32_16x16x32_bf16 v[192:195], v[40:43], v[80:83], v[192:195]
    ds_read_b64 v[64:65], v248 offset:4096
    v_mfma_f32_16x16x32_bf16 v[232:235], v[40:43], v[84:87], v[232:235]
    ds_read_b64 v[66:67], v249 offset:4096
    ds_read_b64 v[68:69], v248 offset:6144
    v_mfma_f32_16x16x32_bf16 v[116:119], v[44:47], v[72:75], v[116:119]
    ds_read_b64 v[70:71], v249 offset:6144
    v_mfma_f32_16x16x32_bf16 v[156:159], v[44:47], v[76:79], v[156:159]
    ds_read_b64_tr_b16 v[16:17], v252 offset:0
    v_mfma_f32_16x16x32_bf16 v[196:199], v[44:47], v[80:83], v[196:199]
    ds_read_b64_tr_b16 v[18:19], v253 offset:0
    v_mfma_f32_16x16x32_bf16 v[236:239], v[44:47], v[84:87], v[236:239]
    ds_read_b64_tr_b16 v[20:21], v252 offset:10240
    ds_read_b64_tr_b16 v[22:23], v253 offset:10240
    v_mfma_f32_16x16x32_bf16 v[120:123], v[48:51], v[72:75], v[120:123]
    ds_read_b64_tr_b16 v[24:25], v252 offset:32
    v_mfma_f32_16x16x32_bf16 v[160:163], v[48:51], v[76:79], v[160:163]
    ds_read_b64_tr_b16 v[26:27], v253 offset:32
    v_mfma_f32_16x16x32_bf16 v[200:203], v[48:51], v[80:83], v[200:203]
    ds_read_b64_tr_b16 v[28:29], v252 offset:10272
    v_mfma_f32_16x16x32_bf16 v[240:243], v[48:51], v[84:87], v[240:243]
    ds_read_b64_tr_b16 v[30:31], v253 offset:10272
    ds_read_b64_tr_b16 v[32:33], v252 offset:64
    v_mfma_f32_16x16x32_bf16 v[124:127], v[52:55], v[72:75], v[124:127]
    ds_read_b64_tr_b16 v[34:35], v253 offset:64
    v_mfma_f32_16x16x32_bf16 v[164:167], v[52:55], v[76:79], v[164:167]
    ds_read_b64_tr_b16 v[36:37], v252 offset:10304
    v_mfma_f32_16x16x32_bf16 v[204:207], v[52:55], v[80:83], v[204:207]
    ds_read_b64_tr_b16 v[38:39], v253 offset:10304
    v_mfma_f32_16x16x32_bf16 v[244:247], v[52:55], v[84:87], v[244:247]
    ds_read_b64_tr_b16 v[40:41], v252 offset:96
    ds_read_b64_tr_b16 v[42:43], v253 offset:96
    s_waitcnt lgkmcnt(12)
    v_mfma_f32_16x16x32_bf16 v[88:91], v[16:19], v[56:59], v[88:91]
    ds_read_b64_tr_b16 v[44:45], v252 offset:10336
    v_mfma_f32_16x16x32_bf16 v[128:131], v[16:19], v[60:63], v[128:131]
    ds_read_b64_tr_b16 v[46:47], v253 offset:10336
    v_mfma_f32_16x16x32_bf16 v[168:171], v[16:19], v[64:67], v[168:171]
    v_mfma_f32_16x16x32_bf16 v[208:211], v[16:19], v[68:71], v[208:211]
    ds_read_b64_tr_b16 v[48:49], v252 offset:128
    ds_read_b64_tr_b16 v[50:51], v253 offset:128
    s_waitcnt lgkmcnt(14)
    v_mfma_f32_16x16x32_bf16 v[92:95], v[20:23], v[56:59], v[92:95]
    v_mfma_f32_16x16x32_bf16 v[132:135], v[20:23], v[60:63], v[132:135]
    v_mfma_f32_16x16x32_bf16 v[172:175], v[20:23], v[64:67], v[172:175]
    v_mfma_f32_16x16x32_bf16 v[212:215], v[20:23], v[68:71], v[212:215]
    ds_read_b64_tr_b16 v[52:53], v252 offset:10368
    ds_read_b64_tr_b16 v[54:55], v253 offset:10368
    s_waitcnt lgkmcnt(14)
    v_mfma_f32_16x16x32_bf16 v[96:99], v[24:27], v[56:59], v[96:99]
    ds_read_b64 v[72:73], v250 offset:0
    v_mfma_f32_16x16x32_bf16 v[136:139], v[24:27], v[60:63], v[136:139]
    ds_read_b64 v[74:75], v251 offset:0
    v_mfma_f32_16x16x32_bf16 v[176:179], v[24:27], v[64:67], v[176:179]
    ds_read_b64 v[76:77], v250 offset:2048
    v_mfma_f32_16x16x32_bf16 v[216:219], v[24:27], v[68:71], v[216:219]
    ds_read_b64 v[78:79], v251 offset:2048
    ds_read_b64 v[80:81], v250 offset:4096
    s_waitcnt lgkmcnt(15)
    v_mfma_f32_16x16x32_bf16 v[100:103], v[28:31], v[56:59], v[100:103]
    ds_read_b64 v[82:83], v251 offset:4096
    v_mfma_f32_16x16x32_bf16 v[140:143], v[28:31], v[60:63], v[140:143]
    ds_read_b64 v[84:85], v250 offset:6144
    v_mfma_f32_16x16x32_bf16 v[180:183], v[28:31], v[64:67], v[180:183]
    ds_read_b64 v[86:87], v251 offset:6144
    v_mfma_f32_16x16x32_bf16 v[220:223], v[28:31], v[68:71], v[220:223]
    ds_read_b64_tr_b16 v[16:17], v252 offset:5120
    ds_read_b64_tr_b16 v[18:19], v253 offset:5120
    v_mfma_f32_16x16x32_bf16 v[104:107], v[32:35], v[56:59], v[104:107]
    ds_read_b64_tr_b16 v[20:21], v252 offset:15360
    v_mfma_f32_16x16x32_bf16 v[144:147], v[32:35], v[60:63], v[144:147]
    ds_read_b64_tr_b16 v[22:23], v253 offset:15360
    v_mfma_f32_16x16x32_bf16 v[184:187], v[32:35], v[64:67], v[184:187]
    v_mfma_f32_16x16x32_bf16 v[224:227], v[32:35], v[68:71], v[224:227]
    ds_read_b64_tr_b16 v[24:25], v252 offset:5152
    ds_read_b64_tr_b16 v[26:27], v253 offset:5152
    s_waitcnt lgkmcnt(15)
    v_mfma_f32_16x16x32_bf16 v[108:111], v[36:39], v[56:59], v[108:111]
    v_mfma_f32_16x16x32_bf16 v[148:151], v[36:39], v[60:63], v[148:151]
    v_mfma_f32_16x16x32_bf16 v[188:191], v[36:39], v[64:67], v[188:191]
    v_mfma_f32_16x16x32_bf16 v[228:231], v[36:39], v[68:71], v[228:231]
    ds_read_b64_tr_b16 v[28:29], v252 offset:15392
    ds_read_b64_tr_b16 v[30:31], v253 offset:15392
    v_mfma_f32_16x16x32_bf16 v[112:115], v[40:43], v[56:59], v[112:115]
    v_mfma_f32_16x16x32_bf16 v[152:155], v[40:43], v[60:63], v[152:155]
    v_mfma_f32_16x16x32_bf16 v[192:195], v[40:43], v[64:67], v[192:195]
    v_mfma_f32_16x16x32_bf16 v[232:235], v[40:43], v[68:71], v[232:235]
    ds_read_b64_tr_b16 v[32:33], v252 offset:5184
    ds_read_b64_tr_b16 v[34:35], v253 offset:5184
    v_mfma_f32_16x16x32_bf16 v[116:119], v[44:47], v[56:59], v[116:119]
    v_mfma_f32_16x16x32_bf16 v[156:159], v[44:47], v[60:63], v[156:159]
    v_mfma_f32_16x16x32_bf16 v[196:199], v[44:47], v[64:67], v[196:199]
    v_mfma_f32_16x16x32_bf16 v[236:239], v[44:47], v[68:71], v[236:239]
    ds_read_b64_tr_b16 v[36:37], v252 offset:15424
    ds_read_b64_tr_b16 v[38:39], v253 offset:15424
    v_mfma_f32_16x16x32_bf16 v[120:123], v[48:51], v[56:59], v[120:123]
    v_mfma_f32_16x16x32_bf16 v[160:163], v[48:51], v[60:63], v[160:163]
    v_mfma_f32_16x16x32_bf16 v[200:203], v[48:51], v[64:67], v[200:203]
    v_mfma_f32_16x16x32_bf16 v[240:243], v[48:51], v[68:71], v[240:243]
    ds_read_b64_tr_b16 v[40:41], v252 offset:5216
    ds_read_b64_tr_b16 v[42:43], v253 offset:5216
    s_waitcnt lgkmcnt(15)
    v_mfma_f32_16x16x32_bf16 v[124:127], v[52:55], v[56:59], v[124:127]
    v_mfma_f32_16x16x32_bf16 v[164:167], v[52:55], v[60:63], v[164:167]
    v_mfma_f32_16x16x32_bf16 v[204:207], v[52:55], v[64:67], v[204:207]
    v_mfma_f32_16x16x32_bf16 v[244:247], v[52:55], v[68:71], v[244:247]
    ds_read_b64_tr_b16 v[44:45], v252 offset:15456
    ds_read_b64_tr_b16 v[46:47], v253 offset:15456
    s_waitcnt lgkmcnt(14)
    v_mfma_f32_16x16x32_bf16 v[88:91], v[16:19], v[72:75], v[88:91]
    v_mfma_f32_16x16x32_bf16 v[128:131], v[16:19], v[76:79], v[128:131]
    v_mfma_f32_16x16x32_bf16 v[168:171], v[16:19], v[80:83], v[168:171]
    v_mfma_f32_16x16x32_bf16 v[208:211], v[16:19], v[84:87], v[208:211]
    ds_read_b64_tr_b16 v[48:49], v252 offset:5248
    ds_read_b64_tr_b16 v[50:51], v253 offset:5248
    s_waitcnt lgkmcnt(14)
    v_mfma_f32_16x16x32_bf16 v[92:95], v[20:23], v[72:75], v[92:95]
    v_mfma_f32_16x16x32_bf16 v[132:135], v[20:23], v[76:79], v[132:135]
    v_mfma_f32_16x16x32_bf16 v[172:175], v[20:23], v[80:83], v[172:175]
    v_mfma_f32_16x16x32_bf16 v[212:215], v[20:23], v[84:87], v[212:215]
    ds_read_b64_tr_b16 v[52:53], v252 offset:15488
    ds_read_b64_tr_b16 v[54:55], v253 offset:15488
    s_waitcnt lgkmcnt(14)
    v_mfma_f32_16x16x32_bf16 v[96:99], v[24:27], v[72:75], v[96:99]
    v_mfma_f32_16x16x32_bf16 v[136:139], v[24:27], v[76:79], v[136:139]
    v_mfma_f32_16x16x32_bf16 v[176:179], v[24:27], v[80:83], v[176:179]
    v_mfma_f32_16x16x32_bf16 v[216:219], v[24:27], v[84:87], v[216:219]
    s_waitcnt lgkmcnt(12)
    v_mfma_f32_16x16x32_bf16 v[100:103], v[28:31], v[72:75], v[100:103]
    ds_read_b128 v[8:11], v12 offset:32
    v_mfma_f32_16x16x32_bf16 v[140:143], v[28:31], v[76:79], v[140:143]
    v_mfma_f32_16x16x32_bf16 v[180:183], v[28:31], v[80:83], v[180:183]
    v_mfma_f32_16x16x32_bf16 v[220:223], v[28:31], v[84:87], v[220:223]
    s_waitcnt lgkmcnt(11)
    v_mfma_f32_16x16x32_bf16 v[104:107], v[32:35], v[72:75], v[104:107]
    v_mfma_f32_16x16x32_bf16 v[144:147], v[32:35], v[76:79], v[144:147]
    v_mfma_f32_16x16x32_bf16 v[184:187], v[32:35], v[80:83], v[184:187]
    v_mfma_f32_16x16x32_bf16 v[224:227], v[32:35], v[84:87], v[224:227]
    s_waitcnt lgkmcnt(0)
    v_mfma_f32_16x16x32_bf16 v[108:111], v[36:39], v[72:75], v[108:111]
    v_mov_b32 v15, 3
    v_min3_u32 v8, v8, v9, v10
    v_mfma_f32_16x16x32_bf16 v[148:151], v[36:39], v[76:79], v[148:151]
    ds_write_b32 v254, v15 offset:48
    v_min_u32 v8, v8, v11
    v_mfma_f32_16x16x32_bf16 v[188:191], v[36:39], v[80:83], v[188:191]
    v_cmp_gt_u32 vcc, 4, v8
    v_mfma_f32_16x16x32_bf16 v[228:231], v[36:39], v[84:87], v[228:231]
    s_cbranch_vccnz L_ffn_s3a
L_ffn_s3b:
    ds_read_b64 v[56:57], v2 offset:0
    ds_read_b64 v[58:59], v3 offset:0
    v_mfma_f32_16x16x32_bf16 v[112:115], v[40:43], v[72:75], v[112:115]
    ds_read_b64 v[60:61], v2 offset:2048
    v_mfma_f32_16x16x32_bf16 v[152:155], v[40:43], v[76:79], v[152:155]
    ds_read_b64 v[62:63], v3 offset:2048
    v_mfma_f32_16x16x32_bf16 v[192:195], v[40:43], v[80:83], v[192:195]
    ds_read_b64 v[64:65], v2 offset:4096
    v_mfma_f32_16x16x32_bf16 v[232:235], v[40:43], v[84:87], v[232:235]
    ds_read_b64 v[66:67], v3 offset:4096
    ds_read_b64 v[68:69], v2 offset:6144
    v_mfma_f32_16x16x32_bf16 v[116:119], v[44:47], v[72:75], v[116:119]
    ds_read_b64 v[70:71], v3 offset:6144
    v_mfma_f32_16x16x32_bf16 v[156:159], v[44:47], v[76:79], v[156:159]
    ds_read_b64_tr_b16 v[16:17], v6 offset:0
    v_mfma_f32_16x16x32_bf16 v[196:199], v[44:47], v[80:83], v[196:199]
    ds_read_b64_tr_b16 v[18:19], v7 offset:0
    v_mfma_f32_16x16x32_bf16 v[236:239], v[44:47], v[84:87], v[236:239]
    ds_read_b64_tr_b16 v[20:21], v6 offset:10240
    ds_read_b64_tr_b16 v[22:23], v7 offset:10240
    v_mfma_f32_16x16x32_bf16 v[120:123], v[48:51], v[72:75], v[120:123]
    ds_read_b64_tr_b16 v[24:25], v6 offset:32
    v_mfma_f32_16x16x32_bf16 v[160:163], v[48:51], v[76:79], v[160:163]
    ds_read_b64_tr_b16 v[26:27], v7 offset:32
    v_mfma_f32_16x16x32_bf16 v[200:203], v[48:51], v[80:83], v[200:203]
    ds_read_b64_tr_b16 v[28:29], v6 offset:10272
    v_mfma_f32_16x16x32_bf16 v[240:243], v[48:51], v[84:87], v[240:243]
    ds_read_b64_tr_b16 v[30:31], v7 offset:10272
    ds_read_b64_tr_b16 v[32:33], v6 offset:64
    v_mfma_f32_16x16x32_bf16 v[124:127], v[52:55], v[72:75], v[124:127]
    ds_read_b64_tr_b16 v[34:35], v7 offset:64
    v_mfma_f32_16x16x32_bf16 v[164:167], v[52:55], v[76:79], v[164:167]
    ds_read_b64_tr_b16 v[36:37], v6 offset:10304
    v_mfma_f32_16x16x32_bf16 v[204:207], v[52:55], v[80:83], v[204:207]
    ds_read_b64_tr_b16 v[38:39], v7 offset:10304
    v_mfma_f32_16x16x32_bf16 v[244:247], v[52:55], v[84:87], v[244:247]
    ds_read_b64_tr_b16 v[40:41], v6 offset:96
    ds_read_b64_tr_b16 v[42:43], v7 offset:96
    s_waitcnt lgkmcnt(12)
    v_mfma_f32_16x16x32_bf16 v[88:91], v[16:19], v[56:59], v[88:91]
    ds_read_b64_tr_b16 v[44:45], v6 offset:10336
    v_mfma_f32_16x16x32_bf16 v[128:131], v[16:19], v[60:63], v[128:131]
    ds_read_b64_tr_b16 v[46:47], v7 offset:10336
    v_mfma_f32_16x16x32_bf16 v[168:171], v[16:19], v[64:67], v[168:171]
    v_mfma_f32_16x16x32_bf16 v[208:211], v[16:19], v[68:71], v[208:211]
    ds_read_b64_tr_b16 v[48:49], v6 offset:128
    ds_read_b64_tr_b16 v[50:51], v7 offset:128
    s_waitcnt lgkmcnt(14)
    v_mfma_f32_16x16x32_bf16 v[92:95], v[20:23], v[56:59], v[92:95]
    v_mfma_f32_16x16x32_bf16 v[132:135], v[20:23], v[60:63], v[132:135]
    v_mfma_f32_16x16x32_bf16 v[172:175], v[20:23], v[64:67], v[172:175]
    v_mfma_f32_16x16x32_bf16 v[212:215], v[20:23], v[68:71], v[212:215]
    ds_read_b64_tr_b16 v[52:53], v6 offset:10368
    ds_read_b64_tr_b16 v[54:55], v7 offset:10368
    s_waitcnt lgkmcnt(14)
    v_mfma_f32_16x16x32_bf16 v[96:99], v[24:27], v[56:59], v[96:99]
    ds_read_b64 v[72:73], v4 offset:0
    v_mfma_f32_16x16x32_bf16 v[136:139], v[24:27], v[60:63], v[136:139]
    ds_read_b64 v[74:75], v5 offset:0
    v_mfma_f32_16x16x32_bf16 v[176:179], v[24:27], v[64:67], v[176:179]
    ds_read_b64 v[76:77], v4 offset:2048
    v_mfma_f32_16x16x32_bf16 v[216:219], v[24:27], v[68:71], v[216:219]
    ds_read_b64 v[78:79], v5 offset:2048
    ds_read_b64 v[80:81], v4 offset:4096
    s_waitcnt lgkmcnt(15)
    v_mfma_f32_16x16x32_bf16 v[100:103], v[28:31], v[56:59], v[100:103]
    ds_read_b64 v[82:83], v5 offset:4096
    v_mfma_f32_16x16x32_bf16 v[140:143], v[28:31], v[60:63], v[140:143]
    ds_read_b64 v[84:85], v4 offset:6144
    v_mfma_f32_16x16x32_bf16 v[180:183], v[28:31], v[64:67], v[180:183]
    ds_read_b64 v[86:87], v5 offset:6144
    v_mfma_f32_16x16x32_bf16 v[220:223], v[28:31], v[68:71], v[220:223]
    ds_read_b64_tr_b16 v[16:17], v6 offset:5120
    ds_read_b64_tr_b16 v[18:19], v7 offset:5120
    v_mfma_f32_16x16x32_bf16 v[104:107], v[32:35], v[56:59], v[104:107]
    ds_read_b64_tr_b16 v[20:21], v6 offset:15360
    v_mfma_f32_16x16x32_bf16 v[144:147], v[32:35], v[60:63], v[144:147]
    ds_read_b64_tr_b16 v[22:23], v7 offset:15360
    v_mfma_f32_16x16x32_bf16 v[184:187], v[32:35], v[64:67], v[184:187]
    v_mfma_f32_16x16x32_bf16 v[224:227], v[32:35], v[68:71], v[224:227]
    ds_read_b64_tr_b16 v[24:25], v6 offset:5152
    ds_read_b64_tr_b16 v[26:27], v7 offset:5152
    s_waitcnt lgkmcnt(15)
    v_mfma_f32_16x16x32_bf16 v[108:111], v[36:39], v[56:59], v[108:111]
    v_mfma_f32_16x16x32_bf16 v[148:151], v[36:39], v[60:63], v[148:151]
    v_mfma_f32_16x16x32_bf16 v[188:191], v[36:39], v[64:67], v[188:191]
    v_mfma_f32_16x16x32_bf16 v[228:231], v[36:39], v[68:71], v[228:231]
    ds_read_b64_tr_b16 v[28:29], v6 offset:15392
    ds_read_b64_tr_b16 v[30:31], v7 offset:15392
    v_mfma_f32_16x16x32_bf16 v[112:115], v[40:43], v[56:59], v[112:115]
    v_mfma_f32_16x16x32_bf16 v[152:155], v[40:43], v[60:63], v[152:155]
    v_mfma_f32_16x16x32_bf16 v[192:195], v[40:43], v[64:67], v[192:195]
    v_mfma_f32_16x16x32_bf16 v[232:235], v[40:43], v[68:71], v[232:235]
    ds_read_b64_tr_b16 v[32:33], v6 offset:5184
    ds_read_b64_tr_b16 v[34:35], v7 offset:5184
    v_mfma_f32_16x16x32_bf16 v[116:119], v[44:47], v[56:59], v[116:119]
    v_mfma_f32_16x16x32_bf16 v[156:159], v[44:47], v[60:63], v[156:159]
    v_mfma_f32_16x16x32_bf16 v[196:199], v[44:47], v[64:67], v[196:199]
    v_mfma_f32_16x16x32_bf16 v[236:239], v[44:47], v[68:71], v[236:239]
    ds_read_b64_tr_b16 v[36:37], v6 offset:15424
    ds_read_b64_tr_b16 v[38:39], v7 offset:15424
    v_mfma_f32_16x16x32_bf16 v[120:123], v[48:51], v[56:59], v[120:123]
    v_mfma_f32_16x16x32_bf16 v[160:163], v[48:51], v[60:63], v[160:163]
    v_mfma_f32_16x16x32_bf16 v[200:203], v[48:51], v[64:67], v[200:203]
    v_mfma_f32_16x16x32_bf16 v[240:243], v[48:51], v[68:71], v[240:243]
    ds_read_b64_tr_b16 v[40:41], v6 offset:5216
    ds_read_b64_tr_b16 v[42:43], v7 offset:5216
    s_waitcnt lgkmcnt(15)
    v_mfma_f32_16x16x32_bf16 v[124:127], v[52:55], v[56:59], v[124:127]
    v_mfma_f32_16x16x32_bf16 v[164:167], v[52:55], v[60:63], v[164:167]
    v_mfma_f32_16x16x32_bf16 v[204:207], v[52:55], v[64:67], v[204:207]
    v_mfma_f32_16x16x32_bf16 v[244:247], v[52:55], v[68:71], v[244:247]
    ds_read_b64_tr_b16 v[44:45], v6 offset:15456
    ds_read_b64_tr_b16 v[46:47], v7 offset:15456
    s_waitcnt lgkmcnt(14)
    v_mfma_f32_16x16x32_bf16 v[88:91], v[16:19], v[72:75], v[88:91]
    v_mfma_f32_16x16x32_bf16 v[128:131], v[16:19], v[76:79], v[128:131]
    v_mfma_f32_16x16x32_bf16 v[168:171], v[16:19], v[80:83], v[168:171]
    v_mfma_f32_16x16x32_bf16 v[208:211], v[16:19], v[84:87], v[208:211]
    ds_read_b64_tr_b16 v[48:49], v6 offset:5248
    ds_read_b64_tr_b16 v[50:51], v7 offset:5248
    s_waitcnt lgkmcnt(14)
    v_mfma_f32_16x16x32_bf16 v[92:95], v[20:23], v[72:75], v[92:95]
    v_mfma_f32_16x16x32_bf16 v[132:135], v[20:23], v[76:79], v[132:135]
    v_mfma_f32_16x16x32_bf16 v[172:175], v[20:23], v[80:83], v[172:175]
    v_mfma_f32_16x16x32_bf16 v[212:215], v[20:23], v[84:87], v[212:215]
    ds_read_b64_tr_b16 v[52:53], v6 offset:15488
    ds_read_b64_tr_b16 v[54:55], v7 offset:15488
    s_waitcnt lgkmcnt(14)
    v_mfma_f32_16x16x32_bf16 v[96:99], v[24:27], v[72:75], v[96:99]
    v_mfma_f32_16x16x32_bf16 v[136:139], v[24:27], v[76:79], v[136:139]
    v_mfma_f32_16x16x32_bf16 v[176:179], v[24:27], v[80:83], v[176:179]
    v_mfma_f32_16x16x32_bf16 v[216:219], v[24:27], v[84:87], v[216:219]
    s_waitcnt lgkmcnt(12)
    v_mfma_f32_16x16x32_bf16 v[100:103], v[28:31], v[72:75], v[100:103]
    ds_read_b128 v[8:11], v12 offset:32
    v_mfma_f32_16x16x32_bf16 v[140:143], v[28:31], v[76:79], v[140:143]
    v_mfma_f32_16x16x32_bf16 v[180:183], v[28:31], v[80:83], v[180:183]
    v_mfma_f32_16x16x32_bf16 v[220:223], v[28:31], v[84:87], v[220:223]
    s_waitcnt lgkmcnt(11)
    v_mfma_f32_16x16x32_bf16 v[104:107], v[32:35], v[72:75], v[104:107]
    v_mfma_f32_16x16x32_bf16 v[144:147], v[32:35], v[76:79], v[144:147]
    v_mfma_f32_16x16x32_bf16 v[184:187], v[32:35], v[80:83], v[184:187]
    v_mfma_f32_16x16x32_bf16 v[224:227], v[32:35], v[84:87], v[224:227]
    s_waitcnt lgkmcnt(0)
    v_mfma_f32_16x16x32_bf16 v[108:111], v[36:39], v[72:75], v[108:111]
    v_mov_b32 v15, 4
    v_min3_u32 v8, v8, v9, v10
    v_mfma_f32_16x16x32_bf16 v[148:151], v[36:39], v[76:79], v[148:151]
    ds_write_b32 v254, v15 offset:48
    v_min_u32 v8, v8, v11
    v_mfma_f32_16x16x32_bf16 v[188:191], v[36:39], v[80:83], v[188:191]
    v_cmp_gt_u32 vcc, 5, v8
    v_mfma_f32_16x16x32_bf16 v[228:231], v[36:39], v[84:87], v[228:231]
    s_cbranch_vccnz L_ffn_s4a
L_ffn_s4b:
    ds_read_b64 v[56:57], v2 offset:53248
    ds_read_b64 v[58:59], v3 offset:53248
    v_mfma_f32_16x16x32_bf16 v[112:115], v[40:43], v[72:75], v[112:115]
    ds_read_b64 v[60:61], v2 offset:55296
    v_mfma_f32_16x16x32_bf16 v[152:155], v[40:43], v[76:79], v[152:155]
    ds_read_b64 v[62:63], v3 offset:55296
    v_mfma_f32_16x16x32_bf16 v[192:195], v[40:43], v[80:83], v[192:195]
    ds_read_b64 v[64:65], v2 offset:57344
    v_mfma_f32_16x16x32_bf16 v[232:235], v[40:43], v[84:87], v[232:235]
    ds_read_b64 v[66:67], v3 offset:57344
    ds_read_b64 v[68:69], v2 offset:59392
    v_mfma_f32_16x16x32_bf16 v[116:119], v[44:47], v[72:75], v[116:119]
    ds_read_b64 v[70:71], v3 offset:59392
    v_mfma_f32_16x16x32_bf16 v[156:159], v[44:47], v[76:79], v[156:159]
    ds_read_b64_tr_b16 v[16:17], v13 offset:0
    v_mfma_f32_16x16x32_bf16 v[196:199], v[44:47], v[80:83], v[196:199]
    ds_read_b64_tr_b16 v[18:19], v14 offset:0
    v_mfma_f32_16x16x32_bf16 v[236:239], v[44:47], v[84:87], v[236:239]
    ds_read_b64_tr_b16 v[20:21], v13 offset:10240
    ds_read_b64_tr_b16 v[22:23], v14 offset:10240
    v_mfma_f32_16x16x32_bf16 v[120:123], v[48:51], v[72:75], v[120:123]
    ds_read_b64_tr_b16 v[24:25], v13 offset:32
    v_mfma_f32_16x16x32_bf16 v[160:163], v[48:51], v[76:79], v[160:163]
    ds_read_b64_tr_b16 v[26:27], v14 offset:32
    v_mfma_f32_16x16x32_bf16 v[200:203], v[48:51], v[80:83], v[200:203]
    ds_read_b64_tr_b16 v[28:29], v13 offset:10272
    v_mfma_f32_16x16x32_bf16 v[240:243], v[48:51], v[84:87], v[240:243]
    ds_read_b64_tr_b16 v[30:31], v14 offset:10272
    ds_read_b64_tr_b16 v[32:33], v13 offset:64
    v_mfma_f32_16x16x32_bf16 v[124:127], v[52:55], v[72:75], v[124:127]
    ds_read_b64_tr_b16 v[34:35], v14 offset:64
    v_mfma_f32_16x16x32_bf16 v[164:167], v[52:55], v[76:79], v[164:167]
    ds_read_b64_tr_b16 v[36:37], v13 offset:10304
    v_mfma_f32_16x16x32_bf16 v[204:207], v[52:55], v[80:83], v[204:207]
    ds_read_b64_tr_b16 v[38:39], v14 offset:10304
    v_mfma_f32_16x16x32_bf16 v[244:247], v[52:55], v[84:87], v[244:247]
    ds_read_b64_tr_b16 v[40:41], v13 offset:96
    ds_read_b64_tr_b16 v[42:43], v14 offset:96
    s_waitcnt lgkmcnt(12)
    v_mfma_f32_16x16x32_bf16 v[88:91], v[16:19], v[56:59], v[88:91]
    ds_read_b64_tr_b16 v[44:45], v13 offset:10336
    v_mfma_f32_16x16x32_bf16 v[128:131], v[16:19], v[60:63], v[128:131]
    ds_read_b64_tr_b16 v[46:47], v14 offset:10336
    v_mfma_f32_16x16x32_bf16 v[168:171], v[16:19], v[64:67], v[168:171]
    v_mfma_f32_16x16x32_bf16 v[208:211], v[16:19], v[68:71], v[208:211]
    ds_read_b64_tr_b16 v[48:49], v13 offset:128
    ds_read_b64_tr_b16 v[50:51], v14 offset:128
    s_waitcnt lgkmcnt(14)
    v_mfma_f32_16x16x32_bf16 v[92:95], v[20:23], v[56:59], v[92:95]
    v_mfma_f32_16x16x32_bf16 v[132:135], v[20:23], v[60:63], v[132:135]
    v_mfma_f32_16x16x32_bf16 v[172:175], v[20:23], v[64:67], v[172:175]
    v_mfma_f32_16x16x32_bf16 v[212:215], v[20:23], v[68:71], v[212:215]
    ds_read_b64_tr_b16 v[52:53], v13 offset:10368
    ds_read_b64_tr_b16 v[54:55], v14 offset:10368
    s_waitcnt lgkmcnt(14)
    v_mfma_f32_16x16x32_bf16 v[96:99], v[24:27], v[56:59], v[96:99]
    ds_read_b64 v[72:73], v4 offset:53248
    v_mfma_f32_16x16x32_bf16 v[136:139], v[24:27], v[60:63], v[136:139]
    ds_read_b64 v[74:75], v5 offset:53248
    v_mfma_f32_16x16x32_bf16 v[176:179], v[24:27], v[64:67], v[176:179]
    ds_read_b64 v[76:77], v4 offset:55296
    v_mfma_f32_16x16x32_bf16 v[216:219], v[24:27], v[68:71], v[216:219]
    ds_read_b64 v[78:79], v5 offset:55296
    ds_read_b64 v[80:81], v4 offset:57344
    s_waitcnt lgkmcnt(15)
    v_mfma_f32_16x16x32_bf16 v[100:103], v[28:31], v[56:59], v[100:103]
    ds_read_b64 v[82:83], v5 offset:57344
    v_mfma_f32_16x16x32_bf16 v[140:143], v[28:31], v[60:63], v[140:143]
    ds_read_b64 v[84:85], v4 offset:59392
    v_mfma_f32_16x16x32_bf16 v[180:183], v[28:31], v[64:67], v[180:183]
    ds_read_b64 v[86:87], v5 offset:59392
    v_mfma_f32_16x16x32_bf16 v[220:223], v[28:31], v[68:71], v[220:223]
    ds_read_b64_tr_b16 v[16:17], v13 offset:5120
    ds_read_b64_tr_b16 v[18:19], v14 offset:5120
    v_mfma_f32_16x16x32_bf16 v[104:107], v[32:35], v[56:59], v[104:107]
    ds_read_b64_tr_b16 v[20:21], v13 offset:15360
    v_mfma_f32_16x16x32_bf16 v[144:147], v[32:35], v[60:63], v[144:147]
    ds_read_b64_tr_b16 v[22:23], v14 offset:15360
    v_mfma_f32_16x16x32_bf16 v[184:187], v[32:35], v[64:67], v[184:187]
    v_mfma_f32_16x16x32_bf16 v[224:227], v[32:35], v[68:71], v[224:227]
    ds_read_b64_tr_b16 v[24:25], v13 offset:5152
    ds_read_b64_tr_b16 v[26:27], v14 offset:5152
    s_waitcnt lgkmcnt(15)
    v_mfma_f32_16x16x32_bf16 v[108:111], v[36:39], v[56:59], v[108:111]
    v_mfma_f32_16x16x32_bf16 v[148:151], v[36:39], v[60:63], v[148:151]
    v_mfma_f32_16x16x32_bf16 v[188:191], v[36:39], v[64:67], v[188:191]
    v_mfma_f32_16x16x32_bf16 v[228:231], v[36:39], v[68:71], v[228:231]
    ds_read_b64_tr_b16 v[28:29], v13 offset:15392
    ds_read_b64_tr_b16 v[30:31], v14 offset:15392
    v_mfma_f32_16x16x32_bf16 v[112:115], v[40:43], v[56:59], v[112:115]
    v_mfma_f32_16x16x32_bf16 v[152:155], v[40:43], v[60:63], v[152:155]
    v_mfma_f32_16x16x32_bf16 v[192:195], v[40:43], v[64:67], v[192:195]
    v_mfma_f32_16x16x32_bf16 v[232:235], v[40:43], v[68:71], v[232:235]
    ds_read_b64_tr_b16 v[32:33], v13 offset:5184
    ds_read_b64_tr_b16 v[34:35], v14 offset:5184
    v_mfma_f32_16x16x32_bf16 v[116:119], v[44:47], v[56:59], v[116:119]
    v_mfma_f32_16x16x32_bf16 v[156:159], v[44:47], v[60:63], v[156:159]
    v_mfma_f32_16x16x32_bf16 v[196:199], v[44:47], v[64:67], v[196:199]
    v_mfma_f32_16x16x32_bf16 v[236:239], v[44:47], v[68:71], v[236:239]
    ds_read_b64_tr_b16 v[36:37], v13 offset:15424
    ds_read_b64_tr_b16 v[38:39], v14 offset:15424
    v_mfma_f32_16x16x32_bf16 v[120:123], v[48:51], v[56:59], v[120:123]
    v_mfma_f32_16x16x32_bf16 v[160:163], v[48:51], v[60:63], v[160:163]
    v_mfma_f32_16x16x32_bf16 v[200:203], v[48:51], v[64:67], v[200:203]
    v_mfma_f32_16x16x32_bf16 v[240:243], v[48:51], v[68:71], v[240:243]
    ds_read_b64_tr_b16 v[40:41], v13 offset:5216
    ds_read_b64_tr_b16 v[42:43], v14 offset:5216
    s_waitcnt lgkmcnt(15)
    v_mfma_f32_16x16x32_bf16 v[124:127], v[52:55], v[56:59], v[124:127]
    v_mfma_f32_16x16x32_bf16 v[164:167], v[52:55], v[60:63], v[164:167]
    v_mfma_f32_16x16x32_bf16 v[204:207], v[52:55], v[64:67], v[204:207]
    v_mfma_f32_16x16x32_bf16 v[244:247], v[52:55], v[68:71], v[244:247]
    ds_read_b64_tr_b16 v[44:45], v13 offset:15456
    ds_read_b64_tr_b16 v[46:47], v14 offset:15456
    s_waitcnt lgkmcnt(14)
    v_mfma_f32_16x16x32_bf16 v[88:91], v[16:19], v[72:75], v[88:91]
    v_mfma_f32_16x16x32_bf16 v[128:131], v[16:19], v[76:79], v[128:131]
    v_mfma_f32_16x16x32_bf16 v[168:171], v[16:19], v[80:83], v[168:171]
    v_mfma_f32_16x16x32_bf16 v[208:211], v[16:19], v[84:87], v[208:211]
    ds_read_b64_tr_b16 v[48:49], v13 offset:5248
    ds_read_b64_tr_b16 v[50:51], v14 offset:5248
    s_waitcnt lgkmcnt(14)
    v_mfma_f32_16x16x32_bf16 v[92:95], v[20:23], v[72:75], v[92:95]
    v_mfma_f32_16x16x32_bf16 v[132:135], v[20:23], v[76:79], v[132:135]
    v_mfma_f32_16x16x32_bf16 v[172:175], v[20:23], v[80:83], v[172:175]
    v_mfma_f32_16x16x32_bf16 v[212:215], v[20:23], v[84:87], v[212:215]
    ds_read_b64_tr_b16 v[52:53], v13 offset:15488
    ds_read_b64_tr_b16 v[54:55], v14 offset:15488
    s_waitcnt lgkmcnt(14)
    v_mfma_f32_16x16x32_bf16 v[96:99], v[24:27], v[72:75], v[96:99]
    v_mfma_f32_16x16x32_bf16 v[136:139], v[24:27], v[76:79], v[136:139]
    v_mfma_f32_16x16x32_bf16 v[176:179], v[24:27], v[80:83], v[176:179]
    v_mfma_f32_16x16x32_bf16 v[216:219], v[24:27], v[84:87], v[216:219]
    s_waitcnt lgkmcnt(12)
    v_mfma_f32_16x16x32_bf16 v[100:103], v[28:31], v[72:75], v[100:103]
    ds_read_b128 v[8:11], v12 offset:32
    v_mfma_f32_16x16x32_bf16 v[140:143], v[28:31], v[76:79], v[140:143]
    v_mfma_f32_16x16x32_bf16 v[180:183], v[28:31], v[80:83], v[180:183]
    v_mfma_f32_16x16x32_bf16 v[220:223], v[28:31], v[84:87], v[220:223]
    s_waitcnt lgkmcnt(11)
    v_mfma_f32_16x16x32_bf16 v[104:107], v[32:35], v[72:75], v[104:107]
    v_mfma_f32_16x16x32_bf16 v[144:147], v[32:35], v[76:79], v[144:147]
    v_mfma_f32_16x16x32_bf16 v[184:187], v[32:35], v[80:83], v[184:187]
    v_mfma_f32_16x16x32_bf16 v[224:227], v[32:35], v[84:87], v[224:227]
    s_waitcnt lgkmcnt(0)
    v_mfma_f32_16x16x32_bf16 v[108:111], v[36:39], v[72:75], v[108:111]
    v_mov_b32 v15, 5
    v_min3_u32 v8, v8, v9, v10
    v_mfma_f32_16x16x32_bf16 v[148:151], v[36:39], v[76:79], v[148:151]
    ds_write_b32 v254, v15 offset:48
    v_min_u32 v8, v8, v11
    v_mfma_f32_16x16x32_bf16 v[188:191], v[36:39], v[80:83], v[188:191]
    v_cmp_gt_u32 vcc, 6, v8
    v_mfma_f32_16x16x32_bf16 v[228:231], v[36:39], v[84:87], v[228:231]
    s_cbranch_vccnz L_ffn_s5a
L_ffn_s5b:
    ds_read_b64 v[56:57], v248 offset:0
    ds_read_b64 v[58:59], v249 offset:0
    v_mfma_f32_16x16x32_bf16 v[112:115], v[40:43], v[72:75], v[112:115]
    ds_read_b64 v[60:61], v248 offset:2048
    v_mfma_f32_16x16x32_bf16 v[152:155], v[40:43], v[76:79], v[152:155]
    ds_read_b64 v[62:63], v249 offset:2048
    v_mfma_f32_16x16x32_bf16 v[192:195], v[40:43], v[80:83], v[192:195]
    ds_read_b64 v[64:65], v248 offset:4096
    v_mfma_f32_16x16x32_bf16 v[232:235], v[40:43], v[84:87], v[232:235]
    ds_read_b64 v[66:67], v249 offset:4096
    ds_read_b64 v[68:69], v248 offset:6144
    v_mfma_f32_16x16x32_bf16 v[116:119], v[44:47], v[72:75], v[116:119]
    ds_read_b64 v[70:71], v249 offset:6144
    v_mfma_f32_16x16x32_bf16 v[156:159], v[44:47], v[76:79], v[156:159]
    ds_read_b64_tr_b16 v[16:17], v252 offset:0
    v_mfma_f32_16x16x32_bf16 v[196:199], v[44:47], v[80:83], v[196:199]
    ds_read_b64_tr_b16 v[18:19], v253 offset:0
    v_mfma_f32_16x16x32_bf16 v[236:239], v[44:47], v[84:87], v[236:239]
    ds_read_b64_tr_b16 v[20:21], v252 offset:10240
    ds_read_b64_tr_b16 v[22:23], v253 offset:10240
    v_mfma_f32_16x16x32_bf16 v[120:123], v[48:51], v[72:75], v[120:123]
    ds_read_b64_tr_b16 v[24:25], v252 offset:32
    v_mfma_f32_16x16x32_bf16 v[160:163], v[48:51], v[76:79], v[160:163]
    ds_read_b64_tr_b16 v[26:27], v253 offset:32
    v_mfma_f32_16x16x32_bf16 v[200:203], v[48:51], v[80:83], v[200:203]
    ds_read_b64_tr_b16 v[28:29], v252 offset:10272
    v_mfma_f32_16x16x32_bf16 v[240:243], v[48:51], v[84:87], v[240:243]
    ds_read_b64_tr_b16 v[30:31], v253 offset:10272
    ds_read_b64_tr_b16 v[32:33], v252 offset:64
    v_mfma_f32_16x16x32_bf16 v[124:127], v[52:55], v[72:75], v[124:127]
    ds_read_b64_tr_b16 v[34:35], v253 offset:64
    v_mfma_f32_16x16x32_bf16 v[164:167], v[52:55], v[76:79], v[164:167]
    ds_read_b64_tr_b16 v[36:37], v252 offset:10304
    v_mfma_f32_16x16x32_bf16 v[204:207], v[52:55], v[80:83], v[204:207]
    ds_read_b64_tr_b16 v[38:39], v253 offset:10304
    v_mfma_f32_16x16x32_bf16 v[244:247], v[52:55], v[84:87], v[244:247]
    ds_read_b64_tr_b16 v[40:41], v252 offset:96
    ds_read_b64_tr_b16 v[42:43], v253 offset:96
    s_waitcnt lgkmcnt(12)
    v_mfma_f32_16x16x32_bf16 v[88:91], v[16:19], v[56:59], v[88:91]
    ds_read_b64_tr_b16 v[44:45], v252 offset:10336
    v_mfma_f32_16x16x32_bf16 v[128:131], v[16:19], v[60:63], v[128:131]
    ds_read_b64_tr_b16 v[46:47], v253 offset:10336
    v_mfma_f32_16x16x32_bf16 v[168:171], v[16:19], v[64:67], v[168:171]
    v_mfma_f32_16x16x32_bf16 v[208:211], v[16:19], v[68:71], v[208:211]
    ds_read_b64_tr_b16 v[48:49], v252 offset:128
    ds_read_b64_tr_b16 v[50:51], v253 offset:128
    s_waitcnt lgkmcnt(14)
    v_mfma_f32_16x16x32_bf16 v[92:95], v[20:23], v[56:59], v[92:95]
    v_mfma_f32_16x16x32_bf16 v[132:135], v[20:23], v[60:63], v[132:135]
    v_mfma_f32_16x16x32_bf16 v[172:175], v[20:23], v[64:67], v[172:175]
    v_mfma_f32_16x16x32_bf16 v[212:215], v[20:23], v[68:71], v[212:215]
    ds_read_b64_tr_b16 v[52:53], v252 offset:10368
    ds_read_b64_tr_b16 v[54:55], v253 offset:10368
    s_waitcnt lgkmcnt(14)
    v_mfma_f32_16x16x32_bf16 v[96:99], v[24:27], v[56:59], v[96:99]
    ds_read_b64 v[72:73], v250 offset:0
    v_mfma_f32_16x16x32_bf16 v[136:139], v[24:27], v[60:63], v[136:139]
    ds_read_b64 v[74:75], v251 offset:0
    v_mfma_f32_16x16x32_bf16 v[176:179], v[24:27], v[64:67], v[176:179]
    ds_read_b64 v[76:77], v250 offset:2048
    v_mfma_f32_16x16x32_bf16 v[216:219], v[24:27], v[68:71], v[216:219]
    ds_read_b64 v[78:79], v251 offset:2048
    ds_read_b64 v[80:81], v250 offset:4096
    s_waitcnt lgkmcnt(15)
    v_mfma_f32_16x16x32_bf16 v[100:103], v[28:31], v[56:59], v[100:103]
    ds_read_b64 v[82:83], v251 offset:4096
    v_mfma_f32_16x16x32_bf16 v[140:143], v[28:31], v[60:63], v[140:143]
    ds_read_b64 v[84:85], v250 offset:6144
    v_mfma_f32_16x16x32_bf16 v[180:183], v[28:31], v[64:67], v[180:183]
    ds_read_b64 v[86:87], v251 offset:6144
    v_mfma_f32_16x16x32_bf16 v[220:223], v[28:31], v[68:71], v[220:223]
    ds_read_b64_tr_b16 v[16:17], v252 offset:5120
    ds_read_b64_tr_b16 v[18:19], v253 offset:5120
    v_mfma_f32_16x16x32_bf16 v[104:107], v[32:35], v[56:59], v[104:107]
    ds_read_b64_tr_b16 v[20:21], v252 offset:15360
    v_mfma_f32_16x16x32_bf16 v[144:147], v[32:35], v[60:63], v[144:147]
    ds_read_b64_tr_b16 v[22:23], v253 offset:15360
    v_mfma_f32_16x16x32_bf16 v[184:187], v[32:35], v[64:67], v[184:187]
    v_mfma_f32_16x16x32_bf16 v[224:227], v[32:35], v[68:71], v[224:227]
    ds_read_b64_tr_b16 v[24:25], v252 offset:5152
    ds_read_b64_tr_b16 v[26:27], v253 offset:5152
    s_waitcnt lgkmcnt(15)
    v_mfma_f32_16x16x32_bf16 v[108:111], v[36:39], v[56:59], v[108:111]
    v_mfma_f32_16x16x32_bf16 v[148:151], v[36:39], v[60:63], v[148:151]
    v_mfma_f32_16x16x32_bf16 v[188:191], v[36:39], v[64:67], v[188:191]
    v_mfma_f32_16x16x32_bf16 v[228:231], v[36:39], v[68:71], v[228:231]
    ds_read_b64_tr_b16 v[28:29], v252 offset:15392
    ds_read_b64_tr_b16 v[30:31], v253 offset:15392
    v_mfma_f32_16x16x32_bf16 v[112:115], v[40:43], v[56:59], v[112:115]
    v_mfma_f32_16x16x32_bf16 v[152:155], v[40:43], v[60:63], v[152:155]
    v_mfma_f32_16x16x32_bf16 v[192:195], v[40:43], v[64:67], v[192:195]
    v_mfma_f32_16x16x32_bf16 v[232:235], v[40:43], v[68:71], v[232:235]
    ds_read_b64_tr_b16 v[32:33], v252 offset:5184
    ds_read_b64_tr_b16 v[34:35], v253 offset:5184
    v_mfma_f32_16x16x32_bf16 v[116:119], v[44:47], v[56:59], v[116:119]
    v_mfma_f32_16x16x32_bf16 v[156:159], v[44:47], v[60:63], v[156:159]
    v_mfma_f32_16x16x32_bf16 v[196:199], v[44:47], v[64:67], v[196:199]
    v_mfma_f32_16x16x32_bf16 v[236:239], v[44:47], v[68:71], v[236:239]
    ds_read_b64_tr_b16 v[36:37], v252 offset:15424
    ds_read_b64_tr_b16 v[38:39], v253 offset:15424
    v_mfma_f32_16x16x32_bf16 v[120:123], v[48:51], v[56:59], v[120:123]
    v_mfma_f32_16x16x32_bf16 v[160:163], v[48:51], v[60:63], v[160:163]
    v_mfma_f32_16x16x32_bf16 v[200:203], v[48:51], v[64:67], v[200:203]
    v_mfma_f32_16x16x32_bf16 v[240:243], v[48:51], v[68:71], v[240:243]
    ds_read_b64_tr_b16 v[40:41], v252 offset:5216
    ds_read_b64_tr_b16 v[42:43], v253 offset:5216
    s_waitcnt lgkmcnt(15)
    v_mfma_f32_16x16x32_bf16 v[124:127], v[52:55], v[56:59], v[124:127]
    v_mfma_f32_16x16x32_bf16 v[164:167], v[52:55], v[60:63], v[164:167]
    v_mfma_f32_16x16x32_bf16 v[204:207], v[52:55], v[64:67], v[204:207]
    v_mfma_f32_16x16x32_bf16 v[244:247], v[52:55], v[68:71], v[244:247]
    ds_read_b64_tr_b16 v[44:45], v252 offset:15456
    ds_read_b64_tr_b16 v[46:47], v253 offset:15456
    s_waitcnt lgkmcnt(14)
    v_mfma_f32_16x16x32_bf16 v[88:91], v[16:19], v[72:75], v[88:91]
    v_mfma_f32_16x16x32_bf16 v[128:131], v[16:19], v[76:79], v[128:131]
    v_mfma_f32_16x16x32_bf16 v[168:171], v[16:19], v[80:83], v[168:171]
    v_mfma_f32_16x16x32_bf16 v[208:211], v[16:19], v[84:87], v[208:211]
    ds_read_b64_tr_b16 v[48:49], v252 offset:5248
    ds_read_b64_tr_b16 v[50:51], v253 offset:5248
    s_waitcnt lgkmcnt(14)
    v_mfma_f32_16x16x32_bf16 v[92:95], v[20:23], v[72:75], v[92:95]
    v_mfma_f32_16x16x32_bf16 v[132:135], v[20:23], v[76:79], v[132:135]
    v_mfma_f32_16x16x32_bf16 v[172:175], v[20:23], v[80:83], v[172:175]
    v_mfma_f32_16x16x32_bf16 v[212:215], v[20:23], v[84:87], v[212:215]
    ds_read_b64_tr_b16 v[52:53], v252 offset:15488
    ds_read_b64_tr_b16 v[54:55], v253 offset:15488
    s_waitcnt lgkmcnt(14)
    v_mfma_f32_16x16x32_bf16 v[96:99], v[24:27], v[72:75], v[96:99]
    v_mfma_f32_16x16x32_bf16 v[136:139], v[24:27], v[76:79], v[136:139]
    v_mfma_f32_16x16x32_bf16 v[176:179], v[24:27], v[80:83], v[176:179]
    v_mfma_f32_16x16x32_bf16 v[216:219], v[24:27], v[84:87], v[216:219]
    s_waitcnt lgkmcnt(12)
    v_mfma_f32_16x16x32_bf16 v[100:103], v[28:31], v[72:75], v[100:103]
    ds_read_b128 v[8:11], v12 offset:32
    v_mfma_f32_16x16x32_bf16 v[140:143], v[28:31], v[76:79], v[140:143]
    v_mfma_f32_16x16x32_bf16 v[180:183], v[28:31], v[80:83], v[180:183]
    v_mfma_f32_16x16x32_bf16 v[220:223], v[28:31], v[84:87], v[220:223]
    s_waitcnt lgkmcnt(11)
    v_mfma_f32_16x16x32_bf16 v[104:107], v[32:35], v[72:75], v[104:107]
    v_mfma_f32_16x16x32_bf16 v[144:147], v[32:35], v[76:79], v[144:147]
    v_mfma_f32_16x16x32_bf16 v[184:187], v[32:35], v[80:83], v[184:187]
    v_mfma_f32_16x16x32_bf16 v[224:227], v[32:35], v[84:87], v[224:227]
    s_waitcnt lgkmcnt(0)
    v_mfma_f32_16x16x32_bf16 v[108:111], v[36:39], v[72:75], v[108:111]
    v_mov_b32 v15, 6
    v_min3_u32 v8, v8, v9, v10
    v_mfma_f32_16x16x32_bf16 v[148:151], v[36:39], v[76:79], v[148:151]
    ds_write_b32 v254, v15 offset:48
    v_min_u32 v8, v8, v11
    v_mfma_f32_16x16x32_bf16 v[188:191], v[36:39], v[80:83], v[188:191]
    v_cmp_gt_u32 vcc, 7, v8
    v_mfma_f32_16x16x32_bf16 v[228:231], v[36:39], v[84:87], v[228:231]
    s_cbranch_vccnz L_ffn_s6a
L_ffn_s6b:
    ds_read_b64 v[56:57], v2 offset:0
    ds_read_b64 v[58:59], v3 offset:0
    v_mfma_f32_16x16x32_bf16 v[112:115], v[40:43], v[72:75], v[112:115]
    ds_read_b64 v[60:61], v2 offset:2048
    v_mfma_f32_16x16x32_bf16 v[152:155], v[40:43], v[76:79], v[152:155]
    ds_read_b64 v[62:63], v3 offset:2048
    v_mfma_f32_16x16x32_bf16 v[192:195], v[40:43], v[80:83], v[192:195]
    ds_read_b64 v[64:65], v2 offset:4096
    v_mfma_f32_16x16x32_bf16 v[232:235], v[40:43], v[84:87], v[232:235]
    ds_read_b64 v[66:67], v3 offset:4096
    ds_read_b64 v[68:69], v2 offset:6144
    v_mfma_f32_16x16x32_bf16 v[116:119], v[44:47], v[72:75], v[116:119]
    ds_read_b64 v[70:71], v3 offset:6144
    v_mfma_f32_16x16x32_bf16 v[156:159], v[44:47], v[76:79], v[156:159]
    ds_read_b64_tr_b16 v[16:17], v6 offset:0
    v_mfma_f32_16x16x32_bf16 v[196:199], v[44:47], v[80:83], v[196:199]
    ds_read_b64_tr_b16 v[18:19], v7 offset:0
    v_mfma_f32_16x16x32_bf16 v[236:239], v[44:47], v[84:87], v[236:239]
    ds_read_b64_tr_b16 v[20:21], v6 offset:10240
    ds_read_b64_tr_b16 v[22:23], v7 offset:10240
    v_mfma_f32_16x16x32_bf16 v[120:123], v[48:51], v[72:75], v[120:123]
    ds_read_b64_tr_b16 v[24:25], v6 offset:32
    v_mfma_f32_16x16x32_bf16 v[160:163], v[48:51], v[76:79], v[160:163]
    ds_read_b64_tr_b16 v[26:27], v7 offset:32
    v_mfma_f32_16x16x32_bf16 v[200:203], v[48:51], v[80:83], v[200:203]
    ds_read_b64_tr_b16 v[28:29], v6 offset:10272
    v_mfma_f32_16x16x32_bf16 v[240:243], v[48:51], v[84:87], v[240:243]
    ds_read_b64_tr_b16 v[30:31], v7 offset:10272
    ds_read_b64_tr_b16 v[32:33], v6 offset:64
    v_mfma_f32_16x16x32_bf16 v[124:127], v[52:55], v[72:75], v[124:127]
    ds_read_b64_tr_b16 v[34:35], v7 offset:64
    v_mfma_f32_16x16x32_bf16 v[164:167], v[52:55], v[76:79], v[164:167]
    ds_read_b64_tr_b16 v[36:37], v6 offset:10304
    v_mfma_f32_16x16x32_bf16 v[204:207], v[52:55], v[80:83], v[204:207]
    ds_read_b64_tr_b16 v[38:39], v7 offset:10304
    v_mfma_f32_16x16x32_bf16 v[244:247], v[52:55], v[84:87], v[244:247]
    ds_read_b64_tr_b16 v[40:41], v6 offset:96
    ds_read_b64_tr_b16 v[42:43], v7 offset:96
    s_waitcnt lgkmcnt(12)
    v_mfma_f32_16x16x32_bf16 v[88:91], v[16:19], v[56:59], v[88:91]
    ds_read_b64_tr_b16 v[44:45], v6 offset:10336
    v_mfma_f32_16x16x32_bf16 v[128:131], v[16:19], v[60:63], v[128:131]
    ds_read_b64_tr_b16 v[46:47], v7 offset:10336
    v_mfma_f32_16x16x32_bf16 v[168:171], v[16:19], v[64:67], v[168:171]
    v_mfma_f32_16x16x32_bf16 v[208:211], v[16:19], v[68:71], v[208:211]
    ds_read_b64_tr_b16 v[48:49], v6 offset:128
    ds_read_b64_tr_b16 v[50:51], v7 offset:128
    s_waitcnt lgkmcnt(14)
    v_mfma_f32_16x16x32_bf16 v[92:95], v[20:23], v[56:59], v[92:95]
    v_mfma_f32_16x16x32_bf16 v[132:135], v[20:23], v[60:63], v[132:135]
    v_mfma_f32_16x16x32_bf16 v[172:175], v[20:23], v[64:67], v[172:175]
    v_mfma_f32_16x16x32_bf16 v[212:215], v[20:23], v[68:71], v[212:215]
    ds_read_b64_tr_b16 v[52:53], v6 offset:10368
    ds_read_b64_tr_b16 v[54:55], v7 offset:10368
    s_waitcnt lgkmcnt(14)
    v_mfma_f32_16x16x32_bf16 v[96:99], v[24:27], v[56:59], v[96:99]
    ds_read_b64 v[72:73], v4 offset:0
    v_mfma_f32_16x16x32_bf16 v[136:139], v[24:27], v[60:63], v[136:139]
    ds_read_b64 v[74:75], v5 offset:0
    v_mfma_f32_16x16x32_bf16 v[176:179], v[24:27], v[64:67], v[176:179]
    ds_read_b64 v[76:77], v4 offset:2048
    v_mfma_f32_16x16x32_bf16 v[216:219], v[24:27], v[68:71], v[216:219]
    ds_read_b64 v[78:79], v5 offset:2048
    ds_read_b64 v[80:81], v4 offset:4096
    s_waitcnt lgkmcnt(15)
    v_mfma_f32_16x16x32_bf16 v[100:103], v[28:31], v[56:59], v[100:103]
    ds_read_b64 v[82:83], v5 offset:4096
    v_mfma_f32_16x16x32_bf16 v[140:143], v[28:31], v[60:63], v[140:143]
    ds_read_b64 v[84:85], v4 offset:6144
    v_mfma_f32_16x16x32_bf16 v[180:183], v[28:31], v[64:67], v[180:183]
    ds_read_b64 v[86:87], v5 offset:6144
    v_mfma_f32_16x16x32_bf16 v[220:223], v[28:31], v[68:71], v[220:223]
    ds_read_b64_tr_b16 v[16:17], v6 offset:5120
    ds_read_b64_tr_b16 v[18:19], v7 offset:5120
    v_mfma_f32_16x16x32_bf16 v[104:107], v[32:35], v[56:59], v[104:107]
    ds_read_b64_tr_b16 v[20:21], v6 offset:15360
    v_mfma_f32_16x16x32_bf16 v[144:147], v[32:35], v[60:63], v[144:147]
    ds_read_b64_tr_b16 v[22:23], v7 offset:15360
    v_mfma_f32_16x16x32_bf16 v[184:187], v[32:35], v[64:67], v[184:187]
    v_mfma_f32_16x16x32_bf16 v[224:227], v[32:35], v[68:71], v[224:227]
    ds_read_b64_tr_b16 v[24:25], v6 offset:5152
    ds_read_b64_tr_b16 v[26:27], v7 offset:5152
    s_waitcnt lgkmcnt(15)
    v_mfma_f32_16x16x32_bf16 v[108:111], v[36:39], v[56:59], v[108:111]
    v_mfma_f32_16x16x32_bf16 v[148:151], v[36:39], v[60:63], v[148:151]
    v_mfma_f32_16x16x32_bf16 v[188:191], v[36:39], v[64:67], v[188:191]
    v_mfma_f32_16x16x32_bf16 v[228:231], v[36:39], v[68:71], v[228:231]
    ds_read_b64_tr_b16 v[28:29], v6 offset:15392
    ds_read_b64_tr_b16 v[30:31], v7 offset:15392
    v_mfma_f32_16x16x32_bf16 v[112:115], v[40:43], v[56:59], v[112:115]
    v_mfma_f32_16x16x32_bf16 v[152:155], v[40:43], v[60:63], v[152:155]
    v_mfma_f32_16x16x32_bf16 v[192:195], v[40:43], v[64:67], v[192:195]
    v_mfma_f32_16x16x32_bf16 v[232:235], v[40:43], v[68:71], v[232:235]
    ds_read_b64_tr_b16 v[32:33], v6 offset:5184
    ds_read_b64_tr_b16 v[34:35], v7 offset:5184
    v_mfma_f32_16x16x32_bf16 v[116:119], v[44:47], v[56:59], v[116:119]
    v_mfma_f32_16x16x32_bf16 v[156:159], v[44:47], v[60:63], v[156:159]
    v_mfma_f32_16x16x32_bf16 v[196:199], v[44:47], v[64:67], v[196:199]
    v_mfma_f32_16x16x32_bf16 v[236:239], v[44:47], v[68:71], v[236:239]
    ds_read_b64_tr_b16 v[36:37], v6 offset:15424
    ds_read_b64_tr_b16 v[38:39], v7 offset:15424
    v_mfma_f32_16x16x32_bf16 v[120:123], v[48:51], v[56:59], v[120:123]
    v_mfma_f32_16x16x32_bf16 v[160:163], v[48:51], v[60:63], v[160:163]
    v_mfma_f32_16x16x32_bf16 v[200:203], v[48:51], v[64:67], v[200:203]
    v_mfma_f32_16x16x32_bf16 v[240:243], v[48:51], v[68:71], v[240:243]
    ds_read_b64_tr_b16 v[40:41], v6 offset:5216
    ds_read_b64_tr_b16 v[42:43], v7 offset:5216
    s_waitcnt lgkmcnt(15)
    v_mfma_f32_16x16x32_bf16 v[124:127], v[52:55], v[56:59], v[124:127]
    v_mfma_f32_16x16x32_bf16 v[164:167], v[52:55], v[60:63], v[164:167]
    v_mfma_f32_16x16x32_bf16 v[204:207], v[52:55], v[64:67], v[204:207]
    v_mfma_f32_16x16x32_bf16 v[244:247], v[52:55], v[68:71], v[244:247]
    ds_read_b64_tr_b16 v[44:45], v6 offset:15456
    ds_read_b64_tr_b16 v[46:47], v7 offset:15456
    s_waitcnt lgkmcnt(14)
    v_mfma_f32_16x16x32_bf16 v[88:91], v[16:19], v[72:75], v[88:91]
    v_mfma_f32_16x16x32_bf16 v[128:131], v[16:19], v[76:79], v[128:131]
    v_mfma_f32_16x16x32_bf16 v[168:171], v[16:19], v[80:83], v[168:171]
    v_mfma_f32_16x16x32_bf16 v[208:211], v[16:19], v[84:87], v[208:211]
    ds_read_b64_tr_b16 v[48:49], v6 offset:5248
    ds_read_b64_tr_b16 v[50:51], v7 offset:5248
    s_waitcnt lgkmcnt(14)
    v_mfma_f32_16x16x32_bf16 v[92:95], v[20:23], v[72:75], v[92:95]
    v_mfma_f32_16x16x32_bf16 v[132:135], v[20:23], v[76:79], v[132:135]
    v_mfma_f32_16x16x32_bf16 v[172:175], v[20:23], v[80:83], v[172:175]
    v_mfma_f32_16x16x32_bf16 v[212:215], v[20:23], v[84:87], v[212:215]
    ds_read_b64_tr_b16 v[52:53], v6 offset:15488
    ds_read_b64_tr_b16 v[54:55], v7 offset:15488
    s_waitcnt lgkmcnt(14)
    v_mfma_f32_16x16x32_bf16 v[96:99], v[24:27], v[72:75], v[96:99]
    v_mfma_f32_16x16x32_bf16 v[136:139], v[24:27], v[76:79], v[136:139]
    v_mfma_f32_16x16x32_bf16 v[176:179], v[24:27], v[80:83], v[176:179]
    v_mfma_f32_16x16x32_bf16 v[216:219], v[24:27], v[84:87], v[216:219]
    s_waitcnt lgkmcnt(12)
    v_mfma_f32_16x16x32_bf16 v[100:103], v[28:31], v[72:75], v[100:103]
    ds_read_b128 v[8:11], v12 offset:32
    v_mfma_f32_16x16x32_bf16 v[140:143], v[28:31], v[76:79], v[140:143]
    v_mfma_f32_16x16x32_bf16 v[180:183], v[28:31], v[80:83], v[180:183]
    v_mfma_f32_16x16x32_bf16 v[220:223], v[28:31], v[84:87], v[220:223]
    s_waitcnt lgkmcnt(11)
    v_mfma_f32_16x16x32_bf16 v[104:107], v[32:35], v[72:75], v[104:107]
    v_mfma_f32_16x16x32_bf16 v[144:147], v[32:35], v[76:79], v[144:147]
    v_mfma_f32_16x16x32_bf16 v[184:187], v[32:35], v[80:83], v[184:187]
    v_mfma_f32_16x16x32_bf16 v[224:227], v[32:35], v[84:87], v[224:227]
    s_waitcnt lgkmcnt(0)
    v_mfma_f32_16x16x32_bf16 v[108:111], v[36:39], v[72:75], v[108:111]
    v_mov_b32 v15, 7
    v_min3_u32 v8, v8, v9, v10
    v_mfma_f32_16x16x32_bf16 v[148:151], v[36:39], v[76:79], v[148:151]
    ds_write_b32 v254, v15 offset:48
    v_min_u32 v8, v8, v11
    v_mfma_f32_16x16x32_bf16 v[188:191], v[36:39], v[80:83], v[188:191]
    v_cmp_gt_u32 vcc, 8, v8
    v_mfma_f32_16x16x32_bf16 v[228:231], v[36:39], v[84:87], v[228:231]
    s_cbranch_vccnz L_ffn_s7a
L_ffn_s7b:
    ds_read_b64 v[56:57], v2 offset:53248
    ds_read_b64 v[58:59], v3 offset:53248
    v_mfma_f32_16x16x32_bf16 v[112:115], v[40:43], v[72:75], v[112:115]
    ds_read_b64 v[60:61], v2 offset:55296
    v_mfma_f32_16x16x32_bf16 v[152:155], v[40:43], v[76:79], v[152:155]
    ds_read_b64 v[62:63], v3 offset:55296
    v_mfma_f32_16x16x32_bf16 v[192:195], v[40:43], v[80:83], v[192:195]
    ds_read_b64 v[64:65], v2 offset:57344
    v_mfma_f32_16x16x32_bf16 v[232:235], v[40:43], v[84:87], v[232:235]
    ds_read_b64 v[66:67], v3 offset:57344
    ds_read_b64 v[68:69], v2 offset:59392
    v_mfma_f32_16x16x32_bf16 v[116:119], v[44:47], v[72:75], v[116:119]
    ds_read_b64 v[70:71], v3 offset:59392
    v_mfma_f32_16x16x32_bf16 v[156:159], v[44:47], v[76:79], v[156:159]
    ds_read_b64_tr_b16 v[16:17], v13 offset:0
    v_mfma_f32_16x16x32_bf16 v[196:199], v[44:47], v[80:83], v[196:199]
    ds_read_b64_tr_b16 v[18:19], v14 offset:0
    v_mfma_f32_16x16x32_bf16 v[236:239], v[44:47], v[84:87], v[236:239]
    ds_read_b64_tr_b16 v[20:21], v13 offset:10240
    ds_read_b64_tr_b16 v[22:23], v14 offset:10240
    v_mfma_f32_16x16x32_bf16 v[120:123], v[48:51], v[72:75], v[120:123]
    ds_read_b64_tr_b16 v[24:25], v13 offset:32
    v_mfma_f32_16x16x32_bf16 v[160:163], v[48:51], v[76:79], v[160:163]
    ds_read_b64_tr_b16 v[26:27], v14 offset:32
    v_mfma_f32_16x16x32_bf16 v[200:203], v[48:51], v[80:83], v[200:203]
    ds_read_b64_tr_b16 v[28:29], v13 offset:10272
    v_mfma_f32_16x16x32_bf16 v[240:243], v[48:51], v[84:87], v[240:243]
    ds_read_b64_tr_b16 v[30:31], v14 offset:10272
    ds_read_b64_tr_b16 v[32:33], v13 offset:64
    v_mfma_f32_16x16x32_bf16 v[124:127], v[52:55], v[72:75], v[124:127]
    ds_read_b64_tr_b16 v[34:35], v14 offset:64
    v_mfma_f32_16x16x32_bf16 v[164:167], v[52:55], v[76:79], v[164:167]
    ds_read_b64_tr_b16 v[36:37], v13 offset:10304
    v_mfma_f32_16x16x32_bf16 v[204:207], v[52:55], v[80:83], v[204:207]
    ds_read_b64_tr_b16 v[38:39], v14 offset:10304
    v_mfma_f32_16x16x32_bf16 v[244:247], v[52:55], v[84:87], v[244:247]
    ds_read_b64_tr_b16 v[40:41], v13 offset:96
    ds_read_b64_tr_b16 v[42:43], v14 offset:96
    s_waitcnt lgkmcnt(12)
    v_mfma_f32_16x16x32_bf16 v[88:91], v[16:19], v[56:59], v[88:91]
    ds_read_b64_tr_b16 v[44:45], v13 offset:10336
    v_mfma_f32_16x16x32_bf16 v[128:131], v[16:19], v[60:63], v[128:131]
    ds_read_b64_tr_b16 v[46:47], v14 offset:10336
    v_mfma_f32_16x16x32_bf16 v[168:171], v[16:19], v[64:67], v[168:171]
    v_mfma_f32_16x16x32_bf16 v[208:211], v[16:19], v[68:71], v[208:211]
    ds_read_b64_tr_b16 v[48:49], v13 offset:128
    ds_read_b64_tr_b16 v[50:51], v14 offset:128
    s_waitcnt lgkmcnt(14)
    v_mfma_f32_16x16x32_bf16 v[92:95], v[20:23], v[56:59], v[92:95]
    v_mfma_f32_16x16x32_bf16 v[132:135], v[20:23], v[60:63], v[132:135]
    v_mfma_f32_16x16x32_bf16 v[172:175], v[20:23], v[64:67], v[172:175]
    v_mfma_f32_16x16x32_bf16 v[212:215], v[20:23], v[68:71], v[212:215]
    ds_read_b64_tr_b16 v[52:53], v13 offset:10368
    ds_read_b64_tr_b16 v[54:55], v14 offset:10368
    s_waitcnt lgkmcnt(14)
    v_mfma_f32_16x16x32_bf16 v[96:99], v[24:27], v[56:59], v[96:99]
    ds_read_b64 v[72:73], v4 offset:53248
    v_mfma_f32_16x16x32_bf16 v[136:139], v[24:27], v[60:63], v[136:139]
    ds_read_b64 v[74:75], v5 offset:53248
    v_mfma_f32_16x16x32_bf16 v[176:179], v[24:27], v[64:67], v[176:179]
    ds_read_b64 v[76:77], v4 offset:55296
    v_mfma_f32_16x16x32_bf16 v[216:219], v[24:27], v[68:71], v[216:219]
    ds_read_b64 v[78:79], v5 offset:55296
    ds_read_b64 v[80:81], v4 offset:57344
    s_waitcnt lgkmcnt(15)
    v_mfma_f32_16x16x32_bf16 v[100:103], v[28:31], v[56:59], v[100:103]
    ds_read_b64 v[82:83], v5 offset:57344
    v_mfma_f32_16x16x32_bf16 v[140:143], v[28:31], v[60:63], v[140:143]
    ds_read_b64 v[84:85], v4 offset:59392
    v_mfma_f32_16x16x32_bf16 v[180:183], v[28:31], v[64:67], v[180:183]
    ds_read_b64 v[86:87], v5 offset:59392
    v_mfma_f32_16x16x32_bf16 v[220:223], v[28:31], v[68:71], v[220:223]
    ds_read_b64_tr_b16 v[16:17], v13 offset:5120
    ds_read_b64_tr_b16 v[18:19], v14 offset:5120
    v_mfma_f32_16x16x32_bf16 v[104:107], v[32:35], v[56:59], v[104:107]
    ds_read_b64_tr_b16 v[20:21], v13 offset:15360
    v_mfma_f32_16x16x32_bf16 v[144:147], v[32:35], v[60:63], v[144:147]
    ds_read_b64_tr_b16 v[22:23], v14 offset:15360
    v_mfma_f32_16x16x32_bf16 v[184:187], v[32:35], v[64:67], v[184:187]
    v_mfma_f32_16x16x32_bf16 v[224:227], v[32:35], v[68:71], v[224:227]
    ds_read_b64_tr_b16 v[24:25], v13 offset:5152
    ds_read_b64_tr_b16 v[26:27], v14 offset:5152
    s_waitcnt lgkmcnt(15)
    v_mfma_f32_16x16x32_bf16 v[108:111], v[36:39], v[56:59], v[108:111]
    v_mfma_f32_16x16x32_bf16 v[148:151], v[36:39], v[60:63], v[148:151]
    v_mfma_f32_16x16x32_bf16 v[188:191], v[36:39], v[64:67], v[188:191]
    v_mfma_f32_16x16x32_bf16 v[228:231], v[36:39], v[68:71], v[228:231]
    ds_read_b64_tr_b16 v[28:29], v13 offset:15392
    ds_read_b64_tr_b16 v[30:31], v14 offset:15392
    v_mfma_f32_16x16x32_bf16 v[112:115], v[40:43], v[56:59], v[112:115]
    v_mfma_f32_16x16x32_bf16 v[152:155], v[40:43], v[60:63], v[152:155]
    v_mfma_f32_16x16x32_bf16 v[192:195], v[40:43], v[64:67], v[192:195]
    v_mfma_f32_16x16x32_bf16 v[232:235], v[40:43], v[68:71], v[232:235]
    ds_read_b64_tr_b16 v[32:33], v13 offset:5184
    ds_read_b64_tr_b16 v[34:35], v14 offset:5184
    v_mfma_f32_16x16x32_bf16 v[116:119], v[44:47], v[56:59], v[116:119]
    v_mfma_f32_16x16x32_bf16 v[156:159], v[44:47], v[60:63], v[156:159]
    v_mfma_f32_16x16x32_bf16 v[196:199], v[44:47], v[64:67], v[196:199]
    v_mfma_f32_16x16x32_bf16 v[236:239], v[44:47], v[68:71], v[236:239]
    ds_read_b64_tr_b16 v[36:37], v13 offset:15424
    ds_read_b64_tr_b16 v[38:39], v14 offset:15424
    v_mfma_f32_16x16x32_bf16 v[120:123], v[48:51], v[56:59], v[120:123]
    v_mfma_f32_16x16x32_bf16 v[160:163], v[48:51], v[60:63], v[160:163]
    v_mfma_f32_16x16x32_bf16 v[200:203], v[48:51], v[64:67], v[200:203]
    v_mfma_f32_16x16x32_bf16 v[240:243], v[48:51], v[68:71], v[240:243]
    ds_read_b64_tr_b16 v[40:41], v13 offset:5216
    ds_read_b64_tr_b16 v[42:43], v14 offset:5216
    s_waitcnt lgkmcnt(15)
    v_mfma_f32_16x16x32_bf16 v[124:127], v[52:55], v[56:59], v[124:127]
    v_mfma_f32_16x16x32_bf16 v[164:167], v[52:55], v[60:63], v[164:167]
    v_mfma_f32_16x16x32_bf16 v[204:207], v[52:55], v[64:67], v[204:207]
    v_mfma_f32_16x16x32_bf16 v[244:247], v[52:55], v[68:71], v[244:247]
    ds_read_b64_tr_b16 v[44:45], v13 offset:15456
    ds_read_b64_tr_b16 v[46:47], v14 offset:15456
    s_waitcnt lgkmcnt(14)
    v_mfma_f32_16x16x32_bf16 v[88:91], v[16:19], v[72:75], v[88:91]
    v_mfma_f32_16x16x32_bf16 v[128:131], v[16:19], v[76:79], v[128:131]
    v_mfma_f32_16x16x32_bf16 v[168:171], v[16:19], v[80:83], v[168:171]
    v_mfma_f32_16x16x32_bf16 v[208:211], v[16:19], v[84:87], v[208:211]
    ds_read_b64_tr_b16 v[48:49], v13 offset:5248
    ds_read_b64_tr_b16 v[50:51], v14 offset:5248
    s_waitcnt lgkmcnt(14)
    v_mfma_f32_16x16x32_bf16 v[92:95], v[20:23], v[72:75], v[92:95]
    v_mfma_f32_16x16x32_bf16 v[132:135], v[20:23], v[76:79], v[132:135]
    v_mfma_f32_16x16x32_bf16 v[172:175], v[20:23], v[80:83], v[172:175]
    v_mfma_f32_16x16x32_bf16 v[212:215], v[20:23], v[84:87], v[212:215]
    ds_read_b64_tr_b16 v[52:53], v13 offset:15488
    ds_read_b64_tr_b16 v[54:55], v14 offset:15488
    s_waitcnt lgkmcnt(14)
    v_mfma_f32_16x16x32_bf16 v[96:99], v[24:27], v[72:75], v[96:99]
    v_mfma_f32_16x16x32_bf16 v[136:139], v[24:27], v[76:79], v[136:139]
    v_mfma_f32_16x16x32_bf16 v[176:179], v[24:27], v[80:83], v[176:179]
    v_mfma_f32_16x16x32_bf16 v[216:219], v[24:27], v[84:87], v[216:219]
    s_waitcnt lgkmcnt(12)
    v_mfma_f32_16x16x32_bf16 v[100:103], v[28:31], v[72:75], v[100:103]
    ds_read_b128 v[8:11], v12 offset:32
    v_mfma_f32_16x16x32_bf16 v[140:143], v[28:31], v[76:79], v[140:143]
    v_mfma_f32_16x16x32_bf16 v[180:183], v[28:31], v[80:83], v[180:183]
    v_mfma_f32_16x16x32_bf16 v[220:223], v[28:31], v[84:87], v[220:223]
    s_waitcnt lgkmcnt(11)
    v_mfma_f32_16x16x32_bf16 v[104:107], v[32:35], v[72:75], v[104:107]
    v_mfma_f32_16x16x32_bf16 v[144:147], v[32:35], v[76:79], v[144:147]
    v_mfma_f32_16x16x32_bf16 v[184:187], v[32:35], v[80:83], v[184:187]
    v_mfma_f32_16x16x32_bf16 v[224:227], v[32:35], v[84:87], v[224:227]
    s_waitcnt lgkmcnt(0)
    v_mfma_f32_16x16x32_bf16 v[108:111], v[36:39], v[72:75], v[108:111]
    v_mov_b32 v15, 8
    v_min3_u32 v8, v8, v9, v10
    v_mfma_f32_16x16x32_bf16 v[148:151], v[36:39], v[76:79], v[148:151]
    ds_write_b32 v254, v15 offset:48
    v_min_u32 v8, v8, v11
    v_mfma_f32_16x16x32_bf16 v[188:191], v[36:39], v[80:83], v[188:191]
    v_cmp_gt_u32 vcc, 9, v8
    v_mfma_f32_16x16x32_bf16 v[228:231], v[36:39], v[84:87], v[228:231]
    s_cbranch_vccnz L_ffn_s8a
L_ffn_s8b:
    ds_read_b64 v[56:57], v248 offset:0
    ds_read_b64 v[58:59], v249 offset:0
    v_mfma_f32_16x16x32_bf16 v[112:115], v[40:43], v[72:75], v[112:115]
    ds_read_b64 v[60:61], v248 offset:2048
    v_mfma_f32_16x16x32_bf16 v[152:155], v[40:43], v[76:79], v[152:155]
    ds_read_b64 v[62:63], v249 offset:2048
    v_mfma_f32_16x16x32_bf16 v[192:195], v[40:43], v[80:83], v[192:195]
    ds_read_b64 v[64:65], v248 offset:4096
    v_mfma_f32_16x16x32_bf16 v[232:235], v[40:43], v[84:87], v[232:235]
    ds_read_b64 v[66:67], v249 offset:4096
    ds_read_b64 v[68:69], v248 offset:6144
    v_mfma_f32_16x16x32_bf16 v[116:119], v[44:47], v[72:75], v[116:119]
    ds_read_b64 v[70:71], v249 offset:6144
    v_mfma_f32_16x16x32_bf16 v[156:159], v[44:47], v[76:79], v[156:159]
    ds_read_b64_tr_b16 v[16:17], v252 offset:0
    v_mfma_f32_16x16x32_bf16 v[196:199], v[44:47], v[80:83], v[196:199]
    ds_read_b64_tr_b16 v[18:19], v253 offset:0
    v_mfma_f32_16x16x32_bf16 v[236:239], v[44:47], v[84:87], v[236:239]
    ds_read_b64_tr_b16 v[20:21], v252 offset:10240
    ds_read_b64_tr_b16 v[22:23], v253 offset:10240
    v_mfma_f32_16x16x32_bf16 v[120:123], v[48:51], v[72:75], v[120:123]
    ds_read_b64_tr_b16 v[24:25], v252 offset:32
    v_mfma_f32_16x16x32_bf16 v[160:163], v[48:51], v[76:79], v[160:163]
    ds_read_b64_tr_b16 v[26:27], v253 offset:32
    v_mfma_f32_16x16x32_bf16 v[200:203], v[48:51], v[80:83], v[200:203]
    ds_read_b64_tr_b16 v[28:29], v252 offset:10272
    v_mfma_f32_16x16x32_bf16 v[240:243], v[48:51], v[84:87], v[240:243]
    ds_read_b64_tr_b16 v[30:31], v253 offset:10272
    ds_read_b64_tr_b16 v[32:33], v252 offset:64
    v_mfma_f32_16x16x32_bf16 v[124:127], v[52:55], v[72:75], v[124:127]
    ds_read_b64_tr_b16 v[34:35], v253 offset:64
    v_mfma_f32_16x16x32_bf16 v[164:167], v[52:55], v[76:79], v[164:167]
    ds_read_b64_tr_b16 v[36:37], v252 offset:10304
    v_mfma_f32_16x16x32_bf16 v[204:207], v[52:55], v[80:83], v[204:207]
    ds_read_b64_tr_b16 v[38:39], v253 offset:10304
    v_mfma_f32_16x16x32_bf16 v[244:247], v[52:55], v[84:87], v[244:247]
    ds_read_b64_tr_b16 v[40:41], v252 offset:96
    ds_read_b64_tr_b16 v[42:43], v253 offset:96
    s_waitcnt lgkmcnt(12)
    v_mfma_f32_16x16x32_bf16 v[88:91], v[16:19], v[56:59], v[88:91]
    ds_read_b64_tr_b16 v[44:45], v252 offset:10336
    v_mfma_f32_16x16x32_bf16 v[128:131], v[16:19], v[60:63], v[128:131]
    ds_read_b64_tr_b16 v[46:47], v253 offset:10336
    v_mfma_f32_16x16x32_bf16 v[168:171], v[16:19], v[64:67], v[168:171]
    v_mfma_f32_16x16x32_bf16 v[208:211], v[16:19], v[68:71], v[208:211]
    ds_read_b64_tr_b16 v[48:49], v252 offset:128
    ds_read_b64_tr_b16 v[50:51], v253 offset:128
    s_waitcnt lgkmcnt(14)
    v_mfma_f32_16x16x32_bf16 v[92:95], v[20:23], v[56:59], v[92:95]
    v_mfma_f32_16x16x32_bf16 v[132:135], v[20:23], v[60:63], v[132:135]
    v_mfma_f32_16x16x32_bf16 v[172:175], v[20:23], v[64:67], v[172:175]
    v_mfma_f32_16x16x32_bf16 v[212:215], v[20:23], v[68:71], v[212:215]
    ds_read_b64_tr_b16 v[52:53], v252 offset:10368
    ds_read_b64_tr_b16 v[54:55], v253 offset:10368
    s_waitcnt lgkmcnt(14)
    v_mfma_f32_16x16x32_bf16 v[96:99], v[24:27], v[56:59], v[96:99]
    ds_read_b64 v[72:73], v250 offset:0
    v_mfma_f32_16x16x32_bf16 v[136:139], v[24:27], v[60:63], v[136:139]
    ds_read_b64 v[74:75], v251 offset:0
    v_mfma_f32_16x16x32_bf16 v[176:179], v[24:27], v[64:67], v[176:179]
    ds_read_b64 v[76:77], v250 offset:2048
    v_mfma_f32_16x16x32_bf16 v[216:219], v[24:27], v[68:71], v[216:219]
    ds_read_b64 v[78:79], v251 offset:2048
    ds_read_b64 v[80:81], v250 offset:4096
    s_waitcnt lgkmcnt(15)
    v_mfma_f32_16x16x32_bf16 v[100:103], v[28:31], v[56:59], v[100:103]
    ds_read_b64 v[82:83], v251 offset:4096
    v_mfma_f32_16x16x32_bf16 v[140:143], v[28:31], v[60:63], v[140:143]
    ds_read_b64 v[84:85], v250 offset:6144
    v_mfma_f32_16x16x32_bf16 v[180:183], v[28:31], v[64:67], v[180:183]
    ds_read_b64 v[86:87], v251 offset:6144
    v_mfma_f32_16x16x32_bf16 v[220:223], v[28:31], v[68:71], v[220:223]
    ds_read_b64_tr_b16 v[16:17], v252 offset:5120
    ds_read_b64_tr_b16 v[18:19], v253 offset:5120
    v_mfma_f32_16x16x32_bf16 v[104:107], v[32:35], v[56:59], v[104:107]
    ds_read_b64_tr_b16 v[20:21], v252 offset:15360
    v_mfma_f32_16x16x32_bf16 v[144:147], v[32:35], v[60:63], v[144:147]
    ds_read_b64_tr_b16 v[22:23], v253 offset:15360
    v_mfma_f32_16x16x32_bf16 v[184:187], v[32:35], v[64:67], v[184:187]
    v_mfma_f32_16x16x32_bf16 v[224:227], v[32:35], v[68:71], v[224:227]
    ds_read_b64_tr_b16 v[24:25], v252 offset:5152
    ds_read_b64_tr_b16 v[26:27], v253 offset:5152
    s_waitcnt lgkmcnt(15)
    v_mfma_f32_16x16x32_bf16 v[108:111], v[36:39], v[56:59], v[108:111]
    v_mfma_f32_16x16x32_bf16 v[148:151], v[36:39], v[60:63], v[148:151]
    v_mfma_f32_16x16x32_bf16 v[188:191], v[36:39], v[64:67], v[188:191]
    v_mfma_f32_16x16x32_bf16 v[228:231], v[36:39], v[68:71], v[228:231]
    ds_read_b64_tr_b16 v[28:29], v252 offset:15392
    ds_read_b64_tr_b16 v[30:31], v253 offset:15392
    v_mfma_f32_16x16x32_bf16 v[112:115], v[40:43], v[56:59], v[112:115]
    v_mfma_f32_16x16x32_bf16 v[152:155], v[40:43], v[60:63], v[152:155]
    v_mfma_f32_16x16x32_bf16 v[192:195], v[40:43], v[64:67], v[192:195]
    v_mfma_f32_16x16x32_bf16 v[232:235], v[40:43], v[68:71], v[232:235]
    ds_read_b64_tr_b16 v[32:33], v252 offset:5184
    ds_read_b64_tr_b16 v[34:35], v253 offset:5184
    v_mfma_f32_16x16x32_bf16 v[116:119], v[44:47], v[56:59], v[116:119]
    v_mfma_f32_16x16x32_bf16 v[156:159], v[44:47], v[60:63], v[156:159]
    v_mfma_f32_16x16x32_bf16 v[196:199], v[44:47], v[64:67], v[196:199]
    v_mfma_f32_16x16x32_bf16 v[236:239], v[44:47], v[68:71], v[236:239]
    ds_read_b64_tr_b16 v[36:37], v252 offset:15424
    ds_read_b64_tr_b16 v[38:39], v253 offset:15424
    v_mfma_f32_16x16x32_bf16 v[120:123], v[48:51], v[56:59], v[120:123]
    v_mfma_f32_16x16x32_bf16 v[160:163], v[48:51], v[60:63], v[160:163]
    v_mfma_f32_16x16x32_bf16 v[200:203], v[48:51], v[64:67], v[200:203]
    v_mfma_f32_16x16x32_bf16 v[240:243], v[48:51], v[68:71], v[240:243]
    ds_read_b64_tr_b16 v[40:41], v252 offset:5216
    ds_read_b64_tr_b16 v[42:43], v253 offset:5216
    s_waitcnt lgkmcnt(15)
    v_mfma_f32_16x16x32_bf16 v[124:127], v[52:55], v[56:59], v[124:127]
    v_mfma_f32_16x16x32_bf16 v[164:167], v[52:55], v[60:63], v[164:167]
    v_mfma_f32_16x16x32_bf16 v[204:207], v[52:55], v[64:67], v[204:207]
    v_mfma_f32_16x16x32_bf16 v[244:247], v[52:55], v[68:71], v[244:247]
    ds_read_b64_tr_b16 v[44:45], v252 offset:15456
    ds_read_b64_tr_b16 v[46:47], v253 offset:15456
    s_waitcnt lgkmcnt(14)
    v_mfma_f32_16x16x32_bf16 v[88:91], v[16:19], v[72:75], v[88:91]
    v_mfma_f32_16x16x32_bf16 v[128:131], v[16:19], v[76:79], v[128:131]
    v_mfma_f32_16x16x32_bf16 v[168:171], v[16:19], v[80:83], v[168:171]
    v_mfma_f32_16x16x32_bf16 v[208:211], v[16:19], v[84:87], v[208:211]
    ds_read_b64_tr_b16 v[48:49], v252 offset:5248
    ds_read_b64_tr_b16 v[50:51], v253 offset:5248
    s_waitcnt lgkmcnt(14)
    v_mfma_f32_16x16x32_bf16 v[92:95], v[20:23], v[72:75], v[92:95]
    v_mfma_f32_16x16x32_bf16 v[132:135], v[20:23], v[76:79], v[132:135]
    v_mfma_f32_16x16x32_bf16 v[172:175], v[20:23], v[80:83], v[172:175]
    v_mfma_f32_16x16x32_bf16 v[212:215], v[20:23], v[84:87], v[212:215]
    ds_read_b64_tr_b16 v[52:53], v252 offset:15488
    ds_read_b64_tr_b16 v[54:55], v253 offset:15488
    s_waitcnt lgkmcnt(14)
    v_mfma_f32_16x16x32_bf16 v[96:99], v[24:27], v[72:75], v[96:99]
    v_mfma_f32_16x16x32_bf16 v[136:139], v[24:27], v[76:79], v[136:139]
    v_mfma_f32_16x16x32_bf16 v[176:179], v[24:27], v[80:83], v[176:179]
    v_mfma_f32_16x16x32_bf16 v[216:219], v[24:27], v[84:87], v[216:219]
    s_waitcnt lgkmcnt(12)
    v_mfma_f32_16x16x32_bf16 v[100:103], v[28:31], v[72:75], v[100:103]
    ds_read_b128 v[8:11], v12 offset:32
    v_mfma_f32_16x16x32_bf16 v[140:143], v[28:31], v[76:79], v[140:143]
    v_mfma_f32_16x16x32_bf16 v[180:183], v[28:31], v[80:83], v[180:183]
    v_mfma_f32_16x16x32_bf16 v[220:223], v[28:31], v[84:87], v[220:223]
    s_waitcnt lgkmcnt(11)
    v_mfma_f32_16x16x32_bf16 v[104:107], v[32:35], v[72:75], v[104:107]
    v_mfma_f32_16x16x32_bf16 v[144:147], v[32:35], v[76:79], v[144:147]
    v_mfma_f32_16x16x32_bf16 v[184:187], v[32:35], v[80:83], v[184:187]
    v_mfma_f32_16x16x32_bf16 v[224:227], v[32:35], v[84:87], v[224:227]
    s_waitcnt lgkmcnt(0)
    v_mfma_f32_16x16x32_bf16 v[108:111], v[36:39], v[72:75], v[108:111]
    v_mov_b32 v15, 9
    v_min3_u32 v8, v8, v9, v10
    v_mfma_f32_16x16x32_bf16 v[148:151], v[36:39], v[76:79], v[148:151]
    ds_write_b32 v254, v15 offset:48
    v_min_u32 v8, v8, v11
    v_mfma_f32_16x16x32_bf16 v[188:191], v[36:39], v[80:83], v[188:191]
    v_cmp_gt_u32 vcc, 10, v8
    v_mfma_f32_16x16x32_bf16 v[228:231], v[36:39], v[84:87], v[228:231]
    s_cbranch_vccnz L_ffn_s9a
L_ffn_s9b:
    ds_read_b64 v[56:57], v2 offset:0
    ds_read_b64 v[58:59], v3 offset:0
    v_mfma_f32_16x16x32_bf16 v[112:115], v[40:43], v[72:75], v[112:115]
    ds_read_b64 v[60:61], v2 offset:2048
    v_mfma_f32_16x16x32_bf16 v[152:155], v[40:43], v[76:79], v[152:155]
    ds_read_b64 v[62:63], v3 offset:2048
    v_mfma_f32_16x16x32_bf16 v[192:195], v[40:43], v[80:83], v[192:195]
    ds_read_b64 v[64:65], v2 offset:4096
    v_mfma_f32_16x16x32_bf16 v[232:235], v[40:43], v[84:87], v[232:235]
    ds_read_b64 v[66:67], v3 offset:4096
    ds_read_b64 v[68:69], v2 offset:6144
    v_mfma_f32_16x16x32_bf16 v[116:119], v[44:47], v[72:75], v[116:119]
    ds_read_b64 v[70:71], v3 offset:6144
    v_mfma_f32_16x16x32_bf16 v[156:159], v[44:47], v[76:79], v[156:159]
    ds_read_b64_tr_b16 v[16:17], v6 offset:0
    v_mfma_f32_16x16x32_bf16 v[196:199], v[44:47], v[80:83], v[196:199]
    ds_read_b64_tr_b16 v[18:19], v7 offset:0
    v_mfma_f32_16x16x32_bf16 v[236:239], v[44:47], v[84:87], v[236:239]
    ds_read_b64_tr_b16 v[20:21], v6 offset:10240
    ds_read_b64_tr_b16 v[22:23], v7 offset:10240
    v_mfma_f32_16x16x32_bf16 v[120:123], v[48:51], v[72:75], v[120:123]
    ds_read_b64_tr_b16 v[24:25], v6 offset:32
    v_mfma_f32_16x16x32_bf16 v[160:163], v[48:51], v[76:79], v[160:163]
    ds_read_b64_tr_b16 v[26:27], v7 offset:32
    v_mfma_f32_16x16x32_bf16 v[200:203], v[48:51], v[80:83], v[200:203]
    ds_read_b64_tr_b16 v[28:29], v6 offset:10272
    v_mfma_f32_16x16x32_bf16 v[240:243], v[48:51], v[84:87], v[240:243]
    ds_read_b64_tr_b16 v[30:31], v7 offset:10272
    ds_read_b64_tr_b16 v[32:33], v6 offset:64
    v_mfma_f32_16x16x32_bf16 v[124:127], v[52:55], v[72:75], v[124:127]
    ds_read_b64_tr_b16 v[34:35], v7 offset:64
    v_mfma_f32_16x16x32_bf16 v[164:167], v[52:55], v[76:79], v[164:167]
    ds_read_b64_tr_b16 v[36:37], v6 offset:10304
    v_mfma_f32_16x16x32_bf16 v[204:207], v[52:55], v[80:83], v[204:207]
    ds_read_b64_tr_b16 v[38:39], v7 offset:10304
    v_mfma_f32_16x16x32_bf16 v[244:247], v[52:55], v[84:87], v[244:247]
    ds_read_b64_tr_b16 v[40:41], v6 offset:96
    ds_read_b64_tr_b16 v[42:43], v7 offset:96
    s_waitcnt lgkmcnt(12)
    v_mfma_f32_16x16x32_bf16 v[88:91], v[16:19], v[56:59], v[88:91]
    ds_read_b64_tr_b16 v[44:45], v6 offset:10336
    v_mfma_f32_16x16x32_bf16 v[128:131], v[16:19], v[60:63], v[128:131]
    ds_read_b64_tr_b16 v[46:47], v7 offset:10336
    v_mfma_f32_16x16x32_bf16 v[168:171], v[16:19], v[64:67], v[168:171]
    v_mfma_f32_16x16x32_bf16 v[208:211], v[16:19], v[68:71], v[208:211]
    ds_read_b64_tr_b16 v[48:49], v6 offset:128
    ds_read_b64_tr_b16 v[50:51], v7 offset:128
    s_waitcnt lgkmcnt(14)
    v_mfma_f32_16x16x32_bf16 v[92:95], v[20:23], v[56:59], v[92:95]
    v_mfma_f32_16x16x32_bf16 v[132:135], v[20:23], v[60:63], v[132:135]
    v_mfma_f32_16x16x32_bf16 v[172:175], v[20:23], v[64:67], v[172:175]
    v_mfma_f32_16x16x32_bf16 v[212:215], v[20:23], v[68:71], v[212:215]
    ds_read_b64_tr_b16 v[52:53], v6 offset:10368
    ds_read_b64_tr_b16 v[54:55], v7 offset:10368
    s_waitcnt lgkmcnt(14)
    v_mfma_f32_16x16x32_bf16 v[96:99], v[24:27], v[56:59], v[96:99]
    ds_read_b64 v[72:73], v4 offset:0
    v_mfma_f32_16x16x32_bf16 v[136:139], v[24:27], v[60:63], v[136:139]
    ds_read_b64 v[74:75], v5 offset:0
    v_mfma_f32_16x16x32_bf16 v[176:179], v[24:27], v[64:67], v[176:179]
    ds_read_b64 v[76:77], v4 offset:2048
    v_mfma_f32_16x16x32_bf16 v[216:219], v[24:27], v[68:71], v[216:219]
    ds_read_b64 v[78:79], v5 offset:2048
    ds_read_b64 v[80:81], v4 offset:4096
    s_waitcnt lgkmcnt(15)
    v_mfma_f32_16x16x32_bf16 v[100:103], v[28:31], v[56:59], v[100:103]
    ds_read_b64 v[82:83], v5 offset:4096
    v_mfma_f32_16x16x32_bf16 v[140:143], v[28:31], v[60:63], v[140:143]
    ds_read_b64 v[84:85], v4 offset:6144
    v_mfma_f32_16x16x32_bf16 v[180:183], v[28:31], v[64:67], v[180:183]
    ds_read_b64 v[86:87], v5 offset:6144
    v_mfma_f32_16x16x32_bf16 v[220:223], v[28:31], v[68:71], v[220:223]
    ds_read_b64_tr_b16 v[16:17], v6 offset:5120
    ds_read_b64_tr_b16 v[18:19], v7 offset:5120
    v_mfma_f32_16x16x32_bf16 v[104:107], v[32:35], v[56:59], v[104:107]
    ds_read_b64_tr_b16 v[20:21], v6 offset:15360
    v_mfma_f32_16x16x32_bf16 v[144:147], v[32:35], v[60:63], v[144:147]
    ds_read_b64_tr_b16 v[22:23], v7 offset:15360
    v_mfma_f32_16x16x32_bf16 v[184:187], v[32:35], v[64:67], v[184:187]
    v_mfma_f32_16x16x32_bf16 v[224:227], v[32:35], v[68:71], v[224:227]
    ds_read_b64_tr_b16 v[24:25], v6 offset:5152
    ds_read_b64_tr_b16 v[26:27], v7 offset:5152
    s_waitcnt lgkmcnt(15)
    v_mfma_f32_16x16x32_bf16 v[108:111], v[36:39], v[56:59], v[108:111]
    v_mfma_f32_16x16x32_bf16 v[148:151], v[36:39], v[60:63], v[148:151]
    v_mfma_f32_16x16x32_bf16 v[188:191], v[36:39], v[64:67], v[188:191]
    v_mfma_f32_16x16x32_bf16 v[228:231], v[36:39], v[68:71], v[228:231]
    ds_read_b64_tr_b16 v[28:29], v6 offset:15392
    ds_read_b64_tr_b16 v[30:31], v7 offset:15392
    v_mfma_f32_16x16x32_bf16 v[112:115], v[40:43], v[56:59], v[112:115]
    v_mfma_f32_16x16x32_bf16 v[152:155], v[40:43], v[60:63], v[152:155]
    v_mfma_f32_16x16x32_bf16 v[192:195], v[40:43], v[64:67], v[192:195]
    v_mfma_f32_16x16x32_bf16 v[232:235], v[40:43], v[68:71], v[232:235]
    ds_read_b64_tr_b16 v[32:33], v6 offset:5184
    ds_read_b64_tr_b16 v[34:35], v7 offset:5184
    v_mfma_f32_16x16x32_bf16 v[116:119], v[44:47], v[56:59], v[116:119]
    v_mfma_f32_16x16x32_bf16 v[156:159], v[44:47], v[60:63], v[156:159]
    v_mfma_f32_16x16x32_bf16 v[196:199], v[44:47], v[64:67], v[196:199]
    v_mfma_f32_16x16x32_bf16 v[236:239], v[44:47], v[68:71], v[236:239]
    ds_read_b64_tr_b16 v[36:37], v6 offset:15424
    ds_read_b64_tr_b16 v[38:39], v7 offset:15424
    v_mfma_f32_16x16x32_bf16 v[120:123], v[48:51], v[56:59], v[120:123]
    v_mfma_f32_16x16x32_bf16 v[160:163], v[48:51], v[60:63], v[160:163]
    v_mfma_f32_16x16x32_bf16 v[200:203], v[48:51], v[64:67], v[200:203]
    v_mfma_f32_16x16x32_bf16 v[240:243], v[48:51], v[68:71], v[240:243]
    ds_read_b64_tr_b16 v[40:41], v6 offset:5216
    ds_read_b64_tr_b16 v[42:43], v7 offset:5216
    s_waitcnt lgkmcnt(15)
    v_mfma_f32_16x16x32_bf16 v[124:127], v[52:55], v[56:59], v[124:127]
    v_mfma_f32_16x16x32_bf16 v[164:167], v[52:55], v[60:63], v[164:167]
    v_mfma_f32_16x16x32_bf16 v[204:207], v[52:55], v[64:67], v[204:207]
    v_mfma_f32_16x16x32_bf16 v[244:247], v[52:55], v[68:71], v[244:247]
    ds_read_b64_tr_b16 v[44:45], v6 offset:15456
    ds_read_b64_tr_b16 v[46:47], v7 offset:15456
    s_waitcnt lgkmcnt(14)
    v_mfma_f32_16x16x32_bf16 v[88:91], v[16:19], v[72:75], v[88:91]
    v_mfma_f32_16x16x32_bf16 v[128:131], v[16:19], v[76:79], v[128:131]
    v_mfma_f32_16x16x32_bf16 v[168:171], v[16:19], v[80:83], v[168:171]
    v_mfma_f32_16x16x32_bf16 v[208:211], v[16:19], v[84:87], v[208:211]
    ds_read_b64_tr_b16 v[48:49], v6 offset:5248
    ds_read_b64_tr_b16 v[50:51], v7 offset:5248
    s_waitcnt lgkmcnt(14)
    v_mfma_f32_16x16x32_bf16 v[92:95], v[20:23], v[72:75], v[92:95]
    v_mfma_f32_16x16x32_bf16 v[132:135], v[20:23], v[76:79], v[132:135]
    v_mfma_f32_16x16x32_bf16 v[172:175], v[20:23], v[80:83], v[172:175]
    v_mfma_f32_16x16x32_bf16 v[212:215], v[20:23], v[84:87], v[212:215]
    ds_read_b64_tr_b16 v[52:53], v6 offset:15488
    ds_read_b64_tr_b16 v[54:55], v7 offset:15488
    s_waitcnt lgkmcnt(14)
    v_mfma_f32_16x16x32_bf16 v[96:99], v[24:27], v[72:75], v[96:99]
    v_mfma_f32_16x16x32_bf16 v[136:139], v[24:27], v[76:79], v[136:139]
    v_mfma_f32_16x16x32_bf16 v[176:179], v[24:27], v[80:83], v[176:179]
    v_mfma_f32_16x16x32_bf16 v[216:219], v[24:27], v[84:87], v[216:219]
    s_waitcnt lgkmcnt(12)
    v_mfma_f32_16x16x32_bf16 v[100:103], v[28:31], v[72:75], v[100:103]
    ds_read_b128 v[8:11], v12 offset:32
    v_mfma_f32_16x16x32_bf16 v[140:143], v[28:31], v[76:79], v[140:143]
    v_mfma_f32_16x16x32_bf16 v[180:183], v[28:31], v[80:83], v[180:183]
    v_mfma_f32_16x16x32_bf16 v[220:223], v[28:31], v[84:87], v[220:223]
    s_waitcnt lgkmcnt(11)
    v_mfma_f32_16x16x32_bf16 v[104:107], v[32:35], v[72:75], v[104:107]
    v_mfma_f32_16x16x32_bf16 v[144:147], v[32:35], v[76:79], v[144:147]
    v_mfma_f32_16x16x32_bf16 v[184:187], v[32:35], v[80:83], v[184:187]
    v_mfma_f32_16x16x32_bf16 v[224:227], v[32:35], v[84:87], v[224:227]
    s_waitcnt lgkmcnt(0)
    v_mfma_f32_16x16x32_bf16 v[108:111], v[36:39], v[72:75], v[108:111]
    v_mov_b32 v15, 10
    v_min3_u32 v8, v8, v9, v10
    v_mfma_f32_16x16x32_bf16 v[148:151], v[36:39], v[76:79], v[148:151]
    ds_write_b32 v254, v15 offset:48
    v_min_u32 v8, v8, v11
    v_mfma_f32_16x16x32_bf16 v[188:191], v[36:39], v[80:83], v[188:191]
    v_cmp_gt_u32 vcc, 11, v8
    v_mfma_f32_16x16x32_bf16 v[228:231], v[36:39], v[84:87], v[228:231]
    s_cbranch_vccnz L_ffn_s10a
L_ffn_s10b:
    v_mfma_f32_16x16x32_bf16 v[112:115], v[40:43], v[72:75], v[112:115]
    v_mfma_f32_16x16x32_bf16 v[152:155], v[40:43], v[76:79], v[152:155]
    v_mfma_f32_16x16x32_bf16 v[192:195], v[40:43], v[80:83], v[192:195]
    v_mfma_f32_16x16x32_bf16 v[232:235], v[40:43], v[84:87], v[232:235]
    v_mfma_f32_16x16x32_bf16 v[116:119], v[44:47], v[72:75], v[116:119]
    v_mfma_f32_16x16x32_bf16 v[156:159], v[44:47], v[76:79], v[156:159]
    v_mfma_f32_16x16x32_bf16 v[196:199], v[44:47], v[80:83], v[196:199]
    v_mfma_f32_16x16x32_bf16 v[236:239], v[44:47], v[84:87], v[236:239]
    v_mfma_f32_16x16x32_bf16 v[120:123], v[48:51], v[72:75], v[120:123]
    v_mfma_f32_16x16x32_bf16 v[160:163], v[48:51], v[76:79], v[160:163]
    v_mfma_f32_16x16x32_bf16 v[200:203], v[48:51], v[80:83], v[200:203]
    v_mfma_f32_16x16x32_bf16 v[240:243], v[48:51], v[84:87], v[240:243]
    v_mfma_f32_16x16x32_bf16 v[124:127], v[52:55], v[72:75], v[124:127]
    v_mfma_f32_16x16x32_bf16 v[164:167], v[52:55], v[76:79], v[164:167]
    v_mfma_f32_16x16x32_bf16 v[204:207], v[52:55], v[80:83], v[204:207]
    v_mfma_f32_16x16x32_bf16 v[244:247], v[52:55], v[84:87], v[244:247]
    v_and_b32 v8, 15, v0
    v_lshrrev_b32 v9, 4, v0
    s_lshl_b32 s68, s3, 9
    s_add_u32 s68, s68, 159744
    v_lshlrev_b32 v2, 3, v8
    v_add_u32 v2, s68, v2
    v_lshlrev_b32 v3, 4, v9
    v_add_u32 v3, 161792, v3
    ds_read_b64 v[56:57], v2 offset:0
    ds_read_b64 v[58:59], v2 offset:128
    ds_read_b64 v[60:61], v2 offset:256
    ds_read_b64 v[62:63], v2 offset:384
    ds_read_b128 v[16:19], v3 offset:0
    ds_read_b128 v[20:23], v3 offset:512
    ds_read_b128 v[24:27], v3 offset:64
    ds_read_b128 v[28:31], v3 offset:576
    ds_read_b128 v[32:35], v3 offset:128
    ds_read_b128 v[36:39], v3 offset:640
    ds_read_b128 v[40:43], v3 offset:192
    ds_read_b128 v[44:47], v3 offset:704
    ds_read_b128 v[48:51], v3 offset:256
    ds_read_b128 v[52:55], v3 offset:768
    s_lshl_b32 s68, s60, 2
    s_add_u32 s68, s68, s3
    s_mul_i32 s68, s68, 385024
    s_add_u32 s44, s34, s68
    s_addc_u32 s45, s35, 0
    s_mov_b32 s46, 385024
    s_mov_b32 s47, 0x00020000
    s_lshr_b32 s69, s62, 1
    s_mul_i32 s69, s69, 5
    s_add_u32 s69, s69, 40
    s_and_b32 s70, s62, 1
    s_lshl_b32 s71, s70, 1
    s_add_u32 s71, s71, s69
    s_lshl_b32 s71, s71, 12
    s_add_u32 s72, s71, 4096
    s_add_u32 s69, s69, 4
    s_min_u32 s69, s69, 93
    s_lshl_b32 s69, s69, 12
    s_lshl_b32 s70, s70, 9
    s_add_u32 s69, s69, s70
    s_cmp_eq_u32 s62, 21
    s_cselect_b32 s72, s71, s72
    s_cselect_b32 s71, 0x7000000, s71
    v_lshrrev_b32 v4, 1, v9
    v_lshlrev_b32 v4, 8, v4
    v_lshl_add_u32 v4, v8, 4, v4
    v_and_b32 v5, 1, v9
    v_lshl_add_u32 v4, v5, 3, v4
    s_waitcnt lgkmcnt(10)
    v_rcp_f32 v64, v57
    v_mul_f32 v72, v57, v57
    v_rcp_f32 v66, v59
    v_mul_f32 v74, v59, v59
    v_rcp_f32 v68, v61
    v_mul_f32 v76, v61, v61
    v_rcp_f32 v70, v63
    v_mul_f32 v78, v63, v63
    v_mul_f32 v64, 0xbfb8aa3b, v64
    v_mul_f32 v66, 0xbfb8aa3b, v66
    v_mul_f32 v68, 0xbfb8aa3b, v68
    v_mul_f32 v70, 0xbfb8aa3b, v70
    s_waitcnt lgkmcnt(0)
    v_pk_fma_f32 v[88:89], v[56:57], v[16:17], v[88:89] op_sel:[0,0,0] op_sel_hi:[0,1,1] neg_lo:[1,0,0] neg_hi:[1,0,0]
    v_pk_fma_f32 v[90:91], v[56:57], v[18:19], v[90:91] op_sel:[0,0,0] op_sel_hi:[0,1,1] neg_lo:[1,0,0] neg_hi:[1,0,0]
    v_pk_fma_f32 v[92:93], v[56:57], v[20:21], v[92:93] op_sel:[0,0,0] op_sel_hi:[0,1,1] neg_lo:[1,0,0] neg_hi:[1,0,0]
    v_pk_fma_f32 v[94:95], v[56:57], v[22:23], v[94:95] op_sel:[0,0,0] op_sel_hi:[0,1,1] neg_lo:[1,0,0] neg_hi:[1,0,0]
    v_pk_mul_f32 v[80:81], v[88:89], v[64:65] op_sel_hi:[1,0]
    v_pk_mul_f32 v[82:83], v[90:91], v[64:65] op_sel_hi:[1,0]
    v_pk_mul_f32 v[88:89], v[88:89], v[92:93]
    v_pk_mul_f32 v[90:91], v[90:91], v[94:95]
    v_pk_fma_f32 v[96:97], v[56:57], v[24:25], v[96:97] op_sel:[0,0,0] op_sel_hi:[0,1,1] neg_lo:[1,0,0] neg_hi:[1,0,0]
    v_pk_fma_f32 v[98:99], v[56:57], v[26:27], v[98:99] op_sel:[0,0,0] op_sel_hi:[0,1,1] neg_lo:[1,0,0] neg_hi:[1,0,0]
    v_exp_f32 v92, v80
    v_pk_fma_f32 v[100:101], v[56:57], v[28:29], v[100:101] op_sel:[0,0,0] op_sel_hi:[0,1,1] neg_lo:[1,0,0] neg_hi:[1,0,0]
    v_pk_fma_f32 v[102:103], v[56:57], v[30:31], v[102:103] op_sel:[0,0,0] op_sel_hi:[0,1,1] neg_lo:[1,0,0] neg_hi:[1,0,0]
    v_exp_f32 v93, v81
    v_pk_mul_f32 v[84:85], v[96:97], v[64:65] op_sel_hi:[1,0]
    v_exp_f32 v94, v82
    v_pk_mul_f32 v[86:87], v[98:99], v[64:65] op_sel_hi:[1,0]
    v_exp_f32 v95, v83
    v_pk_mul_f32 v[96:97], v[96:97], v[100:101]
    v_pk_mul_f32 v[98:99], v[98:99], v[102:103]
    v_pk_fma_f32 v[92:93], v[92:93], v[72:73], v[72:73] op_sel_hi:[1,0,0]
    v_pk_fma_f32 v[94:95], v[94:95], v[72:73], v[72:73] op_sel_hi:[1,0,0]
    v_exp_f32 v100, v84
    v_pk_fma_f32 v[104:105], v[56:57], v[32:33], v[104:105] op_sel:[0,0,0] op_sel_hi:[0,1,1] neg_lo:[1,0,0] neg_hi:[1,0,0]
    v_pk_fma_f32 v[106:107], v[56:57], v[34:35], v[106:107] op_sel:[0,0,0] op_sel_hi:[0,1,1] neg_lo:[1,0,0] neg_hi:[1,0,0]
    v_exp_f32 v101, v85
    v_pk_fma_f32 v[108:109], v[56:57], v[36:37], v[108:109] op_sel:[0,0,0] op_sel_hi:[0,1,1] neg_lo:[1,0,0] neg_hi:[1,0,0]
    v_pk_fma_f32 v[110:111], v[56:57], v[38:39], v[110:111] op_sel:[0,0,0] op_sel_hi:[0,1,1] neg_lo:[1,0,0] neg_hi:[1,0,0]
    v_exp_f32 v102, v86
    v_pk_mul_f32 v[80:81], v[104:105], v[64:65] op_sel_hi:[1,0]
    v_pk_mul_f32 v[82:83], v[106:107], v[64:65] op_sel_hi:[1,0]
    v_exp_f32 v103, v87
    v_pk_mul_f32 v[104:105], v[104:105], v[108:109]
    v_pk_mul_f32 v[106:107], v[106:107], v[110:111]
    v_pk_fma_f32 v[100:101], v[100:101], v[72:73], v[72:73] op_sel_hi:[1,0,0]
    v_exp_f32 v108, v80
    v_pk_fma_f32 v[102:103], v[102:103], v[72:73], v[72:73] op_sel_hi:[1,0,0]
    v_exp_f32 v109, v81
    v_pk_fma_f32 v[112:113], v[56:57], v[40:41], v[112:113] op_sel:[0,0,0] op_sel_hi:[0,1,1] neg_lo:[1,0,0] neg_hi:[1,0,0]
    v_exp_f32 v110, v82
    v_pk_fma_f32 v[114:115], v[56:57], v[42:43], v[114:115] op_sel:[0,0,0] op_sel_hi:[0,1,1] neg_lo:[1,0,0] neg_hi:[1,0,0]
    v_exp_f32 v111, v83
    v_pk_fma_f32 v[116:117], v[56:57], v[44:45], v[116:117] op_sel:[0,0,0] op_sel_hi:[0,1,1] neg_lo:[1,0,0] neg_hi:[1,0,0]
    v_rcp_f32 v92, v92
    v_pk_fma_f32 v[118:119], v[56:57], v[46:47], v[118:119] op_sel:[0,0,0] op_sel_hi:[0,1,1] neg_lo:[1,0,0] neg_hi:[1,0,0]
    v_rcp_f32 v93, v93
    v_pk_mul_f32 v[84:85], v[112:113], v[64:65] op_sel_hi:[1,0]
    v_rcp_f32 v94, v94
    v_pk_mul_f32 v[86:87], v[114:115], v[64:65] op_sel_hi:[1,0]
    v_rcp_f32 v95, v95
    v_pk_mul_f32 v[112:113], v[112:113], v[116:117]
    v_pk_mul_f32 v[114:115], v[114:115], v[118:119]
    v_pk_mul_f32 v[88:89], v[88:89], v[92:93]
    v_pk_mul_f32 v[90:91], v[90:91], v[94:95]
    v_exp_f32 v116, v84
    v_cvt_pk_bf16_f32 v92, v88, v89
    v_cvt_pk_bf16_f32 v93, v90, v91
    v_exp_f32 v117, v85
    v_pk_fma_f32 v[108:109], v[108:109], v[72:73], v[72:73] op_sel_hi:[1,0,0]
    v_pk_fma_f32 v[110:111], v[110:111], v[72:73], v[72:73] op_sel_hi:[1,0,0]
    v_exp_f32 v118, v86
    v_pk_fma_f32 v[120:121], v[56:57], v[48:49], v[120:121] op_sel:[0,0,0] op_sel_hi:[0,1,1] neg_lo:[1,0,0] neg_hi:[1,0,0]
    v_pk_fma_f32 v[122:123], v[56:57], v[50:51], v[122:123] op_sel:[0,0,0] op_sel_hi:[0,1,1] neg_lo:[1,0,0] neg_hi:[1,0,0]
    v_exp_f32 v119, v87
    v_pk_fma_f32 v[124:125], v[56:57], v[52:53], v[124:125] op_sel:[0,0,0] op_sel_hi:[0,1,1] neg_lo:[1,0,0] neg_hi:[1,0,0]
    v_rcp_f32 v100, v100
    v_pk_fma_f32 v[126:127], v[56:57], v[54:55], v[126:127] op_sel:[0,0,0] op_sel_hi:[0,1,1] neg_lo:[1,0,0] neg_hi:[1,0,0]
    v_rcp_f32 v101, v101
    v_pk_mul_f32 v[80:81], v[120:121], v[64:65] op_sel_hi:[1,0]
    v_rcp_f32 v102, v102
    v_pk_mul_f32 v[82:83], v[122:123], v[64:65] op_sel_hi:[1,0]
    v_rcp_f32 v103, v103
    v_pk_mul_f32 v[120:121], v[120:121], v[124:125]
    v_pk_mul_f32 v[122:123], v[122:123], v[126:127]
    v_pk_mul_f32 v[96:97], v[96:97], v[100:101]
    v_pk_mul_f32 v[98:99], v[98:99], v[102:103]
    v_exp_f32 v124, v80
    v_cvt_pk_bf16_f32 v94, v96, v97
    v_cvt_pk_bf16_f32 v95, v98, v99
    v_exp_f32 v125, v81
    buffer_store_dwordx4 v[92:95], v1, s[44:47], s71 offen offset:0 sc1
    v_pk_fma_f32 v[116:117], v[116:117], v[72:73], v[72:73] op_sel_hi:[1,0,0]
    v_exp_f32 v126, v82
    v_pk_fma_f32 v[118:119], v[118:119], v[72:73], v[72:73] op_sel_hi:[1,0,0]
    v_pk_fma_f32 v[128:129], v[58:59], v[16:17], v[128:129] op_sel:[0,0,0] op_sel_hi:[0,1,1] neg_lo:[1,0,0] neg_hi:[1,0,0]
    v_exp_f32 v127, v83
    v_pk_fma_f32 v[130:131], v[58:59], v[18:19], v[130:131] op_sel:[0,0,0] op_sel_hi:[0,1,1] neg_lo:[1,0,0] neg_hi:[1,0,0]
    v_pk_fma_f32 v[132:133], v[58:59], v[20:21], v[132:133] op_sel:[0,0,0] op_sel_hi:[0,1,1] neg_lo:[1,0,0] neg_hi:[1,0,0]
    v_rcp_f32 v108, v108
    v_pk_fma_f32 v[134:135], v[58:59], v[22:23], v[134:135] op_sel:[0,0,0] op_sel_hi:[0,1,1] neg_lo:[1,0,0] neg_hi:[1,0,0]
    v_rcp_f32 v109, v109
    v_pk_mul_f32 v[84:85], v[128:129], v[66:67] op_sel_hi:[1,0]
    v_rcp_f32 v110, v110
    v_pk_mul_f32 v[86:87], v[130:131], v[66:67] op_sel_hi:[1,0]
    v_rcp_f32 v111, v111
    v_pk_mul_f32 v[128:129], v[128:129], v[132:133]
    v_pk_mul_f32 v[130:131], v[130:131], v[134:135]
    v_pk_mul_f32 v[104:105], v[104:105], v[108:109]
    v_pk_mul_f32 v[106:107], v[106:107], v[110:111]
    v_exp_f32 v132, v84
    v_cvt_pk_bf16_f32 v108, v104, v105
    v_cvt_pk_bf16_f32 v109, v106, v107
    v_exp_f32 v133, v85
    v_pk_fma_f32 v[124:125], v[124:125], v[72:73], v[72:73] op_sel_hi:[1,0,0]
    v_pk_fma_f32 v[126:127], v[126:127], v[72:73], v[72:73] op_sel_hi:[1,0,0]
    v_exp_f32 v134, v86
    v_pk_fma_f32 v[136:137], v[58:59], v[24:25], v[136:137] op_sel:[0,0,0] op_sel_hi:[0,1,1] neg_lo:[1,0,0] neg_hi:[1,0,0]
    v_pk_fma_f32 v[138:139], v[58:59], v[26:27], v[138:139] op_sel:[0,0,0] op_sel_hi:[0,1,1] neg_lo:[1,0,0] neg_hi:[1,0,0]
    v_exp_f32 v135, v87
    v_pk_fma_f32 v[140:141], v[58:59], v[28:29], v[140:141] op_sel:[0,0,0] op_sel_hi:[0,1,1] neg_lo:[1,0,0] neg_hi:[1,0,0]
    v_rcp_f32 v116, v116
    v_pk_fma_f32 v[142:143], v[58:59], v[30:31], v[142:143] op_sel:[0,0,0] op_sel_hi:[0,1,1] neg_lo:[1,0,0] neg_hi:[1,0,0]
    v_rcp_f32 v117, v117
    v_pk_mul_f32 v[80:81], v[136:137], v[66:67] op_sel_hi:[1,0]
    v_rcp_f32 v118, v118
    v_pk_mul_f32 v[82:83], v[138:139], v[66:67] op_sel_hi:[1,0]
    v_rcp_f32 v119, v119
    v_pk_mul_f32 v[136:137], v[136:137], v[140:141]
    v_pk_mul_f32 v[138:139], v[138:139], v[142:143]
    v_pk_mul_f32 v[112:113], v[112:113], v[116:117]
    v_pk_mul_f32 v[114:115], v[114:115], v[118:119]
    v_exp_f32 v140, v80
    v_cvt_pk_bf16_f32 v110, v112, v113
    v_cvt_pk_bf16_f32 v111, v114, v115
    v_exp_f32 v141, v81
    buffer_store_dwordx4 v[108:111], v1, s[44:47], s72 offen offset:0 sc1
    v_pk_fma_f32 v[132:133], v[132:133], v[74:75], v[74:75] op_sel_hi:[1,0,0]
    v_exp_f32 v142, v82
    v_pk_fma_f32 v[134:135], v[134:135], v[74:75], v[74:75] op_sel_hi:[1,0,0]
    v_pk_fma_f32 v[144:145], v[58:59], v[32:33], v[144:145] op_sel:[0,0,0] op_sel_hi:[0,1,1] neg_lo:[1,0,0] neg_hi:[1,0,0]
    v_exp_f32 v143, v83
    v_pk_fma_f32 v[146:147], v[58:59], v[34:35], v[146:147] op_sel:[0,0,0] op_sel_hi:[0,1,1] neg_lo:[1,0,0] neg_hi:[1,0,0]
    v_pk_fma_f32 v[148:149], v[58:59], v[36:37], v[148:149] op_sel:[0,0,0] op_sel_hi:[0,1,1] neg_lo:[1,0,0] neg_hi:[1,0,0]
    v_rcp_f32 v124, v124
    v_pk_fma_f32 v[150:151], v[58:59], v[38:39], v[150:151] op_sel:[0,0,0] op_sel_hi:[0,1,1] neg_lo:[1,0,0] neg_hi:[1,0,0]
    v_rcp_f32 v125, v125
    v_pk_mul_f32 v[84:85], v[144:145], v[66:67] op_sel_hi:[1,0]
    v_rcp_f32 v126, v126
    v_pk_mul_f32 v[86:87], v[146:147], v[66:67] op_sel_hi:[1,0]
    v_rcp_f32 v127, v127
    v_pk_mul_f32 v[144:145], v[144:145], v[148:149]
    v_pk_mul_f32 v[146:147], v[146:147], v[150:151]
    v_pk_mul_f32 v[120:121], v[120:121], v[124:125]
    v_pk_mul_f32 v[122:123], v[122:123], v[126:127]
    v_exp_f32 v148, v84
    v_cvt_pk_bf16_f32 v124, v120, v121
    v_cvt_pk_bf16_f32 v125, v122, v123
    v_exp_f32 v149, v85
    buffer_store_dwordx2 v[124:125], v4, s[44:47], s69 offen offset:0 sc1
    v_pk_fma_f32 v[140:141], v[140:141], v[74:75], v[74:75] op_sel_hi:[1,0,0]
    v_exp_f32 v150, v86
    v_pk_fma_f32 v[142:143], v[142:143], v[74:75], v[74:75] op_sel_hi:[1,0,0]
    v_pk_fma_f32 v[152:153], v[58:59], v[40:41], v[152:153] op_sel:[0,0,0] op_sel_hi:[0,1,1] neg_lo:[1,0,0] neg_hi:[1,0,0]
    v_exp_f32 v151, v87
    v_pk_fma_f32 v[154:155], v[58:59], v[42:43], v[154:155] op_sel:[0,0,0] op_sel_hi:[0,1,1] neg_lo:[1,0,0] neg_hi:[1,0,0]
    v_pk_fma_f32 v[156:157], v[58:59], v[44:45], v[156:157] op_sel:[0,0,0] op_sel_hi:[0,1,1] neg_lo:[1,0,0] neg_hi:[1,0,0]
    v_rcp_f32 v132, v132
    v_pk_fma_f32 v[158:159], v[58:59], v[46:47], v[158:159] op_sel:[0,0,0] op_sel_hi:[0,1,1] neg_lo:[1,0,0] neg_hi:[1,0,0]
    v_rcp_f32 v133, v133
    v_pk_mul_f32 v[80:81], v[152:153], v[66:67] op_sel_hi:[1,0]
    v_rcp_f32 v134, v134
    v_pk_mul_f32 v[82:83], v[154:155], v[66:67] op_sel_hi:[1,0]
    v_rcp_f32 v135, v135
    v_pk_mul_f32 v[152:153], v[152:153], v[156:157]
    v_pk_mul_f32 v[154:155], v[154:155], v[158:159]
    v_pk_mul_f32 v[128:129], v[128:129], v[132:133]
    v_pk_mul_f32 v[130:131], v[130:131], v[134:135]
    v_exp_f32 v156, v80
    v_cvt_pk_bf16_f32 v132, v128, v129
    v_cvt_pk_bf16_f32 v133, v130, v131
    v_exp_f32 v157, v81
    v_pk_fma_f32 v[148:149], v[148:149], v[74:75], v[74:75] op_sel_hi:[1,0,0]
    v_pk_fma_f32 v[150:151], v[150:151], v[74:75], v[74:75] op_sel_hi:[1,0,0]
    v_exp_f32 v158, v82
    v_pk_fma_f32 v[160:161], v[58:59], v[48:49], v[160:161] op_sel:[0,0,0] op_sel_hi:[0,1,1] neg_lo:[1,0,0] neg_hi:[1,0,0]
    v_pk_fma_f32 v[162:163], v[58:59], v[50:51], v[162:163] op_sel:[0,0,0] op_sel_hi:[0,1,1] neg_lo:[1,0,0] neg_hi:[1,0,0]
    v_exp_f32 v159, v83
    v_pk_fma_f32 v[164:165], v[58:59], v[52:53], v[164:165] op_sel:[0,0,0] op_sel_hi:[0,1,1] neg_lo:[1,0,0] neg_hi:[1,0,0]
    v_rcp_f32 v140, v140
    v_pk_fma_f32 v[166:167], v[58:59], v[54:55], v[166:167] op_sel:[0,0,0] op_sel_hi:[0,1,1] neg_lo:[1,0,0] neg_hi:[1,0,0]
    v_rcp_f32 v141, v141
    v_pk_mul_f32 v[84:85], v[160:161], v[66:67] op_sel_hi:[1,0]
    v_rcp_f32 v142, v142
    v_pk_mul_f32 v[86:87], v[162:163], v[66:67] op_sel_hi:[1,0]
    v_rcp_f32 v143, v143
    v_pk_mul_f32 v[160:161], v[160:161], v[164:165]
    v_pk_mul_f32 v[162:163], v[162:163], v[166:167]
    v_pk_mul_f32 v[136:137], v[136:137], v[140:141]
    v_pk_mul_f32 v[138:139], v[138:139], v[142:143]
    v_exp_f32 v164, v84
    v_cvt_pk_bf16_f32 v134, v136, v137
    v_cvt_pk_bf16_f32 v135, v138, v139
    v_exp_f32 v165, v85
    buffer_store_dwordx4 v[132:135], v1, s[44:47], s71 offen offset:1024 sc1
    v_pk_fma_f32 v[156:157], v[156:157], v[74:75], v[74:75] op_sel_hi:[1,0,0]
    v_exp_f32 v166, v86
    v_pk_fma_f32 v[158:159], v[158:159], v[74:75], v[74:75] op_sel_hi:[1,0,0]
    v_pk_fma_f32 v[168:169], v[60:61], v[16:17], v[168:169] op_sel:[0,0,0] op_sel_hi:[0,1,1] neg_lo:[1,0,0] neg_hi:[1,0,0]
    v_exp_f32 v167, v87
    v_pk_fma_f32 v[170:171], v[60:61], v[18:19], v[170:171] op_sel:[0,0,0] op_sel_hi:[0,1,1] neg_lo:[1,0,0] neg_hi:[1,0,0]
    v_pk_fma_f32 v[172:173], v[60:61], v[20:21], v[172:173] op_sel:[0,0,0] op_sel_hi:[0,1,1] neg_lo:[1,0,0] neg_hi:[1,0,0]
    v_rcp_f32 v148, v148
    v_pk_fma_f32 v[174:175], v[60:61], v[22:23], v[174:175] op_sel:[0,0,0] op_sel_hi:[0,1,1] neg_lo:[1,0,0] neg_hi:[1,0,0]
    v_rcp_f32 v149, v149
    v_pk_mul_f32 v[80:81], v[168:169], v[68:69] op_sel_hi:[1,0]
    v_rcp_f32 v150, v150
    v_pk_mul_f32 v[82:83], v[170:171], v[68:69] op_sel_hi:[1,0]
    v_rcp_f32 v151, v151
    v_pk_mul_f32 v[168:169], v[168:169], v[172:173]
    v_pk_mul_f32 v[170:171], v[170:171], v[174:175]
    v_pk_mul_f32 v[144:145], v[144:145], v[148:149]
    v_pk_mul_f32 v[146:147], v[146:147], v[150:151]
    v_exp_f32 v172, v80
    v_cvt_pk_bf16_f32 v148, v144, v145
    v_cvt_pk_bf16_f32 v149, v146, v147
    v_exp_f32 v173, v81
    v_pk_fma_f32 v[164:165], v[164:165], v[74:75], v[74:75] op_sel_hi:[1,0,0]
    v_pk_fma_f32 v[166:167], v[166:167], v[74:75], v[74:75] op_sel_hi:[1,0,0]
    v_exp_f32 v174, v82
    v_pk_fma_f32 v[176:177], v[60:61], v[24:25], v[176:177] op_sel:[0,0,0] op_sel_hi:[0,1,1] neg_lo:[1,0,0] neg_hi:[1,0,0]
    v_pk_fma_f32 v[178:179], v[60:61], v[26:27], v[178:179] op_sel:[0,0,0] op_sel_hi:[0,1,1] neg_lo:[1,0,0] neg_hi:[1,0,0]
    v_exp_f32 v175, v83
    v_pk_fma_f32 v[180:181], v[60:61], v[28:29], v[180:181] op_sel:[0,0,0] op_sel_hi:[0,1,1] neg_lo:[1,0,0] neg_hi:[1,0,0]
    v_rcp_f32 v156, v156
    v_pk_fma_f32 v[182:183], v[60:61], v[30:31], v[182:183] op_sel:[0,0,0] op_sel_hi:[0,1,1] neg_lo:[1,0,0] neg_hi:[1,0,0]
    v_rcp_f32 v157, v157
    v_pk_mul_f32 v[84:85], v[176:177], v[68:69] op_sel_hi:[1,0]
    v_rcp_f32 v158, v158
    v_pk_mul_f32 v[86:87], v[178:179], v[68:69] op_sel_hi:[1,0]
    v_rcp_f32 v159, v159
    v_pk_mul_f32 v[176:177], v[176:177], v[180:181]
    v_pk_mul_f32 v[178:179], v[178:179], v[182:183]
    v_pk_mul_f32 v[152:153], v[152:153], v[156:157]
    v_pk_mul_f32 v[154:155], v[154:155], v[158:159]
    v_exp_f32 v180, v84
    v_cvt_pk_bf16_f32 v150, v152, v153
    v_cvt_pk_bf16_f32 v151, v154, v155
    v_exp_f32 v181, v85
    buffer_store_dwordx4 v[148:151], v1, s[44:47], s72 offen offset:1024 sc1
    v_pk_fma_f32 v[172:173], v[172:173], v[76:77], v[76:77] op_sel_hi:[1,0,0]
    v_exp_f32 v182, v86
    v_pk_fma_f32 v[174:175], v[174:175], v[76:77], v[76:77] op_sel_hi:[1,0,0]
    v_pk_fma_f32 v[184:185], v[60:61], v[32:33], v[184:185] op_sel:[0,0,0] op_sel_hi:[0,1,1] neg_lo:[1,0,0] neg_hi:[1,0,0]
    v_exp_f32 v183, v87
    v_pk_fma_f32 v[186:187], v[60:61], v[34:35], v[186:187] op_sel:[0,0,0] op_sel_hi:[0,1,1] neg_lo:[1,0,0] neg_hi:[1,0,0]
    v_pk_fma_f32 v[188:189], v[60:61], v[36:37], v[188:189] op_sel:[0,0,0] op_sel_hi:[0,1,1] neg_lo:[1,0,0] neg_hi:[1,0,0]
    v_rcp_f32 v164, v164
    v_pk_fma_f32 v[190:191], v[60:61], v[38:39], v[190:191] op_sel:[0,0,0] op_sel_hi:[0,1,1] neg_lo:[1,0,0] neg_hi:[1,0,0]
    v_rcp_f32 v165, v165
    v_pk_mul_f32 v[80:81], v[184:185], v[68:69] op_sel_hi:[1,0]
    v_rcp_f32 v166, v166
    v_pk_mul_f32 v[82:83], v[186:187], v[68:69] op_sel_hi:[1,0]
    v_rcp_f32 v167, v167
    v_pk_mul_f32 v[184:185], v[184:185], v[188:189]
    v_pk_mul_f32 v[186:187], v[186:187], v[190:191]
    v_pk_mul_f32 v[160:161], v[160:161], v[164:165]
    v_pk_mul_f32 v[162:163], v[162:163], v[166:167]
    v_exp_f32 v188, v80
    v_cvt_pk_bf16_f32 v164, v160, v161
    v_cvt_pk_bf16_f32 v165, v162, v163
    v_exp_f32 v189, v81
    buffer_store_dwordx2 v[164:165], v4, s[44:47], s69 offen offset:1024 sc1
    v_pk_fma_f32 v[180:181], v[180:181], v[76:77], v[76:77] op_sel_hi:[1,0,0]
    v_exp_f32 v190, v82
    v_pk_fma_f32 v[182:183], v[182:183], v[76:77], v[76:77] op_sel_hi:[1,0,0]
    v_pk_fma_f32 v[192:193], v[60:61], v[40:41], v[192:193] op_sel:[0,0,0] op_sel_hi:[0,1,1] neg_lo:[1,0,0] neg_hi:[1,0,0]
    v_exp_f32 v191, v83
    v_pk_fma_f32 v[194:195], v[60:61], v[42:43], v[194:195] op_sel:[0,0,0] op_sel_hi:[0,1,1] neg_lo:[1,0,0] neg_hi:[1,0,0]
    v_pk_fma_f32 v[196:197], v[60:61], v[44:45], v[196:197] op_sel:[0,0,0] op_sel_hi:[0,1,1] neg_lo:[1,0,0] neg_hi:[1,0,0]
    v_rcp_f32 v172, v172
    v_pk_fma_f32 v[198:199], v[60:61], v[46:47], v[198:199] op_sel:[0,0,0] op_sel_hi:[0,1,1] neg_lo:[1,0,0] neg_hi:[1,0,0]
    v_rcp_f32 v173, v173
    v_pk_mul_f32 v[84:85], v[192:193], v[68:69] op_sel_hi:[1,0]
    v_rcp_f32 v174, v174
    v_pk_mul_f32 v[86:87], v[194:195], v[68:69] op_sel_hi:[1,0]
    v_rcp_f32 v175, v175
    v_pk_mul_f32 v[192:193], v[192:193], v[196:197]
    v_pk_mul_f32 v[194:195], v[194:195], v[198:199]
    v_pk_mul_f32 v[168:169], v[168:169], v[172:173]
    v_pk_mul_f32 v[170:171], v[170:171], v[174:175]
    v_exp_f32 v196, v84
    v_cvt_pk_bf16_f32 v172, v168, v169
    v_cvt_pk_bf16_f32 v173, v170, v171
    v_exp_f32 v197, v85
    v_pk_fma_f32 v[188:189], v[188:189], v[76:77], v[76:77] op_sel_hi:[1,0,0]
    v_pk_fma_f32 v[190:191], v[190:191], v[76:77], v[76:77] op_sel_hi:[1,0,0]
    v_exp_f32 v198, v86
    v_pk_fma_f32 v[200:201], v[60:61], v[48:49], v[200:201] op_sel:[0,0,0] op_sel_hi:[0,1,1] neg_lo:[1,0,0] neg_hi:[1,0,0]
    v_pk_fma_f32 v[202:203], v[60:61], v[50:51], v[202:203] op_sel:[0,0,0] op_sel_hi:[0,1,1] neg_lo:[1,0,0] neg_hi:[1,0,0]
    v_exp_f32 v199, v87
    v_pk_fma_f32 v[204:205], v[60:61], v[52:53], v[204:205] op_sel:[0,0,0] op_sel_hi:[0,1,1] neg_lo:[1,0,0] neg_hi:[1,0,0]
    v_rcp_f32 v180, v180
    v_pk_fma_f32 v[206:207], v[60:61], v[54:55], v[206:207] op_sel:[0,0,0] op_sel_hi:[0,1,1] neg_lo:[1,0,0] neg_hi:[1,0,0]
    v_rcp_f32 v181, v181
    v_pk_mul_f32 v[80:81], v[200:201], v[68:69] op_sel_hi:[1,0]
    v_rcp_f32 v182, v182
    v_pk_mul_f32 v[82:83], v[202:203], v[68:69] op_sel_hi:[1,0]
    v_rcp_f32 v183, v183
    v_pk_mul_f32 v[200:201], v[200:201], v[204:205]
    v_pk_mul_f32 v[202:203], v[202:203], v[206:207]
    v_pk_mul_f32 v[176:177], v[176:177], v[180:181]
    v_pk_mul_f32 v[178:179], v[178:179], v[182:183]
    v_exp_f32 v204, v80
    v_cvt_pk_bf16_f32 v174, v176, v177
    v_cvt_pk_bf16_f32 v175, v178, v179
    v_exp_f32 v205, v81
    buffer_store_dwordx4 v[172:175], v1, s[44:47], s71 offen offset:2048 sc1
    v_pk_fma_f32 v[196:197], v[196:197], v[76:77], v[76:77] op_sel_hi:[1,0,0]
    v_exp_f32 v206, v82
    v_pk_fma_f32 v[198:199], v[198:199], v[76:77], v[76:77] op_sel_hi:[1,0,0]
    v_pk_fma_f32 v[208:209], v[62:63], v[16:17], v[208:209] op_sel:[0,0,0] op_sel_hi:[0,1,1] neg_lo:[1,0,0] neg_hi:[1,0,0]
    v_exp_f32 v207, v83
    v_pk_fma_f32 v[210:211], v[62:63], v[18:19], v[210:211] op_sel:[0,0,0] op_sel_hi:[0,1,1] neg_lo:[1,0,0] neg_hi:[1,0,0]
    v_pk_fma_f32 v[212:213], v[62:63], v[20:21], v[212:213] op_sel:[0,0,0] op_sel_hi:[0,1,1] neg_lo:[1,0,0] neg_hi:[1,0,0]
    v_rcp_f32 v188, v188
    v_pk_fma_f32 v[214:215], v[62:63], v[22:23], v[214:215] op_sel:[0,0,0] op_sel_hi:[0,1,1] neg_lo:[1,0,0] neg_hi:[1,0,0]
    v_rcp_f32 v189, v189
    v_pk_mul_f32 v[84:85], v[208:209], v[70:71] op_sel_hi:[1,0]
    v_rcp_f32 v190, v190
    v_pk_mul_f32 v[86:87], v[210:211], v[70:71] op_sel_hi:[1,0]
    v_rcp_f32 v191, v191
    v_pk_mul_f32 v[208:209], v[208:209], v[212:213]
    v_pk_mul_f32 v[210:211], v[210:211], v[214:215]
    v_pk_mul_f32 v[184:185], v[184:185], v[188:189]
    v_pk_mul_f32 v[186:187], v[186:187], v[190:191]
    v_exp_f32 v212, v84
    v_cvt_pk_bf16_f32 v188, v184, v185
    v_cvt_pk_bf16_f32 v189, v186, v187
    v_exp_f32 v213, v85
    v_pk_fma_f32 v[204:205], v[204:205], v[76:77], v[76:77] op_sel_hi:[1,0,0]
    v_pk_fma_f32 v[206:207], v[206:207], v[76:77], v[76:77] op_sel_hi:[1,0,0]
    v_exp_f32 v214, v86
    v_pk_fma_f32 v[216:217], v[62:63], v[24:25], v[216:217] op_sel:[0,0,0] op_sel_hi:[0,1,1] neg_lo:[1,0,0] neg_hi:[1,0,0]
    v_pk_fma_f32 v[218:219], v[62:63], v[26:27], v[218:219] op_sel:[0,0,0] op_sel_hi:[0,1,1] neg_lo:[1,0,0] neg_hi:[1,0,0]
    v_exp_f32 v215, v87
    v_pk_fma_f32 v[220:221], v[62:63], v[28:29], v[220:221] op_sel:[0,0,0] op_sel_hi:[0,1,1] neg_lo:[1,0,0] neg_hi:[1,0,0]
    v_rcp_f32 v196, v196
    v_pk_fma_f32 v[222:223], v[62:63], v[30:31], v[222:223] op_sel:[0,0,0] op_sel_hi:[0,1,1] neg_lo:[1,0,0] neg_hi:[1,0,0]
    v_rcp_f32 v197, v197
    v_pk_mul_f32 v[80:81], v[216:217], v[70:71] op_sel_hi:[1,0]
    v_rcp_f32 v198, v198
    v_pk_mul_f32 v[82:83], v[218:219], v[70:71] op_sel_hi:[1,0]
    v_rcp_f32 v199, v199
    v_pk_mul_f32 v[216:217], v[216:217], v[220:221]
    v_pk_mul_f32 v[218:219], v[218:219], v[222:223]
    v_pk_mul_f32 v[192:193], v[192:193], v[196:197]
    v_pk_mul_f32 v[194:195], v[194:195], v[198:199]
    v_exp_f32 v220, v80
    v_cvt_pk_bf16_f32 v190, v192, v193
    v_cvt_pk_bf16_f32 v191, v194, v195
    v_exp_f32 v221, v81
    buffer_store_dwordx4 v[188:191], v1, s[44:47], s72 offen offset:2048 sc1
    v_pk_fma_f32 v[212:213], v[212:213], v[78:79], v[78:79] op_sel_hi:[1,0,0]
    v_exp_f32 v222, v82
    v_pk_fma_f32 v[214:215], v[214:215], v[78:79], v[78:79] op_sel_hi:[1,0,0]
    v_pk_fma_f32 v[224:225], v[62:63], v[32:33], v[224:225] op_sel:[0,0,0] op_sel_hi:[0,1,1] neg_lo:[1,0,0] neg_hi:[1,0,0]
    v_exp_f32 v223, v83
    v_pk_fma_f32 v[226:227], v[62:63], v[34:35], v[226:227] op_sel:[0,0,0] op_sel_hi:[0,1,1] neg_lo:[1,0,0] neg_hi:[1,0,0]
    v_pk_fma_f32 v[228:229], v[62:63], v[36:37], v[228:229] op_sel:[0,0,0] op_sel_hi:[0,1,1] neg_lo:[1,0,0] neg_hi:[1,0,0]
    v_rcp_f32 v204, v204
    v_pk_fma_f32 v[230:231], v[62:63], v[38:39], v[230:231] op_sel:[0,0,0] op_sel_hi:[0,1,1] neg_lo:[1,0,0] neg_hi:[1,0,0]
    v_rcp_f32 v205, v205
    v_pk_mul_f32 v[84:85], v[224:225], v[70:71] op_sel_hi:[1,0]
    v_rcp_f32 v206, v206
    v_pk_mul_f32 v[86:87], v[226:227], v[70:71] op_sel_hi:[1,0]
    v_rcp_f32 v207, v207
    v_pk_mul_f32 v[224:225], v[224:225], v[228:229]
    v_pk_mul_f32 v[226:227], v[226:227], v[230:231]
    v_pk_mul_f32 v[200:201], v[200:201], v[204:205]
    v_pk_mul_f32 v[202:203], v[202:203], v[206:207]
    v_exp_f32 v228, v84
    v_cvt_pk_bf16_f32 v204, v200, v201
    v_cvt_pk_bf16_f32 v205, v202, v203
    v_exp_f32 v229, v85
    buffer_store_dwordx2 v[204:205], v4, s[44:47], s69 offen offset:2048 sc1
    v_pk_fma_f32 v[220:221], v[220:221], v[78:79], v[78:79] op_sel_hi:[1,0,0]
    v_exp_f32 v230, v86
    v_pk_fma_f32 v[222:223], v[222:223], v[78:79], v[78:79] op_sel_hi:[1,0,0]
    v_pk_fma_f32 v[232:233], v[62:63], v[40:41], v[232:233] op_sel:[0,0,0] op_sel_hi:[0,1,1] neg_lo:[1,0,0] neg_hi:[1,0,0]
    v_exp_f32 v231, v87
    v_pk_fma_f32 v[234:235], v[62:63], v[42:43], v[234:235] op_sel:[0,0,0] op_sel_hi:[0,1,1] neg_lo:[1,0,0] neg_hi:[1,0,0]
    v_pk_fma_f32 v[236:237], v[62:63], v[44:45], v[236:237] op_sel:[0,0,0] op_sel_hi:[0,1,1] neg_lo:[1,0,0] neg_hi:[1,0,0]
    v_rcp_f32 v212, v212
    v_pk_fma_f32 v[238:239], v[62:63], v[46:47], v[238:239] op_sel:[0,0,0] op_sel_hi:[0,1,1] neg_lo:[1,0,0] neg_hi:[1,0,0]
    v_rcp_f32 v213, v213
    v_pk_mul_f32 v[80:81], v[232:233], v[70:71] op_sel_hi:[1,0]
    v_rcp_f32 v214, v214
    v_pk_mul_f32 v[82:83], v[234:235], v[70:71] op_sel_hi:[1,0]
    v_rcp_f32 v215, v215
    v_pk_mul_f32 v[232:233], v[232:233], v[236:237]
    v_pk_mul_f32 v[234:235], v[234:235], v[238:239]
    v_pk_mul_f32 v[208:209], v[208:209], v[212:213]
    v_pk_mul_f32 v[210:211], v[210:211], v[214:215]
    v_exp_f32 v236, v80
    v_cvt_pk_bf16_f32 v212, v208, v209
    v_cvt_pk_bf16_f32 v213, v210, v211
    v_exp_f32 v237, v81
    v_pk_fma_f32 v[228:229], v[228:229], v[78:79], v[78:79] op_sel_hi:[1,0,0]
    v_pk_fma_f32 v[230:231], v[230:231], v[78:79], v[78:79] op_sel_hi:[1,0,0]
    v_exp_f32 v238, v82
    v_pk_fma_f32 v[240:241], v[62:63], v[48:49], v[240:241] op_sel:[0,0,0] op_sel_hi:[0,1,1] neg_lo:[1,0,0] neg_hi:[1,0,0]
    v_pk_fma_f32 v[242:243], v[62:63], v[50:51], v[242:243] op_sel:[0,0,0] op_sel_hi:[0,1,1] neg_lo:[1,0,0] neg_hi:[1,0,0]
    v_exp_f32 v239, v83
    v_pk_fma_f32 v[244:245], v[62:63], v[52:53], v[244:245] op_sel:[0,0,0] op_sel_hi:[0,1,1] neg_lo:[1,0,0] neg_hi:[1,0,0]
    v_rcp_f32 v220, v220
    v_pk_fma_f32 v[246:247], v[62:63], v[54:55], v[246:247] op_sel:[0,0,0] op_sel_hi:[0,1,1] neg_lo:[1,0,0] neg_hi:[1,0,0]
    v_rcp_f32 v221, v221
    v_pk_mul_f32 v[84:85], v[240:241], v[70:71] op_sel_hi:[1,0]
    v_rcp_f32 v222, v222
    v_pk_mul_f32 v[86:87], v[242:243], v[70:71] op_sel_hi:[1,0]
    v_rcp_f32 v223, v223
    v_pk_mul_f32 v[240:241], v[240:241], v[244:245]
    v_pk_mul_f32 v[242:243], v[242:243], v[246:247]
    v_pk_mul_f32 v[216:217], v[216:217], v[220:221]
    v_exp_f32 v244, v84
    v_pk_mul_f32 v[218:219], v[218:219], v[222:223]
    v_exp_f32 v245, v85
    v_cvt_pk_bf16_f32 v214, v216, v217
    v_exp_f32 v246, v86
    v_cvt_pk_bf16_f32 v215, v218, v219
    v_exp_f32 v247, v87
    buffer_store_dwordx4 v[212:215], v1, s[44:47], s71 offen offset:3072 sc1
    v_rcp_f32 v228, v228
    v_pk_fma_f32 v[236:237], v[236:237], v[78:79], v[78:79] op_sel_hi:[1,0,0]
    v_rcp_f32 v229, v229
    v_pk_fma_f32 v[238:239], v[238:239], v[78:79], v[78:79] op_sel_hi:[1,0,0]
    v_rcp_f32 v230, v230
    v_rcp_f32 v231, v231
    s_nop 0
    v_pk_mul_f32 v[224:225], v[224:225], v[228:229]
    v_rcp_f32 v236, v236
    v_pk_mul_f32 v[226:227], v[226:227], v[230:231]
    v_rcp_f32 v237, v237
    v_cvt_pk_bf16_f32 v228, v224, v225
    v_rcp_f32 v238, v238
    v_cvt_pk_bf16_f32 v229, v226, v227
    v_rcp_f32 v239, v239
    v_pk_fma_f32 v[244:245], v[244:245], v[78:79], v[78:79] op_sel_hi:[1,0,0]
    v_pk_fma_f32 v[246:247], v[246:247], v[78:79], v[78:79] op_sel_hi:[1,0,0]
    s_nop 0
    v_pk_mul_f32 v[232:233], v[232:233], v[236:237]
    v_rcp_f32 v244, v244
    v_pk_mul_f32 v[234:235], v[234:235], v[238:239]
    v_rcp_f32 v245, v245
    v_cvt_pk_bf16_f32 v230, v232, v233
    v_rcp_f32 v246, v246
    v_cvt_pk_bf16_f32 v231, v234, v235
    v_rcp_f32 v247, v247
    buffer_store_dwordx4 v[228:231], v1, s[44:47], s72 offen offset:3072 sc1
    s_nop 0
    v_pk_mul_f32 v[240:241], v[240:241], v[244:245]
    v_pk_mul_f32 v[242:243], v[242:243], v[246:247]
    v_cvt_pk_bf16_f32 v244, v240, v241
    v_cvt_pk_bf16_f32 v245, v242, v243
    buffer_store_dwordx2 v[244:245], v4, s[44:47], s69 offen offset:3072 sc1
    s_nop 0
L_p2:
    s_add_u32 s68, s64, s63
    s_and_b32 s68, s68, 3
    s_mov_b32 s68, 0
    s_lshl_b32 s68, s68, 2
    s_lshr_b32 s68, 0x2103210, s68
    s_and_b32 s68, s68, 0xffff
    s_mul_i32 s69, s68, 0x10001
    s_cmp_eq_u32 0, 1
    s_cselect_b32 s70, 0x44444444, 0
    s_cselect_b32 s71, 0, 0x8888
    s_cselect_b32 s72, 0x4444, 0
    s_add_u32 s92, s70, 0x44440000
    s_add_u32 s93, s71, s68
    s_xor_b32 s70, s70, 0x44440000
    s_cmp_eq_u32 s3, 1
    s_cselect_b32 s92, s70, s92
    s_cselect_b32 s93, 0xba98, s93
    s_add_u32 s92, s92, s69
    v_add_u32 v246, 4096, v1
    s_add_u32 s40, s34, 0xf40000
    s_addc_u32 s41, s35, 0
    s_mov_b32 s42, 131072
    s_mov_b32 s43, 0x00020000
    s_lshl_b32 s71, s60, 2
    s_add_u32 s71, s71, s3
    s_lshl_b32 s71, s71, 5
    s_add_u32 s71, s71, s61
    s_lshl_b32 s71, s71, 7
    v_mov_b32 v14, s66
    v_lshlrev_b32 v15, 2, v0
    v_and_b32 v8, 15, v0
    v_lshrrev_b32 v9, 4, v0
    v_bfe_u32 v2, v0, 1, 3
    v_xor_b32 v2, v2, v9
    v_lshlrev_b32 v2, 4, v2
    v_lshl_add_u32 v2, v8, 7, v2
    v_xor_b32 v3, 64, v2
    s_cmp_lt_u32 s3, 2
    s_cbranch_scc1 L_p2_c
    v_mov_b32 v2, v1
    v_add_u32 v3, 1024, v1
L_p2_c:
    s_mul_i32 s76, s3, 10240
    v_add_u32 v2, s76, v2
    v_add_u32 v3, s76, v3
    v_add_u32 v4, s90, v2
    v_add_u32 v5, s90, v3
    v_add_u32 v6, s90, v4
    v_add_u32 v7, s90, v5
    s_lshl_b32 s68, s3, 2
    s_add_u32 s68, s68, s91
    v_mov_b32 v12, s68
    s_mov_b32 s87, s71
    s_waitcnt vmcnt(0)
    s_mov_b32 exec_hi, 0
    buffer_store_dword v14, v15, s[40:43], s87 offen sc1
    s_mov_b64 exec, -1
L_p2_r0:
    ds_read_b32 v13, v12 offset:0
    s_waitcnt lgkmcnt(0)
    v_readfirstlane_b32 s73, v13
    s_nop 0
    s_cmp_ge_u32 s73, 1
    s_cbranch_scc1 L_p2_r0x
    s_add_u32 s67, s67, 1
    s_cmp_lt_u32 s67, 0x2000000
    s_cbranch_scc1 L_p2_r0
L_p2_r0x:
    ds_read_b128 v[96:99], v4 offset:0
    ds_read_b128 v[100:103], v4 offset:2048
    ds_read_b128 v[104:107], v4 offset:4096
    ds_read_b128 v[108:111], v4 offset:6144
    ds_read_b128 v[112:115], v4 offset:8192
    ds_read_b128 v[116:119], v5 offset:0
    ds_read_b128 v[120:123], v5 offset:2048
    ds_read_b128 v[124:127], v5 offset:4096
    ds_read_b128 v[128:131], v5 offset:6144
    ds_read_b128 v[132:135], v5 offset:8192
    s_waitcnt lgkmcnt(0)
    v_mov_b32 v13, 1
    ds_write_b32 v12, v13 offset:16
L_p2_r1:
    ds_read_b32 v13, v12 offset:0
    s_waitcnt lgkmcnt(0)
    v_readfirstlane_b32 s73, v13
    s_nop 0
    s_cmp_ge_u32 s73, 2
    s_cbranch_scc1 L_p2_r1x
    s_add_u32 s67, s67, 1
    s_cmp_lt_u32 s67, 0x2000000
    s_cbranch_scc1 L_p2_r1
L_p2_r1x:
    ds_read_b128 v[136:139], v6 offset:0
    ds_read_b128 v[140:143], v6 offset:2048
    ds_read_b128 v[144:147], v6 offset:4096
    ds_read_b128 v[148:151], v6 offset:6144
    ds_read_b128 v[152:155], v6 offset:8192
    ds_read_b128 v[156:159], v7 offset:0
    ds_read_b128 v[160:163], v7 offset:2048
    ds_read_b128 v[164:167], v7 offset:4096
    ds_read_b128 v[168:171], v7 offset:6144
    ds_read_b128 v[172:175], v7 offset:8192
    s_waitcnt lgkmcnt(0)
    v_mov_b32 v13, 2
    ds_write_b32 v12, v13 offset:16
    v_add_u32 v10, s76, v1
    v_add_u32 v11, s90, v10
    s_mov_b32 s68, 0x160c0600
    s_mov_b32 s69, 0x09090605
    s_lshl_b32 s70, s3, 3
    s_lshr_b32 s68, s68, s70
    s_lshr_b32 s69, s69, s70
    s_and_b32 s68, s68, 0xff
    s_and_b32 s69, s69, 0xff
    v_min_u32 v244, s69, v0
    v_lshlrev_b32 v244, 7, v244
    s_lshl_b32 s70, s63, 5
    s_add_u32 s68, s68, s70
    s_lshl_b32 s68, s68, 7
    s_mul_i32 s70, s63, 385024
    s_add_u32 s44, s34, s70
    s_addc_u32 s45, s35, 0
    s_mov_b32 s46, 385024
    s_mov_b32 s47, 0x00020000
    s_mul_i32 s74, s3, 98304
    s_lshr_b32 s69, s3, 1
    s_lshl_b32 s69, s69, 13
    s_sub_u32 s74, s74, s69
    s_mov_b32 s80, 0x66666666
    s_cmp_eq_u32 s3, 1
    s_cselect_b32 s80, 0x77777777, s80
    s_cmp_eq_u32 s3, 2
    s_cselect_b32 s80, 0xaaaaaaaa, s80
    s_cmp_eq_u32 s3, 3
    s_cselect_b32 s80, 0xaaaaaaaa, s80
    s_mov_b32 s81, 0x6666
    s_cmp_eq_u32 s3, 1
    s_cselect_b32 s81, 0x7777, s81
    s_cmp_eq_u32 s3, 2
    s_cselect_b32 s81, 0xaaaa, s81
    s_cmp_eq_u32 s3, 3
    s_cselect_b32 s81, 0xaaaa, s81
    s_mov_b32 s84, s68
    s_bfe_u32 s82, s80, 0x40004
L_p2_poll:
    buffer_load_dword v245, v244, s[40:43], s84 offen sc1
    s_waitcnt vmcnt(0)
    v_cmp_ne_u32 vcc, s66, v245
    s_nop 1
    s_ff1_i32_b64 s83, vcc
    s_cmp_ge_u32 s83, s82
    s_cbranch_scc1 L_p2_go
    s_sleep 2
    s_add_u32 s67, s67, 16
    s_cmp_lt_u32 s67, 0x2000000
    s_cbranch_scc1 L_p2_poll
L_p2_go:
    s_bfe_u32 s85, s92, 0x40000
    s_lshl_b32 s85, s85, 13
    s_add_u32 s85, s85, s74
    buffer_load_dwordx4 v[176:179], v1, s[44:47], s85 offen offset:0 sc1
    buffer_load_dwordx4 v[180:183], v1, s[44:47], s85 offen offset:1024 sc1
    buffer_load_dwordx4 v[184:187], v1, s[44:47], s85 offen offset:2048 sc1
    buffer_load_dwordx4 v[188:191], v1, s[44:47], s85 offen offset:3072 sc1
    buffer_load_dwordx4 v[192:195], v246, s[44:47], s85 offen offset:0 sc1
    buffer_load_dwordx4 v[196:199], v246, s[44:47], s85 offen offset:1024 sc1
    buffer_load_dwordx4 v[200:203], v246, s[44:47], s85 offen offset:2048 sc1
    buffer_load_dwordx4 v[204:207], v246, s[44:47], s85 offen offset:3072 sc1
    s_bfe_u32 s86, s92, 0x40004
    s_lshl_b32 s86, s86, 13
    s_add_u32 s86, s86, s74
    buffer_load_dwordx4 v[208:211], v1, s[44:47], s86 offen offset:0 sc1
    buffer_load_dwordx4 v[212:215], v1, s[44:47], s86 offen offset:1024 sc1
    buffer_load_dwordx4 v[216:219], v1, s[44:47], s86 offen offset:2048 sc1
    buffer_load_dwordx4 v[220:223], v1, s[44:47], s86 offen offset:3072 sc1
    s_waitcnt vmcnt(8)
    v_mfma_f32_16x16x32_bf16 v[16:19], v[96:99], v[176:179], 0
    v_mfma_f32_16x16x32_bf16 v[36:39], v[96:99], v[180:183], 0
    v_mfma_f32_16x16x32_bf16 v[56:59], v[96:99], v[184:187], 0
    v_mfma_f32_16x16x32_bf16 v[76:79], v[96:99], v[188:191], 0
    buffer_load_dwordx4 v[224:227], v246, s[44:47], s86 offen offset:0 sc1
    v_mfma_f32_16x16x32_bf16 v[20:23], v[100:103], v[176:179], 0
    v_mfma_f32_16x16x32_bf16 v[40:43], v[100:103], v[180:183], 0
    v_mfma_f32_16x16x32_bf16 v[60:63], v[100:103], v[184:187], 0
    v_mfma_f32_16x16x32_bf16 v[80:83], v[100:103], v[188:191], 0
    buffer_load_dwordx4 v[228:231], v246, s[44:47], s86 offen offset:1024 sc1
    v_mfma_f32_16x16x32_bf16 v[24:27], v[104:107], v[176:179], 0
    v_mfma_f32_16x16x32_bf16 v[44:47], v[104:107], v[180:183], 0
    v_mfma_f32_16x16x32_bf16 v[64:67], v[104:107], v[184:187], 0
    v_mfma_f32_16x16x32_bf16 v[84:87], v[104:107], v[188:191], 0
    buffer_load_dwordx4 v[232:235], v246, s[44:47], s86 offen offset:2048 sc1
    v_mfma_f32_16x16x32_bf16 v[28:31], v[108:111], v[176:179], 0
    v_mfma_f32_16x16x32_bf16 v[48:51], v[108:111], v[180:183], 0
    v_mfma_f32_16x16x32_bf16 v[68:71], v[108:111], v[184:187], 0
    v_mfma_f32_16x16x32_bf16 v[88:91], v[108:111], v[188:191], 0
    buffer_load_dwordx4 v[236:239], v246, s[44:47], s86 offen offset:3072 sc1
    v_mfma_f32_16x16x32_bf16 v[32:35], v[112:115], v[176:179], 0
    v_mfma_f32_16x16x32_bf16 v[52:55], v[112:115], v[180:183], 0
    v_mfma_f32_16x16x32_bf16 v[72:75], v[112:115], v[184:187], 0
    v_mfma_f32_16x16x32_bf16 v[92:95], v[112:115], v[188:191], 0
    s_waitcnt vmcnt(8)
    v_mfma_f32_16x16x32_bf16 v[16:19], v[116:119], v[192:195], v[16:19]
    v_mfma_f32_16x16x32_bf16 v[36:39], v[116:119], v[196:199], v[36:39]
    s_bfe_u32 s85, s92, 0x40008
    s_lshl_b32 s85, s85, 13
    s_add_u32 s85, s85, s74
    buffer_load_dwordx4 v[176:179], v1, s[44:47], s85 offen offset:0 sc1
    v_mfma_f32_16x16x32_bf16 v[56:59], v[116:119], v[200:203], v[56:59]
    v_mfma_f32_16x16x32_bf16 v[76:79], v[116:119], v[204:207], v[76:79]
    v_mfma_f32_16x16x32_bf16 v[20:23], v[120:123], v[192:195], v[20:23]
    v_mfma_f32_16x16x32_bf16 v[40:43], v[120:123], v[196:199], v[40:43]
    buffer_load_dwordx4 v[180:183], v1, s[44:47], s85 offen offset:1024 sc1
    v_mfma_f32_16x16x32_bf16 v[60:63], v[120:123], v[200:203], v[60:63]
    v_mfma_f32_16x16x32_bf16 v[80:83], v[120:123], v[204:207], v[80:83]
    v_mfma_f32_16x16x32_bf16 v[24:27], v[124:127], v[192:195], v[24:27]
    v_mfma_f32_16x16x32_bf16 v[44:47], v[124:127], v[196:199], v[44:47]
    buffer_load_dwordx4 v[184:187], v1, s[44:47], s85 offen offset:2048 sc1
    v_mfma_f32_16x16x32_bf16 v[64:67], v[124:127], v[200:203], v[64:67]
    v_mfma_f32_16x16x32_bf16 v[84:87], v[124:127], v[204:207], v[84:87]
    v_mfma_f32_16x16x32_bf16 v[28:31], v[128:131], v[192:195], v[28:31]
    v_mfma_f32_16x16x32_bf16 v[48:51], v[128:131], v[196:199], v[48:51]
    buffer_load_dwordx4 v[188:191], v1, s[44:47], s85 offen offset:3072 sc1
    v_mfma_f32_16x16x32_bf16 v[68:71], v[128:131], v[200:203], v[68:71]
    ds_read_b32 v9, v12
    v_mfma_f32_16x16x32_bf16 v[88:91], v[128:131], v[204:207], v[88:91]
    v_mfma_f32_16x16x32_bf16 v[32:35], v[132:135], v[192:195], v[32:35]
    v_mfma_f32_16x16x32_bf16 v[52:55], v[132:135], v[196:199], v[52:55]
    v_mfma_f32_16x16x32_bf16 v[72:75], v[132:135], v[200:203], v[72:75]
    v_mfma_f32_16x16x32_bf16 v[92:95], v[132:135], v[204:207], v[92:95]
    s_waitcnt vmcnt(8)
    v_mfma_f32_16x16x32_bf16 v[16:19], v[136:139], v[208:211], v[16:19]
    s_waitcnt lgkmcnt(0)
    v_cmp_gt_u32 vcc, 3, v9
    v_mfma_f32_16x16x32_bf16 v[36:39], v[136:139], v[212:215], v[36:39]
    s_cbranch_vccnz L_p2_r2a
L_p2_r2b:
    v_mfma_f32_16x16x32_bf16 v[56:59], v[136:139], v[216:219], v[56:59]
    ds_read_b128 v[96:99], v2 offset:0
    v_mfma_f32_16x16x32_bf16 v[76:79], v[136:139], v[220:223], v[76:79]
    buffer_load_dwordx4 v[192:195], v246, s[44:47], s85 offen offset:0 sc1
    v_mfma_f32_16x16x32_bf16 v[20:23], v[140:143], v[208:211], v[20:23]
    ds_read_b128 v[100:103], v2 offset:2048
    v_mfma_f32_16x16x32_bf16 v[40:43], v[140:143], v[212:215], v[40:43]
    v_mfma_f32_16x16x32_bf16 v[60:63], v[140:143], v[216:219], v[60:63]
    ds_read_b128 v[104:107], v2 offset:4096
    v_mfma_f32_16x16x32_bf16 v[80:83], v[140:143], v[220:223], v[80:83]
    buffer_load_dwordx4 v[196:199], v246, s[44:47], s85 offen offset:1024 sc1
    v_mfma_f32_16x16x32_bf16 v[24:27], v[144:147], v[208:211], v[24:27]
    ds_read_b128 v[108:111], v2 offset:6144
    v_mfma_f32_16x16x32_bf16 v[44:47], v[144:147], v[212:215], v[44:47]
    v_mfma_f32_16x16x32_bf16 v[64:67], v[144:147], v[216:219], v[64:67]
    ds_read_b128 v[112:115], v2 offset:8192
    v_mfma_f32_16x16x32_bf16 v[84:87], v[144:147], v[220:223], v[84:87]
    buffer_load_dwordx4 v[200:203], v246, s[44:47], s85 offen offset:2048 sc1
    v_mfma_f32_16x16x32_bf16 v[28:31], v[148:151], v[208:211], v[28:31]
    ds_read_b128 v[116:119], v3 offset:0
    v_mfma_f32_16x16x32_bf16 v[48:51], v[148:151], v[212:215], v[48:51]
    v_mfma_f32_16x16x32_bf16 v[68:71], v[148:151], v[216:219], v[68:71]
    ds_read_b128 v[120:123], v3 offset:2048
    v_mfma_f32_16x16x32_bf16 v[88:91], v[148:151], v[220:223], v[88:91]
    buffer_load_dwordx4 v[204:207], v246, s[44:47], s85 offen offset:3072 sc1
    v_mfma_f32_16x16x32_bf16 v[32:35], v[152:155], v[208:211], v[32:35]
    ds_read_b128 v[124:127], v3 offset:4096
    v_mfma_f32_16x16x32_bf16 v[52:55], v[152:155], v[212:215], v[52:55]
    v_mfma_f32_16x16x32_bf16 v[72:75], v[152:155], v[216:219], v[72:75]
    ds_read_b128 v[128:131], v3 offset:6144
    v_mfma_f32_16x16x32_bf16 v[92:95], v[152:155], v[220:223], v[92:95]
    s_waitcnt vmcnt(8)
    v_mfma_f32_16x16x32_bf16 v[16:19], v[156:159], v[224:227], v[16:19]
    ds_read_b128 v[132:135], v3 offset:8192
    v_mfma_f32_16x16x32_bf16 v[36:39], v[156:159], v[228:231], v[36:39]
    s_bfe_u32 s86, s92, 0x4000c
    s_lshl_b32 s86, s86, 13
    s_add_u32 s86, s86, s74
    buffer_load_dwordx4 v[208:211], v1, s[44:47], s86 offen offset:0 sc1
    v_mfma_f32_16x16x32_bf16 v[56:59], v[156:159], v[232:235], v[56:59]
    v_mfma_f32_16x16x32_bf16 v[76:79], v[156:159], v[236:239], v[76:79]
    v_mfma_f32_16x16x32_bf16 v[20:23], v[160:163], v[224:227], v[20:23]
    v_mfma_f32_16x16x32_bf16 v[40:43], v[160:163], v[228:231], v[40:43]
    buffer_load_dwordx4 v[212:215], v1, s[44:47], s86 offen offset:1024 sc1
    v_mfma_f32_16x16x32_bf16 v[60:63], v[160:163], v[232:235], v[60:63]
    v_mfma_f32_16x16x32_bf16 v[80:83], v[160:163], v[236:239], v[80:83]
    v_mfma_f32_16x16x32_bf16 v[24:27], v[164:167], v[224:227], v[24:27]
    v_mfma_f32_16x16x32_bf16 v[44:47], v[164:167], v[228:231], v[44:47]
    buffer_load_dwordx4 v[216:219], v1, s[44:47], s86 offen offset:2048 sc1
    v_mfma_f32_16x16x32_bf16 v[64:67], v[164:167], v[232:235], v[64:67]
    s_waitcnt lgkmcnt(0)
    v_mov_b32 v13, 3
    v_mfma_f32_16x16x32_bf16 v[84:87], v[164:167], v[236:239], v[84:87]
    ds_write_b32 v12, v13 offset:16
    v_mfma_f32_16x16x32_bf16 v[28:31], v[168:171], v[224:227], v[28:31]
    v_mfma_f32_16x16x32_bf16 v[48:51], v[168:171], v[228:231], v[48:51]
    buffer_load_dwordx4 v[220:223], v1, s[44:47], s86 offen offset:3072 sc1
    v_mfma_f32_16x16x32_bf16 v[68:71], v[168:171], v[232:235], v[68:71]
    ds_read_b32 v9, v12
    v_mfma_f32_16x16x32_bf16 v[88:91], v[168:171], v[236:239], v[88:91]
    v_mfma_f32_16x16x32_bf16 v[32:35], v[172:175], v[224:227], v[32:35]
    v_mfma_f32_16x16x32_bf16 v[52:55], v[172:175], v[228:231], v[52:55]
    v_mfma_f32_16x16x32_bf16 v[72:75], v[172:175], v[232:235], v[72:75]
    v_mfma_f32_16x16x32_bf16 v[92:95], v[172:175], v[236:239], v[92:95]
    s_waitcnt vmcnt(8)
    v_mfma_f32_16x16x32_bf16 v[16:19], v[96:99], v[176:179], v[16:19]
    s_waitcnt lgkmcnt(0)
    v_cmp_gt_u32 vcc, 4, v9
    v_mfma_f32_16x16x32_bf16 v[36:39], v[96:99], v[180:183], v[36:39]
    s_cbranch_vccnz L_p2_r3a
L_p2_r3b:
    v_mfma_f32_16x16x32_bf16 v[56:59], v[96:99], v[184:187], v[56:59]
    ds_read_b128 v[136:139], v4 offset:0
    v_mfma_f32_16x16x32_bf16 v[76:79], v[96:99], v[188:191], v[76:79]
    buffer_load_dwordx4 v[224:227], v246, s[44:47], s86 offen offset:0 sc1
    v_mfma_f32_16x16x32_bf16 v[20:23], v[100:103], v[176:179], v[20:23]
    ds_read_b128 v[140:143], v4 offset:2048
    v_mfma_f32_16x16x32_bf16 v[40:43], v[100:103], v[180:183], v[40:43]
    v_mfma_f32_16x16x32_bf16 v[60:63], v[100:103], v[184:187], v[60:63]
    ds_read_b128 v[144:147], v4 offset:4096
    v_mfma_f32_16x16x32_bf16 v[80:83], v[100:103], v[188:191], v[80:83]
    buffer_load_dwordx4 v[228:231], v246, s[44:47], s86 offen offset:1024 sc1
    v_mfma_f32_16x16x32_bf16 v[24:27], v[104:107], v[176:179], v[24:27]
    ds_read_b128 v[148:151], v4 offset:6144
    v_mfma_f32_16x16x32_bf16 v[44:47], v[104:107], v[180:183], v[44:47]
    v_mfma_f32_16x16x32_bf16 v[64:67], v[104:107], v[184:187], v[64:67]
    ds_read_b128 v[152:155], v4 offset:8192
    v_mfma_f32_16x16x32_bf16 v[84:87], v[104:107], v[188:191], v[84:87]
    buffer_load_dwordx4 v[232:235], v246, s[44:47], s86 offen offset:2048 sc1
    v_mfma_f32_16x16x32_bf16 v[28:31], v[108:111], v[176:179], v[28:31]
    ds_read_b128 v[156:159], v5 offset:0
    v_mfma_f32_16x16x32_bf16 v[48:51], v[108:111], v[180:183], v[48:51]
    v_mfma_f32_16x16x32_bf16 v[68:71], v[108:111], v[184:187], v[68:71]
    ds_read_b128 v[160:163], v5 offset:2048
    v_mfma_f32_16x16x32_bf16 v[88:91], v[108:111], v[188:191], v[88:91]
    buffer_load_dwordx4 v[236:239], v246, s[44:47], s86 offen offset:3072 sc1
    v_mfma_f32_16x16x32_bf16 v[32:35], v[112:115], v[176:179], v[32:35]
    ds_read_b128 v[164:167], v5 offset:4096
    v_mfma_f32_16x16x32_bf16 v[52:55], v[112:115], v[180:183], v[52:55]
    v_mfma_f32_16x16x32_bf16 v[72:75], v[112:115], v[184:187], v[72:75]
    ds_read_b128 v[168:171], v5 offset:6144
    v_mfma_f32_16x16x32_bf16 v[92:95], v[112:115], v[188:191], v[92:95]
    s_waitcnt vmcnt(8)
    v_mfma_f32_16x16x32_bf16 v[16:19], v[116:119], v[192:195], v[16:19]
    ds_read_b128 v[172:175], v5 offset:8192
    v_mfma_f32_16x16x32_bf16 v[36:39], v[116:119], v[196:199], v[36:39]
    s_bfe_u32 s85, s92, 0x40010
    s_lshl_b32 s85, s85, 13
    s_add_u32 s85, s85, s74
    buffer_load_dwordx4 v[176:179], v1, s[44:47], s85 offen offset:0 sc1
    v_mfma_f32_16x16x32_bf16 v[56:59], v[116:119], v[200:203], v[56:59]
    v_mfma_f32_16x16x32_bf16 v[76:79], v[116:119], v[204:207], v[76:79]
    v_mfma_f32_16x16x32_bf16 v[20:23], v[120:123], v[192:195], v[20:23]
    v_mfma_f32_16x16x32_bf16 v[40:43], v[120:123], v[196:199], v[40:43]
    buffer_load_dwordx4 v[180:183], v1, s[44:47], s85 offen offset:1024 sc1
    v_mfma_f32_16x16x32_bf16 v[60:63], v[120:123], v[200:203], v[60:63]
    v_mfma_f32_16x16x32_bf16 v[80:83], v[120:123], v[204:207], v[80:83]
    v_mfma_f32_16x16x32_bf16 v[24:27], v[124:127], v[192:195], v[24:27]
    v_mfma_f32_16x16x32_bf16 v[44:47], v[124:127], v[196:199], v[44:47]
    buffer_load_dwordx4 v[184:187], v1, s[44:47], s85 offen offset:2048 sc1
    v_mfma_f32_16x16x32_bf16 v[64:67], v[124:127], v[200:203], v[64:67]
    s_waitcnt lgkmcnt(0)
    v_mov_b32 v13, 4
    v_mfma_f32_16x16x32_bf16 v[84:87], v[124:127], v[204:207], v[84:87]
    ds_write_b32 v12, v13 offset:16
    v_mfma_f32_16x16x32_bf16 v[28:31], v[128:131], v[192:195], v[28:31]
    v_mfma_f32_16x16x32_bf16 v[48:51], v[128:131], v[196:199], v[48:51]
    buffer_load_dwordx4 v[188:191], v1, s[44:47], s85 offen offset:3072 sc1
    v_mfma_f32_16x16x32_bf16 v[68:71], v[128:131], v[200:203], v[68:71]
    ds_read_b32 v9, v12
    v_mfma_f32_16x16x32_bf16 v[88:91], v[128:131], v[204:207], v[88:91]
    v_mfma_f32_16x16x32_bf16 v[32:35], v[132:135], v[192:195], v[32:35]
    v_mfma_f32_16x16x32_bf16 v[52:55], v[132:135], v[196:199], v[52:55]
    v_mfma_f32_16x16x32_bf16 v[72:75], v[132:135], v[200:203], v[72:75]
    v_mfma_f32_16x16x32_bf16 v[92:95], v[132:135], v[204:207], v[92:95]
    s_waitcnt vmcnt(8)
    v_mfma_f32_16x16x32_bf16 v[16:19], v[136:139], v[208:211], v[16:19]
    s_waitcnt lgkmcnt(0)
    v_cmp_gt_u32 vcc, 5, v9
    v_mfma_f32_16x16x32_bf16 v[36:39], v[136:139], v[212:215], v[36:39]
    s_cbranch_vccnz L_p2_r4a
L_p2_r4b:
    v_mfma_f32_16x16x32_bf16 v[56:59], v[136:139], v[216:219], v[56:59]
    ds_read_b128 v[96:99], v6 offset:0
    v_mfma_f32_16x16x32_bf16 v[76:79], v[136:139], v[220:223], v[76:79]
    buffer_load_dwordx4 v[192:195], v246, s[44:47], s85 offen offset:0 sc1
    v_mfma_f32_16x16x32_bf16 v[20:23], v[140:143], v[208:211], v[20:23]
    ds_read_b128 v[100:103], v6 offset:2048
    v_mfma_f32_16x16x32_bf16 v[40:43], v[140:143], v[212:215], v[40:43]
    v_mfma_f32_16x16x32_bf16 v[60:63], v[140:143], v[216:219], v[60:63]
    ds_read_b128 v[104:107], v6 offset:4096
    v_mfma_f32_16x16x32_bf16 v[80:83], v[140:143], v[220:223], v[80:83]
    buffer_load_dwordx4 v[196:199], v246, s[44:47], s85 offen offset:1024 sc1
    v_mfma_f32_16x16x32_bf16 v[24:27], v[144:147], v[208:211], v[24:27]
    ds_read_b128 v[108:111], v6 offset:6144
    v_mfma_f32_16x16x32_bf16 v[44:47], v[144:147], v[212:215], v[44:47]
    v_mfma_f32_16x16x32_bf16 v[64:67], v[144:147], v[216:219], v[64:67]
    ds_read_b128 v[112:115], v6 offset:8192
    v_mfma_f32_16x16x32_bf16 v[84:87], v[144:147], v[220:223], v[84:87]
    buffer_load_dwordx4 v[200:203], v246, s[44:47], s85 offen offset:2048 sc1
    v_mfma_f32_16x16x32_bf16 v[28:31], v[148:151], v[208:211], v[28:31]
    ds_read_b128 v[116:119], v7 offset:0
    v_mfma_f32_16x16x32_bf16 v[48:51], v[148:151], v[212:215], v[48:51]
    v_mfma_f32_16x16x32_bf16 v[68:71], v[148:151], v[216:219], v[68:71]
    ds_read_b128 v[120:123], v7 offset:2048
    v_mfma_f32_16x16x32_bf16 v[88:91], v[148:151], v[220:223], v[88:91]
    buffer_load_dwordx4 v[204:207], v246, s[44:47], s85 offen offset:3072 sc1
    v_mfma_f32_16x16x32_bf16 v[32:35], v[152:155], v[208:211], v[32:35]
    ds_read_b128 v[124:127], v7 offset:4096
    v_mfma_f32_16x16x32_bf16 v[52:55], v[152:155], v[212:215], v[52:55]
    v_mfma_f32_16x16x32_bf16 v[72:75], v[152:155], v[216:219], v[72:75]
    ds_read_b128 v[128:131], v7 offset:6144
    v_mfma_f32_16x16x32_bf16 v[92:95], v[152:155], v[220:223], v[92:95]
    s_waitcnt vmcnt(8)
    v_mfma_f32_16x16x32_bf16 v[16:19], v[156:159], v[224:227], v[16:19]
    ds_read_b128 v[132:135], v7 offset:8192
    v_mfma_f32_16x16x32_bf16 v[36:39], v[156:159], v[228:231], v[36:39]
    s_bfe_u32 s86, s92, 0x40014
    s_lshl_b32 s86, s86, 13
    s_add_u32 s86, s86, s74
    buffer_load_dwordx4 v[208:211], v1, s[44:47], s86 offen offset:0 sc1
    v_mfma_f32_16x16x32_bf16 v[56:59], v[156:159], v[232:235], v[56:59]
    v_mfma_f32_16x16x32_bf16 v[76:79], v[156:159], v[236:239], v[76:79]
    v_mfma_f32_16x16x32_bf16 v[20:23], v[160:163], v[224:227], v[20:23]
    v_mfma_f32_16x16x32_bf16 v[40:43], v[160:163], v[228:231], v[40:43]
    buffer_load_dwordx4 v[212:215], v1, s[44:47], s86 offen offset:1024 sc1
    v_mfma_f32_16x16x32_bf16 v[60:63], v[160:163], v[232:235], v[60:63]
    v_mfma_f32_16x16x32_bf16 v[80:83], v[160:163], v[236:239], v[80:83]
    v_mfma_f32_16x16x32_bf16 v[24:27], v[164:167], v[224:227], v[24:27]
    v_mfma_f32_16x16x32_bf16 v[44:47], v[164:167], v[228:231], v[44:47]
    buffer_load_dwordx4 v[216:219], v1, s[44:47], s86 offen offset:2048 sc1
    v_mfma_f32_16x16x32_bf16 v[64:67], v[164:167], v[232:235], v[64:67]
    s_waitcnt lgkmcnt(0)
    v_mov_b32 v13, 5
    v_mfma_f32_16x16x32_bf16 v[84:87], v[164:167], v[236:239], v[84:87]
    ds_write_b32 v12, v13 offset:16
    v_mfma_f32_16x16x32_bf16 v[28:31], v[168:171], v[224:227], v[28:31]
    v_mfma_f32_16x16x32_bf16 v[48:51], v[168:171], v[228:231], v[48:51]
    buffer_load_dwordx4 v[220:223], v1, s[44:47], s86 offen offset:3072 sc1
    v_mfma_f32_16x16x32_bf16 v[68:71], v[168:171], v[232:235], v[68:71]
    ds_read_b32 v9, v12
    v_mfma_f32_16x16x32_bf16 v[88:91], v[168:171], v[236:239], v[88:91]
    v_mfma_f32_16x16x32_bf16 v[32:35], v[172:175], v[224:227], v[32:35]
    v_mfma_f32_16x16x32_bf16 v[52:55], v[172:175], v[228:231], v[52:55]
    v_mfma_f32_16x16x32_bf16 v[72:75], v[172:175], v[232:235], v[72:75]
    v_mfma_f32_16x16x32_bf16 v[92:95], v[172:175], v[236:239], v[92:95]
    s_waitcnt vmcnt(8)
    v_mfma_f32_16x16x32_bf16 v[16:19], v[96:99], v[176:179], v[16:19]
    s_waitcnt lgkmcnt(0)
    v_cmp_gt_u32 vcc, 6, v9
    v_mfma_f32_16x16x32_bf16 v[36:39], v[96:99], v[180:183], v[36:39]
    s_cbranch_vccnz L_p2_r5a
L_p2_r5b:
    v_mfma_f32_16x16x32_bf16 v[56:59], v[96:99], v[184:187], v[56:59]
    ds_read_b128 v[136:139], v2 offset:0
    v_mfma_f32_16x16x32_bf16 v[76:79], v[96:99], v[188:191], v[76:79]
    buffer_load_dwordx4 v[224:227], v246, s[44:47], s86 offen offset:0 sc1
    v_mfma_f32_16x16x32_bf16 v[20:23], v[100:103], v[176:179], v[20:23]
    ds_read_b128 v[140:143], v2 offset:2048
    v_mfma_f32_16x16x32_bf16 v[40:43], v[100:103], v[180:183], v[40:43]
    v_mfma_f32_16x16x32_bf16 v[60:63], v[100:103], v[184:187], v[60:63]
    ds_read_b128 v[144:147], v2 offset:4096
    v_mfma_f32_16x16x32_bf16 v[80:83], v[100:103], v[188:191], v[80:83]
    buffer_load_dwordx4 v[228:231], v246, s[44:47], s86 offen offset:1024 sc1
    v_mfma_f32_16x16x32_bf16 v[24:27], v[104:107], v[176:179], v[24:27]
    ds_read_b128 v[148:151], v2 offset:6144
    v_mfma_f32_16x16x32_bf16 v[44:47], v[104:107], v[180:183], v[44:47]
    v_mfma_f32_16x16x32_bf16 v[64:67], v[104:107], v[184:187], v[64:67]
    ds_read_b128 v[152:155], v2 offset:8192
    v_mfma_f32_16x16x32_bf16 v[84:87], v[104:107], v[188:191], v[84:87]
    buffer_load_dwordx4 v[232:235], v246, s[44:47], s86 offen offset:2048 sc1
    v_mfma_f32_16x16x32_bf16 v[28:31], v[108:111], v[176:179], v[28:31]
    ds_read_b128 v[156:159], v3 offset:0
    v_mfma_f32_16x16x32_bf16 v[48:51], v[108:111], v[180:183], v[48:51]
    v_mfma_f32_16x16x32_bf16 v[68:71], v[108:111], v[184:187], v[68:71]
    ds_read_b128 v[160:163], v3 offset:2048
    v_mfma_f32_16x16x32_bf16 v[88:91], v[108:111], v[188:191], v[88:91]
    buffer_load_dwordx4 v[236:239], v246, s[44:47], s86 offen offset:3072 sc1
    v_mfma_f32_16x16x32_bf16 v[32:35], v[112:115], v[176:179], v[32:35]
    ds_read_b128 v[164:167], v3 offset:4096
    v_mfma_f32_16x16x32_bf16 v[52:55], v[112:115], v[180:183], v[52:55]
    v_mfma_f32_16x16x32_bf16 v[72:75], v[112:115], v[184:187], v[72:75]
    ds_read_b128 v[168:171], v3 offset:6144
    v_mfma_f32_16x16x32_bf16 v[92:95], v[112:115], v[188:191], v[92:95]
    s_waitcnt vmcnt(8)
    v_mfma_f32_16x16x32_bf16 v[16:19], v[116:119], v[192:195], v[16:19]
    ds_read_b128 v[172:175], v3 offset:8192
    v_mfma_f32_16x16x32_bf16 v[36:39], v[116:119], v[196:199], v[36:39]
    s_bfe_u32 s85, s92, 0x40018
    s_lshl_b32 s85, s85, 13
    s_add_u32 s85, s85, s74
    buffer_load_dwordx4 v[176:179], v1, s[44:47], s85 offen offset:0 sc1
    v_mfma_f32_16x16x32_bf16 v[56:59], v[116:119], v[200:203], v[56:59]
    v_mfma_f32_16x16x32_bf16 v[76:79], v[116:119], v[204:207], v[76:79]
    v_mfma_f32_16x16x32_bf16 v[20:23], v[120:123], v[192:195], v[20:23]
    v_mfma_f32_16x16x32_bf16 v[40:43], v[120:123], v[196:199], v[40:43]
    buffer_load_dwordx4 v[180:183], v1, s[44:47], s85 offen offset:1024 sc1
    v_mfma_f32_16x16x32_bf16 v[60:63], v[120:123], v[200:203], v[60:63]
    v_mfma_f32_16x16x32_bf16 v[80:83], v[120:123], v[204:207], v[80:83]
    v_mfma_f32_16x16x32_bf16 v[24:27], v[124:127], v[192:195], v[24:27]
    v_mfma_f32_16x16x32_bf16 v[44:47], v[124:127], v[196:199], v[44:47]
    buffer_load_dwordx4 v[184:187], v1, s[44:47], s85 offen offset:2048 sc1
    v_mfma_f32_16x16x32_bf16 v[64:67], v[124:127], v[200:203], v[64:67]
    s_waitcnt lgkmcnt(0)
    v_mov_b32 v13, 6
    v_mfma_f32_16x16x32_bf16 v[84:87], v[124:127], v[204:207], v[84:87]
    ds_write_b32 v12, v13 offset:16
    v_mfma_f32_16x16x32_bf16 v[28:31], v[128:131], v[192:195], v[28:31]
    v_mfma_f32_16x16x32_bf16 v[48:51], v[128:131], v[196:199], v[48:51]
    buffer_load_dwordx4 v[188:191], v1, s[44:47], s85 offen offset:3072 sc1
    v_mfma_f32_16x16x32_bf16 v[68:71], v[128:131], v[200:203], v[68:71]
    ds_read_b32 v9, v12
    v_mfma_f32_16x16x32_bf16 v[88:91], v[128:131], v[204:207], v[88:91]
    v_mfma_f32_16x16x32_bf16 v[32:35], v[132:135], v[192:195], v[32:35]
    v_mfma_f32_16x16x32_bf16 v[52:55], v[132:135], v[196:199], v[52:55]
    v_mfma_f32_16x16x32_bf16 v[72:75], v[132:135], v[200:203], v[72:75]
    v_mfma_f32_16x16x32_bf16 v[92:95], v[132:135], v[204:207], v[92:95]
    s_waitcnt vmcnt(8)
    v_mfma_f32_16x16x32_bf16 v[16:19], v[136:139], v[208:211], v[16:19]
    s_waitcnt lgkmcnt(0)
    v_cmp_gt_u32 vcc, 7, v9
    v_mfma_f32_16x16x32_bf16 v[36:39], v[136:139], v[212:215], v[36:39]
    s_cbranch_vccnz L_p2_r6a
L_p2_r6b:
    v_mfma_f32_16x16x32_bf16 v[56:59], v[136:139], v[216:219], v[56:59]
    ds_read_b128 v[96:99], v4 offset:0
    v_mfma_f32_16x16x32_bf16 v[76:79], v[136:139], v[220:223], v[76:79]
    buffer_load_dwordx4 v[192:195], v246, s[44:47], s85 offen offset:0 sc1
    v_mfma_f32_16x16x32_bf16 v[20:23], v[140:143], v[208:211], v[20:23]
    ds_read_b128 v[100:103], v4 offset:2048
    v_mfma_f32_16x16x32_bf16 v[40:43], v[140:143], v[212:215], v[40:43]
    v_mfma_f32_16x16x32_bf16 v[60:63], v[140:143], v[216:219], v[60:63]
    ds_read_b128 v[104:107], v4 offset:4096
    v_mfma_f32_16x16x32_bf16 v[80:83], v[140:143], v[220:223], v[80:83]
    buffer_load_dwordx4 v[196:199], v246, s[44:47], s85 offen offset:1024 sc1
    v_mfma_f32_16x16x32_bf16 v[24:27], v[144:147], v[208:211], v[24:27]
    ds_read_b128 v[108:111], v4 offset:6144
    v_mfma_f32_16x16x32_bf16 v[44:47], v[144:147], v[212:215], v[44:47]
    v_mfma_f32_16x16x32_bf16 v[64:67], v[144:147], v[216:219], v[64:67]
    ds_read_b128 v[112:115], v4 offset:8192
    v_mfma_f32_16x16x32_bf16 v[84:87], v[144:147], v[220:223], v[84:87]
    buffer_load_dwordx4 v[200:203], v246, s[44:47], s85 offen offset:2048 sc1
    v_mfma_f32_16x16x32_bf16 v[28:31], v[148:151], v[208:211], v[28:31]
    ds_read_b128 v[116:119], v5 offset:0
    v_mfma_f32_16x16x32_bf16 v[48:51], v[148:151], v[212:215], v[48:51]
    v_mfma_f32_16x16x32_bf16 v[68:71], v[148:151], v[216:219], v[68:71]
    ds_read_b128 v[120:123], v5 offset:2048
    v_mfma_f32_16x16x32_bf16 v[88:91], v[148:151], v[220:223], v[88:91]
    buffer_load_dwordx4 v[204:207], v246, s[44:47], s85 offen offset:3072 sc1
    v_mfma_f32_16x16x32_bf16 v[32:35], v[152:155], v[208:211], v[32:35]
    ds_read_b128 v[124:127], v5 offset:4096
    v_mfma_f32_16x16x32_bf16 v[52:55], v[152:155], v[212:215], v[52:55]
    v_mfma_f32_16x16x32_bf16 v[72:75], v[152:155], v[216:219], v[72:75]
    ds_read_b128 v[128:131], v5 offset:6144
    v_mfma_f32_16x16x32_bf16 v[92:95], v[152:155], v[220:223], v[92:95]
    s_waitcnt vmcnt(8)
    v_mfma_f32_16x16x32_bf16 v[16:19], v[156:159], v[224:227], v[16:19]
    ds_read_b128 v[132:135], v5 offset:8192
    v_mfma_f32_16x16x32_bf16 v[36:39], v[156:159], v[228:231], v[36:39]
    s_bfe_u32 s86, s92, 0x4001c
    s_lshl_b32 s86, s86, 13
    s_add_u32 s86, s86, s74
    buffer_load_dwordx4 v[208:211], v1, s[44:47], s86 offen offset:0 sc1
    v_mfma_f32_16x16x32_bf16 v[56:59], v[156:159], v[232:235], v[56:59]
    v_mfma_f32_16x16x32_bf16 v[76:79], v[156:159], v[236:239], v[76:79]
    v_mfma_f32_16x16x32_bf16 v[20:23], v[160:163], v[224:227], v[20:23]
    v_mfma_f32_16x16x32_bf16 v[40:43], v[160:163], v[228:231], v[40:43]
    buffer_load_dwordx4 v[212:215], v1, s[44:47], s86 offen offset:1024 sc1
    v_mfma_f32_16x16x32_bf16 v[60:63], v[160:163], v[232:235], v[60:63]
    v_mfma_f32_16x16x32_bf16 v[80:83], v[160:163], v[236:239], v[80:83]
    v_mfma_f32_16x16x32_bf16 v[24:27], v[164:167], v[224:227], v[24:27]
    v_mfma_f32_16x16x32_bf16 v[44:47], v[164:167], v[228:231], v[44:47]
    buffer_load_dwordx4 v[216:219], v1, s[44:47], s86 offen offset:2048 sc1
    v_mfma_f32_16x16x32_bf16 v[64:67], v[164:167], v[232:235], v[64:67]
    s_waitcnt lgkmcnt(0)
    v_mov_b32 v13, 7
    v_mfma_f32_16x16x32_bf16 v[84:87], v[164:167], v[236:239], v[84:87]
    ds_write_b32 v12, v13 offset:16
    v_mfma_f32_16x16x32_bf16 v[28:31], v[168:171], v[224:227], v[28:31]
    v_mfma_f32_16x16x32_bf16 v[48:51], v[168:171], v[228:231], v[48:51]
    buffer_load_dwordx4 v[220:223], v1, s[44:47], s86 offen offset:3072 sc1
    v_mfma_f32_16x16x32_bf16 v[68:71], v[168:171], v[232:235], v[68:71]
    ds_read_b32 v9, v12
    v_mfma_f32_16x16x32_bf16 v[88:91], v[168:171], v[236:239], v[88:91]
    v_mfma_f32_16x16x32_bf16 v[32:35], v[172:175], v[224:227], v[32:35]
    v_mfma_f32_16x16x32_bf16 v[52:55], v[172:175], v[228:231], v[52:55]
    v_mfma_f32_16x16x32_bf16 v[72:75], v[172:175], v[232:235], v[72:75]
    v_mfma_f32_16x16x32_bf16 v[92:95], v[172:175], v[236:239], v[92:95]
    s_waitcnt vmcnt(8)
    v_mfma_f32_16x16x32_bf16 v[16:19], v[96:99], v[176:179], v[16:19]
    s_waitcnt lgkmcnt(0)
    v_cmp_gt_u32 vcc, 8, v9
    v_mfma_f32_16x16x32_bf16 v[36:39], v[96:99], v[180:183], v[36:39]
    s_cbranch_vccnz L_p2_r7a
L_p2_r7b:
    v_mfma_f32_16x16x32_bf16 v[56:59], v[96:99], v[184:187], v[56:59]
    ds_read_b128 v[136:139], v6 offset:0
    v_mfma_f32_16x16x32_bf16 v[76:79], v[96:99], v[188:191], v[76:79]
    buffer_load_dwordx4 v[224:227], v246, s[44:47], s86 offen offset:0 sc1
    v_mfma_f32_16x16x32_bf16 v[20:23], v[100:103], v[176:179], v[20:23]
    ds_read_b128 v[140:143], v6 offset:2048
    v_mfma_f32_16x16x32_bf16 v[40:43], v[100:103], v[180:183], v[40:43]
    v_mfma_f32_16x16x32_bf16 v[60:63], v[100:103], v[184:187], v[60:63]
    ds_read_b128 v[144:147], v6 offset:4096
    v_mfma_f32_16x16x32_bf16 v[80:83], v[100:103], v[188:191], v[80:83]
    buffer_load_dwordx4 v[228:231], v246, s[44:47], s86 offen offset:1024 sc1
    v_mfma_f32_16x16x32_bf16 v[24:27], v[104:107], v[176:179], v[24:27]
    ds_read_b128 v[148:151], v6 offset:6144
    v_mfma_f32_16x16x32_bf16 v[44:47], v[104:107], v[180:183], v[44:47]
    v_mfma_f32_16x16x32_bf16 v[64:67], v[104:107], v[184:187], v[64:67]
    ds_read_b128 v[152:155], v6 offset:8192
    v_mfma_f32_16x16x32_bf16 v[84:87], v[104:107], v[188:191], v[84:87]
    buffer_load_dwordx4 v[232:235], v246, s[44:47], s86 offen offset:2048 sc1
    v_mfma_f32_16x16x32_bf16 v[28:31], v[108:111], v[176:179], v[28:31]
    ds_read_b128 v[156:159], v7 offset:0
    v_mfma_f32_16x16x32_bf16 v[48:51], v[108:111], v[180:183], v[48:51]
    v_mfma_f32_16x16x32_bf16 v[68:71], v[108:111], v[184:187], v[68:71]
    ds_read_b128 v[160:163], v7 offset:2048
    v_mfma_f32_16x16x32_bf16 v[88:91], v[108:111], v[188:191], v[88:91]
    buffer_load_dwordx4 v[236:239], v246, s[44:47], s86 offen offset:3072 sc1
    v_mfma_f32_16x16x32_bf16 v[32:35], v[112:115], v[176:179], v[32:35]
    ds_read_b128 v[164:167], v7 offset:4096
    v_mfma_f32_16x16x32_bf16 v[52:55], v[112:115], v[180:183], v[52:55]
    v_mfma_f32_16x16x32_bf16 v[72:75], v[112:115], v[184:187], v[72:75]
    ds_read_b128 v[168:171], v7 offset:6144
    v_mfma_f32_16x16x32_bf16 v[92:95], v[112:115], v[188:191], v[92:95]
    s_waitcnt vmcnt(8)
    v_mfma_f32_16x16x32_bf16 v[16:19], v[116:119], v[192:195], v[16:19]
    ds_read_b128 v[172:175], v7 offset:8192
    v_mfma_f32_16x16x32_bf16 v[36:39], v[116:119], v[196:199], v[36:39]
    s_bfe_u32 s85, s93, 0x40000
    s_lshl_b32 s85, s85, 13
    s_add_u32 s85, s85, s74
    buffer_load_dwordx4 v[176:179], v1, s[44:47], s85 offen offset:0 sc1
    v_mfma_f32_16x16x32_bf16 v[56:59], v[116:119], v[200:203], v[56:59]
    v_mfma_f32_16x16x32_bf16 v[76:79], v[116:119], v[204:207], v[76:79]
    v_mfma_f32_16x16x32_bf16 v[20:23], v[120:123], v[192:195], v[20:23]
    v_mfma_f32_16x16x32_bf16 v[40:43], v[120:123], v[196:199], v[40:43]
    buffer_load_dwordx4 v[180:183], v1, s[44:47], s85 offen offset:1024 sc1
    v_mfma_f32_16x16x32_bf16 v[60:63], v[120:123], v[200:203], v[60:63]
    v_mfma_f32_16x16x32_bf16 v[80:83], v[120:123], v[204:207], v[80:83]
    v_mfma_f32_16x16x32_bf16 v[24:27], v[124:127], v[192:195], v[24:27]
    v_mfma_f32_16x16x32_bf16 v[44:47], v[124:127], v[196:199], v[44:47]
    buffer_load_dwordx4 v[184:187], v1, s[44:47], s85 offen offset:2048 sc1
    v_mfma_f32_16x16x32_bf16 v[64:67], v[124:127], v[200:203], v[64:67]
    s_waitcnt lgkmcnt(0)
    v_mov_b32 v13, 8
    v_mfma_f32_16x16x32_bf16 v[84:87], v[124:127], v[204:207], v[84:87]
    ds_write_b32 v12, v13 offset:16
    v_mfma_f32_16x16x32_bf16 v[28:31], v[128:131], v[192:195], v[28:31]
    v_mfma_f32_16x16x32_bf16 v[48:51], v[128:131], v[196:199], v[48:51]
    buffer_load_dwordx4 v[188:191], v1, s[44:47], s85 offen offset:3072 sc1
    v_mfma_f32_16x16x32_bf16 v[68:71], v[128:131], v[200:203], v[68:71]
    ds_read_b32 v9, v12
    v_mfma_f32_16x16x32_bf16 v[88:91], v[128:131], v[204:207], v[88:91]
    v_mfma_f32_16x16x32_bf16 v[32:35], v[132:135], v[192:195], v[32:35]
    v_mfma_f32_16x16x32_bf16 v[52:55], v[132:135], v[196:199], v[52:55]
    v_mfma_f32_16x16x32_bf16 v[72:75], v[132:135], v[200:203], v[72:75]
    v_mfma_f32_16x16x32_bf16 v[92:95], v[132:135], v[204:207], v[92:95]
    s_cmp_lg_u32 s3, 1
    s_cbranch_scc1 L_p2_nosw
    v_mov_b32 v2, v1
    v_add_u32 v3, 1024, v1
    v_add_u32 v2, s76, v2
    v_add_u32 v3, s76, v3
    v_add_u32 v4, s90, v2
    v_add_u32 v5, s90, v3
    v_add_u32 v6, s90, v4
    v_add_u32 v7, s90, v5
L_p2_nosw:
    s_waitcnt vmcnt(8)
    v_mfma_f32_16x16x32_bf16 v[16:19], v[136:139], v[208:211], v[16:19]
    s_waitcnt lgkmcnt(0)
    v_cmp_gt_u32 vcc, 9, v9
    v_mfma_f32_16x16x32_bf16 v[36:39], v[136:139], v[212:215], v[36:39]
    s_cbranch_vccnz L_p2_r8a
L_p2_r8b:
    v_mfma_f32_16x16x32_bf16 v[56:59], v[136:139], v[216:219], v[56:59]
    ds_read_b128 v[96:99], v2 offset:0
    v_mfma_f32_16x16x32_bf16 v[76:79], v[136:139], v[220:223], v[76:79]
    buffer_load_dwordx4 v[192:195], v246, s[44:47], s85 offen offset:0 sc1
    v_mfma_f32_16x16x32_bf16 v[20:23], v[140:143], v[208:211], v[20:23]
    ds_read_b128 v[100:103], v2 offset:2048
    v_mfma_f32_16x16x32_bf16 v[40:43], v[140:143], v[212:215], v[40:43]
    v_mfma_f32_16x16x32_bf16 v[60:63], v[140:143], v[216:219], v[60:63]
    ds_read_b128 v[104:107], v2 offset:4096
    v_mfma_f32_16x16x32_bf16 v[80:83], v[140:143], v[220:223], v[80:83]
    buffer_load_dwordx4 v[196:199], v246, s[44:47], s85 offen offset:1024 sc1
    v_mfma_f32_16x16x32_bf16 v[24:27], v[144:147], v[208:211], v[24:27]
    ds_read_b128 v[108:111], v2 offset:6144
    v_mfma_f32_16x16x32_bf16 v[44:47], v[144:147], v[212:215], v[44:47]
    v_mfma_f32_16x16x32_bf16 v[64:67], v[144:147], v[216:219], v[64:67]
    ds_read_b128 v[112:115], v2 offset:8192
    v_mfma_f32_16x16x32_bf16 v[84:87], v[144:147], v[220:223], v[84:87]
    buffer_load_dwordx4 v[200:203], v246, s[44:47], s85 offen offset:2048 sc1
    v_mfma_f32_16x16x32_bf16 v[28:31], v[148:151], v[208:211], v[28:31]
    ds_read_b128 v[116:119], v3 offset:0
    v_mfma_f32_16x16x32_bf16 v[48:51], v[148:151], v[212:215], v[48:51]
    v_mfma_f32_16x16x32_bf16 v[68:71], v[148:151], v[216:219], v[68:71]
    ds_read_b128 v[120:123], v3 offset:2048
    v_mfma_f32_16x16x32_bf16 v[88:91], v[148:151], v[220:223], v[88:91]
    buffer_load_dwordx4 v[204:207], v246, s[44:47], s85 offen offset:3072 sc1
    v_mfma_f32_16x16x32_bf16 v[32:35], v[152:155], v[208:211], v[32:35]
    ds_read_b128 v[124:127], v3 offset:4096
    v_mfma_f32_16x16x32_bf16 v[52:55], v[152:155], v[212:215], v[52:55]
    v_mfma_f32_16x16x32_bf16 v[72:75], v[152:155], v[216:219], v[72:75]
    ds_read_b128 v[128:131], v3 offset:6144
    v_mfma_f32_16x16x32_bf16 v[92:95], v[152:155], v[220:223], v[92:95]
    s_waitcnt vmcnt(8)
    v_mfma_f32_16x16x32_bf16 v[16:19], v[156:159], v[224:227], v[16:19]
    ds_read_b128 v[132:135], v3 offset:8192
    v_mfma_f32_16x16x32_bf16 v[36:39], v[156:159], v[228:231], v[36:39]
    s_bfe_u32 s86, s93, 0x40004
    s_lshl_b32 s86, s86, 13
    s_add_u32 s86, s86, s74
    buffer_load_dwordx4 v[208:211], v1, s[44:47], s86 offen offset:0 sc1
    v_mfma_f32_16x16x32_bf16 v[56:59], v[156:159], v[232:235], v[56:59]
    v_mfma_f32_16x16x32_bf16 v[76:79], v[156:159], v[236:239], v[76:79]
    v_mfma_f32_16x16x32_bf16 v[20:23], v[160:163], v[224:227], v[20:23]
    v_mfma_f32_16x16x32_bf16 v[40:43], v[160:163], v[228:231], v[40:43]
    buffer_load_dwordx4 v[212:215], v1, s[44:47], s86 offen offset:1024 sc1
    v_mfma_f32_16x16x32_bf16 v[60:63], v[160:163], v[232:235], v[60:63]
    v_mfma_f32_16x16x32_bf16 v[80:83], v[160:163], v[236:239], v[80:83]
    v_mfma_f32_16x16x32_bf16 v[24:27], v[164:167], v[224:227], v[24:27]
    v_mfma_f32_16x16x32_bf16 v[44:47], v[164:167], v[228:231], v[44:47]
    buffer_load_dwordx4 v[216:219], v1, s[44:47], s86 offen offset:2048 sc1
    v_mfma_f32_16x16x32_bf16 v[64:67], v[164:167], v[232:235], v[64:67]
    s_waitcnt lgkmcnt(0)
    v_mov_b32 v13, 9
    v_mfma_f32_16x16x32_bf16 v[84:87], v[164:167], v[236:239], v[84:87]
    ds_write_b32 v12, v13 offset:16
    v_mfma_f32_16x16x32_bf16 v[28:31], v[168:171], v[224:227], v[28:31]
    v_mfma_f32_16x16x32_bf16 v[48:51], v[168:171], v[228:231], v[48:51]
    buffer_load_dwordx4 v[220:223], v1, s[44:47], s86 offen offset:3072 sc1
    v_mfma_f32_16x16x32_bf16 v[68:71], v[168:171], v[232:235], v[68:71]
    ds_read_b32 v9, v12
    v_mfma_f32_16x16x32_bf16 v[88:91], v[168:171], v[236:239], v[88:91]
    v_mfma_f32_16x16x32_bf16 v[32:35], v[172:175], v[224:227], v[32:35]
    v_mfma_f32_16x16x32_bf16 v[52:55], v[172:175], v[228:231], v[52:55]
    v_mfma_f32_16x16x32_bf16 v[72:75], v[172:175], v[232:235], v[72:75]
    v_mfma_f32_16x16x32_bf16 v[92:95], v[172:175], v[236:239], v[92:95]
    s_cmp_eq_u32 s3, 1
    s_cbranch_scc1 L_p2_fl
L_p2_nofl:
    s_waitcnt vmcnt(8)
    v_mfma_f32_16x16x32_bf16 v[16:19], v[96:99], v[176:179], v[16:19]
    s_waitcnt lgkmcnt(0)
    v_cmp_gt_u32 vcc, 10, v9
    v_mfma_f32_16x16x32_bf16 v[36:39], v[96:99], v[180:183], v[36:39]
    s_cbranch_vccnz L_p2_r9a
L_p2_r9b:
    v_mfma_f32_16x16x32_bf16 v[56:59], v[96:99], v[184:187], v[56:59]
    ds_read_b128 v[136:139], v4 offset:0
    v_mfma_f32_16x16x32_bf16 v[76:79], v[96:99], v[188:191], v[76:79]
    buffer_load_dwordx4 v[224:227], v246, s[44:47], s86 offen offset:0 sc1
    v_mfma_f32_16x16x32_bf16 v[20:23], v[100:103], v[176:179], v[20:23]
    ds_read_b128 v[140:143], v4 offset:2048
    v_mfma_f32_16x16x32_bf16 v[40:43], v[100:103], v[180:183], v[40:43]
    v_mfma_f32_16x16x32_bf16 v[60:63], v[100:103], v[184:187], v[60:63]
    ds_read_b128 v[144:147], v4 offset:4096
    v_mfma_f32_16x16x32_bf16 v[80:83], v[100:103], v[188:191], v[80:83]
    buffer_load_dwordx4 v[228:231], v246, s[44:47], s86 offen offset:1024 sc1
    v_mfma_f32_16x16x32_bf16 v[24:27], v[104:107], v[176:179], v[24:27]
    ds_read_b128 v[148:151], v4 offset:6144
    v_mfma_f32_16x16x32_bf16 v[44:47], v[104:107], v[180:183], v[44:47]
    v_mfma_f32_16x16x32_bf16 v[64:67], v[104:107], v[184:187], v[64:67]
    ds_read_b128 v[152:155], v4 offset:8192
    v_mfma_f32_16x16x32_bf16 v[84:87], v[104:107], v[188:191], v[84:87]
    buffer_load_dwordx4 v[232:235], v246, s[44:47], s86 offen offset:2048 sc1
    v_mfma_f32_16x16x32_bf16 v[28:31], v[108:111], v[176:179], v[28:31]
    ds_read_b128 v[156:159], v5 offset:0
    v_mfma_f32_16x16x32_bf16 v[48:51], v[108:111], v[180:183], v[48:51]
    v_mfma_f32_16x16x32_bf16 v[68:71], v[108:111], v[184:187], v[68:71]
    ds_read_b128 v[160:163], v5 offset:2048
    v_mfma_f32_16x16x32_bf16 v[88:91], v[108:111], v[188:191], v[88:91]
    buffer_load_dwordx4 v[236:239], v246, s[44:47], s86 offen offset:3072 sc1
    v_mfma_f32_16x16x32_bf16 v[32:35], v[112:115], v[176:179], v[32:35]
    ds_read_b128 v[164:167], v5 offset:4096
    v_mfma_f32_16x16x32_bf16 v[52:55], v[112:115], v[180:183], v[52:55]
    v_mfma_f32_16x16x32_bf16 v[72:75], v[112:115], v[184:187], v[72:75]
    ds_read_b128 v[168:171], v5 offset:6144
    v_mfma_f32_16x16x32_bf16 v[92:95], v[112:115], v[188:191], v[92:95]
    s_waitcnt vmcnt(8)
    v_mfma_f32_16x16x32_bf16 v[16:19], v[116:119], v[192:195], v[16:19]
    ds_read_b128 v[172:175], v5 offset:8192
    v_mfma_f32_16x16x32_bf16 v[36:39], v[116:119], v[196:199], v[36:39]
    s_bfe_u32 s85, s93, 0x40008
    s_lshl_b32 s85, s85, 13
    s_add_u32 s85, s85, s74
    buffer_load_dwordx4 v[176:179], v1, s[44:47], s85 offen offset:0 sc1
    v_mfma_f32_16x16x32_bf16 v[56:59], v[116:119], v[200:203], v[56:59]
    v_mfma_f32_16x16x32_bf16 v[76:79], v[116:119], v[204:207], v[76:79]
    v_mfma_f32_16x16x32_bf16 v[20:23], v[120:123], v[192:195], v[20:23]
    v_mfma_f32_16x16x32_bf16 v[40:43], v[120:123], v[196:199], v[40:43]
    buffer_load_dwordx4 v[180:183], v1, s[44:47], s85 offen offset:1024 sc1
    v_mfma_f32_16x16x32_bf16 v[60:63], v[120:123], v[200:203], v[60:63]
    v_mfma_f32_16x16x32_bf16 v[80:83], v[120:123], v[204:207], v[80:83]
    v_mfma_f32_16x16x32_bf16 v[24:27], v[124:127], v[192:195], v[24:27]
    v_mfma_f32_16x16x32_bf16 v[44:47], v[124:127], v[196:199], v[44:47]
    buffer_load_dwordx4 v[184:187], v1, s[44:47], s85 offen offset:2048 sc1
    v_mfma_f32_16x16x32_bf16 v[64:67], v[124:127], v[200:203], v[64:67]
    s_waitcnt lgkmcnt(0)
    v_mov_b32 v13, 10
    v_mfma_f32_16x16x32_bf16 v[84:87], v[124:127], v[204:207], v[84:87]
    ds_write_b32 v12, v13 offset:16
    v_mfma_f32_16x16x32_bf16 v[28:31], v[128:131], v[192:195], v[28:31]
    v_mfma_f32_16x16x32_bf16 v[48:51], v[128:131], v[196:199], v[48:51]
    buffer_load_dwordx4 v[188:191], v1, s[44:47], s85 offen offset:3072 sc1
    v_mfma_f32_16x16x32_bf16 v[68:71], v[128:131], v[200:203], v[68:71]
    ds_read_b32 v9, v12
    v_mfma_f32_16x16x32_bf16 v[88:91], v[128:131], v[204:207], v[88:91]
    v_mfma_f32_16x16x32_bf16 v[32:35], v[132:135], v[192:195], v[32:35]
    v_mfma_f32_16x16x32_bf16 v[52:55], v[132:135], v[196:199], v[52:55]
    v_mfma_f32_16x16x32_bf16 v[72:75], v[132:135], v[200:203], v[72:75]
    v_mfma_f32_16x16x32_bf16 v[92:95], v[132:135], v[204:207], v[92:95]
    s_waitcnt vmcnt(8)
    v_mfma_f32_16x16x32_bf16 v[16:19], v[136:139], v[208:211], v[16:19]
    s_waitcnt lgkmcnt(0)
    v_cmp_gt_u32 vcc, 11, v9
    v_mfma_f32_16x16x32_bf16 v[36:39], v[136:139], v[212:215], v[36:39]
    s_cbranch_vccnz L_p2_r10a
L_p2_r10b:
    v_mfma_f32_16x16x32_bf16 v[56:59], v[136:139], v[216:219], v[56:59]
    ds_read_b128 v[96:99], v6 offset:0
    v_mfma_f32_16x16x32_bf16 v[76:79], v[136:139], v[220:223], v[76:79]
    buffer_load_dwordx4 v[192:195], v246, s[44:47], s85 offen offset:0 sc1
    v_mfma_f32_16x16x32_bf16 v[20:23], v[140:143], v[208:211], v[20:23]
    ds_read_b128 v[100:103], v6 offset:2048
    v_mfma_f32_16x16x32_bf16 v[40:43], v[140:143], v[212:215], v[40:43]
    v_mfma_f32_16x16x32_bf16 v[60:63], v[140:143], v[216:219], v[60:63]
    ds_read_b128 v[104:107], v6 offset:4096
    v_mfma_f32_16x16x32_bf16 v[80:83], v[140:143], v[220:223], v[80:83]
    buffer_load_dwordx4 v[196:199], v246, s[44:47], s85 offen offset:1024 sc1
    v_mfma_f32_16x16x32_bf16 v[24:27], v[144:147], v[208:211], v[24:27]
    ds_read_b128 v[108:111], v6 offset:6144
    v_mfma_f32_16x16x32_bf16 v[44:47], v[144:147], v[212:215], v[44:47]
    v_mfma_f32_16x16x32_bf16 v[64:67], v[144:147], v[216:219], v[64:67]
    ds_read_b128 v[112:115], v6 offset:8192
    v_mfma_f32_16x16x32_bf16 v[84:87], v[144:147], v[220:223], v[84:87]
    buffer_load_dwordx4 v[200:203], v246, s[44:47], s85 offen offset:2048 sc1
    v_mfma_f32_16x16x32_bf16 v[28:31], v[148:151], v[208:211], v[28:31]
    ds_read_b128 v[116:119], v7 offset:0
    v_mfma_f32_16x16x32_bf16 v[48:51], v[148:151], v[212:215], v[48:51]
    v_mfma_f32_16x16x32_bf16 v[68:71], v[148:151], v[216:219], v[68:71]
    ds_read_b128 v[120:123], v7 offset:2048
    v_mfma_f32_16x16x32_bf16 v[88:91], v[148:151], v[220:223], v[88:91]
    buffer_load_dwordx4 v[204:207], v246, s[44:47], s85 offen offset:3072 sc1
    v_mfma_f32_16x16x32_bf16 v[32:35], v[152:155], v[208:211], v[32:35]
    ds_read_b128 v[124:127], v7 offset:4096
    v_mfma_f32_16x16x32_bf16 v[52:55], v[152:155], v[212:215], v[52:55]
    v_mfma_f32_16x16x32_bf16 v[72:75], v[152:155], v[216:219], v[72:75]
    ds_read_b128 v[128:131], v7 offset:6144
    v_mfma_f32_16x16x32_bf16 v[92:95], v[152:155], v[220:223], v[92:95]
    s_waitcnt vmcnt(8)
    v_mfma_f32_16x16x32_bf16 v[16:19], v[156:159], v[224:227], v[16:19]
    ds_read_b128 v[132:135], v7 offset:8192
    v_mfma_f32_16x16x32_bf16 v[36:39], v[156:159], v[228:231], v[36:39]
    s_bfe_u32 s86, s93, 0x4000c
    s_lshl_b32 s86, s86, 13
    s_add_u32 s86, s86, s74
    buffer_load_dwordx4 v[208:211], v1, s[44:47], s86 offen offset:0 sc1
    v_mfma_f32_16x16x32_bf16 v[56:59], v[156:159], v[232:235], v[56:59]
    v_mfma_f32_16x16x32_bf16 v[76:79], v[156:159], v[236:239], v[76:79]
    v_mfma_f32_16x16x32_bf16 v[20:23], v[160:163], v[224:227], v[20:23]
    v_mfma_f32_16x16x32_bf16 v[40:43], v[160:163], v[228:231], v[40:43]
    buffer_load_dwordx4 v[212:215], v1, s[44:47], s86 offen offset:1024 sc1
    v_mfma_f32_16x16x32_bf16 v[60:63], v[160:163], v[232:235], v[60:63]
    v_mfma_f32_16x16x32_bf16 v[80:83], v[160:163], v[236:239], v[80:83]
    v_mfma_f32_16x16x32_bf16 v[24:27], v[164:167], v[224:227], v[24:27]
    v_mfma_f32_16x16x32_bf16 v[44:47], v[164:167], v[228:231], v[44:47]
    buffer_load_dwordx4 v[216:219], v1, s[44:47], s86 offen offset:2048 sc1
    v_mfma_f32_16x16x32_bf16 v[64:67], v[164:167], v[232:235], v[64:67]
    s_waitcnt lgkmcnt(0)
    v_mfma_f32_16x16x32_bf16 v[84:87], v[164:167], v[236:239], v[84:87]
    v_mfma_f32_16x16x32_bf16 v[28:31], v[168:171], v[224:227], v[28:31]
    v_mfma_f32_16x16x32_bf16 v[48:51], v[168:171], v[228:231], v[48:51]
    buffer_load_dwordx4 v[220:223], v1, s[44:47], s86 offen offset:3072 sc1
    v_mfma_f32_16x16x32_bf16 v[68:71], v[168:171], v[232:235], v[68:71]
    ds_read_b32 v9, v12
    v_mfma_f32_16x16x32_bf16 v[88:91], v[168:171], v[236:239], v[88:91]
    v_mfma_f32_16x16x32_bf16 v[32:35], v[172:175], v[224:227], v[32:35]
    v_mfma_f32_16x16x32_bf16 v[52:55], v[172:175], v[228:231], v[52:55]
    v_mfma_f32_16x16x32_bf16 v[72:75], v[172:175], v[232:235], v[72:75]
    v_mfma_f32_16x16x32_bf16 v[92:95], v[172:175], v[236:239], v[92:95]
    s_cmp_eq_u32 s3, 1
    s_cbranch_scc1 L_p2_w1
    s_waitcnt vmcnt(8)
    v_mfma_f32_16x16x32_bf16 v[16:19], v[96:99], v[176:179], v[16:19]
    s_waitcnt lgkmcnt(0)
    v_cmp_gt_u32 vcc, 12, v9
    v_mfma_f32_16x16x32_bf16 v[36:39], v[96:99], v[180:183], v[36:39]
    s_cbranch_vccnz L_p2_r11a
L_p2_r11b:
    v_mfma_f32_16x16x32_bf16 v[56:59], v[96:99], v[184:187], v[56:59]
    ds_read_b128 v[136:139], v2 offset:0
    v_mfma_f32_16x16x32_bf16 v[76:79], v[96:99], v[188:191], v[76:79]
    buffer_load_dwordx4 v[224:227], v246, s[44:47], s86 offen offset:0 sc1
    v_mfma_f32_16x16x32_bf16 v[20:23], v[100:103], v[176:179], v[20:23]
    ds_read_b128 v[140:143], v2 offset:2048
    v_mfma_f32_16x16x32_bf16 v[40:43], v[100:103], v[180:183], v[40:43]
    v_mfma_f32_16x16x32_bf16 v[60:63], v[100:103], v[184:187], v[60:63]
    ds_read_b128 v[144:147], v2 offset:4096
    v_mfma_f32_16x16x32_bf16 v[80:83], v[100:103], v[188:191], v[80:83]
    buffer_load_dwordx4 v[228:231], v246, s[44:47], s86 offen offset:1024 sc1
    v_mfma_f32_16x16x32_bf16 v[24:27], v[104:107], v[176:179], v[24:27]
    ds_read_b128 v[148:151], v2 offset:6144
    v_mfma_f32_16x16x32_bf16 v[44:47], v[104:107], v[180:183], v[44:47]
    v_mfma_f32_16x16x32_bf16 v[64:67], v[104:107], v[184:187], v[64:67]
    ds_read_b128 v[152:155], v2 offset:8192
    v_mfma_f32_16x16x32_bf16 v[84:87], v[104:107], v[188:191], v[84:87]
    buffer_load_dwordx4 v[232:235], v246, s[44:47], s86 offen offset:2048 sc1
    v_mfma_f32_16x16x32_bf16 v[28:31], v[108:111], v[176:179], v[28:31]
    ds_read_b128 v[156:159], v3 offset:0
    v_mfma_f32_16x16x32_bf16 v[48:51], v[108:111], v[180:183], v[48:51]
    v_mfma_f32_16x16x32_bf16 v[68:71], v[108:111], v[184:187], v[68:71]
    ds_read_b128 v[160:163], v3 offset:2048
    v_mfma_f32_16x16x32_bf16 v[88:91], v[108:111], v[188:191], v[88:91]
    buffer_load_dwordx4 v[236:239], v246, s[44:47], s86 offen offset:3072 sc1
    v_mfma_f32_16x16x32_bf16 v[32:35], v[112:115], v[176:179], v[32:35]
    ds_read_b128 v[164:167], v3 offset:4096
    v_mfma_f32_16x16x32_bf16 v[52:55], v[112:115], v[180:183], v[52:55]
    v_mfma_f32_16x16x32_bf16 v[72:75], v[112:115], v[184:187], v[72:75]
    ds_read_b128 v[168:171], v3 offset:6144
    v_mfma_f32_16x16x32_bf16 v[92:95], v[112:115], v[188:191], v[92:95]
    s_waitcnt vmcnt(8)
    v_mfma_f32_16x16x32_bf16 v[16:19], v[116:119], v[192:195], v[16:19]
    ds_read_b128 v[172:175], v3 offset:8192
    v_mfma_f32_16x16x32_bf16 v[36:39], v[116:119], v[196:199], v[36:39]
    v_mfma_f32_16x16x32_bf16 v[56:59], v[116:119], v[200:203], v[56:59]
    v_mfma_f32_16x16x32_bf16 v[76:79], v[116:119], v[204:207], v[76:79]
    v_mfma_f32_16x16x32_bf16 v[20:23], v[120:123], v[192:195], v[20:23]
    v_mfma_f32_16x16x32_bf16 v[40:43], v[120:123], v[196:199], v[40:43]
    v_mfma_f32_16x16x32_bf16 v[60:63], v[120:123], v[200:203], v[60:63]
    v_mfma_f32_16x16x32_bf16 v[80:83], v[120:123], v[204:207], v[80:83]
    v_mfma_f32_16x16x32_bf16 v[24:27], v[124:127], v[192:195], v[24:27]
    v_mfma_f32_16x16x32_bf16 v[44:47], v[124:127], v[196:199], v[44:47]
    v_mfma_f32_16x16x32_bf16 v[64:67], v[124:127], v[200:203], v[64:67]
    s_waitcnt lgkmcnt(0)
    v_mfma_f32_16x16x32_bf16 v[84:87], v[124:127], v[204:207], v[84:87]
    v_mfma_f32_16x16x32_bf16 v[28:31], v[128:131], v[192:195], v[28:31]
    v_mfma_f32_16x16x32_bf16 v[48:51], v[128:131], v[196:199], v[48:51]
    v_mfma_f32_16x16x32_bf16 v[68:71], v[128:131], v[200:203], v[68:71]
    v_mfma_f32_16x16x32_bf16 v[88:91], v[128:131], v[204:207], v[88:91]
    v_mfma_f32_16x16x32_bf16 v[32:35], v[132:135], v[192:195], v[32:35]
    v_mfma_f32_16x16x32_bf16 v[52:55], v[132:135], v[196:199], v[52:55]
    v_mfma_f32_16x16x32_bf16 v[72:75], v[132:135], v[200:203], v[72:75]
    v_mfma_f32_16x16x32_bf16 v[92:95], v[132:135], v[204:207], v[92:95]
    s_waitcnt vmcnt(0)
    v_mfma_f32_16x16x32_bf16 v[16:19], v[136:139], v[208:211], v[16:19]
    v_mfma_f32_16x16x32_bf16 v[20:23], v[140:143], v[208:211], v[20:23]
    v_mfma_f32_16x16x32_bf16 v[16:19], v[156:159], v[224:227], v[16:19]
    v_mfma_f32_16x16x32_bf16 v[20:23], v[160:163], v[224:227], v[20:23]
    v_mfma_f32_16x16x32_bf16 v[24:27], v[144:147], v[208:211], v[24:27]
    v_mfma_f32_16x16x32_bf16 v[28:31], v[148:151], v[208:211], v[28:31]
    v_mfma_f32_16x16x32_bf16 v[24:27], v[164:167], v[224:227], v[24:27]
    v_mfma_f32_16x16x32_bf16 v[28:31], v[168:171], v[224:227], v[28:31]
    v_mfma_f32_16x16x32_bf16 v[32:35], v[152:155], v[208:211], v[32:35]
    v_mfma_f32_16x16x32_bf16 v[36:39], v[136:139], v[212:215], v[36:39]
    v_mfma_f32_16x16x32_bf16 v[32:35], v[172:175], v[224:227], v[32:35]
    v_mfma_f32_16x16x32_bf16 v[36:39], v[156:159], v[228:231], v[36:39]
    ds_write_b128 v10, v[16:19] offset:0
    ds_write_b128 v10, v[20:23] offset:1024
    v_mfma_f32_16x16x32_bf16 v[40:43], v[140:143], v[212:215], v[40:43]
    v_mfma_f32_16x16x32_bf16 v[44:47], v[144:147], v[212:215], v[44:47]
    v_mfma_f32_16x16x32_bf16 v[40:43], v[160:163], v[228:231], v[40:43]
    v_mfma_f32_16x16x32_bf16 v[44:47], v[164:167], v[228:231], v[44:47]
    ds_write_b128 v10, v[24:27] offset:2048
    ds_write_b128 v10, v[28:31] offset:3072
    v_mfma_f32_16x16x32_bf16 v[48:51], v[148:151], v[212:215], v[48:51]
    v_mfma_f32_16x16x32_bf16 v[52:55], v[152:155], v[212:215], v[52:55]
    v_mfma_f32_16x16x32_bf16 v[48:51], v[168:171], v[228:231], v[48:51]
    v_mfma_f32_16x16x32_bf16 v[52:55], v[172:175], v[228:231], v[52:55]
    ds_write_b128 v10, v[32:35] offset:4096
    ds_write_b128 v10, v[36:39] offset:5120
    v_mfma_f32_16x16x32_bf16 v[56:59], v[136:139], v[216:219], v[56:59]
    v_mfma_f32_16x16x32_bf16 v[60:63], v[140:143], v[216:219], v[60:63]
    v_mfma_f32_16x16x32_bf16 v[56:59], v[156:159], v[232:235], v[56:59]
    v_mfma_f32_16x16x32_bf16 v[60:63], v[160:163], v[232:235], v[60:63]
    ds_write_b128 v10, v[40:43] offset:6144
    ds_write_b128 v10, v[44:47] offset:7168
    v_mfma_f32_16x16x32_bf16 v[64:67], v[144:147], v[216:219], v[64:67]
    v_mfma_f32_16x16x32_bf16 v[68:71], v[148:151], v[216:219], v[68:71]
    v_mfma_f32_16x16x32_bf16 v[64:67], v[164:167], v[232:235], v[64:67]
    v_mfma_f32_16x16x32_bf16 v[68:71], v[168:171], v[232:235], v[68:71]
    ds_write_b128 v10, v[48:51] offset:8192
    ds_write_b128 v10, v[52:55] offset:9216
    v_mfma_f32_16x16x32_bf16 v[72:75], v[152:155], v[216:219], v[72:75]
    v_mfma_f32_16x16x32_bf16 v[76:79], v[136:139], v[220:223], v[76:79]
    v_mfma_f32_16x16x32_bf16 v[72:75], v[172:175], v[232:235], v[72:75]
    v_mfma_f32_16x16x32_bf16 v[76:79], v[156:159], v[236:239], v[76:79]
    ds_write_b128 v11, v[56:59] offset:0
    ds_write_b128 v11, v[60:63] offset:1024
    v_mfma_f32_16x16x32_bf16 v[80:83], v[140:143], v[220:223], v[80:83]
    v_mfma_f32_16x16x32_bf16 v[84:87], v[144:147], v[220:223], v[84:87]
    v_mfma_f32_16x16x32_bf16 v[80:83], v[160:163], v[236:239], v[80:83]
    v_mfma_f32_16x16x32_bf16 v[84:87], v[164:167], v[236:239], v[84:87]
    ds_write_b128 v11, v[64:67] offset:2048
    ds_write_b128 v11, v[68:71] offset:3072
    v_mfma_f32_16x16x32_bf16 v[88:91], v[148:151], v[220:223], v[88:91]
    v_mfma_f32_16x16x32_bf16 v[92:95], v[152:155], v[220:223], v[92:95]
    v_mfma_f32_16x16x32_bf16 v[88:91], v[168:171], v[236:239], v[88:91]
    v_mfma_f32_16x16x32_bf16 v[92:95], v[172:175], v[236:239], v[92:95]
    ds_write_b128 v11, v[72:75] offset:4096
    ds_write_b128 v11, v[76:79] offset:5120
    s_nop 3
    ds_write_b128 v11, v[80:83] offset:6144
    ds_write_b128 v11, v[84:87] offset:7168
    s_nop 3
    ds_write_b128 v11, v[88:91] offset:8192
    ds_write_b128 v11, v[92:95] offset:9216
L_p2_end:
    s_waitcnt lgkmcnt(0)
    s_barrier
    s_endpgm
L_p2_w1:
    s_waitcnt vmcnt(4)
    v_mfma_f32_16x16x32_bf16 v[16:19], v[96:99], v[176:179], v[16:19]
    v_mfma_f32_16x16x32_bf16 v[20:23], v[100:103], v[176:179], v[20:23]
    v_mfma_f32_16x16x32_bf16 v[16:19], v[116:119], v[192:195], v[16:19]
    v_mfma_f32_16x16x32_bf16 v[20:23], v[120:123], v[192:195], v[20:23]
    v_mfma_f32_16x16x32_bf16 v[24:27], v[104:107], v[176:179], v[24:27]
    v_mfma_f32_16x16x32_bf16 v[28:31], v[108:111], v[176:179], v[28:31]
    v_mfma_f32_16x16x32_bf16 v[24:27], v[124:127], v[192:195], v[24:27]
    v_mfma_f32_16x16x32_bf16 v[28:31], v[128:131], v[192:195], v[28:31]
    v_mfma_f32_16x16x32_bf16 v[32:35], v[112:115], v[176:179], v[32:35]
    v_mfma_f32_16x16x32_bf16 v[36:39], v[96:99], v[180:183], v[36:39]
    v_mfma_f32_16x16x32_bf16 v[32:35], v[132:135], v[192:195], v[32:35]
    v_mfma_f32_16x16x32_bf16 v[36:39], v[116:119], v[196:199], v[36:39]
    ds_write_b128 v10, v[16:19] offset:0
    ds_write_b128 v10, v[20:23] offset:1024
    v_mfma_f32_16x16x32_bf16 v[40:43], v[100:103], v[180:183], v[40:43]
    v_mfma_f32_16x16x32_bf16 v[44:47], v[104:107], v[180:183], v[44:47]
    v_mfma_f32_16x16x32_bf16 v[40:43], v[120:123], v[196:199], v[40:43]
    v_mfma_f32_16x16x32_bf16 v[44:47], v[124:127], v[196:199], v[44:47]
    ds_write_b128 v10, v[24:27] offset:2048
    ds_write_b128 v10, v[28:31] offset:3072
    v_mfma_f32_16x16x32_bf16 v[48:51], v[108:111], v[180:183], v[48:51]
    v_mfma_f32_16x16x32_bf16 v[52:55], v[112:115], v[180:183], v[52:55]
    v_mfma_f32_16x16x32_bf16 v[48:51], v[128:131], v[196:199], v[48:51]
    v_mfma_f32_16x16x32_bf16 v[52:55], v[132:135], v[196:199], v[52:55]
    ds_write_b128 v10, v[32:35] offset:4096
    ds_write_b128 v10, v[36:39] offset:5120
    v_mfma_f32_16x16x32_bf16 v[56:59], v[96:99], v[184:187], v[56:59]
    v_mfma_f32_16x16x32_bf16 v[60:63], v[100:103], v[184:187], v[60:63]
    v_mfma_f32_16x16x32_bf16 v[56:59], v[116:119], v[200:203], v[56:59]
    v_mfma_f32_16x16x32_bf16 v[60:63], v[120:123], v[200:203], v[60:63]
    ds_write_b128 v10, v[40:43] offset:6144
    ds_write_b128 v10, v[44:47] offset:7168
    v_mfma_f32_16x16x32_bf16 v[64:67], v[104:107], v[184:187], v[64:67]
    v_mfma_f32_16x16x32_bf16 v[68:71], v[108:111], v[184:187], v[68:71]
    v_mfma_f32_16x16x32_bf16 v[64:67], v[124:127], v[200:203], v[64:67]
    v_mfma_f32_16x16x32_bf16 v[68:71], v[128:131], v[200:203], v[68:71]
    ds_write_b128 v10, v[48:51] offset:8192
    ds_write_b128 v10, v[52:55] offset:9216
    v_mfma_f32_16x16x32_bf16 v[72:75], v[112:115], v[184:187], v[72:75]
    v_mfma_f32_16x16x32_bf16 v[76:79], v[96:99], v[188:191], v[76:79]
    v_mfma_f32_16x16x32_bf16 v[72:75], v[132:135], v[200:203], v[72:75]
    v_mfma_f32_16x16x32_bf16 v[76:79], v[116:119], v[204:207], v[76:79]
    ds_write_b128 v11, v[56:59] offset:0
    ds_write_b128 v11, v[60:63] offset:1024
    v_mfma_f32_16x16x32_bf16 v[80:83], v[100:103], v[188:191], v[80:83]
    v_mfma_f32_16x16x32_bf16 v[84:87], v[104:107], v[188:191], v[84:87]
    v_mfma_f32_16x16x32_bf16 v[80:83], v[120:123], v[204:207], v[80:83]
    v_mfma_f32_16x16x32_bf16 v[84:87], v[124:127], v[204:207], v[84:87]
    ds_write_b128 v11, v[64:67] offset:2048
    ds_write_b128 v11, v[68:71] offset:3072
    v_mfma_f32_16x16x32_bf16 v[88:91], v[108:111], v[188:191], v[88:91]
    v_mfma_f32_16x16x32_bf16 v[92:95], v[112:115], v[188:191], v[92:95]
    v_mfma_f32_16x16x32_bf16 v[88:91], v[128:131], v[204:207], v[88:91]
    v_mfma_f32_16x16x32_bf16 v[92:95], v[132:135], v[204:207], v[92:95]
    ds_write_b128 v11, v[72:75] offset:4096
    ds_write_b128 v11, v[76:79] offset:5120
    s_nop 3
    ds_write_b128 v11, v[80:83] offset:6144
    ds_write_b128 v11, v[84:87] offset:7168
    s_nop 3
    ds_write_b128 v11, v[88:91] offset:8192
    ds_write_b128 v11, v[92:95] offset:9216
    s_branch L_p2_end
L_p2_fl:
    v_add_u32 v240, 40960, v1
    v_add_u32 v241, s90, v240
    v_add_u32 v242, s90, v241
    s_cmp_lt_u32 s61, 10
    s_cselect_b32 s68, 101376, 0
    s_add_u32 s68, s68, 5120
    v_add_u32 v243, s68, v240
    ds_write_b128 v240, v[16:19] offset:0
    ds_write_b128 v241, v[36:39] offset:0
    ds_write_b128 v242, v[56:59] offset:0
    ds_write_b128 v243, v[76:79] offset:0
    ds_write_b128 v240, v[20:23] offset:1024
    ds_write_b128 v241, v[40:43] offset:1024
    ds_write_b128 v242, v[60:63] offset:1024
    ds_write_b128 v243, v[80:83] offset:1024
    ds_write_b128 v240, v[24:27] offset:2048
    ds_write_b128 v241, v[44:47] offset:2048
    ds_write_b128 v242, v[64:67] offset:2048
    ds_write_b128 v243, v[84:87] offset:2048
    ds_write_b128 v240, v[28:31] offset:3072
    ds_write_b128 v241, v[48:51] offset:3072
    ds_write_b128 v242, v[68:71] offset:3072
    ds_write_b128 v243, v[88:91] offset:3072
    ds_write_b128 v240, v[32:35] offset:4096
    ds_write_b128 v241, v[52:55] offset:4096
    ds_write_b128 v242, v[72:75] offset:4096
    ds_write_b128 v243, v[92:95] offset:4096
    s_waitcnt lgkmcnt(0)
    v_mov_b32 v16, 0
    v_mov_b32 v17, 0
    v_mov_b32 v18, 0
    v_mov_b32 v19, 0
    v_mov_b32 v20, 0
    v_mov_b32 v21, 0
    v_mov_b32 v22, 0
    v_mov_b32 v23, 0
    v_mov_b32 v24, 0
    v_mov_b32 v25, 0
    v_mov_b32 v26, 0
    v_mov_b32 v27, 0
    v_mov_b32 v28, 0
    v_mov_b32 v29, 0
    v_mov_b32 v30, 0
    v_mov_b32 v31, 0
    v_mov_b32 v32, 0
    v_mov_b32 v33, 0
    v_mov_b32 v34, 0
    v_mov_b32 v35, 0
    v_mov_b32 v36, 0
    v_mov_b32 v37, 0
    v_mov_b32 v38, 0
    v_mov_b32 v39, 0
    v_mov_b32 v40, 0
    v_mov_b32 v41, 0
    v_mov_b32 v42, 0
    v_mov_b32 v43, 0
    v_mov_b32 v44, 0
    v_mov_b32 v45, 0
    v_mov_b32 v46, 0
    v_mov_b32 v47, 0
    v_mov_b32 v48, 0
    v_mov_b32 v49, 0
    v_mov_b32 v50, 0
    v_mov_b32 v51, 0
    v_mov_b32 v52, 0
    v_mov_b32 v53, 0
    v_mov_b32 v54, 0
    v_mov_b32 v55, 0
    v_mov_b32 v56, 0
    v_mov_b32 v57, 0
    v_mov_b32 v58, 0
    v_mov_b32 v59, 0
    v_mov_b32 v60, 0
    v_mov_b32 v61, 0
    v_mov_b32 v62, 0
    v_mov_b32 v63, 0
    v_mov_b32 v64, 0
    v_mov_b32 v65, 0
    v_mov_b32 v66, 0
    v_mov_b32 v67, 0
    v_mov_b32 v68, 0
    v_mov_b32 v69, 0
    v_mov_b32 v70, 0
    v_mov_b32 v71, 0
    v_mov_b32 v72, 0
    v_mov_b32 v73, 0
    v_mov_b32 v74, 0
    v_mov_b32 v75, 0
    v_mov_b32 v76, 0
    v_mov_b32 v77, 0
    v_mov_b32 v78, 0
    v_mov_b32 v79, 0
    v_mov_b32 v80, 0
    v_mov_b32 v81, 0
    v_mov_b32 v82, 0
    v_mov_b32 v83, 0
    v_mov_b32 v84, 0
    v_mov_b32 v85, 0
    v_mov_b32 v86, 0
    v_mov_b32 v87, 0
    v_mov_b32 v88, 0
    v_mov_b32 v89, 0
    v_mov_b32 v90, 0
    v_mov_b32 v91, 0
    v_mov_b32 v92, 0
    v_mov_b32 v93, 0
    v_mov_b32 v94, 0
    v_mov_b32 v95, 0
    s_nop 1
    s_branch L_p2_nofl
L_p2_r2a:
    ds_read_b32 v9, v12
    s_waitcnt lgkmcnt(0)
    v_cmp_gt_u32 vcc, 3, v9
    s_cbranch_vccz L_p2_r2b
    s_add_u32 s67, s67, 1
    s_cmp_lt_u32 s67, 0x2000000
    s_cbranch_scc1 L_p2_r2a
    s_branch L_p2_r2b
L_p2_r3a:
    ds_read_b32 v9, v12
    s_waitcnt lgkmcnt(0)
    v_cmp_gt_u32 vcc, 4, v9
    s_cbranch_vccz L_p2_r3b
    s_add_u32 s67, s67, 1
    s_cmp_lt_u32 s67, 0x2000000
    s_cbranch_scc1 L_p2_r3a
    s_branch L_p2_r3b
L_p2_r4a:
    ds_read_b32 v9, v12
    s_waitcnt lgkmcnt(0)
    v_cmp_gt_u32 vcc, 5, v9
    s_cbranch_vccz L_p2_r4b
    s_add_u32 s67, s67, 1
    s_cmp_lt_u32 s67, 0x2000000
    s_cbranch_scc1 L_p2_r4a
    s_branch L_p2_r4b
L_p2_r5a:
    ds_read_b32 v9, v12
    s_waitcnt lgkmcnt(0)
    v_cmp_gt_u32 vcc, 6, v9
    s_cbranch_vccz L_p2_r5b
    s_add_u32 s67, s67, 1
    s_cmp_lt_u32 s67, 0x2000000
    s_cbranch_scc1 L_p2_r5a
    s_branch L_p2_r5b
L_p2_r6a:
    ds_read_b32 v9, v12
    s_waitcnt lgkmcnt(0)
    v_cmp_gt_u32 vcc, 7, v9
    s_cbranch_vccz L_p2_r6b
    s_add_u32 s67, s67, 1
    s_cmp_lt_u32 s67, 0x2000000
    s_cbranch_scc1 L_p2_r6a
    s_branch L_p2_r6b
L_p2_r7a:
    ds_read_b32 v9, v12
    s_waitcnt lgkmcnt(0)
    v_cmp_gt_u32 vcc, 8, v9
    s_cbranch_vccz L_p2_r7b
    s_add_u32 s67, s67, 1
    s_cmp_lt_u32 s67, 0x2000000
    s_cbranch_scc1 L_p2_r7a
    s_branch L_p2_r7b
L_p2_r8a:
    ds_read_b32 v9, v12
    s_waitcnt lgkmcnt(0)
    v_cmp_gt_u32 vcc, 9, v9
    s_cbranch_vccz L_p2_r8b
    s_add_u32 s67, s67, 1
    s_cmp_lt_u32 s67, 0x2000000
    s_cbranch_scc1 L_p2_r8a
    s_branch L_p2_r8b
L_p2_r9a:
    ds_read_b32 v9, v12
    s_waitcnt lgkmcnt(0)
    v_cmp_gt_u32 vcc, 10, v9
    s_cbranch_vccz L_p2_r9b
    s_add_u32 s67, s67, 1
    s_cmp_lt_u32 s67, 0x2000000
    s_cbranch_scc1 L_p2_r9a
    s_branch L_p2_r9b
L_p2_r10a:
    ds_read_b32 v9, v12
    s_waitcnt lgkmcnt(0)
    v_cmp_gt_u32 vcc, 11, v9
    s_cbranch_vccz L_p2_r10b
    s_add_u32 s67, s67, 1
    s_cmp_lt_u32 s67, 0x2000000
    s_cbranch_scc1 L_p2_r10a
    s_branch L_p2_r10b
L_p2_r11a:
    ds_read_b32 v9, v12
    s_waitcnt lgkmcnt(0)
    v_cmp_gt_u32 vcc, 12, v9
    s_cbranch_vccz L_p2_r11b
    s_add_u32 s67, s67, 1
    s_cmp_lt_u32 s67, 0x2000000
    s_cbranch_scc1 L_p2_r11a
    s_branch L_p2_r11b
L_c_ssm:
    v_lshlrev_b32 v100, 16, v100
    v_lshlrev_b32 v101, 16, v101
    v_lshlrev_b32 v102, 16, v102
    s_mov_b32 s68, 0x3fb8aa3b
    s_mov_b32 s69, 0x32a57060
    s_mov_b32 s70, 0x3f317218
    v_mul_f32 v104, s68, v102
    v_fma_f32 v105, v102, s68, -v104
    v_fma_f32 v105, v102, s69, v105
    v_exp_f32 v104, v104
    v_mul_f32 v105, s70, v105
    v_fma_f32 v102, v104, v105, v104
    v_cvt_pk_bf16_f32 v102, v102, v102
    v_lshlrev_b32 v102, 16, v102
    v_mul_f32 v106, v102, v100
    v_mul_f32 v107, v102, v101
    v_mul_f32 v104, s68, v106
    v_fma_f32 v105, v106, s68, -v104
    v_fma_f32 v105, v106, s69, v105
    v_exp_f32 v104, v104
    v_mul_f32 v105, s70, v105
    v_fma_f32 v106, v104, v105, v104
    s_mov_b32 s68, 0x3e22f983
    s_mov_b32 s69, 0x31dc9c88
    v_mul_f32 v104, s68, v107
    v_fma_f32 v105, v107, s68, -v104
    v_fma_f32 v105, v107, s69, v105
    v_rndne_f32 v103, v104
    v_sub_f32 v104, v104, v103
    v_add_f32 v104, v104, v105
    v_cos_f32 v108, v104
    v_sin_f32 v109, v104
    s_nop 0
    v_mul_f32 v110, v106, v108
    v_mul_f32 v111, v106, v109
    v_max_f32 v106, |v100|, |v101|
    v_rcp_f32 v107, v106
    v_add_f32 v108, -1.0, v110
    v_mul_f32 v100, v100, v107
    v_mul_f32 v101, v101, v107
    v_mul_f32 v109, v100, v100
    v_fma_f32 v109, v101, v101, v109
    v_mul_f32 v109, v109, v106
    v_rcp_f32 v109, v109
    v_mul_f32 v104, v108, v100
    v_fma_f32 v104, v111, v101, v104
    v_mul_f32 v105, v111, v100
    v_fma_f32 v105, -v108, v101, v105
    v_add_f32 v109, v109, v109
    v_mul_f32 v112, v104, v109
    v_mul_f32 v113, v105, v109
    v_pk_mul_f32 v[124:125], v[110:111], v[110:111] op_sel:[0,0] op_sel_hi:[0,1]
    s_nop 0
    v_pk_fma_f32 v[114:115], v[110:111], v[110:111], v[124:125] op_sel:[1,1,0] op_sel_hi:[1,0,1] neg_lo:[1,0,0]
    s_nop 0
    v_pk_mul_f32 v[124:125], v[114:115], v[114:115] op_sel:[0,0] op_sel_hi:[0,1]
    s_nop 0
    v_pk_fma_f32 v[126:127], v[114:115], v[114:115], v[124:125] op_sel:[1,1,0] op_sel_hi:[1,0,1] neg_lo:[1,0,0]
    s_nop 0
    v_pk_mul_f32 v[124:125], v[126:127], v[126:127] op_sel:[0,0] op_sel_hi:[0,1]
    s_nop 0
    v_pk_fma_f32 v[114:115], v[126:127], v[126:127], v[124:125] op_sel:[1,1,0] op_sel_hi:[1,0,1] neg_lo:[1,0,0]
    s_nop 0
    v_pk_mul_f32 v[124:125], v[114:115], v[114:115] op_sel:[0,0] op_sel_hi:[0,1]
    s_nop 0
    v_pk_fma_f32 v[240:241], v[114:115], v[114:115], v[124:125] op_sel:[1,1,0] op_sel_hi:[1,0,1] neg_lo:[1,0,0]
    s_nop 0
    v_pk_mul_f32 v[124:125], v[240:241], v[240:241] op_sel:[0,0] op_sel_hi:[0,1]
    s_nop 0
    v_pk_fma_f32 v[128:129], v[240:241], v[240:241], v[124:125] op_sel:[1,1,0] op_sel_hi:[1,0,1] neg_lo:[1,0,0]
    s_nop 0
    v_pk_mul_f32 v[124:125], v[128:129], v[128:129] op_sel:[0,0] op_sel_hi:[0,1]
    s_nop 0
    v_pk_fma_f32 v[130:131], v[128:129], v[128:129], v[124:125] op_sel:[1,1,0] op_sel_hi:[1,0,1] neg_lo:[1,0,0]
    s_nop 0
    v_pk_mul_f32 v[124:125], v[130:131], v[130:131] op_sel:[0,0] op_sel_hi:[0,1]
    s_nop 0
    v_pk_fma_f32 v[132:133], v[130:131], v[130:131], v[124:125] op_sel:[1,1,0] op_sel_hi:[1,0,1] neg_lo:[1,0,0]
    s_nop 0
    v_pk_mul_f32 v[124:125], v[132:133], v[132:133] op_sel:[0,0] op_sel_hi:[0,1]
    s_nop 0
    v_pk_fma_f32 v[242:243], v[132:133], v[132:133], v[124:125] op_sel:[1,1,0] op_sel_hi:[1,0,1] neg_lo:[1,0,0]
    v_mov_b32 v116, 1.0
    v_mov_b32 v117, 0
    s_bitcmp0_b32 s3, 0
    s_cbranch_scc1 L_pw0
    v_pk_mul_f32 v[124:125], v[116:117], v[130:131] op_sel:[0,0] op_sel_hi:[0,1]
    s_nop 0
    v_pk_fma_f32 v[126:127], v[116:117], v[130:131], v[124:125] op_sel:[1,1,0] op_sel_hi:[1,0,1] neg_lo:[1,0,0]
    s_nop 0
    v_mov_b32 v116, v126
    v_mov_b32 v117, v127
L_pw0:
    s_bitcmp0_b32 s3, 1
    s_cbranch_scc1 L_pw1
    v_pk_mul_f32 v[124:125], v[116:117], v[132:133] op_sel:[0,0] op_sel_hi:[0,1]
    s_nop 0
    v_pk_fma_f32 v[126:127], v[116:117], v[132:133], v[124:125] op_sel:[1,1,0] op_sel_hi:[1,0,1] neg_lo:[1,0,0]
    s_nop 0
    v_mov_b32 v116, v126
    v_mov_b32 v117, v127
L_pw1:
    v_pk_mul_f32 v[124:125], v[116:117], v[240:241] op_sel:[0,0] op_sel_hi:[0,1]
    s_nop 0
    v_pk_fma_f32 v[118:119], v[116:117], v[240:241], v[124:125] op_sel:[1,1,0] op_sel_hi:[1,0,1] neg_lo:[1,0,0]
    v_pk_mul_f32 v[124:125], v[116:117], v[128:129] op_sel:[0,0] op_sel_hi:[0,1]
    s_nop 0
    v_pk_fma_f32 v[120:121], v[116:117], v[128:129], v[124:125] op_sel:[1,1,0] op_sel_hi:[1,0,1] neg_lo:[1,0,0]
    s_nop 0
    v_pk_mul_f32 v[124:125], v[120:121], v[240:241] op_sel:[0,0] op_sel_hi:[0,1]
    s_nop 0
    v_pk_fma_f32 v[122:123], v[120:121], v[240:241], v[124:125] op_sel:[1,1,0] op_sel_hi:[1,0,1] neg_lo:[1,0,0]
    v_lshlrev_b32 v6, 3, v0
    v_add_u32 v6, 147456, v6
    ds_write_b64 v6, v[240:241] offset:9728
    ds_write_b64 v6, v[242:243] offset:10240
    s_mul_i32 s68, s3, 3584
    s_add_u32 s68, s68, 98304
    v_lshlrev_b32 v2, 3, v0
    v_add_u32 v2, s68, v2
    ds_write_b64 v2, v[110:111] offset:0
    ds_write_b64 v2, v[112:113] offset:512
    ds_write_b64 v2, v[114:115] offset:1024
    ds_write_b64 v2, v[116:117] offset:1536
    ds_write_b64 v2, v[118:119] offset:2048
    ds_write_b64 v2, v[120:121] offset:2560
    ds_write_b64 v2, v[122:123] offset:3072
    v_and_b32 v8, 15, v0
    v_lshrrev_b32 v9, 4, v0
    v_lshlrev_b32 v2, 3, v8
    v_add_u32 v2, s68, v2
    v_lshl_add_u32 v3, v9, 9, v2
    s_waitcnt lgkmcnt(0)
    ds_read_b64 v[208:209], v2 offset:0
    ds_read_b64 v[216:217], v2 offset:512
    ds_read_b64 v[224:225], v2 offset:1024
    ds_read_b64 v[232:233], v3 offset:1536
    ds_read_b64 v[210:211], v2 offset:128
    ds_read_b64 v[218:219], v2 offset:640
    ds_read_b64 v[226:227], v2 offset:1152
    ds_read_b64 v[234:235], v3 offset:1664
    ds_read_b64 v[212:213], v2 offset:256
    ds_read_b64 v[220:221], v2 offset:768
    ds_read_b64 v[228:229], v2 offset:1280
    ds_read_b64 v[236:237], v3 offset:1792
    ds_read_b64 v[214:215], v2 offset:384
    ds_read_b64 v[222:223], v2 offset:896
    ds_read_b64 v[230:231], v2 offset:1408
    ds_read_b64 v[238:239], v3 offset:1920
    v_bfe_u32 v10, v0, 1, 3
    v_xor_b32 v10, v10, v9
    v_lshlrev_b32 v10, 4, v10
    v_lshl_add_u32 v10, v8, 7, v10
    s_lshl_b32 s68, s3, 13
    v_add_u32 v2, s68, v10
    v_xor_b32 v3, 64, v2
    v_add_u32 v4, 98304, v2
    v_add_u32 v5, 98304, v3
    v_add_u32 v6, 32768, v10
    v_xor_b32 v7, 64, v6
    v_add_u32 v12, 98304, v6
    v_add_u32 v13, 98304, v7
    s_waitcnt lgkmcnt(0)
    v_mov_b32 v14, s91
    s_lshl_b32 s68, s3, 2
    v_add_u32 v254, s68, v14
    s_setprio 3
    s_add_u32 s56, s34, 0xf60000
    s_addc_u32 s57, s35, 0
    s_mov_b32 s58, 65536
    s_mov_b32 s59, 0x00020000
    s_barrier
    ds_read_b128 v[48:51], v2 offset:0
    ds_read_b128 v[52:55], v2 offset:2048
    ds_read_b128 v[56:59], v2 offset:4096
    ds_read_b128 v[60:63], v2 offset:6144
    ds_read_b128 v[16:19], v6 offset:0
    ds_read_b128 v[20:23], v6 offset:2048
    ds_read_b128 v[24:27], v6 offset:4096
    ds_read_b128 v[28:31], v6 offset:6144
    ds_read_b128 v[32:35], v6 offset:8192
    ds_read_b128 v[36:39], v6 offset:10240
    s_waitcnt lgkmcnt(5)
    v_mfma_f32_16x16x32_bf16 v[80:83], v[48:51], v[16:19], 0
    v_mfma_f32_16x16x32_bf16 v[84:87], v[52:55], v[16:19], 0
    v_mfma_f32_16x16x32_bf16 v[88:91], v[56:59], v[16:19], 0
    v_mfma_f32_16x16x32_bf16 v[92:95], v[60:63], v[16:19], 0
    ds_read_b128 v[40:43], v6 offset:12288
    s_waitcnt lgkmcnt(5)
    v_mfma_f32_16x16x32_bf16 v[96:99], v[48:51], v[20:23], 0
    v_mfma_f32_16x16x32_bf16 v[100:103], v[52:55], v[20:23], 0
    v_mfma_f32_16x16x32_bf16 v[104:107], v[56:59], v[20:23], 0
    v_mfma_f32_16x16x32_bf16 v[108:111], v[60:63], v[20:23], 0
    ds_read_b128 v[44:47], v6 offset:14336
    ds_read_b128 v[64:67], v3 offset:0
    s_waitcnt lgkmcnt(6)
    v_mfma_f32_16x16x32_bf16 v[112:115], v[48:51], v[24:27], 0
    ds_read_b128 v[68:71], v3 offset:2048
    v_mfma_f32_16x16x32_bf16 v[116:119], v[52:55], v[24:27], 0
    ds_read_b128 v[72:75], v3 offset:4096
    v_mfma_f32_16x16x32_bf16 v[120:123], v[56:59], v[24:27], 0
    ds_read_b128 v[76:79], v3 offset:6144
    v_mfma_f32_16x16x32_bf16 v[124:127], v[60:63], v[24:27], 0
    ds_read_b128 v[16:19], v7 offset:0
    s_waitcnt lgkmcnt(9)
    v_mfma_f32_16x16x32_bf16 v[128:131], v[48:51], v[28:31], 0
    v_mfma_f32_16x16x32_bf16 v[132:135], v[52:55], v[28:31], 0
    v_mfma_f32_16x16x32_bf16 v[136:139], v[56:59], v[28:31], 0
    v_mfma_f32_16x16x32_bf16 v[140:143], v[60:63], v[28:31], 0
    ds_read_b128 v[20:23], v7 offset:2048
    s_waitcnt lgkmcnt(9)
    v_mfma_f32_16x16x32_bf16 v[144:147], v[48:51], v[32:35], 0
    v_mfma_f32_16x16x32_bf16 v[148:151], v[52:55], v[32:35], 0
    v_mfma_f32_16x16x32_bf16 v[152:155], v[56:59], v[32:35], 0
    v_mfma_f32_16x16x32_bf16 v[156:159], v[60:63], v[32:35], 0
    ds_read_b128 v[24:27], v7 offset:4096
    s_waitcnt lgkmcnt(9)
    v_mfma_f32_16x16x32_bf16 v[160:163], v[48:51], v[36:39], 0
    v_mfma_f32_16x16x32_bf16 v[164:167], v[52:55], v[36:39], 0
    v_mfma_f32_16x16x32_bf16 v[168:171], v[56:59], v[36:39], 0
    v_mfma_f32_16x16x32_bf16 v[172:175], v[60:63], v[36:39], 0
    ds_read_b128 v[28:31], v7 offset:6144
    s_waitcnt lgkmcnt(9)
    v_mfma_f32_16x16x32_bf16 v[176:179], v[48:51], v[40:43], 0
    v_mfma_f32_16x16x32_bf16 v[180:183], v[52:55], v[40:43], 0
    v_mfma_f32_16x16x32_bf16 v[184:187], v[56:59], v[40:43], 0
    v_mfma_f32_16x16x32_bf16 v[188:191], v[60:63], v[40:43], 0
    ds_read_b128 v[32:35], v7 offset:8192
    s_waitcnt lgkmcnt(9)
    v_mfma_f32_16x16x32_bf16 v[192:195], v[48:51], v[44:47], 0
    v_mfma_f32_16x16x32_bf16 v[196:199], v[52:55], v[44:47], 0
    v_mfma_f32_16x16x32_bf16 v[200:203], v[56:59], v[44:47], 0
    v_mfma_f32_16x16x32_bf16 v[204:207], v[60:63], v[44:47], 0
    ds_read_b128 v[36:39], v7 offset:10240
    s_waitcnt lgkmcnt(5)
    v_mfma_f32_16x16x32_bf16 v[80:83], v[64:67], v[16:19], v[80:83]
    v_mfma_f32_16x16x32_bf16 v[84:87], v[68:71], v[16:19], v[84:87]
    v_mfma_f32_16x16x32_bf16 v[88:91], v[72:75], v[16:19], v[88:91]
    v_mfma_f32_16x16x32_bf16 v[92:95], v[76:79], v[16:19], v[92:95]
    ds_read_b128 v[40:43], v7 offset:12288
    s_waitcnt lgkmcnt(5)
    v_mfma_f32_16x16x32_bf16 v[96:99], v[64:67], v[20:23], v[96:99]
    v_mfma_f32_16x16x32_bf16 v[100:103], v[68:71], v[20:23], v[100:103]
    v_mfma_f32_16x16x32_bf16 v[104:107], v[72:75], v[20:23], v[104:107]
    v_mfma_f32_16x16x32_bf16 v[108:111], v[76:79], v[20:23], v[108:111]
    ds_read_b128 v[44:47], v7 offset:14336
    s_waitcnt lgkmcnt(5)
    v_mfma_f32_16x16x32_bf16 v[112:115], v[64:67], v[24:27], v[112:115]
    v_mfma_f32_16x16x32_bf16 v[116:119], v[68:71], v[24:27], v[116:119]
    v_mfma_f32_16x16x32_bf16 v[120:123], v[72:75], v[24:27], v[120:123]
    v_mfma_f32_16x16x32_bf16 v[124:127], v[76:79], v[24:27], v[124:127]
    s_waitcnt lgkmcnt(4)
    v_mfma_f32_16x16x32_bf16 v[128:131], v[64:67], v[28:31], v[128:131]
    ds_read_b128 v[8:11], v14 offset:32
    v_mfma_f32_16x16x32_bf16 v[132:135], v[68:71], v[28:31], v[132:135]
    v_mfma_f32_16x16x32_bf16 v[136:139], v[72:75], v[28:31], v[136:139]
    v_mfma_f32_16x16x32_bf16 v[140:143], v[76:79], v[28:31], v[140:143]
    s_waitcnt lgkmcnt(4)
    v_mfma_f32_16x16x32_bf16 v[144:147], v[64:67], v[32:35], v[144:147]
    v_mfma_f32_16x16x32_bf16 v[148:151], v[68:71], v[32:35], v[148:151]
    v_mfma_f32_16x16x32_bf16 v[152:155], v[72:75], v[32:35], v[152:155]
    v_mfma_f32_16x16x32_bf16 v[156:159], v[76:79], v[32:35], v[156:159]
    s_waitcnt lgkmcnt(0)
    v_mfma_f32_16x16x32_bf16 v[160:163], v[64:67], v[36:39], v[160:163]
    v_mov_b32 v15, 1
    v_min3_u32 v8, v8, v9, v10
    v_mfma_f32_16x16x32_bf16 v[164:167], v[68:71], v[36:39], v[164:167]
    ds_write_b32 v254, v15 offset:48
    v_min_u32 v8, v8, v11
    v_mfma_f32_16x16x32_bf16 v[168:171], v[72:75], v[36:39], v[168:171]
    v_cmp_gt_u32 vcc, 2, v8
    v_mfma_f32_16x16x32_bf16 v[172:175], v[76:79], v[36:39], v[172:175]
    s_cbranch_vccnz L_ssm_s1a
L_ssm_s1b:
    ds_read_b128 v[48:51], v2 offset:49152
    ds_read_b128 v[52:55], v2 offset:51200
    v_mfma_f32_16x16x32_bf16 v[176:179], v[64:67], v[40:43], v[176:179]
    ds_read_b128 v[56:59], v2 offset:53248
    v_mfma_f32_16x16x32_bf16 v[180:183], v[68:71], v[40:43], v[180:183]
    ds_read_b128 v[60:63], v2 offset:55296
    v_mfma_f32_16x16x32_bf16 v[184:187], v[72:75], v[40:43], v[184:187]
    ds_read_b128 v[16:19], v6 offset:49152
    v_mfma_f32_16x16x32_bf16 v[188:191], v[76:79], v[40:43], v[188:191]
    ds_read_b128 v[20:23], v6 offset:51200
    ds_read_b128 v[24:27], v6 offset:53248
    v_mfma_f32_16x16x32_bf16 v[192:195], v[64:67], v[44:47], v[192:195]
    ds_read_b128 v[28:31], v6 offset:55296
    v_mfma_f32_16x16x32_bf16 v[196:199], v[68:71], v[44:47], v[196:199]
    ds_read_b128 v[32:35], v6 offset:57344
    v_mfma_f32_16x16x32_bf16 v[200:203], v[72:75], v[44:47], v[200:203]
    v_mfma_f32_16x16x32_bf16 v[204:207], v[76:79], v[44:47], v[204:207]
    ds_read_b128 v[36:39], v6 offset:59392
    s_waitcnt lgkmcnt(5)
    v_mfma_f32_16x16x32_bf16 v[80:83], v[48:51], v[16:19], v[80:83]
    v_mfma_f32_16x16x32_bf16 v[84:87], v[52:55], v[16:19], v[84:87]
    v_mfma_f32_16x16x32_bf16 v[88:91], v[56:59], v[16:19], v[88:91]
    v_mfma_f32_16x16x32_bf16 v[92:95], v[60:63], v[16:19], v[92:95]
    ds_read_b128 v[40:43], v6 offset:61440
    s_waitcnt lgkmcnt(5)
    v_mfma_f32_16x16x32_bf16 v[96:99], v[48:51], v[20:23], v[96:99]
    v_mfma_f32_16x16x32_bf16 v[100:103], v[52:55], v[20:23], v[100:103]
    v_mfma_f32_16x16x32_bf16 v[104:107], v[56:59], v[20:23], v[104:107]
    v_mfma_f32_16x16x32_bf16 v[108:111], v[60:63], v[20:23], v[108:111]
    ds_read_b128 v[44:47], v6 offset:63488
    ds_read_b128 v[64:67], v3 offset:49152
    s_waitcnt lgkmcnt(6)
    v_mfma_f32_16x16x32_bf16 v[112:115], v[48:51], v[24:27], v[112:115]
    ds_read_b128 v[68:71], v3 offset:51200
    v_mfma_f32_16x16x32_bf16 v[116:119], v[52:55], v[24:27], v[116:119]
    ds_read_b128 v[72:75], v3 offset:53248
    v_mfma_f32_16x16x32_bf16 v[120:123], v[56:59], v[24:27], v[120:123]
    ds_read_b128 v[76:79], v3 offset:55296
    v_mfma_f32_16x16x32_bf16 v[124:127], v[60:63], v[24:27], v[124:127]
    ds_read_b128 v[16:19], v7 offset:49152
    s_waitcnt lgkmcnt(9)
    v_mfma_f32_16x16x32_bf16 v[128:131], v[48:51], v[28:31], v[128:131]
    v_mfma_f32_16x16x32_bf16 v[132:135], v[52:55], v[28:31], v[132:135]
    v_mfma_f32_16x16x32_bf16 v[136:139], v[56:59], v[28:31], v[136:139]
    v_mfma_f32_16x16x32_bf16 v[140:143], v[60:63], v[28:31], v[140:143]
    ds_read_b128 v[20:23], v7 offset:51200
    s_waitcnt lgkmcnt(9)
    v_mfma_f32_16x16x32_bf16 v[144:147], v[48:51], v[32:35], v[144:147]
    v_mfma_f32_16x16x32_bf16 v[148:151], v[52:55], v[32:35], v[148:151]
    v_mfma_f32_16x16x32_bf16 v[152:155], v[56:59], v[32:35], v[152:155]
    v_mfma_f32_16x16x32_bf16 v[156:159], v[60:63], v[32:35], v[156:159]
    ds_read_b128 v[24:27], v7 offset:53248
    s_waitcnt lgkmcnt(9)
    v_mfma_f32_16x16x32_bf16 v[160:163], v[48:51], v[36:39], v[160:163]
    v_mfma_f32_16x16x32_bf16 v[164:167], v[52:55], v[36:39], v[164:167]
    v_mfma_f32_16x16x32_bf16 v[168:171], v[56:59], v[36:39], v[168:171]
    v_mfma_f32_16x16x32_bf16 v[172:175], v[60:63], v[36:39], v[172:175]
    ds_read_b128 v[28:31], v7 offset:55296
    s_waitcnt lgkmcnt(9)
    v_mfma_f32_16x16x32_bf16 v[176:179], v[48:51], v[40:43], v[176:179]
    v_mfma_f32_16x16x32_bf16 v[180:183], v[52:55], v[40:43], v[180:183]
    v_mfma_f32_16x16x32_bf16 v[184:187], v[56:59], v[40:43], v[184:187]
    v_mfma_f32_16x16x32_bf16 v[188:191], v[60:63], v[40:43], v[188:191]
    ds_read_b128 v[32:35], v7 offset:57344
    s_waitcnt lgkmcnt(9)
    v_mfma_f32_16x16x32_bf16 v[192:195], v[48:51], v[44:47], v[192:195]
    v_mfma_f32_16x16x32_bf16 v[196:199], v[52:55], v[44:47], v[196:199]
    v_mfma_f32_16x16x32_bf16 v[200:203], v[56:59], v[44:47], v[200:203]
    v_mfma_f32_16x16x32_bf16 v[204:207], v[60:63], v[44:47], v[204:207]
    ds_read_b128 v[36:39], v7 offset:59392
    s_waitcnt lgkmcnt(5)
    v_mfma_f32_16x16x32_bf16 v[80:83], v[64:67], v[16:19], v[80:83]
    v_mfma_f32_16x16x32_bf16 v[84:87], v[68:71], v[16:19], v[84:87]
    v_mfma_f32_16x16x32_bf16 v[88:91], v[72:75], v[16:19], v[88:91]
    v_mfma_f32_16x16x32_bf16 v[92:95], v[76:79], v[16:19], v[92:95]
    ds_read_b128 v[40:43], v7 offset:61440
    s_waitcnt lgkmcnt(5)
    v_mfma_f32_16x16x32_bf16 v[96:99], v[64:67], v[20:23], v[96:99]
    v_mfma_f32_16x16x32_bf16 v[100:103], v[68:71], v[20:23], v[100:103]
    v_mfma_f32_16x16x32_bf16 v[104:107], v[72:75], v[20:23], v[104:107]
    v_mfma_f32_16x16x32_bf16 v[108:111], v[76:79], v[20:23], v[108:111]
    ds_read_b128 v[44:47], v7 offset:63488
    s_waitcnt lgkmcnt(5)
    v_mfma_f32_16x16x32_bf16 v[112:115], v[64:67], v[24:27], v[112:115]
    v_mfma_f32_16x16x32_bf16 v[116:119], v[68:71], v[24:27], v[116:119]
    v_mfma_f32_16x16x32_bf16 v[120:123], v[72:75], v[24:27], v[120:123]
    v_mfma_f32_16x16x32_bf16 v[124:127], v[76:79], v[24:27], v[124:127]
    s_waitcnt lgkmcnt(4)
    v_mfma_f32_16x16x32_bf16 v[128:131], v[64:67], v[28:31], v[128:131]
    ds_read_b128 v[8:11], v14 offset:32
    v_mfma_f32_16x16x32_bf16 v[132:135], v[68:71], v[28:31], v[132:135]
    v_mfma_f32_16x16x32_bf16 v[136:139], v[72:75], v[28:31], v[136:139]
    v_mfma_f32_16x16x32_bf16 v[140:143], v[76:79], v[28:31], v[140:143]
    s_waitcnt lgkmcnt(4)
    v_mfma_f32_16x16x32_bf16 v[144:147], v[64:67], v[32:35], v[144:147]
    v_mfma_f32_16x16x32_bf16 v[148:151], v[68:71], v[32:35], v[148:151]
    v_mfma_f32_16x16x32_bf16 v[152:155], v[72:75], v[32:35], v[152:155]
    v_mfma_f32_16x16x32_bf16 v[156:159], v[76:79], v[32:35], v[156:159]
    s_waitcnt lgkmcnt(0)
    v_mfma_f32_16x16x32_bf16 v[160:163], v[64:67], v[36:39], v[160:163]
    v_mov_b32 v15, 2
    v_min3_u32 v8, v8, v9, v10
    v_mfma_f32_16x16x32_bf16 v[164:167], v[68:71], v[36:39], v[164:167]
    ds_write_b32 v254, v15 offset:48
    v_min_u32 v8, v8, v11
    v_mfma_f32_16x16x32_bf16 v[168:171], v[72:75], v[36:39], v[168:171]
    v_cmp_gt_u32 vcc, 3, v8
    v_mfma_f32_16x16x32_bf16 v[172:175], v[76:79], v[36:39], v[172:175]
    s_cbranch_vccnz L_ssm_s2a
L_ssm_s2b:
    ds_read_b128 v[48:51], v4 offset:0
    ds_read_b128 v[52:55], v4 offset:2048
    v_mfma_f32_16x16x32_bf16 v[176:179], v[64:67], v[40:43], v[176:179]
    ds_read_b128 v[56:59], v4 offset:4096
    v_mfma_f32_16x16x32_bf16 v[180:183], v[68:71], v[40:43], v[180:183]
    ds_read_b128 v[60:63], v4 offset:6144
    v_mfma_f32_16x16x32_bf16 v[184:187], v[72:75], v[40:43], v[184:187]
    ds_read_b128 v[16:19], v12 offset:0
    v_mfma_f32_16x16x32_bf16 v[188:191], v[76:79], v[40:43], v[188:191]
    ds_read_b128 v[20:23], v12 offset:2048
    ds_read_b128 v[24:27], v12 offset:4096
    v_mfma_f32_16x16x32_bf16 v[192:195], v[64:67], v[44:47], v[192:195]
    ds_read_b128 v[28:31], v12 offset:6144
    v_mfma_f32_16x16x32_bf16 v[196:199], v[68:71], v[44:47], v[196:199]
    ds_read_b128 v[32:35], v12 offset:8192
    v_mfma_f32_16x16x32_bf16 v[200:203], v[72:75], v[44:47], v[200:203]
    v_mfma_f32_16x16x32_bf16 v[204:207], v[76:79], v[44:47], v[204:207]
    ds_read_b128 v[36:39], v12 offset:10240
    s_waitcnt lgkmcnt(5)
    v_mfma_f32_16x16x32_bf16 v[80:83], v[48:51], v[16:19], v[80:83]
    v_mfma_f32_16x16x32_bf16 v[84:87], v[52:55], v[16:19], v[84:87]
    v_mfma_f32_16x16x32_bf16 v[88:91], v[56:59], v[16:19], v[88:91]
    v_mfma_f32_16x16x32_bf16 v[92:95], v[60:63], v[16:19], v[92:95]
    ds_read_b128 v[40:43], v12 offset:12288
    s_waitcnt lgkmcnt(5)
    v_mfma_f32_16x16x32_bf16 v[96:99], v[48:51], v[20:23], v[96:99]
    v_mfma_f32_16x16x32_bf16 v[100:103], v[52:55], v[20:23], v[100:103]
    v_mfma_f32_16x16x32_bf16 v[104:107], v[56:59], v[20:23], v[104:107]
    v_mfma_f32_16x16x32_bf16 v[108:111], v[60:63], v[20:23], v[108:111]
    ds_read_b128 v[44:47], v12 offset:14336
    ds_read_b128 v[64:67], v5 offset:0
    s_waitcnt lgkmcnt(6)
    v_mfma_f32_16x16x32_bf16 v[112:115], v[48:51], v[24:27], v[112:115]
    ds_read_b128 v[68:71], v5 offset:2048
    v_mfma_f32_16x16x32_bf16 v[116:119], v[52:55], v[24:27], v[116:119]
    ds_read_b128 v[72:75], v5 offset:4096
    v_mfma_f32_16x16x32_bf16 v[120:123], v[56:59], v[24:27], v[120:123]
    ds_read_b128 v[76:79], v5 offset:6144
    v_mfma_f32_16x16x32_bf16 v[124:127], v[60:63], v[24:27], v[124:127]
    ds_read_b128 v[16:19], v13 offset:0
    s_waitcnt lgkmcnt(9)
    v_mfma_f32_16x16x32_bf16 v[128:131], v[48:51], v[28:31], v[128:131]
    v_mfma_f32_16x16x32_bf16 v[132:135], v[52:55], v[28:31], v[132:135]
    v_mfma_f32_16x16x32_bf16 v[136:139], v[56:59], v[28:31], v[136:139]
    v_mfma_f32_16x16x32_bf16 v[140:143], v[60:63], v[28:31], v[140:143]
    ds_read_b128 v[20:23], v13 offset:2048
    s_waitcnt lgkmcnt(9)
    v_mfma_f32_16x16x32_bf16 v[144:147], v[48:51], v[32:35], v[144:147]
    v_mfma_f32_16x16x32_bf16 v[148:151], v[52:55], v[32:35], v[148:151]
    v_mfma_f32_16x16x32_bf16 v[152:155], v[56:59], v[32:35], v[152:155]
    v_mfma_f32_16x16x32_bf16 v[156:159], v[60:63], v[32:35], v[156:159]
    ds_read_b128 v[24:27], v13 offset:4096
    s_waitcnt lgkmcnt(9)
    v_mfma_f32_16x16x32_bf16 v[160:163], v[48:51], v[36:39], v[160:163]
    v_mfma_f32_16x16x32_bf16 v[164:167], v[52:55], v[36:39], v[164:167]
    v_mfma_f32_16x16x32_bf16 v[168:171], v[56:59], v[36:39], v[168:171]
    v_mfma_f32_16x16x32_bf16 v[172:175], v[60:63], v[36:39], v[172:175]
    ds_read_b128 v[28:31], v13 offset:6144
    s_waitcnt lgkmcnt(9)
    v_mfma_f32_16x16x32_bf16 v[176:179], v[48:51], v[40:43], v[176:179]
    v_mfma_f32_16x16x32_bf16 v[180:183], v[52:55], v[40:43], v[180:183]
    v_mfma_f32_16x16x32_bf16 v[184:187], v[56:59], v[40:43], v[184:187]
    v_mfma_f32_16x16x32_bf16 v[188:191], v[60:63], v[40:43], v[188:191]
    ds_read_b128 v[32:35], v13 offset:8192
    s_waitcnt lgkmcnt(9)
    v_mfma_f32_16x16x32_bf16 v[192:195], v[48:51], v[44:47], v[192:195]
    v_mfma_f32_16x16x32_bf16 v[196:199], v[52:55], v[44:47], v[196:199]
    v_mfma_f32_16x16x32_bf16 v[200:203], v[56:59], v[44:47], v[200:203]
    v_mfma_f32_16x16x32_bf16 v[204:207], v[60:63], v[44:47], v[204:207]
    ds_read_b128 v[36:39], v13 offset:10240
    s_waitcnt lgkmcnt(5)
    v_mfma_f32_16x16x32_bf16 v[80:83], v[64:67], v[16:19], v[80:83]
    v_mfma_f32_16x16x32_bf16 v[84:87], v[68:71], v[16:19], v[84:87]
    v_mfma_f32_16x16x32_bf16 v[88:91], v[72:75], v[16:19], v[88:91]
    v_mfma_f32_16x16x32_bf16 v[92:95], v[76:79], v[16:19], v[92:95]
    ds_read_b128 v[40:43], v13 offset:12288
    s_waitcnt lgkmcnt(5)
    v_mfma_f32_16x16x32_bf16 v[96:99], v[64:67], v[20:23], v[96:99]
    v_mfma_f32_16x16x32_bf16 v[100:103], v[68:71], v[20:23], v[100:103]
    v_mfma_f32_16x16x32_bf16 v[104:107], v[72:75], v[20:23], v[104:107]
    v_mfma_f32_16x16x32_bf16 v[108:111], v[76:79], v[20:23], v[108:111]
    ds_read_b128 v[44:47], v13 offset:14336
    s_waitcnt lgkmcnt(5)
    v_mfma_f32_16x16x32_bf16 v[112:115], v[64:67], v[24:27], v[112:115]
    v_mfma_f32_16x16x32_bf16 v[116:119], v[68:71], v[24:27], v[116:119]
    v_mfma_f32_16x16x32_bf16 v[120:123], v[72:75], v[24:27], v[120:123]
    v_mfma_f32_16x16x32_bf16 v[124:127], v[76:79], v[24:27], v[124:127]
    s_waitcnt lgkmcnt(4)
    v_mfma_f32_16x16x32_bf16 v[128:131], v[64:67], v[28:31], v[128:131]
    ds_read_b128 v[8:11], v14 offset:32
    v_mfma_f32_16x16x32_bf16 v[132:135], v[68:71], v[28:31], v[132:135]
    v_mfma_f32_16x16x32_bf16 v[136:139], v[72:75], v[28:31], v[136:139]
    v_mfma_f32_16x16x32_bf16 v[140:143], v[76:79], v[28:31], v[140:143]
    s_waitcnt lgkmcnt(4)
    v_mfma_f32_16x16x32_bf16 v[144:147], v[64:67], v[32:35], v[144:147]
    v_mfma_f32_16x16x32_bf16 v[148:151], v[68:71], v[32:35], v[148:151]
    v_mfma_f32_16x16x32_bf16 v[152:155], v[72:75], v[32:35], v[152:155]
    v_mfma_f32_16x16x32_bf16 v[156:159], v[76:79], v[32:35], v[156:159]
    s_waitcnt lgkmcnt(0)
    v_mfma_f32_16x16x32_bf16 v[160:163], v[64:67], v[36:39], v[160:163]
    v_mov_b32 v15, 3
    v_min3_u32 v8, v8, v9, v10
    v_mfma_f32_16x16x32_bf16 v[164:167], v[68:71], v[36:39], v[164:167]
    ds_write_b32 v254, v15 offset:48
    v_min_u32 v8, v8, v11
    v_mfma_f32_16x16x32_bf16 v[168:171], v[72:75], v[36:39], v[168:171]
    v_cmp_gt_u32 vcc, 4, v8
    v_mfma_f32_16x16x32_bf16 v[172:175], v[76:79], v[36:39], v[172:175]
    s_cbranch_vccnz L_ssm_s3a
L_ssm_s3b:
    ds_read_b128 v[48:51], v2 offset:0
    ds_read_b128 v[52:55], v2 offset:2048
    v_mfma_f32_16x16x32_bf16 v[176:179], v[64:67], v[40:43], v[176:179]
    ds_read_b128 v[56:59], v2 offset:4096
    v_mfma_f32_16x16x32_bf16 v[180:183], v[68:71], v[40:43], v[180:183]
    ds_read_b128 v[60:63], v2 offset:6144
    v_mfma_f32_16x16x32_bf16 v[184:187], v[72:75], v[40:43], v[184:187]
    ds_read_b128 v[16:19], v6 offset:0
    v_mfma_f32_16x16x32_bf16 v[188:191], v[76:79], v[40:43], v[188:191]
    ds_read_b128 v[20:23], v6 offset:2048
    ds_read_b128 v[24:27], v6 offset:4096
    v_mfma_f32_16x16x32_bf16 v[192:195], v[64:67], v[44:47], v[192:195]
    ds_read_b128 v[28:31], v6 offset:6144
    v_mfma_f32_16x16x32_bf16 v[196:199], v[68:71], v[44:47], v[196:199]
    ds_read_b128 v[32:35], v6 offset:8192
    v_mfma_f32_16x16x32_bf16 v[200:203], v[72:75], v[44:47], v[200:203]
    v_mfma_f32_16x16x32_bf16 v[204:207], v[76:79], v[44:47], v[204:207]
    ds_read_b128 v[36:39], v6 offset:10240
    s_waitcnt lgkmcnt(5)
    v_mfma_f32_16x16x32_bf16 v[80:83], v[48:51], v[16:19], v[80:83]
    v_mfma_f32_16x16x32_bf16 v[84:87], v[52:55], v[16:19], v[84:87]
    v_mfma_f32_16x16x32_bf16 v[88:91], v[56:59], v[16:19], v[88:91]
    v_mfma_f32_16x16x32_bf16 v[92:95], v[60:63], v[16:19], v[92:95]
    ds_read_b128 v[40:43], v6 offset:12288
    s_waitcnt lgkmcnt(5)
    v_mfma_f32_16x16x32_bf16 v[96:99], v[48:51], v[20:23], v[96:99]
    v_mfma_f32_16x16x32_bf16 v[100:103], v[52:55], v[20:23], v[100:103]
    v_mfma_f32_16x16x32_bf16 v[104:107], v[56:59], v[20:23], v[104:107]
    v_mfma_f32_16x16x32_bf16 v[108:111], v[60:63], v[20:23], v[108:111]
    ds_read_b128 v[44:47], v6 offset:14336
    ds_read_b128 v[64:67], v3 offset:0
    s_waitcnt lgkmcnt(6)
    v_mfma_f32_16x16x32_bf16 v[112:115], v[48:51], v[24:27], v[112:115]
    ds_read_b128 v[68:71], v3 offset:2048
    v_mfma_f32_16x16x32_bf16 v[116:119], v[52:55], v[24:27], v[116:119]
    ds_read_b128 v[72:75], v3 offset:4096
    v_mfma_f32_16x16x32_bf16 v[120:123], v[56:59], v[24:27], v[120:123]
    ds_read_b128 v[76:79], v3 offset:6144
    v_mfma_f32_16x16x32_bf16 v[124:127], v[60:63], v[24:27], v[124:127]
    ds_read_b128 v[16:19], v7 offset:0
    s_waitcnt lgkmcnt(9)
    v_mfma_f32_16x16x32_bf16 v[128:131], v[48:51], v[28:31], v[128:131]
    v_mfma_f32_16x16x32_bf16 v[132:135], v[52:55], v[28:31], v[132:135]
    v_mfma_f32_16x16x32_bf16 v[136:139], v[56:59], v[28:31], v[136:139]
    v_mfma_f32_16x16x32_bf16 v[140:143], v[60:63], v[28:31], v[140:143]
    ds_read_b128 v[20:23], v7 offset:2048
    s_waitcnt lgkmcnt(9)
    v_mfma_f32_16x16x32_bf16 v[144:147], v[48:51], v[32:35], v[144:147]
    v_mfma_f32_16x16x32_bf16 v[148:151], v[52:55], v[32:35], v[148:151]
    v_mfma_f32_16x16x32_bf16 v[152:155], v[56:59], v[32:35], v[152:155]
    v_mfma_f32_16x16x32_bf16 v[156:159], v[60:63], v[32:35], v[156:159]
    ds_read_b128 v[24:27], v7 offset:4096
    s_waitcnt lgkmcnt(9)
    v_mfma_f32_16x16x32_bf16 v[160:163], v[48:51], v[36:39], v[160:163]
    v_mfma_f32_16x16x32_bf16 v[164:167], v[52:55], v[36:39], v[164:167]
    v_mfma_f32_16x16x32_bf16 v[168:171], v[56:59], v[36:39], v[168:171]
    v_mfma_f32_16x16x32_bf16 v[172:175], v[60:63], v[36:39], v[172:175]
    ds_read_b128 v[28:31], v7 offset:6144
    s_waitcnt lgkmcnt(9)
    v_mfma_f32_16x16x32_bf16 v[176:179], v[48:51], v[40:43], v[176:179]
    v_mfma_f32_16x16x32_bf16 v[180:183], v[52:55], v[40:43], v[180:183]
    v_mfma_f32_16x16x32_bf16 v[184:187], v[56:59], v[40:43], v[184:187]
    v_mfma_f32_16x16x32_bf16 v[188:191], v[60:63], v[40:43], v[188:191]
    ds_read_b128 v[32:35], v7 offset:8192
    s_waitcnt lgkmcnt(9)
    v_mfma_f32_16x16x32_bf16 v[192:195], v[48:51], v[44:47], v[192:195]
    v_mfma_f32_16x16x32_bf16 v[196:199], v[52:55], v[44:47], v[196:199]
    v_mfma_f32_16x16x32_bf16 v[200:203], v[56:59], v[44:47], v[200:203]
    v_mfma_f32_16x16x32_bf16 v[204:207], v[60:63], v[44:47], v[204:207]
    ds_read_b128 v[36:39], v7 offset:10240
    s_waitcnt lgkmcnt(5)
    v_mfma_f32_16x16x32_bf16 v[80:83], v[64:67], v[16:19], v[80:83]
    v_mfma_f32_16x16x32_bf16 v[84:87], v[68:71], v[16:19], v[84:87]
    v_mfma_f32_16x16x32_bf16 v[88:91], v[72:75], v[16:19], v[88:91]
    v_mfma_f32_16x16x32_bf16 v[92:95], v[76:79], v[16:19], v[92:95]
    ds_read_b128 v[40:43], v7 offset:12288
    s_waitcnt lgkmcnt(5)
    v_mfma_f32_16x16x32_bf16 v[96:99], v[64:67], v[20:23], v[96:99]
    v_mfma_f32_16x16x32_bf16 v[100:103], v[68:71], v[20:23], v[100:103]
    v_mfma_f32_16x16x32_bf16 v[104:107], v[72:75], v[20:23], v[104:107]
    v_mfma_f32_16x16x32_bf16 v[108:111], v[76:79], v[20:23], v[108:111]
    ds_read_b128 v[44:47], v7 offset:14336
    s_waitcnt lgkmcnt(5)
    v_mfma_f32_16x16x32_bf16 v[112:115], v[64:67], v[24:27], v[112:115]
    v_mfma_f32_16x16x32_bf16 v[116:119], v[68:71], v[24:27], v[116:119]
    v_mfma_f32_16x16x32_bf16 v[120:123], v[72:75], v[24:27], v[120:123]
    v_mfma_f32_16x16x32_bf16 v[124:127], v[76:79], v[24:27], v[124:127]
    s_waitcnt lgkmcnt(4)
    v_mfma_f32_16x16x32_bf16 v[128:131], v[64:67], v[28:31], v[128:131]
    ds_read_b128 v[8:11], v14 offset:32
    v_mfma_f32_16x16x32_bf16 v[132:135], v[68:71], v[28:31], v[132:135]
    v_mfma_f32_16x16x32_bf16 v[136:139], v[72:75], v[28:31], v[136:139]
    v_mfma_f32_16x16x32_bf16 v[140:143], v[76:79], v[28:31], v[140:143]
    s_waitcnt lgkmcnt(4)
    v_mfma_f32_16x16x32_bf16 v[144:147], v[64:67], v[32:35], v[144:147]
    v_mfma_f32_16x16x32_bf16 v[148:151], v[68:71], v[32:35], v[148:151]
    v_mfma_f32_16x16x32_bf16 v[152:155], v[72:75], v[32:35], v[152:155]
    v_mfma_f32_16x16x32_bf16 v[156:159], v[76:79], v[32:35], v[156:159]
    s_waitcnt lgkmcnt(0)
    v_mfma_f32_16x16x32_bf16 v[160:163], v[64:67], v[36:39], v[160:163]
    v_mov_b32 v15, 4
    v_min3_u32 v8, v8, v9, v10
    v_mfma_f32_16x16x32_bf16 v[164:167], v[68:71], v[36:39], v[164:167]
    ds_write_b32 v254, v15 offset:48
    v_min_u32 v8, v8, v11
    v_mfma_f32_16x16x32_bf16 v[168:171], v[72:75], v[36:39], v[168:171]
    v_cmp_gt_u32 vcc, 5, v8
    v_mfma_f32_16x16x32_bf16 v[172:175], v[76:79], v[36:39], v[172:175]
    s_cbranch_vccnz L_ssm_s4a
L_ssm_s4b:
    ds_read_b128 v[48:51], v2 offset:49152
    ds_read_b128 v[52:55], v2 offset:51200
    v_mfma_f32_16x16x32_bf16 v[176:179], v[64:67], v[40:43], v[176:179]
    ds_read_b128 v[56:59], v2 offset:53248
    v_mfma_f32_16x16x32_bf16 v[180:183], v[68:71], v[40:43], v[180:183]
    ds_read_b128 v[60:63], v2 offset:55296
    v_mfma_f32_16x16x32_bf16 v[184:187], v[72:75], v[40:43], v[184:187]
    ds_read_b128 v[16:19], v6 offset:49152
    v_mfma_f32_16x16x32_bf16 v[188:191], v[76:79], v[40:43], v[188:191]
    ds_read_b128 v[20:23], v6 offset:51200
    ds_read_b128 v[24:27], v6 offset:53248
    v_mfma_f32_16x16x32_bf16 v[192:195], v[64:67], v[44:47], v[192:195]
    ds_read_b128 v[28:31], v6 offset:55296
    v_mfma_f32_16x16x32_bf16 v[196:199], v[68:71], v[44:47], v[196:199]
    ds_read_b128 v[32:35], v6 offset:57344
    v_mfma_f32_16x16x32_bf16 v[200:203], v[72:75], v[44:47], v[200:203]
    v_mfma_f32_16x16x32_bf16 v[204:207], v[76:79], v[44:47], v[204:207]
    ds_read_b128 v[36:39], v6 offset:59392
    s_waitcnt lgkmcnt(5)
    v_mfma_f32_16x16x32_bf16 v[80:83], v[48:51], v[16:19], v[80:83]
    v_mfma_f32_16x16x32_bf16 v[84:87], v[52:55], v[16:19], v[84:87]
    v_mfma_f32_16x16x32_bf16 v[88:91], v[56:59], v[16:19], v[88:91]
    v_mfma_f32_16x16x32_bf16 v[92:95], v[60:63], v[16:19], v[92:95]
    ds_read_b128 v[40:43], v6 offset:61440
    s_waitcnt lgkmcnt(5)
    v_mfma_f32_16x16x32_bf16 v[96:99], v[48:51], v[20:23], v[96:99]
    v_mfma_f32_16x16x32_bf16 v[100:103], v[52:55], v[20:23], v[100:103]
    v_mfma_f32_16x16x32_bf16 v[104:107], v[56:59], v[20:23], v[104:107]
    v_mfma_f32_16x16x32_bf16 v[108:111], v[60:63], v[20:23], v[108:111]
    ds_read_b128 v[44:47], v6 offset:63488
    ds_read_b128 v[64:67], v3 offset:49152
    s_waitcnt lgkmcnt(6)
    v_mfma_f32_16x16x32_bf16 v[112:115], v[48:51], v[24:27], v[112:115]
    ds_read_b128 v[68:71], v3 offset:51200
    v_mfma_f32_16x16x32_bf16 v[116:119], v[52:55], v[24:27], v[116:119]
    ds_read_b128 v[72:75], v3 offset:53248
    v_mfma_f32_16x16x32_bf16 v[120:123], v[56:59], v[24:27], v[120:123]
    ds_read_b128 v[76:79], v3 offset:55296
    v_mfma_f32_16x16x32_bf16 v[124:127], v[60:63], v[24:27], v[124:127]
    ds_read_b128 v[16:19], v7 offset:49152
    s_waitcnt lgkmcnt(9)
    v_mfma_f32_16x16x32_bf16 v[128:131], v[48:51], v[28:31], v[128:131]
    v_mfma_f32_16x16x32_bf16 v[132:135], v[52:55], v[28:31], v[132:135]
    v_mfma_f32_16x16x32_bf16 v[136:139], v[56:59], v[28:31], v[136:139]
    v_mfma_f32_16x16x32_bf16 v[140:143], v[60:63], v[28:31], v[140:143]
    ds_read_b128 v[20:23], v7 offset:51200
    s_waitcnt lgkmcnt(9)
    v_mfma_f32_16x16x32_bf16 v[144:147], v[48:51], v[32:35], v[144:147]
    v_mfma_f32_16x16x32_bf16 v[148:151], v[52:55], v[32:35], v[148:151]
    v_mfma_f32_16x16x32_bf16 v[152:155], v[56:59], v[32:35], v[152:155]
    v_mfma_f32_16x16x32_bf16 v[156:159], v[60:63], v[32:35], v[156:159]
    ds_read_b128 v[24:27], v7 offset:53248
    s_waitcnt lgkmcnt(9)
    v_mfma_f32_16x16x32_bf16 v[160:163], v[48:51], v[36:39], v[160:163]
    v_mfma_f32_16x16x32_bf16 v[164:167], v[52:55], v[36:39], v[164:167]
    v_mfma_f32_16x16x32_bf16 v[168:171], v[56:59], v[36:39], v[168:171]
    v_mfma_f32_16x16x32_bf16 v[172:175], v[60:63], v[36:39], v[172:175]
    ds_read_b128 v[28:31], v7 offset:55296
    s_waitcnt lgkmcnt(9)
    v_mfma_f32_16x16x32_bf16 v[176:179], v[48:51], v[40:43], v[176:179]
    v_mfma_f32_16x16x32_bf16 v[180:183], v[52:55], v[40:43], v[180:183]
    v_mfma_f32_16x16x32_bf16 v[184:187], v[56:59], v[40:43], v[184:187]
    v_mfma_f32_16x16x32_bf16 v[188:191], v[60:63], v[40:43], v[188:191]
    ds_read_b128 v[32:35], v7 offset:57344
    s_waitcnt lgkmcnt(9)
    v_mfma_f32_16x16x32_bf16 v[192:195], v[48:51], v[44:47], v[192:195]
    v_mfma_f32_16x16x32_bf16 v[196:199], v[52:55], v[44:47], v[196:199]
    v_mfma_f32_16x16x32_bf16 v[200:203], v[56:59], v[44:47], v[200:203]
    v_mfma_f32_16x16x32_bf16 v[204:207], v[60:63], v[44:47], v[204:207]
    ds_read_b128 v[36:39], v7 offset:59392
    s_waitcnt lgkmcnt(5)
    v_mfma_f32_16x16x32_bf16 v[80:83], v[64:67], v[16:19], v[80:83]
    v_mfma_f32_16x16x32_bf16 v[84:87], v[68:71], v[16:19], v[84:87]
    v_mfma_f32_16x16x32_bf16 v[88:91], v[72:75], v[16:19], v[88:91]
    v_mfma_f32_16x16x32_bf16 v[92:95], v[76:79], v[16:19], v[92:95]
    ds_read_b128 v[40:43], v7 offset:61440
    s_waitcnt lgkmcnt(5)
    v_mfma_f32_16x16x32_bf16 v[96:99], v[64:67], v[20:23], v[96:99]
    v_mfma_f32_16x16x32_bf16 v[100:103], v[68:71], v[20:23], v[100:103]
    v_mfma_f32_16x16x32_bf16 v[104:107], v[72:75], v[20:23], v[104:107]
    v_mfma_f32_16x16x32_bf16 v[108:111], v[76:79], v[20:23], v[108:111]
    ds_read_b128 v[44:47], v7 offset:63488
    s_waitcnt lgkmcnt(5)
    v_mfma_f32_16x16x32_bf16 v[112:115], v[64:67], v[24:27], v[112:115]
    v_mfma_f32_16x16x32_bf16 v[116:119], v[68:71], v[24:27], v[116:119]
    v_mfma_f32_16x16x32_bf16 v[120:123], v[72:75], v[24:27], v[120:123]
    v_mfma_f32_16x16x32_bf16 v[124:127], v[76:79], v[24:27], v[124:127]
    s_waitcnt lgkmcnt(4)
    v_mfma_f32_16x16x32_bf16 v[128:131], v[64:67], v[28:31], v[128:131]
    ds_read_b128 v[8:11], v14 offset:32
    v_mfma_f32_16x16x32_bf16 v[132:135], v[68:71], v[28:31], v[132:135]
    v_mfma_f32_16x16x32_bf16 v[136:139], v[72:75], v[28:31], v[136:139]
    v_mfma_f32_16x16x32_bf16 v[140:143], v[76:79], v[28:31], v[140:143]
    s_waitcnt lgkmcnt(4)
    v_mfma_f32_16x16x32_bf16 v[144:147], v[64:67], v[32:35], v[144:147]
    v_mfma_f32_16x16x32_bf16 v[148:151], v[68:71], v[32:35], v[148:151]
    v_mfma_f32_16x16x32_bf16 v[152:155], v[72:75], v[32:35], v[152:155]
    v_mfma_f32_16x16x32_bf16 v[156:159], v[76:79], v[32:35], v[156:159]
    s_waitcnt lgkmcnt(0)
    v_mfma_f32_16x16x32_bf16 v[160:163], v[64:67], v[36:39], v[160:163]
    v_mov_b32 v15, 5
    v_min3_u32 v8, v8, v9, v10
    v_mfma_f32_16x16x32_bf16 v[164:167], v[68:71], v[36:39], v[164:167]
    ds_write_b32 v254, v15 offset:48
    v_min_u32 v8, v8, v11
    v_mfma_f32_16x16x32_bf16 v[168:171], v[72:75], v[36:39], v[168:171]
    v_cmp_gt_u32 vcc, 6, v8
    v_mfma_f32_16x16x32_bf16 v[172:175], v[76:79], v[36:39], v[172:175]
    s_cbranch_vccnz L_ssm_s5a
L_ssm_s5b:
    ds_read_b128 v[48:51], v4 offset:0
    ds_read_b128 v[52:55], v4 offset:2048
    v_mfma_f32_16x16x32_bf16 v[176:179], v[64:67], v[40:43], v[176:179]
    ds_read_b128 v[56:59], v4 offset:4096
    v_mfma_f32_16x16x32_bf16 v[180:183], v[68:71], v[40:43], v[180:183]
    ds_read_b128 v[60:63], v4 offset:6144
    v_mfma_f32_16x16x32_bf16 v[184:187], v[72:75], v[40:43], v[184:187]
    ds_read_b128 v[16:19], v12 offset:0
    v_mfma_f32_16x16x32_bf16 v[188:191], v[76:79], v[40:43], v[188:191]
    ds_read_b128 v[20:23], v12 offset:2048
    ds_read_b128 v[24:27], v12 offset:4096
    v_mfma_f32_16x16x32_bf16 v[192:195], v[64:67], v[44:47], v[192:195]
    ds_read_b128 v[28:31], v12 offset:6144
    v_mfma_f32_16x16x32_bf16 v[196:199], v[68:71], v[44:47], v[196:199]
    ds_read_b128 v[32:35], v12 offset:8192
    v_mfma_f32_16x16x32_bf16 v[200:203], v[72:75], v[44:47], v[200:203]
    v_mfma_f32_16x16x32_bf16 v[204:207], v[76:79], v[44:47], v[204:207]
    ds_read_b128 v[36:39], v12 offset:10240
    s_waitcnt lgkmcnt(5)
    v_mfma_f32_16x16x32_bf16 v[80:83], v[48:51], v[16:19], v[80:83]
    v_mfma_f32_16x16x32_bf16 v[84:87], v[52:55], v[16:19], v[84:87]
    v_mfma_f32_16x16x32_bf16 v[88:91], v[56:59], v[16:19], v[88:91]
    v_mfma_f32_16x16x32_bf16 v[92:95], v[60:63], v[16:19], v[92:95]
    ds_read_b128 v[40:43], v12 offset:12288
    s_waitcnt lgkmcnt(5)
    v_mfma_f32_16x16x32_bf16 v[96:99], v[48:51], v[20:23], v[96:99]
    v_mfma_f32_16x16x32_bf16 v[100:103], v[52:55], v[20:23], v[100:103]
    v_mfma_f32_16x16x32_bf16 v[104:107], v[56:59], v[20:23], v[104:107]
    v_mfma_f32_16x16x32_bf16 v[108:111], v[60:63], v[20:23], v[108:111]
    ds_read_b128 v[44:47], v12 offset:14336
    ds_read_b128 v[64:67], v5 offset:0
    s_waitcnt lgkmcnt(6)
    v_mfma_f32_16x16x32_bf16 v[112:115], v[48:51], v[24:27], v[112:115]
    ds_read_b128 v[68:71], v5 offset:2048
    v_mfma_f32_16x16x32_bf16 v[116:119], v[52:55], v[24:27], v[116:119]
    ds_read_b128 v[72:75], v5 offset:4096
    v_mfma_f32_16x16x32_bf16 v[120:123], v[56:59], v[24:27], v[120:123]
    ds_read_b128 v[76:79], v5 offset:6144
    v_mfma_f32_16x16x32_bf16 v[124:127], v[60:63], v[24:27], v[124:127]
    ds_read_b128 v[16:19], v13 offset:0
    s_waitcnt lgkmcnt(9)
    v_mfma_f32_16x16x32_bf16 v[128:131], v[48:51], v[28:31], v[128:131]
    v_mfma_f32_16x16x32_bf16 v[132:135], v[52:55], v[28:31], v[132:135]
    v_mfma_f32_16x16x32_bf16 v[136:139], v[56:59], v[28:31], v[136:139]
    v_mfma_f32_16x16x32_bf16 v[140:143], v[60:63], v[28:31], v[140:143]
    ds_read_b128 v[20:23], v13 offset:2048
    s_waitcnt lgkmcnt(9)
    v_mfma_f32_16x16x32_bf16 v[144:147], v[48:51], v[32:35], v[144:147]
    v_mfma_f32_16x16x32_bf16 v[148:151], v[52:55], v[32:35], v[148:151]
    v_mfma_f32_16x16x32_bf16 v[152:155], v[56:59], v[32:35], v[152:155]
    v_mfma_f32_16x16x32_bf16 v[156:159], v[60:63], v[32:35], v[156:159]
    ds_read_b128 v[24:27], v13 offset:4096
    s_waitcnt lgkmcnt(9)
    v_mfma_f32_16x16x32_bf16 v[160:163], v[48:51], v[36:39], v[160:163]
    v_mfma_f32_16x16x32_bf16 v[164:167], v[52:55], v[36:39], v[164:167]
    v_mfma_f32_16x16x32_bf16 v[168:171], v[56:59], v[36:39], v[168:171]
    v_mfma_f32_16x16x32_bf16 v[172:175], v[60:63], v[36:39], v[172:175]
    ds_read_b128 v[28:31], v13 offset:6144
    s_waitcnt lgkmcnt(9)
    v_mfma_f32_16x16x32_bf16 v[176:179], v[48:51], v[40:43], v[176:179]
    v_mfma_f32_16x16x32_bf16 v[180:183], v[52:55], v[40:43], v[180:183]
    v_mfma_f32_16x16x32_bf16 v[184:187], v[56:59], v[40:43], v[184:187]
    v_mfma_f32_16x16x32_bf16 v[188:191], v[60:63], v[40:43], v[188:191]
    ds_read_b128 v[32:35], v13 offset:8192
    s_waitcnt lgkmcnt(9)
    v_mfma_f32_16x16x32_bf16 v[192:195], v[48:51], v[44:47], v[192:195]
    v_mfma_f32_16x16x32_bf16 v[196:199], v[52:55], v[44:47], v[196:199]
    v_mfma_f32_16x16x32_bf16 v[200:203], v[56:59], v[44:47], v[200:203]
    v_mfma_f32_16x16x32_bf16 v[204:207], v[60:63], v[44:47], v[204:207]
    ds_read_b128 v[36:39], v13 offset:10240
    s_waitcnt lgkmcnt(5)
    v_mfma_f32_16x16x32_bf16 v[80:83], v[64:67], v[16:19], v[80:83]
    v_mfma_f32_16x16x32_bf16 v[84:87], v[68:71], v[16:19], v[84:87]
    v_mfma_f32_16x16x32_bf16 v[88:91], v[72:75], v[16:19], v[88:91]
    v_mfma_f32_16x16x32_bf16 v[92:95], v[76:79], v[16:19], v[92:95]
    ds_read_b128 v[40:43], v13 offset:12288
    s_waitcnt lgkmcnt(5)
    v_mfma_f32_16x16x32_bf16 v[96:99], v[64:67], v[20:23], v[96:99]
    v_mfma_f32_16x16x32_bf16 v[100:103], v[68:71], v[20:23], v[100:103]
    v_mfma_f32_16x16x32_bf16 v[104:107], v[72:75], v[20:23], v[104:107]
    v_mfma_f32_16x16x32_bf16 v[108:111], v[76:79], v[20:23], v[108:111]
    ds_read_b128 v[44:47], v13 offset:14336
    s_waitcnt lgkmcnt(5)
    v_mfma_f32_16x16x32_bf16 v[112:115], v[64:67], v[24:27], v[112:115]
    v_mfma_f32_16x16x32_bf16 v[116:119], v[68:71], v[24:27], v[116:119]
    v_mfma_f32_16x16x32_bf16 v[120:123], v[72:75], v[24:27], v[120:123]
    v_mfma_f32_16x16x32_bf16 v[124:127], v[76:79], v[24:27], v[124:127]
    s_waitcnt lgkmcnt(4)
    v_mfma_f32_16x16x32_bf16 v[128:131], v[64:67], v[28:31], v[128:131]
    ds_read_b128 v[8:11], v14 offset:32
    v_mfma_f32_16x16x32_bf16 v[132:135], v[68:71], v[28:31], v[132:135]
    v_mfma_f32_16x16x32_bf16 v[136:139], v[72:75], v[28:31], v[136:139]
    v_mfma_f32_16x16x32_bf16 v[140:143], v[76:79], v[28:31], v[140:143]
    s_waitcnt lgkmcnt(4)
    v_mfma_f32_16x16x32_bf16 v[144:147], v[64:67], v[32:35], v[144:147]
    v_mfma_f32_16x16x32_bf16 v[148:151], v[68:71], v[32:35], v[148:151]
    v_mfma_f32_16x16x32_bf16 v[152:155], v[72:75], v[32:35], v[152:155]
    v_mfma_f32_16x16x32_bf16 v[156:159], v[76:79], v[32:35], v[156:159]
    s_waitcnt lgkmcnt(0)
    v_mfma_f32_16x16x32_bf16 v[160:163], v[64:67], v[36:39], v[160:163]
    v_mov_b32 v15, 6
    v_min3_u32 v8, v8, v9, v10
    v_mfma_f32_16x16x32_bf16 v[164:167], v[68:71], v[36:39], v[164:167]
    ds_write_b32 v254, v15 offset:48
    v_min_u32 v8, v8, v11
    v_mfma_f32_16x16x32_bf16 v[168:171], v[72:75], v[36:39], v[168:171]
    v_cmp_gt_u32 vcc, 7, v8
    v_mfma_f32_16x16x32_bf16 v[172:175], v[76:79], v[36:39], v[172:175]
    s_cbranch_vccnz L_ssm_s6a
L_ssm_s6b:
    ds_read_b128 v[48:51], v2 offset:0
    ds_read_b128 v[52:55], v2 offset:2048
    v_mfma_f32_16x16x32_bf16 v[176:179], v[64:67], v[40:43], v[176:179]
    ds_read_b128 v[56:59], v2 offset:4096
    v_mfma_f32_16x16x32_bf16 v[180:183], v[68:71], v[40:43], v[180:183]
    ds_read_b128 v[60:63], v2 offset:6144
    v_mfma_f32_16x16x32_bf16 v[184:187], v[72:75], v[40:43], v[184:187]
    ds_read_b128 v[16:19], v6 offset:0
    v_mfma_f32_16x16x32_bf16 v[188:191], v[76:79], v[40:43], v[188:191]
    ds_read_b128 v[20:23], v6 offset:2048
    ds_read_b128 v[24:27], v6 offset:4096
    v_mfma_f32_16x16x32_bf16 v[192:195], v[64:67], v[44:47], v[192:195]
    ds_read_b128 v[28:31], v6 offset:6144
    v_mfma_f32_16x16x32_bf16 v[196:199], v[68:71], v[44:47], v[196:199]
    ds_read_b128 v[32:35], v6 offset:8192
    v_mfma_f32_16x16x32_bf16 v[200:203], v[72:75], v[44:47], v[200:203]
    v_mfma_f32_16x16x32_bf16 v[204:207], v[76:79], v[44:47], v[204:207]
    ds_read_b128 v[36:39], v6 offset:10240
    s_waitcnt lgkmcnt(5)
    v_mfma_f32_16x16x32_bf16 v[80:83], v[48:51], v[16:19], v[80:83]
    v_mfma_f32_16x16x32_bf16 v[84:87], v[52:55], v[16:19], v[84:87]
    v_mfma_f32_16x16x32_bf16 v[88:91], v[56:59], v[16:19], v[88:91]
    v_mfma_f32_16x16x32_bf16 v[92:95], v[60:63], v[16:19], v[92:95]
    ds_read_b128 v[40:43], v6 offset:12288
    s_waitcnt lgkmcnt(5)
    v_mfma_f32_16x16x32_bf16 v[96:99], v[48:51], v[20:23], v[96:99]
    v_mfma_f32_16x16x32_bf16 v[100:103], v[52:55], v[20:23], v[100:103]
    v_mfma_f32_16x16x32_bf16 v[104:107], v[56:59], v[20:23], v[104:107]
    v_mfma_f32_16x16x32_bf16 v[108:111], v[60:63], v[20:23], v[108:111]
    ds_read_b128 v[44:47], v6 offset:14336
    ds_read_b128 v[64:67], v3 offset:0
    s_waitcnt lgkmcnt(6)
    v_mfma_f32_16x16x32_bf16 v[112:115], v[48:51], v[24:27], v[112:115]
    ds_read_b128 v[68:71], v3 offset:2048
    v_mfma_f32_16x16x32_bf16 v[116:119], v[52:55], v[24:27], v[116:119]
    ds_read_b128 v[72:75], v3 offset:4096
    v_mfma_f32_16x16x32_bf16 v[120:123], v[56:59], v[24:27], v[120:123]
    ds_read_b128 v[76:79], v3 offset:6144
    v_mfma_f32_16x16x32_bf16 v[124:127], v[60:63], v[24:27], v[124:127]
    ds_read_b128 v[16:19], v7 offset:0
    s_waitcnt lgkmcnt(9)
    v_mfma_f32_16x16x32_bf16 v[128:131], v[48:51], v[28:31], v[128:131]
    v_mfma_f32_16x16x32_bf16 v[132:135], v[52:55], v[28:31], v[132:135]
    v_mfma_f32_16x16x32_bf16 v[136:139], v[56:59], v[28:31], v[136:139]
    v_mfma_f32_16x16x32_bf16 v[140:143], v[60:63], v[28:31], v[140:143]
    ds_read_b128 v[20:23], v7 offset:2048
    s_waitcnt lgkmcnt(9)
    v_mfma_f32_16x16x32_bf16 v[144:147], v[48:51], v[32:35], v[144:147]
    v_mfma_f32_16x16x32_bf16 v[148:151], v[52:55], v[32:35], v[148:151]
    v_mfma_f32_16x16x32_bf16 v[152:155], v[56:59], v[32:35], v[152:155]
    v_mfma_f32_16x16x32_bf16 v[156:159], v[60:63], v[32:35], v[156:159]
    ds_read_b128 v[24:27], v7 offset:4096
    s_waitcnt lgkmcnt(9)
    v_mfma_f32_16x16x32_bf16 v[160:163], v[48:51], v[36:39], v[160:163]
    v_mfma_f32_16x16x32_bf16 v[164:167], v[52:55], v[36:39], v[164:167]
    v_mfma_f32_16x16x32_bf16 v[168:171], v[56:59], v[36:39], v[168:171]
    v_mfma_f32_16x16x32_bf16 v[172:175], v[60:63], v[36:39], v[172:175]
    ds_read_b128 v[28:31], v7 offset:6144
    s_waitcnt lgkmcnt(9)
    v_mfma_f32_16x16x32_bf16 v[176:179], v[48:51], v[40:43], v[176:179]
    v_mfma_f32_16x16x32_bf16 v[180:183], v[52:55], v[40:43], v[180:183]
    v_mfma_f32_16x16x32_bf16 v[184:187], v[56:59], v[40:43], v[184:187]
    v_mfma_f32_16x16x32_bf16 v[188:191], v[60:63], v[40:43], v[188:191]
    ds_read_b128 v[32:35], v7 offset:8192
    s_waitcnt lgkmcnt(9)
    v_mfma_f32_16x16x32_bf16 v[192:195], v[48:51], v[44:47], v[192:195]
    v_mfma_f32_16x16x32_bf16 v[196:199], v[52:55], v[44:47], v[196:199]
    v_mfma_f32_16x16x32_bf16 v[200:203], v[56:59], v[44:47], v[200:203]
    v_mfma_f32_16x16x32_bf16 v[204:207], v[60:63], v[44:47], v[204:207]
    ds_read_b128 v[36:39], v7 offset:10240
    s_waitcnt lgkmcnt(5)
    v_mfma_f32_16x16x32_bf16 v[80:83], v[64:67], v[16:19], v[80:83]
    v_mfma_f32_16x16x32_bf16 v[84:87], v[68:71], v[16:19], v[84:87]
    v_mfma_f32_16x16x32_bf16 v[88:91], v[72:75], v[16:19], v[88:91]
    v_mfma_f32_16x16x32_bf16 v[92:95], v[76:79], v[16:19], v[92:95]
    ds_read_b128 v[40:43], v7 offset:12288
    s_waitcnt lgkmcnt(5)
    v_mfma_f32_16x16x32_bf16 v[96:99], v[64:67], v[20:23], v[96:99]
    v_mfma_f32_16x16x32_bf16 v[100:103], v[68:71], v[20:23], v[100:103]
    v_mfma_f32_16x16x32_bf16 v[104:107], v[72:75], v[20:23], v[104:107]
    v_mfma_f32_16x16x32_bf16 v[108:111], v[76:79], v[20:23], v[108:111]
    ds_read_b128 v[44:47], v7 offset:14336
    s_waitcnt lgkmcnt(5)
    v_mfma_f32_16x16x32_bf16 v[112:115], v[64:67], v[24:27], v[112:115]
    v_mfma_f32_16x16x32_bf16 v[116:119], v[68:71], v[24:27], v[116:119]
    v_mfma_f32_16x16x32_bf16 v[120:123], v[72:75], v[24:27], v[120:123]
    v_mfma_f32_16x16x32_bf16 v[124:127], v[76:79], v[24:27], v[124:127]
    s_waitcnt lgkmcnt(4)
    v_mfma_f32_16x16x32_bf16 v[128:131], v[64:67], v[28:31], v[128:131]
    ds_read_b128 v[8:11], v14 offset:32
    v_mfma_f32_16x16x32_bf16 v[132:135], v[68:71], v[28:31], v[132:135]
    v_mfma_f32_16x16x32_bf16 v[136:139], v[72:75], v[28:31], v[136:139]
    v_mfma_f32_16x16x32_bf16 v[140:143], v[76:79], v[28:31], v[140:143]
    s_waitcnt lgkmcnt(4)
    v_mfma_f32_16x16x32_bf16 v[144:147], v[64:67], v[32:35], v[144:147]
    v_mfma_f32_16x16x32_bf16 v[148:151], v[68:71], v[32:35], v[148:151]
    v_mfma_f32_16x16x32_bf16 v[152:155], v[72:75], v[32:35], v[152:155]
    v_mfma_f32_16x16x32_bf16 v[156:159], v[76:79], v[32:35], v[156:159]
    s_waitcnt lgkmcnt(0)
    v_mfma_f32_16x16x32_bf16 v[160:163], v[64:67], v[36:39], v[160:163]
    v_mov_b32 v15, 7
    v_min3_u32 v8, v8, v9, v10
    v_mfma_f32_16x16x32_bf16 v[164:167], v[68:71], v[36:39], v[164:167]
    ds_write_b32 v254, v15 offset:48
    v_min_u32 v8, v8, v11
    v_mfma_f32_16x16x32_bf16 v[168:171], v[72:75], v[36:39], v[168:171]
    v_cmp_gt_u32 vcc, 8, v8
    v_mfma_f32_16x16x32_bf16 v[172:175], v[76:79], v[36:39], v[172:175]
    s_cbranch_vccnz L_ssm_s7a
L_ssm_s7b:
    ds_read_b128 v[48:51], v2 offset:49152
    ds_read_b128 v[52:55], v2 offset:51200
    v_mfma_f32_16x16x32_bf16 v[176:179], v[64:67], v[40:43], v[176:179]
    ds_read_b128 v[56:59], v2 offset:53248
    v_mfma_f32_16x16x32_bf16 v[180:183], v[68:71], v[40:43], v[180:183]
    ds_read_b128 v[60:63], v2 offset:55296
    v_mfma_f32_16x16x32_bf16 v[184:187], v[72:75], v[40:43], v[184:187]
    ds_read_b128 v[16:19], v6 offset:49152
    v_mfma_f32_16x16x32_bf16 v[188:191], v[76:79], v[40:43], v[188:191]
    ds_read_b128 v[20:23], v6 offset:51200
    ds_read_b128 v[24:27], v6 offset:53248
    v_mfma_f32_16x16x32_bf16 v[192:195], v[64:67], v[44:47], v[192:195]
    ds_read_b128 v[28:31], v6 offset:55296
    v_mfma_f32_16x16x32_bf16 v[196:199], v[68:71], v[44:47], v[196:199]
    ds_read_b128 v[32:35], v6 offset:57344
    v_mfma_f32_16x16x32_bf16 v[200:203], v[72:75], v[44:47], v[200:203]
    v_mfma_f32_16x16x32_bf16 v[204:207], v[76:79], v[44:47], v[204:207]
    ds_read_b128 v[36:39], v6 offset:59392
    s_waitcnt lgkmcnt(5)
    v_mfma_f32_16x16x32_bf16 v[80:83], v[48:51], v[16:19], v[80:83]
    v_mfma_f32_16x16x32_bf16 v[84:87], v[52:55], v[16:19], v[84:87]
    v_mfma_f32_16x16x32_bf16 v[88:91], v[56:59], v[16:19], v[88:91]
    v_mfma_f32_16x16x32_bf16 v[92:95], v[60:63], v[16:19], v[92:95]
    ds_read_b128 v[40:43], v6 offset:61440
    s_waitcnt lgkmcnt(5)
    v_mfma_f32_16x16x32_bf16 v[96:99], v[48:51], v[20:23], v[96:99]
    v_mfma_f32_16x16x32_bf16 v[100:103], v[52:55], v[20:23], v[100:103]
    v_mfma_f32_16x16x32_bf16 v[104:107], v[56:59], v[20:23], v[104:107]
    v_mfma_f32_16x16x32_bf16 v[108:111], v[60:63], v[20:23], v[108:111]
    ds_read_b128 v[44:47], v6 offset:63488
    ds_read_b128 v[64:67], v3 offset:49152
    s_waitcnt lgkmcnt(6)
    v_mfma_f32_16x16x32_bf16 v[112:115], v[48:51], v[24:27], v[112:115]
    ds_read_b128 v[68:71], v3 offset:51200
    v_mfma_f32_16x16x32_bf16 v[116:119], v[52:55], v[24:27], v[116:119]
    ds_read_b128 v[72:75], v3 offset:53248
    v_mfma_f32_16x16x32_bf16 v[120:123], v[56:59], v[24:27], v[120:123]
    ds_read_b128 v[76:79], v3 offset:55296
    v_mfma_f32_16x16x32_bf16 v[124:127], v[60:63], v[24:27], v[124:127]
    ds_read_b128 v[16:19], v7 offset:49152
    s_waitcnt lgkmcnt(9)
    v_mfma_f32_16x16x32_bf16 v[128:131], v[48:51], v[28:31], v[128:131]
    v_mfma_f32_16x16x32_bf16 v[132:135], v[52:55], v[28:31], v[132:135]
    v_mfma_f32_16x16x32_bf16 v[136:139], v[56:59], v[28:31], v[136:139]
    v_mfma_f32_16x16x32_bf16 v[140:143], v[60:63], v[28:31], v[140:143]
    ds_read_b128 v[20:23], v7 offset:51200
    s_waitcnt lgkmcnt(9)
    v_mfma_f32_16x16x32_bf16 v[144:147], v[48:51], v[32:35], v[144:147]
    v_mfma_f32_16x16x32_bf16 v[148:151], v[52:55], v[32:35], v[148:151]
    v_mfma_f32_16x16x32_bf16 v[152:155], v[56:59], v[32:35], v[152:155]
    v_mfma_f32_16x16x32_bf16 v[156:159], v[60:63], v[32:35], v[156:159]
    ds_read_b128 v[24:27], v7 offset:53248
    s_waitcnt lgkmcnt(9)
    v_mfma_f32_16x16x32_bf16 v[160:163], v[48:51], v[36:39], v[160:163]
    v_mfma_f32_16x16x32_bf16 v[164:167], v[52:55], v[36:39], v[164:167]
    v_mfma_f32_16x16x32_bf16 v[168:171], v[56:59], v[36:39], v[168:171]
    v_mfma_f32_16x16x32_bf16 v[172:175], v[60:63], v[36:39], v[172:175]
    ds_read_b128 v[28:31], v7 offset:55296
    s_waitcnt lgkmcnt(9)
    v_mfma_f32_16x16x32_bf16 v[176:179], v[48:51], v[40:43], v[176:179]
    v_mfma_f32_16x16x32_bf16 v[180:183], v[52:55], v[40:43], v[180:183]
    v_mfma_f32_16x16x32_bf16 v[184:187], v[56:59], v[40:43], v[184:187]
    v_mfma_f32_16x16x32_bf16 v[188:191], v[60:63], v[40:43], v[188:191]
    ds_read_b128 v[32:35], v7 offset:57344
    s_waitcnt lgkmcnt(9)
    v_mfma_f32_16x16x32_bf16 v[192:195], v[48:51], v[44:47], v[192:195]
    v_mfma_f32_16x16x32_bf16 v[196:199], v[52:55], v[44:47], v[196:199]
    v_mfma_f32_16x16x32_bf16 v[200:203], v[56:59], v[44:47], v[200:203]
    v_mfma_f32_16x16x32_bf16 v[204:207], v[60:63], v[44:47], v[204:207]
    ds_read_b128 v[36:39], v7 offset:59392
    s_waitcnt lgkmcnt(5)
    v_mfma_f32_16x16x32_bf16 v[80:83], v[64:67], v[16:19], v[80:83]
    v_mfma_f32_16x16x32_bf16 v[84:87], v[68:71], v[16:19], v[84:87]
    v_mfma_f32_16x16x32_bf16 v[88:91], v[72:75], v[16:19], v[88:91]
    v_mfma_f32_16x16x32_bf16 v[92:95], v[76:79], v[16:19], v[92:95]
    ds_read_b128 v[40:43], v7 offset:61440
    s_waitcnt lgkmcnt(5)
    v_mfma_f32_16x16x32_bf16 v[96:99], v[64:67], v[20:23], v[96:99]
    v_mfma_f32_16x16x32_bf16 v[100:103], v[68:71], v[20:23], v[100:103]
    v_mfma_f32_16x16x32_bf16 v[104:107], v[72:75], v[20:23], v[104:107]
    v_mfma_f32_16x16x32_bf16 v[108:111], v[76:79], v[20:23], v[108:111]
    ds_read_b128 v[44:47], v7 offset:63488
    s_waitcnt lgkmcnt(5)
    v_mfma_f32_16x16x32_bf16 v[112:115], v[64:67], v[24:27], v[112:115]
    v_mfma_f32_16x16x32_bf16 v[116:119], v[68:71], v[24:27], v[116:119]
    v_mfma_f32_16x16x32_bf16 v[120:123], v[72:75], v[24:27], v[120:123]
    v_mfma_f32_16x16x32_bf16 v[124:127], v[76:79], v[24:27], v[124:127]
    s_waitcnt lgkmcnt(4)
    v_mfma_f32_16x16x32_bf16 v[128:131], v[64:67], v[28:31], v[128:131]
    ds_read_b128 v[8:11], v14 offset:32
    v_mfma_f32_16x16x32_bf16 v[132:135], v[68:71], v[28:31], v[132:135]
    v_mfma_f32_16x16x32_bf16 v[136:139], v[72:75], v[28:31], v[136:139]
    v_mfma_f32_16x16x32_bf16 v[140:143], v[76:79], v[28:31], v[140:143]
    s_waitcnt lgkmcnt(4)
    v_mfma_f32_16x16x32_bf16 v[144:147], v[64:67], v[32:35], v[144:147]
    v_mfma_f32_16x16x32_bf16 v[148:151], v[68:71], v[32:35], v[148:151]
    v_mfma_f32_16x16x32_bf16 v[152:155], v[72:75], v[32:35], v[152:155]
    v_mfma_f32_16x16x32_bf16 v[156:159], v[76:79], v[32:35], v[156:159]
    s_waitcnt lgkmcnt(0)
    v_mfma_f32_16x16x32_bf16 v[160:163], v[64:67], v[36:39], v[160:163]
    v_mov_b32 v15, 8
    v_min3_u32 v8, v8, v9, v10
    v_mfma_f32_16x16x32_bf16 v[164:167], v[68:71], v[36:39], v[164:167]
    ds_write_b32 v254, v15 offset:48
    v_min_u32 v8, v8, v11
    v_mfma_f32_16x16x32_bf16 v[168:171], v[72:75], v[36:39], v[168:171]
    v_cmp_gt_u32 vcc, 9, v8
    v_mfma_f32_16x16x32_bf16 v[172:175], v[76:79], v[36:39], v[172:175]
    s_cbranch_vccnz L_ssm_s8a
L_ssm_s8b:
    ds_read_b128 v[48:51], v4 offset:0
    ds_read_b128 v[52:55], v4 offset:2048
    v_mfma_f32_16x16x32_bf16 v[176:179], v[64:67], v[40:43], v[176:179]
    ds_read_b128 v[56:59], v4 offset:4096
    v_mfma_f32_16x16x32_bf16 v[180:183], v[68:71], v[40:43], v[180:183]
    ds_read_b128 v[60:63], v4 offset:6144
    v_mfma_f32_16x16x32_bf16 v[184:187], v[72:75], v[40:43], v[184:187]
    ds_read_b128 v[16:19], v12 offset:0
    v_mfma_f32_16x16x32_bf16 v[188:191], v[76:79], v[40:43], v[188:191]
    ds_read_b128 v[20:23], v12 offset:2048
    ds_read_b128 v[24:27], v12 offset:4096
    v_mfma_f32_16x16x32_bf16 v[192:195], v[64:67], v[44:47], v[192:195]
    ds_read_b128 v[28:31], v12 offset:6144
    v_mfma_f32_16x16x32_bf16 v[196:199], v[68:71], v[44:47], v[196:199]
    ds_read_b128 v[32:35], v12 offset:8192
    v_mfma_f32_16x16x32_bf16 v[200:203], v[72:75], v[44:47], v[200:203]
    v_mfma_f32_16x16x32_bf16 v[204:207], v[76:79], v[44:47], v[204:207]
    ds_read_b128 v[36:39], v12 offset:10240
    s_waitcnt lgkmcnt(5)
    v_mfma_f32_16x16x32_bf16 v[80:83], v[48:51], v[16:19], v[80:83]
    v_mfma_f32_16x16x32_bf16 v[84:87], v[52:55], v[16:19], v[84:87]
    v_mfma_f32_16x16x32_bf16 v[88:91], v[56:59], v[16:19], v[88:91]
    v_mfma_f32_16x16x32_bf16 v[92:95], v[60:63], v[16:19], v[92:95]
    ds_read_b128 v[40:43], v12 offset:12288
    s_waitcnt lgkmcnt(5)
    v_mfma_f32_16x16x32_bf16 v[96:99], v[48:51], v[20:23], v[96:99]
    v_mfma_f32_16x16x32_bf16 v[100:103], v[52:55], v[20:23], v[100:103]
    v_mfma_f32_16x16x32_bf16 v[104:107], v[56:59], v[20:23], v[104:107]
    v_mfma_f32_16x16x32_bf16 v[108:111], v[60:63], v[20:23], v[108:111]
    ds_read_b128 v[44:47], v12 offset:14336
    ds_read_b128 v[64:67], v5 offset:0
    s_waitcnt lgkmcnt(6)
    v_mfma_f32_16x16x32_bf16 v[112:115], v[48:51], v[24:27], v[112:115]
    ds_read_b128 v[68:71], v5 offset:2048
    v_mfma_f32_16x16x32_bf16 v[116:119], v[52:55], v[24:27], v[116:119]
    ds_read_b128 v[72:75], v5 offset:4096
    v_mfma_f32_16x16x32_bf16 v[120:123], v[56:59], v[24:27], v[120:123]
    ds_read_b128 v[76:79], v5 offset:6144
    v_mfma_f32_16x16x32_bf16 v[124:127], v[60:63], v[24:27], v[124:127]
    ds_read_b128 v[16:19], v13 offset:0
    s_waitcnt lgkmcnt(9)
    v_mfma_f32_16x16x32_bf16 v[128:131], v[48:51], v[28:31], v[128:131]
    v_mfma_f32_16x16x32_bf16 v[132:135], v[52:55], v[28:31], v[132:135]
    v_mfma_f32_16x16x32_bf16 v[136:139], v[56:59], v[28:31], v[136:139]
    v_mfma_f32_16x16x32_bf16 v[140:143], v[60:63], v[28:31], v[140:143]
    ds_read_b128 v[20:23], v13 offset:2048
    s_waitcnt lgkmcnt(9)
    v_mfma_f32_16x16x32_bf16 v[144:147], v[48:51], v[32:35], v[144:147]
    v_mfma_f32_16x16x32_bf16 v[148:151], v[52:55], v[32:35], v[148:151]
    v_mfma_f32_16x16x32_bf16 v[152:155], v[56:59], v[32:35], v[152:155]
    v_mfma_f32_16x16x32_bf16 v[156:159], v[60:63], v[32:35], v[156:159]
    ds_read_b128 v[24:27], v13 offset:4096
    s_waitcnt lgkmcnt(9)
    v_mfma_f32_16x16x32_bf16 v[160:163], v[48:51], v[36:39], v[160:163]
    v_mfma_f32_16x16x32_bf16 v[164:167], v[52:55], v[36:39], v[164:167]
    v_mfma_f32_16x16x32_bf16 v[168:171], v[56:59], v[36:39], v[168:171]
    v_mfma_f32_16x16x32_bf16 v[172:175], v[60:63], v[36:39], v[172:175]
    ds_read_b128 v[28:31], v13 offset:6144
    s_waitcnt lgkmcnt(9)
    v_mfma_f32_16x16x32_bf16 v[176:179], v[48:51], v[40:43], v[176:179]
    v_mfma_f32_16x16x32_bf16 v[180:183], v[52:55], v[40:43], v[180:183]
    v_mfma_f32_16x16x32_bf16 v[184:187], v[56:59], v[40:43], v[184:187]
    v_mfma_f32_16x16x32_bf16 v[188:191], v[60:63], v[40:43], v[188:191]
    ds_read_b128 v[32:35], v13 offset:8192
    s_waitcnt lgkmcnt(9)
    v_mfma_f32_16x16x32_bf16 v[192:195], v[48:51], v[44:47], v[192:195]
    v_mfma_f32_16x16x32_bf16 v[196:199], v[52:55], v[44:47], v[196:199]
    v_mfma_f32_16x16x32_bf16 v[200:203], v[56:59], v[44:47], v[200:203]
    v_mfma_f32_16x16x32_bf16 v[204:207], v[60:63], v[44:47], v[204:207]
    ds_read_b128 v[36:39], v13 offset:10240
    s_waitcnt lgkmcnt(5)
    v_mfma_f32_16x16x32_bf16 v[80:83], v[64:67], v[16:19], v[80:83]
    v_mfma_f32_16x16x32_bf16 v[84:87], v[68:71], v[16:19], v[84:87]
    v_mfma_f32_16x16x32_bf16 v[88:91], v[72:75], v[16:19], v[88:91]
    v_mfma_f32_16x16x32_bf16 v[92:95], v[76:79], v[16:19], v[92:95]
    ds_read_b128 v[40:43], v13 offset:12288
    s_waitcnt lgkmcnt(5)
    v_mfma_f32_16x16x32_bf16 v[96:99], v[64:67], v[20:23], v[96:99]
    v_mfma_f32_16x16x32_bf16 v[100:103], v[68:71], v[20:23], v[100:103]
    v_mfma_f32_16x16x32_bf16 v[104:107], v[72:75], v[20:23], v[104:107]
    v_mfma_f32_16x16x32_bf16 v[108:111], v[76:79], v[20:23], v[108:111]
    ds_read_b128 v[44:47], v13 offset:14336
    s_waitcnt lgkmcnt(5)
    v_mfma_f32_16x16x32_bf16 v[112:115], v[64:67], v[24:27], v[112:115]
    v_mfma_f32_16x16x32_bf16 v[116:119], v[68:71], v[24:27], v[116:119]
    v_mfma_f32_16x16x32_bf16 v[120:123], v[72:75], v[24:27], v[120:123]
    v_mfma_f32_16x16x32_bf16 v[124:127], v[76:79], v[24:27], v[124:127]
    s_waitcnt lgkmcnt(4)
    v_mfma_f32_16x16x32_bf16 v[128:131], v[64:67], v[28:31], v[128:131]
    ds_read_b128 v[8:11], v14 offset:32
    v_mfma_f32_16x16x32_bf16 v[132:135], v[68:71], v[28:31], v[132:135]
    v_mfma_f32_16x16x32_bf16 v[136:139], v[72:75], v[28:31], v[136:139]
    v_mfma_f32_16x16x32_bf16 v[140:143], v[76:79], v[28:31], v[140:143]
    s_waitcnt lgkmcnt(4)
    v_mfma_f32_16x16x32_bf16 v[144:147], v[64:67], v[32:35], v[144:147]
    v_mfma_f32_16x16x32_bf16 v[148:151], v[68:71], v[32:35], v[148:151]
    v_mfma_f32_16x16x32_bf16 v[152:155], v[72:75], v[32:35], v[152:155]
    v_mfma_f32_16x16x32_bf16 v[156:159], v[76:79], v[32:35], v[156:159]
    s_waitcnt lgkmcnt(0)
    v_mfma_f32_16x16x32_bf16 v[160:163], v[64:67], v[36:39], v[160:163]
    v_mov_b32 v15, 9
    v_min3_u32 v8, v8, v9, v10
    v_mfma_f32_16x16x32_bf16 v[164:167], v[68:71], v[36:39], v[164:167]
    ds_write_b32 v254, v15 offset:48
    v_min_u32 v8, v8, v11
    v_mfma_f32_16x16x32_bf16 v[168:171], v[72:75], v[36:39], v[168:171]
    v_cmp_gt_u32 vcc, 10, v8
    v_mfma_f32_16x16x32_bf16 v[172:175], v[76:79], v[36:39], v[172:175]
    s_cbranch_vccnz L_ssm_s9a
L_ssm_s9b:
    ds_read_b128 v[48:51], v2 offset:0
    ds_read_b128 v[52:55], v2 offset:2048
    v_mfma_f32_16x16x32_bf16 v[176:179], v[64:67], v[40:43], v[176:179]
    ds_read_b128 v[56:59], v2 offset:4096
    v_mfma_f32_16x16x32_bf16 v[180:183], v[68:71], v[40:43], v[180:183]
    ds_read_b128 v[60:63], v2 offset:6144
    v_mfma_f32_16x16x32_bf16 v[184:187], v[72:75], v[40:43], v[184:187]
    ds_read_b128 v[16:19], v6 offset:0
    v_mfma_f32_16x16x32_bf16 v[188:191], v[76:79], v[40:43], v[188:191]
    ds_read_b128 v[20:23], v6 offset:2048
    ds_read_b128 v[24:27], v6 offset:4096
    v_mfma_f32_16x16x32_bf16 v[192:195], v[64:67], v[44:47], v[192:195]
    ds_read_b128 v[28:31], v6 offset:6144
    v_mfma_f32_16x16x32_bf16 v[196:199], v[68:71], v[44:47], v[196:199]
    ds_read_b128 v[32:35], v6 offset:8192
    v_mfma_f32_16x16x32_bf16 v[200:203], v[72:75], v[44:47], v[200:203]
    v_mfma_f32_16x16x32_bf16 v[204:207], v[76:79], v[44:47], v[204:207]
    ds_read_b128 v[36:39], v6 offset:10240
    s_waitcnt lgkmcnt(5)
    v_mfma_f32_16x16x32_bf16 v[80:83], v[48:51], v[16:19], v[80:83]
    v_mfma_f32_16x16x32_bf16 v[84:87], v[52:55], v[16:19], v[84:87]
    v_mfma_f32_16x16x32_bf16 v[88:91], v[56:59], v[16:19], v[88:91]
    v_mfma_f32_16x16x32_bf16 v[92:95], v[60:63], v[16:19], v[92:95]
    ds_read_b128 v[40:43], v6 offset:12288
    s_waitcnt lgkmcnt(5)
    v_mfma_f32_16x16x32_bf16 v[96:99], v[48:51], v[20:23], v[96:99]
    v_mfma_f32_16x16x32_bf16 v[100:103], v[52:55], v[20:23], v[100:103]
    v_mfma_f32_16x16x32_bf16 v[104:107], v[56:59], v[20:23], v[104:107]
    v_mfma_f32_16x16x32_bf16 v[108:111], v[60:63], v[20:23], v[108:111]
    ds_read_b128 v[44:47], v6 offset:14336
    ds_read_b128 v[64:67], v3 offset:0
    s_waitcnt lgkmcnt(6)
    v_mfma_f32_16x16x32_bf16 v[112:115], v[48:51], v[24:27], v[112:115]
    ds_read_b128 v[68:71], v3 offset:2048
    v_mfma_f32_16x16x32_bf16 v[116:119], v[52:55], v[24:27], v[116:119]
    ds_read_b128 v[72:75], v3 offset:4096
    v_mfma_f32_16x16x32_bf16 v[120:123], v[56:59], v[24:27], v[120:123]
    ds_read_b128 v[76:79], v3 offset:6144
    v_mfma_f32_16x16x32_bf16 v[124:127], v[60:63], v[24:27], v[124:127]
    ds_read_b128 v[16:19], v7 offset:0
    s_waitcnt lgkmcnt(9)
    v_mfma_f32_16x16x32_bf16 v[128:131], v[48:51], v[28:31], v[128:131]
    v_mfma_f32_16x16x32_bf16 v[132:135], v[52:55], v[28:31], v[132:135]
    v_mfma_f32_16x16x32_bf16 v[136:139], v[56:59], v[28:31], v[136:139]
    v_mfma_f32_16x16x32_bf16 v[140:143], v[60:63], v[28:31], v[140:143]
    ds_read_b128 v[20:23], v7 offset:2048
    s_waitcnt lgkmcnt(9)
    v_mfma_f32_16x16x32_bf16 v[144:147], v[48:51], v[32:35], v[144:147]
    v_mfma_f32_16x16x32_bf16 v[148:151], v[52:55], v[32:35], v[148:151]
    v_mfma_f32_16x16x32_bf16 v[152:155], v[56:59], v[32:35], v[152:155]
    v_mfma_f32_16x16x32_bf16 v[156:159], v[60:63], v[32:35], v[156:159]
    ds_read_b128 v[24:27], v7 offset:4096
    s_waitcnt lgkmcnt(9)
    v_mfma_f32_16x16x32_bf16 v[160:163], v[48:51], v[36:39], v[160:163]
    v_mfma_f32_16x16x32_bf16 v[164:167], v[52:55], v[36:39], v[164:167]
    v_mfma_f32_16x16x32_bf16 v[168:171], v[56:59], v[36:39], v[168:171]
    v_mfma_f32_16x16x32_bf16 v[172:175], v[60:63], v[36:39], v[172:175]
    ds_read_b128 v[28:31], v7 offset:6144
    s_waitcnt lgkmcnt(9)
    v_mfma_f32_16x16x32_bf16 v[176:179], v[48:51], v[40:43], v[176:179]
    v_mfma_f32_16x16x32_bf16 v[180:183], v[52:55], v[40:43], v[180:183]
    v_mfma_f32_16x16x32_bf16 v[184:187], v[56:59], v[40:43], v[184:187]
    v_mfma_f32_16x16x32_bf16 v[188:191], v[60:63], v[40:43], v[188:191]
    ds_read_b128 v[32:35], v7 offset:8192
    s_waitcnt lgkmcnt(9)
    v_mfma_f32_16x16x32_bf16 v[192:195], v[48:51], v[44:47], v[192:195]
    v_mfma_f32_16x16x32_bf16 v[196:199], v[52:55], v[44:47], v[196:199]
    v_mfma_f32_16x16x32_bf16 v[200:203], v[56:59], v[44:47], v[200:203]
    v_mfma_f32_16x16x32_bf16 v[204:207], v[60:63], v[44:47], v[204:207]
    ds_read_b128 v[36:39], v7 offset:10240
    s_waitcnt lgkmcnt(5)
    v_mfma_f32_16x16x32_bf16 v[80:83], v[64:67], v[16:19], v[80:83]
    v_mfma_f32_16x16x32_bf16 v[84:87], v[68:71], v[16:19], v[84:87]
    v_mfma_f32_16x16x32_bf16 v[88:91], v[72:75], v[16:19], v[88:91]
    v_mfma_f32_16x16x32_bf16 v[92:95], v[76:79], v[16:19], v[92:95]
    ds_read_b128 v[40:43], v7 offset:12288
    s_waitcnt lgkmcnt(5)
    v_mfma_f32_16x16x32_bf16 v[96:99], v[64:67], v[20:23], v[96:99]
    v_mfma_f32_16x16x32_bf16 v[100:103], v[68:71], v[20:23], v[100:103]
    v_mfma_f32_16x16x32_bf16 v[104:107], v[72:75], v[20:23], v[104:107]
    v_mfma_f32_16x16x32_bf16 v[108:111], v[76:79], v[20:23], v[108:111]
    ds_read_b128 v[44:47], v7 offset:14336
    s_waitcnt lgkmcnt(5)
    v_mfma_f32_16x16x32_bf16 v[112:115], v[64:67], v[24:27], v[112:115]
    v_mfma_f32_16x16x32_bf16 v[116:119], v[68:71], v[24:27], v[116:119]
    v_mfma_f32_16x16x32_bf16 v[120:123], v[72:75], v[24:27], v[120:123]
    v_mfma_f32_16x16x32_bf16 v[124:127], v[76:79], v[24:27], v[124:127]
    s_waitcnt lgkmcnt(4)
    v_mfma_f32_16x16x32_bf16 v[128:131], v[64:67], v[28:31], v[128:131]
    ds_read_b128 v[8:11], v14 offset:32
    v_mfma_f32_16x16x32_bf16 v[132:135], v[68:71], v[28:31], v[132:135]
    v_mfma_f32_16x16x32_bf16 v[136:139], v[72:75], v[28:31], v[136:139]
    v_mfma_f32_16x16x32_bf16 v[140:143], v[76:79], v[28:31], v[140:143]
    s_waitcnt lgkmcnt(4)
    v_mfma_f32_16x16x32_bf16 v[144:147], v[64:67], v[32:35], v[144:147]
    v_mfma_f32_16x16x32_bf16 v[148:151], v[68:71], v[32:35], v[148:151]
    v_mfma_f32_16x16x32_bf16 v[152:155], v[72:75], v[32:35], v[152:155]
    v_mfma_f32_16x16x32_bf16 v[156:159], v[76:79], v[32:35], v[156:159]
    s_waitcnt lgkmcnt(0)
    v_mfma_f32_16x16x32_bf16 v[160:163], v[64:67], v[36:39], v[160:163]
    v_mov_b32 v15, 10
    v_min3_u32 v8, v8, v9, v10
    v_mfma_f32_16x16x32_bf16 v[164:167], v[68:71], v[36:39], v[164:167]
    ds_write_b32 v254, v15 offset:48
    v_min_u32 v8, v8, v11
    v_mfma_f32_16x16x32_bf16 v[168:171], v[72:75], v[36:39], v[168:171]
    v_cmp_gt_u32 vcc, 11, v8
    v_mfma_f32_16x16x32_bf16 v[172:175], v[76:79], v[36:39], v[172:175]
    s_cbranch_vccnz L_ssm_s10a
L_ssm_s10b:
    v_mfma_f32_16x16x32_bf16 v[176:179], v[64:67], v[40:43], v[176:179]
    v_mfma_f32_16x16x32_bf16 v[180:183], v[68:71], v[40:43], v[180:183]
    v_mfma_f32_16x16x32_bf16 v[184:187], v[72:75], v[40:43], v[184:187]
    v_mfma_f32_16x16x32_bf16 v[188:191], v[76:79], v[40:43], v[188:191]
    v_mfma_f32_16x16x32_bf16 v[192:195], v[64:67], v[44:47], v[192:195]
    v_mfma_f32_16x16x32_bf16 v[196:199], v[68:71], v[44:47], v[196:199]
    v_mfma_f32_16x16x32_bf16 v[200:203], v[72:75], v[44:47], v[200:203]
    v_mfma_f32_16x16x32_bf16 v[204:207], v[76:79], v[44:47], v[204:207]
    v_and_b32 v8, 15, v0
    v_lshrrev_b32 v9, 4, v0
    s_lshl_b32 s68, s3, 8
    s_add_u32 s68, s68, 161792
    v_lshlrev_b32 v2, 4, v9
    v_add_u32 v2, s68, v2
    v_lshlrev_b32 v3, 2, v8
    v_add_u32 v3, 156160, v3
    ds_read_b128 v[16:19], v2 offset:0
    ds_read_b128 v[32:35], v2 offset:1024
    ds_read_b128 v[20:23], v2 offset:64
    ds_read_b128 v[36:39], v2 offset:1088
    ds_read_b128 v[24:27], v2 offset:128
    ds_read_b128 v[40:43], v2 offset:1152
    ds_read_b128 v[28:31], v2 offset:192
    ds_read_b128 v[44:47], v2 offset:1216
    ds_read_b32 v48, v3 offset:0
    ds_read_b32 v49, v3 offset:64
    ds_read_b32 v50, v3 offset:128
    ds_read_b32 v51, v3 offset:192
    ds_read_b32 v52, v3 offset:512
    ds_read_b32 v53, v3 offset:576
    ds_read_b32 v54, v3 offset:640
    ds_read_b32 v55, v3 offset:704
    s_lshl_b32 s68, s3, 11
    s_add_u32 s68, s68, 147456
    v_lshlrev_b32 v4, 3, v8
    v_lshl_add_u32 v5, v9, 9, v4
    v_add_u32 v5, s68, v5
    v_add_u32 v4, 155648, v4
    s_waitcnt lgkmcnt(0)
    v_pk_mul_f32 v[80:81], v[80:81], v[16:17]
    v_pk_mul_f32 v[144:145], v[144:145], v[16:17]
    v_pk_mul_f32 v[96:97], v[96:97], v[16:17]
    v_pk_mul_f32 v[160:161], v[160:161], v[16:17]
    v_pk_fma_f32 v[80:81], v[32:33], v[48:49], v[80:81] op_sel:[0,0,0] op_sel_hi:[1,0,1] neg_lo:[1,0,0] neg_hi:[1,0,0]
    v_pk_fma_f32 v[144:145], v[32:33], v[52:53], v[144:145] op_sel:[0,0,0] op_sel_hi:[1,0,1] neg_lo:[1,0,0] neg_hi:[1,0,0]
    v_pk_fma_f32 v[96:97], v[32:33], v[48:49], v[96:97] op_sel:[0,1,0] op_sel_hi:[1,1,1] neg_lo:[1,0,0] neg_hi:[1,0,0]
    v_pk_fma_f32 v[160:161], v[32:33], v[52:53], v[160:161] op_sel:[0,1,0] op_sel_hi:[1,1,1] neg_lo:[1,0,0] neg_hi:[1,0,0]
    v_pk_mul_f32 v[82:83], v[82:83], v[18:19]
    v_pk_mul_f32 v[146:147], v[146:147], v[18:19]
    v_pk_mul_f32 v[98:99], v[98:99], v[18:19]
    v_pk_mul_f32 v[162:163], v[162:163], v[18:19]
    v_pk_fma_f32 v[82:83], v[34:35], v[48:49], v[82:83] op_sel:[0,0,0] op_sel_hi:[1,0,1] neg_lo:[1,0,0] neg_hi:[1,0,0]
    v_pk_fma_f32 v[146:147], v[34:35], v[52:53], v[146:147] op_sel:[0,0,0] op_sel_hi:[1,0,1] neg_lo:[1,0,0] neg_hi:[1,0,0]
    v_pk_fma_f32 v[98:99], v[34:35], v[48:49], v[98:99] op_sel:[0,1,0] op_sel_hi:[1,1,1] neg_lo:[1,0,0] neg_hi:[1,0,0]
    v_pk_fma_f32 v[162:163], v[34:35], v[52:53], v[162:163] op_sel:[0,1,0] op_sel_hi:[1,1,1] neg_lo:[1,0,0] neg_hi:[1,0,0]
    v_pk_fma_f32 v[64:65], v[208:209], v[80:81], v[82:83] op_sel:[0,0,0] op_sel_hi:[0,1,1]
    v_pk_fma_f32 v[66:67], v[208:209], v[144:145], v[146:147] op_sel:[0,0,0] op_sel_hi:[0,1,1]
    v_pk_fma_f32 v[60:61], v[208:209], v[144:145], v[64:65] op_sel:[1,0,0] op_sel_hi:[1,1,1] neg_lo:[1,0,0] neg_hi:[1,0,0]
    v_pk_fma_f32 v[62:63], v[208:209], v[80:81], v[66:67] op_sel:[1,0,0] op_sel_hi:[1,1,1]
    v_pk_fma_f32 v[76:77], v[210:211], v[96:97], v[98:99] op_sel:[0,0,0] op_sel_hi:[0,1,1]
    v_pk_fma_f32 v[78:79], v[210:211], v[160:161], v[162:163] op_sel:[0,0,0] op_sel_hi:[0,1,1]
    v_pk_fma_f32 v[72:73], v[210:211], v[160:161], v[76:77] op_sel:[1,0,0] op_sel_hi:[1,1,1] neg_lo:[1,0,0] neg_hi:[1,0,0]
    v_pk_fma_f32 v[74:75], v[210:211], v[96:97], v[78:79] op_sel:[1,0,0] op_sel_hi:[1,1,1]
    v_pk_mul_f32 v[84:85], v[84:85], v[20:21]
    v_pk_mul_f32 v[148:149], v[148:149], v[20:21]
    v_pk_mul_f32 v[100:101], v[100:101], v[20:21]
    v_pk_mul_f32 v[164:165], v[164:165], v[20:21]
    v_pk_fma_f32 v[84:85], v[36:37], v[48:49], v[84:85] op_sel:[0,0,0] op_sel_hi:[1,0,1] neg_lo:[1,0,0] neg_hi:[1,0,0]
    v_pk_fma_f32 v[148:149], v[36:37], v[52:53], v[148:149] op_sel:[0,0,0] op_sel_hi:[1,0,1] neg_lo:[1,0,0] neg_hi:[1,0,0]
    v_pk_fma_f32 v[100:101], v[36:37], v[48:49], v[100:101] op_sel:[0,1,0] op_sel_hi:[1,1,1] neg_lo:[1,0,0] neg_hi:[1,0,0]
    v_pk_fma_f32 v[164:165], v[36:37], v[52:53], v[164:165] op_sel:[0,1,0] op_sel_hi:[1,1,1] neg_lo:[1,0,0] neg_hi:[1,0,0]
    v_pk_fma_f32 v[64:65], v[208:209], v[60:61], v[84:85] op_sel:[0,0,0] op_sel_hi:[0,1,1]
    v_pk_fma_f32 v[66:67], v[208:209], v[62:63], v[148:149] op_sel:[0,0,0] op_sel_hi:[0,1,1]
    v_pk_fma_f32 v[56:57], v[208:209], v[62:63], v[64:65] op_sel:[1,0,0] op_sel_hi:[1,1,1] neg_lo:[1,0,0] neg_hi:[1,0,0]
    v_pk_fma_f32 v[58:59], v[208:209], v[60:61], v[66:67] op_sel:[1,0,0] op_sel_hi:[1,1,1]
    v_pk_fma_f32 v[76:77], v[210:211], v[72:73], v[100:101] op_sel:[0,0,0] op_sel_hi:[0,1,1]
    v_pk_fma_f32 v[78:79], v[210:211], v[74:75], v[164:165] op_sel:[0,0,0] op_sel_hi:[0,1,1]
    v_pk_fma_f32 v[68:69], v[210:211], v[74:75], v[76:77] op_sel:[1,0,0] op_sel_hi:[1,1,1] neg_lo:[1,0,0] neg_hi:[1,0,0]
    v_pk_fma_f32 v[70:71], v[210:211], v[72:73], v[78:79] op_sel:[1,0,0] op_sel_hi:[1,1,1]
    v_pk_mul_f32 v[86:87], v[86:87], v[22:23]
    v_pk_mul_f32 v[150:151], v[150:151], v[22:23]
    v_pk_mul_f32 v[102:103], v[102:103], v[22:23]
    v_pk_mul_f32 v[166:167], v[166:167], v[22:23]
    v_pk_fma_f32 v[86:87], v[38:39], v[48:49], v[86:87] op_sel:[0,0,0] op_sel_hi:[1,0,1] neg_lo:[1,0,0] neg_hi:[1,0,0]
    v_pk_fma_f32 v[150:151], v[38:39], v[52:53], v[150:151] op_sel:[0,0,0] op_sel_hi:[1,0,1] neg_lo:[1,0,0] neg_hi:[1,0,0]
    v_pk_fma_f32 v[102:103], v[38:39], v[48:49], v[102:103] op_sel:[0,1,0] op_sel_hi:[1,1,1] neg_lo:[1,0,0] neg_hi:[1,0,0]
    v_pk_fma_f32 v[166:167], v[38:39], v[52:53], v[166:167] op_sel:[0,1,0] op_sel_hi:[1,1,1] neg_lo:[1,0,0] neg_hi:[1,0,0]
    v_pk_fma_f32 v[64:65], v[208:209], v[56:57], v[86:87] op_sel:[0,0,0] op_sel_hi:[0,1,1]
    v_pk_fma_f32 v[66:67], v[208:209], v[58:59], v[150:151] op_sel:[0,0,0] op_sel_hi:[0,1,1]
    v_pk_fma_f32 v[60:61], v[208:209], v[58:59], v[64:65] op_sel:[1,0,0] op_sel_hi:[1,1,1] neg_lo:[1,0,0] neg_hi:[1,0,0]
    v_pk_fma_f32 v[62:63], v[208:209], v[56:57], v[66:67] op_sel:[1,0,0] op_sel_hi:[1,1,1]
    v_pk_fma_f32 v[76:77], v[210:211], v[68:69], v[102:103] op_sel:[0,0,0] op_sel_hi:[0,1,1]
    v_pk_fma_f32 v[78:79], v[210:211], v[70:71], v[166:167] op_sel:[0,0,0] op_sel_hi:[0,1,1]
    v_pk_fma_f32 v[72:73], v[210:211], v[70:71], v[76:77] op_sel:[1,0,0] op_sel_hi:[1,1,1] neg_lo:[1,0,0] neg_hi:[1,0,0]
    v_pk_fma_f32 v[74:75], v[210:211], v[68:69], v[78:79] op_sel:[1,0,0] op_sel_hi:[1,1,1]
    v_pk_mul_f32 v[88:89], v[88:89], v[24:25]
    v_pk_mul_f32 v[152:153], v[152:153], v[24:25]
    v_pk_mul_f32 v[104:105], v[104:105], v[24:25]
    v_pk_mul_f32 v[168:169], v[168:169], v[24:25]
    v_pk_fma_f32 v[88:89], v[40:41], v[48:49], v[88:89] op_sel:[0,0,0] op_sel_hi:[1,0,1] neg_lo:[1,0,0] neg_hi:[1,0,0]
    v_pk_fma_f32 v[152:153], v[40:41], v[52:53], v[152:153] op_sel:[0,0,0] op_sel_hi:[1,0,1] neg_lo:[1,0,0] neg_hi:[1,0,0]
    v_pk_fma_f32 v[104:105], v[40:41], v[48:49], v[104:105] op_sel:[0,1,0] op_sel_hi:[1,1,1] neg_lo:[1,0,0] neg_hi:[1,0,0]
    v_pk_fma_f32 v[168:169], v[40:41], v[52:53], v[168:169] op_sel:[0,1,0] op_sel_hi:[1,1,1] neg_lo:[1,0,0] neg_hi:[1,0,0]
    v_pk_fma_f32 v[64:65], v[208:209], v[60:61], v[88:89] op_sel:[0,0,0] op_sel_hi:[0,1,1]
    v_pk_fma_f32 v[66:67], v[208:209], v[62:63], v[152:153] op_sel:[0,0,0] op_sel_hi:[0,1,1]
    v_pk_fma_f32 v[56:57], v[208:209], v[62:63], v[64:65] op_sel:[1,0,0] op_sel_hi:[1,1,1] neg_lo:[1,0,0] neg_hi:[1,0,0]
    v_pk_fma_f32 v[58:59], v[208:209], v[60:61], v[66:67] op_sel:[1,0,0] op_sel_hi:[1,1,1]
    v_pk_fma_f32 v[76:77], v[210:211], v[72:73], v[104:105] op_sel:[0,0,0] op_sel_hi:[0,1,1]
    v_pk_fma_f32 v[78:79], v[210:211], v[74:75], v[168:169] op_sel:[0,0,0] op_sel_hi:[0,1,1]
    v_pk_fma_f32 v[68:69], v[210:211], v[74:75], v[76:77] op_sel:[1,0,0] op_sel_hi:[1,1,1] neg_lo:[1,0,0] neg_hi:[1,0,0]
    v_pk_fma_f32 v[70:71], v[210:211], v[72:73], v[78:79] op_sel:[1,0,0] op_sel_hi:[1,1,1]
    v_pk_mul_f32 v[90:91], v[90:91], v[26:27]
    v_pk_mul_f32 v[154:155], v[154:155], v[26:27]
    v_pk_mul_f32 v[106:107], v[106:107], v[26:27]
    v_pk_mul_f32 v[170:171], v[170:171], v[26:27]
    v_pk_fma_f32 v[90:91], v[42:43], v[48:49], v[90:91] op_sel:[0,0,0] op_sel_hi:[1,0,1] neg_lo:[1,0,0] neg_hi:[1,0,0]
    v_pk_fma_f32 v[154:155], v[42:43], v[52:53], v[154:155] op_sel:[0,0,0] op_sel_hi:[1,0,1] neg_lo:[1,0,0] neg_hi:[1,0,0]
    v_pk_fma_f32 v[106:107], v[42:43], v[48:49], v[106:107] op_sel:[0,1,0] op_sel_hi:[1,1,1] neg_lo:[1,0,0] neg_hi:[1,0,0]
    v_pk_fma_f32 v[170:171], v[42:43], v[52:53], v[170:171] op_sel:[0,1,0] op_sel_hi:[1,1,1] neg_lo:[1,0,0] neg_hi:[1,0,0]
    v_pk_fma_f32 v[64:65], v[208:209], v[56:57], v[90:91] op_sel:[0,0,0] op_sel_hi:[0,1,1]
    v_pk_fma_f32 v[66:67], v[208:209], v[58:59], v[154:155] op_sel:[0,0,0] op_sel_hi:[0,1,1]
    v_pk_fma_f32 v[60:61], v[208:209], v[58:59], v[64:65] op_sel:[1,0,0] op_sel_hi:[1,1,1] neg_lo:[1,0,0] neg_hi:[1,0,0]
    v_pk_fma_f32 v[62:63], v[208:209], v[56:57], v[66:67] op_sel:[1,0,0] op_sel_hi:[1,1,1]
    v_pk_fma_f32 v[76:77], v[210:211], v[68:69], v[106:107] op_sel:[0,0,0] op_sel_hi:[0,1,1]
    v_pk_fma_f32 v[78:79], v[210:211], v[70:71], v[170:171] op_sel:[0,0,0] op_sel_hi:[0,1,1]
    v_pk_fma_f32 v[72:73], v[210:211], v[70:71], v[76:77] op_sel:[1,0,0] op_sel_hi:[1,1,1] neg_lo:[1,0,0] neg_hi:[1,0,0]
    v_pk_fma_f32 v[74:75], v[210:211], v[68:69], v[78:79] op_sel:[1,0,0] op_sel_hi:[1,1,1]
    v_pk_mul_f32 v[92:93], v[92:93], v[28:29]
    v_pk_mul_f32 v[156:157], v[156:157], v[28:29]
    v_pk_mul_f32 v[108:109], v[108:109], v[28:29]
    v_pk_mul_f32 v[172:173], v[172:173], v[28:29]
    v_pk_fma_f32 v[92:93], v[44:45], v[48:49], v[92:93] op_sel:[0,0,0] op_sel_hi:[1,0,1] neg_lo:[1,0,0] neg_hi:[1,0,0]
    v_pk_fma_f32 v[156:157], v[44:45], v[52:53], v[156:157] op_sel:[0,0,0] op_sel_hi:[1,0,1] neg_lo:[1,0,0] neg_hi:[1,0,0]
    v_pk_fma_f32 v[108:109], v[44:45], v[48:49], v[108:109] op_sel:[0,1,0] op_sel_hi:[1,1,1] neg_lo:[1,0,0] neg_hi:[1,0,0]
    v_pk_fma_f32 v[172:173], v[44:45], v[52:53], v[172:173] op_sel:[0,1,0] op_sel_hi:[1,1,1] neg_lo:[1,0,0] neg_hi:[1,0,0]
    v_pk_fma_f32 v[64:65], v[208:209], v[60:61], v[92:93] op_sel:[0,0,0] op_sel_hi:[0,1,1]
    v_pk_fma_f32 v[66:67], v[208:209], v[62:63], v[156:157] op_sel:[0,0,0] op_sel_hi:[0,1,1]
    v_pk_fma_f32 v[56:57], v[208:209], v[62:63], v[64:65] op_sel:[1,0,0] op_sel_hi:[1,1,1] neg_lo:[1,0,0] neg_hi:[1,0,0]
    v_pk_fma_f32 v[58:59], v[208:209], v[60:61], v[66:67] op_sel:[1,0,0] op_sel_hi:[1,1,1]
    v_pk_fma_f32 v[76:77], v[210:211], v[72:73], v[108:109] op_sel:[0,0,0] op_sel_hi:[0,1,1]
    v_pk_fma_f32 v[78:79], v[210:211], v[74:75], v[172:173] op_sel:[0,0,0] op_sel_hi:[0,1,1]
    v_pk_fma_f32 v[68:69], v[210:211], v[74:75], v[76:77] op_sel:[1,0,0] op_sel_hi:[1,1,1] neg_lo:[1,0,0] neg_hi:[1,0,0]
    v_pk_fma_f32 v[70:71], v[210:211], v[72:73], v[78:79] op_sel:[1,0,0] op_sel_hi:[1,1,1]
    v_pk_mul_f32 v[94:95], v[94:95], v[30:31]
    v_pk_mul_f32 v[158:159], v[158:159], v[30:31]
    v_pk_mul_f32 v[110:111], v[110:111], v[30:31]
    v_pk_mul_f32 v[174:175], v[174:175], v[30:31]
    v_pk_fma_f32 v[94:95], v[46:47], v[48:49], v[94:95] op_sel:[0,0,0] op_sel_hi:[1,0,1] neg_lo:[1,0,0] neg_hi:[1,0,0]
    v_pk_fma_f32 v[158:159], v[46:47], v[52:53], v[158:159] op_sel:[0,0,0] op_sel_hi:[1,0,1] neg_lo:[1,0,0] neg_hi:[1,0,0]
    v_pk_fma_f32 v[110:111], v[46:47], v[48:49], v[110:111] op_sel:[0,1,0] op_sel_hi:[1,1,1] neg_lo:[1,0,0] neg_hi:[1,0,0]
    v_pk_fma_f32 v[174:175], v[46:47], v[52:53], v[174:175] op_sel:[0,1,0] op_sel_hi:[1,1,1] neg_lo:[1,0,0] neg_hi:[1,0,0]
    v_pk_fma_f32 v[64:65], v[208:209], v[56:57], v[94:95] op_sel:[0,0,0] op_sel_hi:[0,1,1]
    v_pk_fma_f32 v[66:67], v[208:209], v[58:59], v[158:159] op_sel:[0,0,0] op_sel_hi:[0,1,1]
    v_pk_fma_f32 v[60:61], v[208:209], v[58:59], v[64:65] op_sel:[1,0,0] op_sel_hi:[1,1,1] neg_lo:[1,0,0] neg_hi:[1,0,0]
    v_pk_fma_f32 v[62:63], v[208:209], v[56:57], v[66:67] op_sel:[1,0,0] op_sel_hi:[1,1,1]
    v_pk_fma_f32 v[76:77], v[210:211], v[68:69], v[110:111] op_sel:[0,0,0] op_sel_hi:[0,1,1]
    v_pk_fma_f32 v[78:79], v[210:211], v[70:71], v[174:175] op_sel:[0,0,0] op_sel_hi:[0,1,1]
    v_pk_fma_f32 v[72:73], v[210:211], v[70:71], v[76:77] op_sel:[1,0,0] op_sel_hi:[1,1,1] neg_lo:[1,0,0] neg_hi:[1,0,0]
    v_pk_fma_f32 v[74:75], v[210:211], v[68:69], v[78:79] op_sel:[1,0,0] op_sel_hi:[1,1,1]
    v_mov_b32 v244, v60
    v_mov_b32 v245, v62
    v_mov_b32 v56, v61
    v_mov_b32 v57, v63
    v_pk_fma_f32 v[64:65], v[224:225], v[244:245], v[56:57] op_sel:[0,0,0] op_sel_hi:[0,1,1]
    s_nop 0
    v_pk_fma_f32 v[58:59], v[224:225], v[244:245], v[64:65] op_sel:[1,1,0] op_sel_hi:[1,0,1] neg_lo:[1,0,0]
    ds_write_b64 v5, v[58:59] offset:0
    v_mov_b32 v246, v72
    v_mov_b32 v247, v74
    v_mov_b32 v68, v73
    v_mov_b32 v69, v75
    v_pk_fma_f32 v[76:77], v[226:227], v[246:247], v[68:69] op_sel:[0,0,0] op_sel_hi:[0,1,1]
    s_nop 0
    v_pk_fma_f32 v[70:71], v[226:227], v[246:247], v[76:77] op_sel:[1,1,0] op_sel_hi:[1,0,1] neg_lo:[1,0,0]
    ds_write_b64 v5, v[70:71] offset:128
    v_pk_mul_f32 v[112:113], v[112:113], v[16:17]
    v_pk_mul_f32 v[176:177], v[176:177], v[16:17]
    v_pk_mul_f32 v[128:129], v[128:129], v[16:17]
    v_pk_mul_f32 v[192:193], v[192:193], v[16:17]
    v_pk_fma_f32 v[112:113], v[32:33], v[50:51], v[112:113] op_sel:[0,0,0] op_sel_hi:[1,0,1] neg_lo:[1,0,0] neg_hi:[1,0,0]
    v_pk_fma_f32 v[176:177], v[32:33], v[54:55], v[176:177] op_sel:[0,0,0] op_sel_hi:[1,0,1] neg_lo:[1,0,0] neg_hi:[1,0,0]
    v_pk_fma_f32 v[128:129], v[32:33], v[50:51], v[128:129] op_sel:[0,1,0] op_sel_hi:[1,1,1] neg_lo:[1,0,0] neg_hi:[1,0,0]
    v_pk_fma_f32 v[192:193], v[32:33], v[54:55], v[192:193] op_sel:[0,1,0] op_sel_hi:[1,1,1] neg_lo:[1,0,0] neg_hi:[1,0,0]
    v_pk_mul_f32 v[114:115], v[114:115], v[18:19]
    v_pk_mul_f32 v[178:179], v[178:179], v[18:19]
    v_pk_mul_f32 v[130:131], v[130:131], v[18:19]
    v_pk_mul_f32 v[194:195], v[194:195], v[18:19]
    v_pk_fma_f32 v[114:115], v[34:35], v[50:51], v[114:115] op_sel:[0,0,0] op_sel_hi:[1,0,1] neg_lo:[1,0,0] neg_hi:[1,0,0]
    v_pk_fma_f32 v[178:179], v[34:35], v[54:55], v[178:179] op_sel:[0,0,0] op_sel_hi:[1,0,1] neg_lo:[1,0,0] neg_hi:[1,0,0]
    v_pk_fma_f32 v[130:131], v[34:35], v[50:51], v[130:131] op_sel:[0,1,0] op_sel_hi:[1,1,1] neg_lo:[1,0,0] neg_hi:[1,0,0]
    v_pk_fma_f32 v[194:195], v[34:35], v[54:55], v[194:195] op_sel:[0,1,0] op_sel_hi:[1,1,1] neg_lo:[1,0,0] neg_hi:[1,0,0]
    v_pk_fma_f32 v[64:65], v[212:213], v[112:113], v[114:115] op_sel:[0,0,0] op_sel_hi:[0,1,1]
    v_pk_fma_f32 v[66:67], v[212:213], v[176:177], v[178:179] op_sel:[0,0,0] op_sel_hi:[0,1,1]
    v_pk_fma_f32 v[60:61], v[212:213], v[176:177], v[64:65] op_sel:[1,0,0] op_sel_hi:[1,1,1] neg_lo:[1,0,0] neg_hi:[1,0,0]
    v_pk_fma_f32 v[62:63], v[212:213], v[112:113], v[66:67] op_sel:[1,0,0] op_sel_hi:[1,1,1]
    v_pk_fma_f32 v[76:77], v[214:215], v[128:129], v[130:131] op_sel:[0,0,0] op_sel_hi:[0,1,1]
    v_pk_fma_f32 v[78:79], v[214:215], v[192:193], v[194:195] op_sel:[0,0,0] op_sel_hi:[0,1,1]
    v_pk_fma_f32 v[72:73], v[214:215], v[192:193], v[76:77] op_sel:[1,0,0] op_sel_hi:[1,1,1] neg_lo:[1,0,0] neg_hi:[1,0,0]
    v_pk_fma_f32 v[74:75], v[214:215], v[128:129], v[78:79] op_sel:[1,0,0] op_sel_hi:[1,1,1]
    v_pk_mul_f32 v[116:117], v[116:117], v[20:21]
    v_pk_mul_f32 v[180:181], v[180:181], v[20:21]
    v_pk_mul_f32 v[132:133], v[132:133], v[20:21]
    v_pk_mul_f32 v[196:197], v[196:197], v[20:21]
    v_pk_fma_f32 v[116:117], v[36:37], v[50:51], v[116:117] op_sel:[0,0,0] op_sel_hi:[1,0,1] neg_lo:[1,0,0] neg_hi:[1,0,0]
    v_pk_fma_f32 v[180:181], v[36:37], v[54:55], v[180:181] op_sel:[0,0,0] op_sel_hi:[1,0,1] neg_lo:[1,0,0] neg_hi:[1,0,0]
    v_pk_fma_f32 v[132:133], v[36:37], v[50:51], v[132:133] op_sel:[0,1,0] op_sel_hi:[1,1,1] neg_lo:[1,0,0] neg_hi:[1,0,0]
    v_pk_fma_f32 v[196:197], v[36:37], v[54:55], v[196:197] op_sel:[0,1,0] op_sel_hi:[1,1,1] neg_lo:[1,0,0] neg_hi:[1,0,0]
    v_pk_fma_f32 v[64:65], v[212:213], v[60:61], v[116:117] op_sel:[0,0,0] op_sel_hi:[0,1,1]
    v_pk_fma_f32 v[66:67], v[212:213], v[62:63], v[180:181] op_sel:[0,0,0] op_sel_hi:[0,1,1]
    v_pk_fma_f32 v[56:57], v[212:213], v[62:63], v[64:65] op_sel:[1,0,0] op_sel_hi:[1,1,1] neg_lo:[1,0,0] neg_hi:[1,0,0]
    v_pk_fma_f32 v[58:59], v[212:213], v[60:61], v[66:67] op_sel:[1,0,0] op_sel_hi:[1,1,1]
    v_pk_fma_f32 v[76:77], v[214:215], v[72:73], v[132:133] op_sel:[0,0,0] op_sel_hi:[0,1,1]
    v_pk_fma_f32 v[78:79], v[214:215], v[74:75], v[196:197] op_sel:[0,0,0] op_sel_hi:[0,1,1]
    v_pk_fma_f32 v[68:69], v[214:215], v[74:75], v[76:77] op_sel:[1,0,0] op_sel_hi:[1,1,1] neg_lo:[1,0,0] neg_hi:[1,0,0]
    v_pk_fma_f32 v[70:71], v[214:215], v[72:73], v[78:79] op_sel:[1,0,0] op_sel_hi:[1,1,1]
    v_pk_mul_f32 v[118:119], v[118:119], v[22:23]
    v_pk_mul_f32 v[182:183], v[182:183], v[22:23]
    v_pk_mul_f32 v[134:135], v[134:135], v[22:23]
    v_pk_mul_f32 v[198:199], v[198:199], v[22:23]
    v_pk_fma_f32 v[118:119], v[38:39], v[50:51], v[118:119] op_sel:[0,0,0] op_sel_hi:[1,0,1] neg_lo:[1,0,0] neg_hi:[1,0,0]
    v_pk_fma_f32 v[182:183], v[38:39], v[54:55], v[182:183] op_sel:[0,0,0] op_sel_hi:[1,0,1] neg_lo:[1,0,0] neg_hi:[1,0,0]
    v_pk_fma_f32 v[134:135], v[38:39], v[50:51], v[134:135] op_sel:[0,1,0] op_sel_hi:[1,1,1] neg_lo:[1,0,0] neg_hi:[1,0,0]
    v_pk_fma_f32 v[198:199], v[38:39], v[54:55], v[198:199] op_sel:[0,1,0] op_sel_hi:[1,1,1] neg_lo:[1,0,0] neg_hi:[1,0,0]
    v_pk_fma_f32 v[64:65], v[212:213], v[56:57], v[118:119] op_sel:[0,0,0] op_sel_hi:[0,1,1]
    v_pk_fma_f32 v[66:67], v[212:213], v[58:59], v[182:183] op_sel:[0,0,0] op_sel_hi:[0,1,1]
    v_pk_fma_f32 v[60:61], v[212:213], v[58:59], v[64:65] op_sel:[1,0,0] op_sel_hi:[1,1,1] neg_lo:[1,0,0] neg_hi:[1,0,0]
    v_pk_fma_f32 v[62:63], v[212:213], v[56:57], v[66:67] op_sel:[1,0,0] op_sel_hi:[1,1,1]
    v_pk_fma_f32 v[76:77], v[214:215], v[68:69], v[134:135] op_sel:[0,0,0] op_sel_hi:[0,1,1]
    v_pk_fma_f32 v[78:79], v[214:215], v[70:71], v[198:199] op_sel:[0,0,0] op_sel_hi:[0,1,1]
    v_pk_fma_f32 v[72:73], v[214:215], v[70:71], v[76:77] op_sel:[1,0,0] op_sel_hi:[1,1,1] neg_lo:[1,0,0] neg_hi:[1,0,0]
    v_pk_fma_f32 v[74:75], v[214:215], v[68:69], v[78:79] op_sel:[1,0,0] op_sel_hi:[1,1,1]
    v_pk_mul_f32 v[120:121], v[120:121], v[24:25]
    v_pk_mul_f32 v[184:185], v[184:185], v[24:25]
    v_pk_mul_f32 v[136:137], v[136:137], v[24:25]
    v_pk_mul_f32 v[200:201], v[200:201], v[24:25]
    v_pk_fma_f32 v[120:121], v[40:41], v[50:51], v[120:121] op_sel:[0,0,0] op_sel_hi:[1,0,1] neg_lo:[1,0,0] neg_hi:[1,0,0]
    v_pk_fma_f32 v[184:185], v[40:41], v[54:55], v[184:185] op_sel:[0,0,0] op_sel_hi:[1,0,1] neg_lo:[1,0,0] neg_hi:[1,0,0]
    v_pk_fma_f32 v[136:137], v[40:41], v[50:51], v[136:137] op_sel:[0,1,0] op_sel_hi:[1,1,1] neg_lo:[1,0,0] neg_hi:[1,0,0]
    v_pk_fma_f32 v[200:201], v[40:41], v[54:55], v[200:201] op_sel:[0,1,0] op_sel_hi:[1,1,1] neg_lo:[1,0,0] neg_hi:[1,0,0]
    v_pk_fma_f32 v[64:65], v[212:213], v[60:61], v[120:121] op_sel:[0,0,0] op_sel_hi:[0,1,1]
    v_pk_fma_f32 v[66:67], v[212:213], v[62:63], v[184:185] op_sel:[0,0,0] op_sel_hi:[0,1,1]
    v_pk_fma_f32 v[56:57], v[212:213], v[62:63], v[64:65] op_sel:[1,0,0] op_sel_hi:[1,1,1] neg_lo:[1,0,0] neg_hi:[1,0,0]
    v_pk_fma_f32 v[58:59], v[212:213], v[60:61], v[66:67] op_sel:[1,0,0] op_sel_hi:[1,1,1]
    v_pk_fma_f32 v[76:77], v[214:215], v[72:73], v[136:137] op_sel:[0,0,0] op_sel_hi:[0,1,1]
    v_pk_fma_f32 v[78:79], v[214:215], v[74:75], v[200:201] op_sel:[0,0,0] op_sel_hi:[0,1,1]
    v_pk_fma_f32 v[68:69], v[214:215], v[74:75], v[76:77] op_sel:[1,0,0] op_sel_hi:[1,1,1] neg_lo:[1,0,0] neg_hi:[1,0,0]
    v_pk_fma_f32 v[70:71], v[214:215], v[72:73], v[78:79] op_sel:[1,0,0] op_sel_hi:[1,1,1]
    v_pk_mul_f32 v[122:123], v[122:123], v[26:27]
    v_pk_mul_f32 v[186:187], v[186:187], v[26:27]
    v_pk_mul_f32 v[138:139], v[138:139], v[26:27]
    v_pk_mul_f32 v[202:203], v[202:203], v[26:27]
    v_pk_fma_f32 v[122:123], v[42:43], v[50:51], v[122:123] op_sel:[0,0,0] op_sel_hi:[1,0,1] neg_lo:[1,0,0] neg_hi:[1,0,0]
    v_pk_fma_f32 v[186:187], v[42:43], v[54:55], v[186:187] op_sel:[0,0,0] op_sel_hi:[1,0,1] neg_lo:[1,0,0] neg_hi:[1,0,0]
    v_pk_fma_f32 v[138:139], v[42:43], v[50:51], v[138:139] op_sel:[0,1,0] op_sel_hi:[1,1,1] neg_lo:[1,0,0] neg_hi:[1,0,0]
    v_pk_fma_f32 v[202:203], v[42:43], v[54:55], v[202:203] op_sel:[0,1,0] op_sel_hi:[1,1,1] neg_lo:[1,0,0] neg_hi:[1,0,0]
    v_pk_fma_f32 v[64:65], v[212:213], v[56:57], v[122:123] op_sel:[0,0,0] op_sel_hi:[0,1,1]
    v_pk_fma_f32 v[66:67], v[212:213], v[58:59], v[186:187] op_sel:[0,0,0] op_sel_hi:[0,1,1]
    v_pk_fma_f32 v[60:61], v[212:213], v[58:59], v[64:65] op_sel:[1,0,0] op_sel_hi:[1,1,1] neg_lo:[1,0,0] neg_hi:[1,0,0]
    v_pk_fma_f32 v[62:63], v[212:213], v[56:57], v[66:67] op_sel:[1,0,0] op_sel_hi:[1,1,1]
    v_pk_fma_f32 v[76:77], v[214:215], v[68:69], v[138:139] op_sel:[0,0,0] op_sel_hi:[0,1,1]
    v_pk_fma_f32 v[78:79], v[214:215], v[70:71], v[202:203] op_sel:[0,0,0] op_sel_hi:[0,1,1]
    v_pk_fma_f32 v[72:73], v[214:215], v[70:71], v[76:77] op_sel:[1,0,0] op_sel_hi:[1,1,1] neg_lo:[1,0,0] neg_hi:[1,0,0]
    v_pk_fma_f32 v[74:75], v[214:215], v[68:69], v[78:79] op_sel:[1,0,0] op_sel_hi:[1,1,1]
    v_pk_mul_f32 v[124:125], v[124:125], v[28:29]
    v_pk_mul_f32 v[188:189], v[188:189], v[28:29]
    v_pk_mul_f32 v[140:141], v[140:141], v[28:29]
    v_pk_mul_f32 v[204:205], v[204:205], v[28:29]
    v_pk_fma_f32 v[124:125], v[44:45], v[50:51], v[124:125] op_sel:[0,0,0] op_sel_hi:[1,0,1] neg_lo:[1,0,0] neg_hi:[1,0,0]
    v_pk_fma_f32 v[188:189], v[44:45], v[54:55], v[188:189] op_sel:[0,0,0] op_sel_hi:[1,0,1] neg_lo:[1,0,0] neg_hi:[1,0,0]
    v_pk_fma_f32 v[140:141], v[44:45], v[50:51], v[140:141] op_sel:[0,1,0] op_sel_hi:[1,1,1] neg_lo:[1,0,0] neg_hi:[1,0,0]
    v_pk_fma_f32 v[204:205], v[44:45], v[54:55], v[204:205] op_sel:[0,1,0] op_sel_hi:[1,1,1] neg_lo:[1,0,0] neg_hi:[1,0,0]
    v_pk_fma_f32 v[64:65], v[212:213], v[60:61], v[124:125] op_sel:[0,0,0] op_sel_hi:[0,1,1]
    v_pk_fma_f32 v[66:67], v[212:213], v[62:63], v[188:189] op_sel:[0,0,0] op_sel_hi:[0,1,1]
    v_pk_fma_f32 v[56:57], v[212:213], v[62:63], v[64:65] op_sel:[1,0,0] op_sel_hi:[1,1,1] neg_lo:[1,0,0] neg_hi:[1,0,0]
    v_pk_fma_f32 v[58:59], v[212:213], v[60:61], v[66:67] op_sel:[1,0,0] op_sel_hi:[1,1,1]
    v_pk_fma_f32 v[76:77], v[214:215], v[72:73], v[140:141] op_sel:[0,0,0] op_sel_hi:[0,1,1]
    v_pk_fma_f32 v[78:79], v[214:215], v[74:75], v[204:205] op_sel:[0,0,0] op_sel_hi:[0,1,1]
    v_pk_fma_f32 v[68:69], v[214:215], v[74:75], v[76:77] op_sel:[1,0,0] op_sel_hi:[1,1,1] neg_lo:[1,0,0] neg_hi:[1,0,0]
    v_pk_fma_f32 v[70:71], v[214:215], v[72:73], v[78:79] op_sel:[1,0,0] op_sel_hi:[1,1,1]
    v_pk_mul_f32 v[126:127], v[126:127], v[30:31]
    v_pk_mul_f32 v[190:191], v[190:191], v[30:31]
    v_pk_mul_f32 v[142:143], v[142:143], v[30:31]
    v_pk_mul_f32 v[206:207], v[206:207], v[30:31]
    v_pk_fma_f32 v[126:127], v[46:47], v[50:51], v[126:127] op_sel:[0,0,0] op_sel_hi:[1,0,1] neg_lo:[1,0,0] neg_hi:[1,0,0]
    v_pk_fma_f32 v[190:191], v[46:47], v[54:55], v[190:191] op_sel:[0,0,0] op_sel_hi:[1,0,1] neg_lo:[1,0,0] neg_hi:[1,0,0]
    v_pk_fma_f32 v[142:143], v[46:47], v[50:51], v[142:143] op_sel:[0,1,0] op_sel_hi:[1,1,1] neg_lo:[1,0,0] neg_hi:[1,0,0]
    v_pk_fma_f32 v[206:207], v[46:47], v[54:55], v[206:207] op_sel:[0,1,0] op_sel_hi:[1,1,1] neg_lo:[1,0,0] neg_hi:[1,0,0]
    v_pk_fma_f32 v[64:65], v[212:213], v[56:57], v[126:127] op_sel:[0,0,0] op_sel_hi:[0,1,1]
    v_pk_fma_f32 v[66:67], v[212:213], v[58:59], v[190:191] op_sel:[0,0,0] op_sel_hi:[0,1,1]
    v_pk_fma_f32 v[60:61], v[212:213], v[58:59], v[64:65] op_sel:[1,0,0] op_sel_hi:[1,1,1] neg_lo:[1,0,0] neg_hi:[1,0,0]
    v_pk_fma_f32 v[62:63], v[212:213], v[56:57], v[66:67] op_sel:[1,0,0] op_sel_hi:[1,1,1]
    v_pk_fma_f32 v[76:77], v[214:215], v[68:69], v[142:143] op_sel:[0,0,0] op_sel_hi:[0,1,1]
    v_pk_fma_f32 v[78:79], v[214:215], v[70:71], v[206:207] op_sel:[0,0,0] op_sel_hi:[0,1,1]
    v_pk_fma_f32 v[72:73], v[214:215], v[70:71], v[76:77] op_sel:[1,0,0] op_sel_hi:[1,1,1] neg_lo:[1,0,0] neg_hi:[1,0,0]
    v_pk_fma_f32 v[74:75], v[214:215], v[68:69], v[78:79] op_sel:[1,0,0] op_sel_hi:[1,1,1]
    v_mov_b32 v248, v60
    v_mov_b32 v249, v62
    v_mov_b32 v56, v61
    v_mov_b32 v57, v63
    v_pk_fma_f32 v[64:65], v[228:229], v[248:249], v[56:57] op_sel:[0,0,0] op_sel_hi:[0,1,1]
    s_nop 0
    v_pk_fma_f32 v[58:59], v[228:229], v[248:249], v[64:65] op_sel:[1,1,0] op_sel_hi:[1,0,1] neg_lo:[1,0,0]
    ds_write_b64 v5, v[58:59] offset:256
    v_mov_b32 v250, v72
    v_mov_b32 v251, v74
    v_mov_b32 v68, v73
    v_mov_b32 v69, v75
    v_pk_fma_f32 v[76:77], v[230:231], v[250:251], v[68:69] op_sel:[0,0,0] op_sel_hi:[0,1,1]
    s_nop 0
    v_pk_fma_f32 v[70:71], v[230:231], v[250:251], v[76:77] op_sel:[1,1,0] op_sel_hi:[1,0,1] neg_lo:[1,0,0]
    ds_write_b64 v5, v[70:71] offset:384
    v_mov_b32 v15, 11
    ds_write_b32 v254, v15 offset:48
    s_setprio 0
    v_pk_mul_f32 v[56:57], v[216:217], v[80:81] op_sel:[0,0] op_sel_hi:[0,1]
    v_pk_mul_f32 v[58:59], v[216:217], v[80:81] op_sel:[1,0] op_sel_hi:[1,1]
    v_pk_fma_f32 v[80:81], v[216:217], v[144:145], v[56:57] op_sel:[1,0,0] op_sel_hi:[1,1,1] neg_lo:[1,0,0] neg_hi:[1,0,0]
    v_pk_fma_f32 v[144:145], v[216:217], v[144:145], v[58:59] op_sel:[0,0,0] op_sel_hi:[0,1,1]
    v_pk_mul_f32 v[60:61], v[216:217], v[82:83] op_sel:[0,0] op_sel_hi:[0,1]
    v_pk_mul_f32 v[62:63], v[216:217], v[82:83] op_sel:[1,0] op_sel_hi:[1,1]
    v_pk_fma_f32 v[82:83], v[216:217], v[146:147], v[60:61] op_sel:[1,0,0] op_sel_hi:[1,1,1] neg_lo:[1,0,0] neg_hi:[1,0,0]
    v_pk_fma_f32 v[146:147], v[216:217], v[146:147], v[62:63] op_sel:[0,0,0] op_sel_hi:[0,1,1]
    v_pk_mul_f32 v[56:57], v[216:217], v[84:85] op_sel:[0,0] op_sel_hi:[0,1]
    v_pk_mul_f32 v[58:59], v[216:217], v[84:85] op_sel:[1,0] op_sel_hi:[1,1]
    v_pk_fma_f32 v[84:85], v[216:217], v[148:149], v[56:57] op_sel:[1,0,0] op_sel_hi:[1,1,1] neg_lo:[1,0,0] neg_hi:[1,0,0]
    v_pk_fma_f32 v[148:149], v[216:217], v[148:149], v[58:59] op_sel:[0,0,0] op_sel_hi:[0,1,1]
    v_pk_mul_f32 v[60:61], v[216:217], v[86:87] op_sel:[0,0] op_sel_hi:[0,1]
    v_pk_mul_f32 v[62:63], v[216:217], v[86:87] op_sel:[1,0] op_sel_hi:[1,1]
    v_pk_fma_f32 v[86:87], v[216:217], v[150:151], v[60:61] op_sel:[1,0,0] op_sel_hi:[1,1,1] neg_lo:[1,0,0] neg_hi:[1,0,0]
    v_pk_fma_f32 v[150:151], v[216:217], v[150:151], v[62:63] op_sel:[0,0,0] op_sel_hi:[0,1,1]
    v_pk_mul_f32 v[56:57], v[216:217], v[88:89] op_sel:[0,0] op_sel_hi:[0,1]
    v_pk_mul_f32 v[58:59], v[216:217], v[88:89] op_sel:[1,0] op_sel_hi:[1,1]
    v_pk_fma_f32 v[88:89], v[216:217], v[152:153], v[56:57] op_sel:[1,0,0] op_sel_hi:[1,1,1] neg_lo:[1,0,0] neg_hi:[1,0,0]
    v_pk_fma_f32 v[152:153], v[216:217], v[152:153], v[58:59] op_sel:[0,0,0] op_sel_hi:[0,1,1]
    v_pk_mul_f32 v[60:61], v[216:217], v[90:91] op_sel:[0,0] op_sel_hi:[0,1]
    v_pk_mul_f32 v[62:63], v[216:217], v[90:91] op_sel:[1,0] op_sel_hi:[1,1]
    v_pk_fma_f32 v[90:91], v[216:217], v[154:155], v[60:61] op_sel:[1,0,0] op_sel_hi:[1,1,1] neg_lo:[1,0,0] neg_hi:[1,0,0]
    v_pk_fma_f32 v[154:155], v[216:217], v[154:155], v[62:63] op_sel:[0,0,0] op_sel_hi:[0,1,1]
    v_pk_mul_f32 v[56:57], v[216:217], v[92:93] op_sel:[0,0] op_sel_hi:[0,1]
    v_pk_mul_f32 v[58:59], v[216:217], v[92:93] op_sel:[1,0] op_sel_hi:[1,1]
    v_pk_fma_f32 v[92:93], v[216:217], v[156:157], v[56:57] op_sel:[1,0,0] op_sel_hi:[1,1,1] neg_lo:[1,0,0] neg_hi:[1,0,0]
    v_pk_fma_f32 v[156:157], v[216:217], v[156:157], v[58:59] op_sel:[0,0,0] op_sel_hi:[0,1,1]
    v_pk_mul_f32 v[60:61], v[216:217], v[94:95] op_sel:[0,0] op_sel_hi:[0,1]
    v_pk_mul_f32 v[62:63], v[216:217], v[94:95] op_sel:[1,0] op_sel_hi:[1,1]
    v_pk_fma_f32 v[94:95], v[216:217], v[158:159], v[60:61] op_sel:[1,0,0] op_sel_hi:[1,1,1] neg_lo:[1,0,0] neg_hi:[1,0,0]
    v_pk_fma_f32 v[158:159], v[216:217], v[158:159], v[62:63] op_sel:[0,0,0] op_sel_hi:[0,1,1]
    v_pk_mul_f32 v[56:57], v[218:219], v[96:97] op_sel:[0,0] op_sel_hi:[0,1]
    v_pk_mul_f32 v[58:59], v[218:219], v[96:97] op_sel:[1,0] op_sel_hi:[1,1]
    v_pk_fma_f32 v[96:97], v[218:219], v[160:161], v[56:57] op_sel:[1,0,0] op_sel_hi:[1,1,1] neg_lo:[1,0,0] neg_hi:[1,0,0]
    v_pk_fma_f32 v[160:161], v[218:219], v[160:161], v[58:59] op_sel:[0,0,0] op_sel_hi:[0,1,1]
    v_pk_mul_f32 v[60:61], v[218:219], v[98:99] op_sel:[0,0] op_sel_hi:[0,1]
    v_pk_mul_f32 v[62:63], v[218:219], v[98:99] op_sel:[1,0] op_sel_hi:[1,1]
    v_pk_fma_f32 v[98:99], v[218:219], v[162:163], v[60:61] op_sel:[1,0,0] op_sel_hi:[1,1,1] neg_lo:[1,0,0] neg_hi:[1,0,0]
    v_pk_fma_f32 v[162:163], v[218:219], v[162:163], v[62:63] op_sel:[0,0,0] op_sel_hi:[0,1,1]
    v_pk_mul_f32 v[56:57], v[218:219], v[100:101] op_sel:[0,0] op_sel_hi:[0,1]
    v_pk_mul_f32 v[58:59], v[218:219], v[100:101] op_sel:[1,0] op_sel_hi:[1,1]
    v_pk_fma_f32 v[100:101], v[218:219], v[164:165], v[56:57] op_sel:[1,0,0] op_sel_hi:[1,1,1] neg_lo:[1,0,0] neg_hi:[1,0,0]
    v_pk_fma_f32 v[164:165], v[218:219], v[164:165], v[58:59] op_sel:[0,0,0] op_sel_hi:[0,1,1]
    v_pk_mul_f32 v[60:61], v[218:219], v[102:103] op_sel:[0,0] op_sel_hi:[0,1]
    v_pk_mul_f32 v[62:63], v[218:219], v[102:103] op_sel:[1,0] op_sel_hi:[1,1]
    v_pk_fma_f32 v[102:103], v[218:219], v[166:167], v[60:61] op_sel:[1,0,0] op_sel_hi:[1,1,1] neg_lo:[1,0,0] neg_hi:[1,0,0]
    v_pk_fma_f32 v[166:167], v[218:219], v[166:167], v[62:63] op_sel:[0,0,0] op_sel_hi:[0,1,1]
    v_pk_mul_f32 v[56:57], v[218:219], v[104:105] op_sel:[0,0] op_sel_hi:[0,1]
    v_pk_mul_f32 v[58:59], v[218:219], v[104:105] op_sel:[1,0] op_sel_hi:[1,1]
    v_pk_fma_f32 v[104:105], v[218:219], v[168:169], v[56:57] op_sel:[1,0,0] op_sel_hi:[1,1,1] neg_lo:[1,0,0] neg_hi:[1,0,0]
    v_pk_fma_f32 v[168:169], v[218:219], v[168:169], v[58:59] op_sel:[0,0,0] op_sel_hi:[0,1,1]
    v_pk_mul_f32 v[60:61], v[218:219], v[106:107] op_sel:[0,0] op_sel_hi:[0,1]
    v_pk_mul_f32 v[62:63], v[218:219], v[106:107] op_sel:[1,0] op_sel_hi:[1,1]
    v_pk_fma_f32 v[106:107], v[218:219], v[170:171], v[60:61] op_sel:[1,0,0] op_sel_hi:[1,1,1] neg_lo:[1,0,0] neg_hi:[1,0,0]
    v_pk_fma_f32 v[170:171], v[218:219], v[170:171], v[62:63] op_sel:[0,0,0] op_sel_hi:[0,1,1]
    v_pk_mul_f32 v[56:57], v[218:219], v[108:109] op_sel:[0,0] op_sel_hi:[0,1]
    v_pk_mul_f32 v[58:59], v[218:219], v[108:109] op_sel:[1,0] op_sel_hi:[1,1]
    v_pk_fma_f32 v[108:109], v[218:219], v[172:173], v[56:57] op_sel:[1,0,0] op_sel_hi:[1,1,1] neg_lo:[1,0,0] neg_hi:[1,0,0]
    v_pk_fma_f32 v[172:173], v[218:219], v[172:173], v[58:59] op_sel:[0,0,0] op_sel_hi:[0,1,1]
    v_pk_mul_f32 v[60:61], v[218:219], v[110:111] op_sel:[0,0] op_sel_hi:[0,1]
    v_pk_mul_f32 v[62:63], v[218:219], v[110:111] op_sel:[1,0] op_sel_hi:[1,1]
    v_pk_fma_f32 v[110:111], v[218:219], v[174:175], v[60:61] op_sel:[1,0,0] op_sel_hi:[1,1,1] neg_lo:[1,0,0] neg_hi:[1,0,0]
    v_pk_fma_f32 v[174:175], v[218:219], v[174:175], v[62:63] op_sel:[0,0,0] op_sel_hi:[0,1,1]
    v_pk_mul_f32 v[56:57], v[220:221], v[112:113] op_sel:[0,0] op_sel_hi:[0,1]
    v_pk_mul_f32 v[58:59], v[220:221], v[112:113] op_sel:[1,0] op_sel_hi:[1,1]
    v_pk_fma_f32 v[112:113], v[220:221], v[176:177], v[56:57] op_sel:[1,0,0] op_sel_hi:[1,1,1] neg_lo:[1,0,0] neg_hi:[1,0,0]
    v_pk_fma_f32 v[176:177], v[220:221], v[176:177], v[58:59] op_sel:[0,0,0] op_sel_hi:[0,1,1]
    v_pk_mul_f32 v[60:61], v[220:221], v[114:115] op_sel:[0,0] op_sel_hi:[0,1]
    v_pk_mul_f32 v[62:63], v[220:221], v[114:115] op_sel:[1,0] op_sel_hi:[1,1]
    v_pk_fma_f32 v[114:115], v[220:221], v[178:179], v[60:61] op_sel:[1,0,0] op_sel_hi:[1,1,1] neg_lo:[1,0,0] neg_hi:[1,0,0]
    v_pk_fma_f32 v[178:179], v[220:221], v[178:179], v[62:63] op_sel:[0,0,0] op_sel_hi:[0,1,1]
    v_pk_mul_f32 v[56:57], v[220:221], v[116:117] op_sel:[0,0] op_sel_hi:[0,1]
    v_pk_mul_f32 v[58:59], v[220:221], v[116:117] op_sel:[1,0] op_sel_hi:[1,1]
    v_pk_fma_f32 v[116:117], v[220:221], v[180:181], v[56:57] op_sel:[1,0,0] op_sel_hi:[1,1,1] neg_lo:[1,0,0] neg_hi:[1,0,0]
    v_pk_fma_f32 v[180:181], v[220:221], v[180:181], v[58:59] op_sel:[0,0,0] op_sel_hi:[0,1,1]
    v_pk_mul_f32 v[60:61], v[220:221], v[118:119] op_sel:[0,0] op_sel_hi:[0,1]
    v_pk_mul_f32 v[62:63], v[220:221], v[118:119] op_sel:[1,0] op_sel_hi:[1,1]
    v_pk_fma_f32 v[118:119], v[220:221], v[182:183], v[60:61] op_sel:[1,0,0] op_sel_hi:[1,1,1] neg_lo:[1,0,0] neg_hi:[1,0,0]
    v_pk_fma_f32 v[182:183], v[220:221], v[182:183], v[62:63] op_sel:[0,0,0] op_sel_hi:[0,1,1]
    v_pk_mul_f32 v[56:57], v[220:221], v[120:121] op_sel:[0,0] op_sel_hi:[0,1]
    v_pk_mul_f32 v[58:59], v[220:221], v[120:121] op_sel:[1,0] op_sel_hi:[1,1]
    v_pk_fma_f32 v[120:121], v[220:221], v[184:185], v[56:57] op_sel:[1,0,0] op_sel_hi:[1,1,1] neg_lo:[1,0,0] neg_hi:[1,0,0]
    v_pk_fma_f32 v[184:185], v[220:221], v[184:185], v[58:59] op_sel:[0,0,0] op_sel_hi:[0,1,1]
    v_pk_mul_f32 v[60:61], v[220:221], v[122:123] op_sel:[0,0] op_sel_hi:[0,1]
    v_pk_mul_f32 v[62:63], v[220:221], v[122:123] op_sel:[1,0] op_sel_hi:[1,1]
    v_pk_fma_f32 v[122:123], v[220:221], v[186:187], v[60:61] op_sel:[1,0,0] op_sel_hi:[1,1,1] neg_lo:[1,0,0] neg_hi:[1,0,0]
    v_pk_fma_f32 v[186:187], v[220:221], v[186:187], v[62:63] op_sel:[0,0,0] op_sel_hi:[0,1,1]
    v_pk_mul_f32 v[56:57], v[220:221], v[124:125] op_sel:[0,0] op_sel_hi:[0,1]
    v_pk_mul_f32 v[58:59], v[220:221], v[124:125] op_sel:[1,0] op_sel_hi:[1,1]
    v_pk_fma_f32 v[124:125], v[220:221], v[188:189], v[56:57] op_sel:[1,0,0] op_sel_hi:[1,1,1] neg_lo:[1,0,0] neg_hi:[1,0,0]
    v_pk_fma_f32 v[188:189], v[220:221], v[188:189], v[58:59] op_sel:[0,0,0] op_sel_hi:[0,1,1]
    v_pk_mul_f32 v[60:61], v[220:221], v[126:127] op_sel:[0,0] op_sel_hi:[0,1]
    v_pk_mul_f32 v[62:63], v[220:221], v[126:127] op_sel:[1,0] op_sel_hi:[1,1]
    v_pk_fma_f32 v[126:127], v[220:221], v[190:191], v[60:61] op_sel:[1,0,0] op_sel_hi:[1,1,1] neg_lo:[1,0,0] neg_hi:[1,0,0]
    v_pk_fma_f32 v[190:191], v[220:221], v[190:191], v[62:63] op_sel:[0,0,0] op_sel_hi:[0,1,1]
    v_pk_mul_f32 v[56:57], v[222:223], v[128:129] op_sel:[0,0] op_sel_hi:[0,1]
    v_pk_mul_f32 v[58:59], v[222:223], v[128:129] op_sel:[1,0] op_sel_hi:[1,1]
    v_pk_fma_f32 v[128:129], v[222:223], v[192:193], v[56:57] op_sel:[1,0,0] op_sel_hi:[1,1,1] neg_lo:[1,0,0] neg_hi:[1,0,0]
    v_pk_fma_f32 v[192:193], v[222:223], v[192:193], v[58:59] op_sel:[0,0,0] op_sel_hi:[0,1,1]
    v_pk_mul_f32 v[60:61], v[222:223], v[130:131] op_sel:[0,0] op_sel_hi:[0,1]
    v_pk_mul_f32 v[62:63], v[222:223], v[130:131] op_sel:[1,0] op_sel_hi:[1,1]
    v_pk_fma_f32 v[130:131], v[222:223], v[194:195], v[60:61] op_sel:[1,0,0] op_sel_hi:[1,1,1] neg_lo:[1,0,0] neg_hi:[1,0,0]
    v_pk_fma_f32 v[194:195], v[222:223], v[194:195], v[62:63] op_sel:[0,0,0] op_sel_hi:[0,1,1]
    v_pk_mul_f32 v[56:57], v[222:223], v[132:133] op_sel:[0,0] op_sel_hi:[0,1]
    v_pk_mul_f32 v[58:59], v[222:223], v[132:133] op_sel:[1,0] op_sel_hi:[1,1]
    v_pk_fma_f32 v[132:133], v[222:223], v[196:197], v[56:57] op_sel:[1,0,0] op_sel_hi:[1,1,1] neg_lo:[1,0,0] neg_hi:[1,0,0]
    v_pk_fma_f32 v[196:197], v[222:223], v[196:197], v[58:59] op_sel:[0,0,0] op_sel_hi:[0,1,1]
    v_pk_mul_f32 v[60:61], v[222:223], v[134:135] op_sel:[0,0] op_sel_hi:[0,1]
    v_pk_mul_f32 v[62:63], v[222:223], v[134:135] op_sel:[1,0] op_sel_hi:[1,1]
    v_pk_fma_f32 v[134:135], v[222:223], v[198:199], v[60:61] op_sel:[1,0,0] op_sel_hi:[1,1,1] neg_lo:[1,0,0] neg_hi:[1,0,0]
    v_pk_fma_f32 v[198:199], v[222:223], v[198:199], v[62:63] op_sel:[0,0,0] op_sel_hi:[0,1,1]
    v_pk_mul_f32 v[56:57], v[222:223], v[136:137] op_sel:[0,0] op_sel_hi:[0,1]
    v_pk_mul_f32 v[58:59], v[222:223], v[136:137] op_sel:[1,0] op_sel_hi:[1,1]
    v_pk_fma_f32 v[136:137], v[222:223], v[200:201], v[56:57] op_sel:[1,0,0] op_sel_hi:[1,1,1] neg_lo:[1,0,0] neg_hi:[1,0,0]
    v_pk_fma_f32 v[200:201], v[222:223], v[200:201], v[58:59] op_sel:[0,0,0] op_sel_hi:[0,1,1]
    v_pk_mul_f32 v[60:61], v[222:223], v[138:139] op_sel:[0,0] op_sel_hi:[0,1]
    v_pk_mul_f32 v[62:63], v[222:223], v[138:139] op_sel:[1,0] op_sel_hi:[1,1]
    v_pk_fma_f32 v[138:139], v[222:223], v[202:203], v[60:61] op_sel:[1,0,0] op_sel_hi:[1,1,1] neg_lo:[1,0,0] neg_hi:[1,0,0]
    v_pk_fma_f32 v[202:203], v[222:223], v[202:203], v[62:63] op_sel:[0,0,0] op_sel_hi:[0,1,1]
    v_pk_mul_f32 v[56:57], v[222:223], v[140:141] op_sel:[0,0] op_sel_hi:[0,1]
    v_pk_mul_f32 v[58:59], v[222:223], v[140:141] op_sel:[1,0] op_sel_hi:[1,1]
    v_pk_fma_f32 v[140:141], v[222:223], v[204:205], v[56:57] op_sel:[1,0,0] op_sel_hi:[1,1,1] neg_lo:[1,0,0] neg_hi:[1,0,0]
    v_pk_fma_f32 v[204:205], v[222:223], v[204:205], v[58:59] op_sel:[0,0,0] op_sel_hi:[0,1,1]
    v_pk_mul_f32 v[60:61], v[222:223], v[142:143] op_sel:[0,0] op_sel_hi:[0,1]
    v_pk_mul_f32 v[62:63], v[222:223], v[142:143] op_sel:[1,0] op_sel_hi:[1,1]
    v_pk_fma_f32 v[142:143], v[222:223], v[206:207], v[60:61] op_sel:[1,0,0] op_sel_hi:[1,1,1] neg_lo:[1,0,0] neg_hi:[1,0,0]
    v_pk_fma_f32 v[206:207], v[222:223], v[206:207], v[62:63] op_sel:[0,0,0] op_sel_hi:[0,1,1]
    s_mul_i32 s68, s3, 10240
    v_mul_u32_u24 v6, 144, v8
    v_lshl_add_u32 v6, v9, 5, v6
    v_add_u32 v6, s68, v6
    v_bfe_u32 v7, v0, 2, 2
    v_lshl_add_u32 v7, v9, 3, v7
    v_mul_u32_u24 v7, 144, v7
    v_and_b32 v10, 3, v0
    v_lshl_add_u32 v7, v10, 3, v7
    v_add_u32 v7, s68, v7
    s_lshl_b32 s68, s60, 2
    s_add_u32 s68, s68, s3
    s_mul_i32 s68, s68, 385024
    s_add_u32 s44, s34, s68
    s_addc_u32 s45, s35, 0
    s_mov_b32 s46, 385024
    s_mov_b32 s47, 0x00020000
    s_lshl_b32 s69, s62, 14
L_s2a:
    ds_read_b32 v10, v14 offset:40
    s_waitcnt lgkmcnt(0)
    v_readfirstlane_b32 s73, v10
    s_nop 0
    s_cmp_ge_u32 s73, 12
    s_cbranch_scc1 L_s2ax
    s_add_u32 s67, s67, 1
    s_cmp_lt_u32 s67, 0x2000000
    s_cbranch_scc1 L_s2a
L_s2ax:
L_s2:
    ds_read_b32 v10, v14 offset:44
    s_waitcnt lgkmcnt(0)
    v_readfirstlane_b32 s73, v10
    s_nop 0
    s_cmp_ge_u32 s73, 12
    s_cbranch_scc1 L_s2x
    s_add_u32 s67, s67, 1
    s_cmp_lt_u32 s67, 0x2000000
    s_cbranch_scc1 L_s2
L_s2x:
    s_setprio 3
    ds_read_b64 v[16:17], v5 offset:0
    ds_read_b64 v[24:25], v4 offset:0
    ds_read_b64 v[18:19], v5 offset:128
    ds_read_b64 v[26:27], v4 offset:128
    ds_read_b64 v[20:21], v5 offset:256
    ds_read_b64 v[28:29], v4 offset:256
    ds_read_b64 v[22:23], v5 offset:384
    ds_read_b64 v[30:31], v4 offset:384
    s_waitcnt lgkmcnt(0)
    v_pk_fma_f32 v[64:65], v[232:233], v[24:25], v[16:17] op_sel:[0,0,0] op_sel_hi:[0,1,1]
    v_pk_fma_f32 v[76:77], v[234:235], v[26:27], v[18:19] op_sel:[0,0,0] op_sel_hi:[0,1,1]
    v_pk_fma_f32 v[56:57], v[232:233], v[24:25], v[64:65] op_sel:[1,1,0] op_sel_hi:[1,0,1] neg_lo:[1,0,0]
    v_pk_fma_f32 v[68:69], v[234:235], v[26:27], v[76:77] op_sel:[1,1,0] op_sel_hi:[1,0,1] neg_lo:[1,0,0]
    v_pk_fma_f32 v[64:65], v[224:225], v[56:57], v[244:245] op_sel:[0,0,0] op_sel_hi:[0,1,1]
    v_pk_fma_f32 v[76:77], v[226:227], v[68:69], v[246:247] op_sel:[0,0,0] op_sel_hi:[0,1,1]
    v_pk_fma_f32 v[58:59], v[224:225], v[56:57], v[64:65] op_sel:[1,1,0] op_sel_hi:[1,0,1] neg_lo:[1,0,0]
    v_pk_fma_f32 v[70:71], v[226:227], v[68:69], v[76:77] op_sel:[1,1,0] op_sel_hi:[1,0,1] neg_lo:[1,0,0]
    v_pk_mul_f32 v[64:65], v[216:217], v[56:57] op_sel:[0,0] op_sel_hi:[0,1]
    v_pk_mul_f32 v[76:77], v[218:219], v[68:69] op_sel:[0,0] op_sel_hi:[0,1]
    v_pk_fma_f32 v[60:61], v[216:217], v[56:57], v[64:65] op_sel:[1,1,0] op_sel_hi:[1,0,1] neg_lo:[1,0,0]
    v_pk_fma_f32 v[72:73], v[218:219], v[68:69], v[76:77] op_sel:[1,1,0] op_sel_hi:[1,0,1] neg_lo:[1,0,0]
    v_pk_mul_f32 v[66:67], v[216:217], v[58:59] op_sel:[0,0] op_sel_hi:[0,1]
    v_pk_mul_f32 v[78:79], v[218:219], v[70:71] op_sel:[0,0] op_sel_hi:[0,1]
    v_pk_fma_f32 v[62:63], v[216:217], v[58:59], v[66:67] op_sel:[1,1,0] op_sel_hi:[1,0,1] neg_lo:[1,0,0]
    v_pk_fma_f32 v[74:75], v[218:219], v[70:71], v[78:79] op_sel:[1,1,0] op_sel_hi:[1,0,1] neg_lo:[1,0,0]
    v_mov_b32 v32, v60
    v_mov_b32 v36, v72
    v_mov_b32 v33, v62
    v_mov_b32 v37, v74
    v_mov_b32 v34, v61
    v_mov_b32 v38, v73
    v_mov_b32 v35, v63
    v_mov_b32 v39, v75
    v_pk_fma_f32 v[64:65], v[236:237], v[28:29], v[20:21] op_sel:[0,0,0] op_sel_hi:[0,1,1]
    v_pk_fma_f32 v[76:77], v[238:239], v[30:31], v[22:23] op_sel:[0,0,0] op_sel_hi:[0,1,1]
    v_pk_fma_f32 v[56:57], v[236:237], v[28:29], v[64:65] op_sel:[1,1,0] op_sel_hi:[1,0,1] neg_lo:[1,0,0]
    v_pk_fma_f32 v[68:69], v[238:239], v[30:31], v[76:77] op_sel:[1,1,0] op_sel_hi:[1,0,1] neg_lo:[1,0,0]
    v_pk_fma_f32 v[64:65], v[228:229], v[56:57], v[248:249] op_sel:[0,0,0] op_sel_hi:[0,1,1]
    v_pk_fma_f32 v[76:77], v[230:231], v[68:69], v[250:251] op_sel:[0,0,0] op_sel_hi:[0,1,1]
    v_pk_fma_f32 v[58:59], v[228:229], v[56:57], v[64:65] op_sel:[1,1,0] op_sel_hi:[1,0,1] neg_lo:[1,0,0]
    v_pk_fma_f32 v[70:71], v[230:231], v[68:69], v[76:77] op_sel:[1,1,0] op_sel_hi:[1,0,1] neg_lo:[1,0,0]
    v_pk_mul_f32 v[64:65], v[220:221], v[56:57] op_sel:[0,0] op_sel_hi:[0,1]
    v_pk_mul_f32 v[76:77], v[222:223], v[68:69] op_sel:[0,0] op_sel_hi:[0,1]
    v_pk_fma_f32 v[60:61], v[220:221], v[56:57], v[64:65] op_sel:[1,1,0] op_sel_hi:[1,0,1] neg_lo:[1,0,0]
    v_pk_fma_f32 v[72:73], v[222:223], v[68:69], v[76:77] op_sel:[1,1,0] op_sel_hi:[1,0,1] neg_lo:[1,0,0]
    v_pk_mul_f32 v[66:67], v[220:221], v[58:59] op_sel:[0,0] op_sel_hi:[0,1]
    v_pk_mul_f32 v[78:79], v[222:223], v[70:71] op_sel:[0,0] op_sel_hi:[0,1]
    v_pk_fma_f32 v[62:63], v[220:221], v[58:59], v[66:67] op_sel:[1,1,0] op_sel_hi:[1,0,1] neg_lo:[1,0,0]
    v_pk_fma_f32 v[74:75], v[222:223], v[70:71], v[78:79] op_sel:[1,1,0] op_sel_hi:[1,0,1] neg_lo:[1,0,0]
    v_mov_b32 v40, v60
    v_mov_b32 v44, v72
    v_mov_b32 v41, v62
    v_mov_b32 v45, v74
    v_mov_b32 v42, v61
    v_mov_b32 v46, v73
    v_mov_b32 v43, v63
    v_mov_b32 v47, v75
    v_pk_fma_f32 v[80:81], v[208:209], v[32:33], v[80:81] op_sel:[0,0,0] op_sel_hi:[0,1,1]
    v_pk_fma_f32 v[144:145], v[208:209], v[34:35], v[144:145] op_sel:[0,0,0] op_sel_hi:[0,1,1]
    v_pk_fma_f32 v[80:81], v[208:209], v[34:35], v[80:81] op_sel:[1,0,0] op_sel_hi:[1,1,1] neg_lo:[1,0,0] neg_hi:[1,0,0]
    v_pk_fma_f32 v[144:145], v[208:209], v[32:33], v[144:145] op_sel:[1,0,0] op_sel_hi:[1,1,1]
    v_pk_fma_f32 v[96:97], v[210:211], v[36:37], v[96:97] op_sel:[0,0,0] op_sel_hi:[0,1,1]
    v_pk_fma_f32 v[160:161], v[210:211], v[38:39], v[160:161] op_sel:[0,0,0] op_sel_hi:[0,1,1]
    v_pk_fma_f32 v[96:97], v[210:211], v[38:39], v[96:97] op_sel:[1,0,0] op_sel_hi:[1,1,1] neg_lo:[1,0,0] neg_hi:[1,0,0]
    v_pk_fma_f32 v[160:161], v[210:211], v[36:37], v[160:161] op_sel:[1,0,0] op_sel_hi:[1,1,1]
    v_pk_fma_f32 v[82:83], v[208:209], v[80:81], v[82:83] op_sel:[0,0,0] op_sel_hi:[0,1,1]
    v_pk_fma_f32 v[146:147], v[208:209], v[144:145], v[146:147] op_sel:[0,0,0] op_sel_hi:[0,1,1]
    v_pk_fma_f32 v[82:83], v[208:209], v[144:145], v[82:83] op_sel:[1,0,0] op_sel_hi:[1,1,1] neg_lo:[1,0,0] neg_hi:[1,0,0]
    v_pk_fma_f32 v[146:147], v[208:209], v[80:81], v[146:147] op_sel:[1,0,0] op_sel_hi:[1,1,1]
    v_pk_fma_f32 v[98:99], v[210:211], v[96:97], v[98:99] op_sel:[0,0,0] op_sel_hi:[0,1,1]
    v_pk_fma_f32 v[162:163], v[210:211], v[160:161], v[162:163] op_sel:[0,0,0] op_sel_hi:[0,1,1]
    v_pk_fma_f32 v[98:99], v[210:211], v[160:161], v[98:99] op_sel:[1,0,0] op_sel_hi:[1,1,1] neg_lo:[1,0,0] neg_hi:[1,0,0]
    v_pk_fma_f32 v[162:163], v[210:211], v[96:97], v[162:163] op_sel:[1,0,0] op_sel_hi:[1,1,1]
    v_pk_fma_f32 v[84:85], v[208:209], v[82:83], v[84:85] op_sel:[0,0,0] op_sel_hi:[0,1,1]
    v_pk_fma_f32 v[148:149], v[208:209], v[146:147], v[148:149] op_sel:[0,0,0] op_sel_hi:[0,1,1]
    v_pk_fma_f32 v[84:85], v[208:209], v[146:147], v[84:85] op_sel:[1,0,0] op_sel_hi:[1,1,1] neg_lo:[1,0,0] neg_hi:[1,0,0]
    v_pk_fma_f32 v[148:149], v[208:209], v[82:83], v[148:149] op_sel:[1,0,0] op_sel_hi:[1,1,1]
    v_pk_fma_f32 v[100:101], v[210:211], v[98:99], v[100:101] op_sel:[0,0,0] op_sel_hi:[0,1,1]
    v_pk_fma_f32 v[164:165], v[210:211], v[162:163], v[164:165] op_sel:[0,0,0] op_sel_hi:[0,1,1]
    v_pk_fma_f32 v[100:101], v[210:211], v[162:163], v[100:101] op_sel:[1,0,0] op_sel_hi:[1,1,1] neg_lo:[1,0,0] neg_hi:[1,0,0]
    v_pk_fma_f32 v[164:165], v[210:211], v[98:99], v[164:165] op_sel:[1,0,0] op_sel_hi:[1,1,1]
    v_pk_fma_f32 v[86:87], v[208:209], v[84:85], v[86:87] op_sel:[0,0,0] op_sel_hi:[0,1,1]
    v_pk_fma_f32 v[150:151], v[208:209], v[148:149], v[150:151] op_sel:[0,0,0] op_sel_hi:[0,1,1]
    v_pk_fma_f32 v[86:87], v[208:209], v[148:149], v[86:87] op_sel:[1,0,0] op_sel_hi:[1,1,1] neg_lo:[1,0,0] neg_hi:[1,0,0]
    v_pk_fma_f32 v[150:151], v[208:209], v[84:85], v[150:151] op_sel:[1,0,0] op_sel_hi:[1,1,1]
    v_pk_fma_f32 v[102:103], v[210:211], v[100:101], v[102:103] op_sel:[0,0,0] op_sel_hi:[0,1,1]
    v_pk_fma_f32 v[166:167], v[210:211], v[164:165], v[166:167] op_sel:[0,0,0] op_sel_hi:[0,1,1]
    v_pk_fma_f32 v[102:103], v[210:211], v[164:165], v[102:103] op_sel:[1,0,0] op_sel_hi:[1,1,1] neg_lo:[1,0,0] neg_hi:[1,0,0]
    v_pk_fma_f32 v[166:167], v[210:211], v[100:101], v[166:167] op_sel:[1,0,0] op_sel_hi:[1,1,1]
    v_pk_fma_f32 v[88:89], v[208:209], v[86:87], v[88:89] op_sel:[0,0,0] op_sel_hi:[0,1,1]
    v_pk_fma_f32 v[152:153], v[208:209], v[150:151], v[152:153] op_sel:[0,0,0] op_sel_hi:[0,1,1]
    v_pk_fma_f32 v[88:89], v[208:209], v[150:151], v[88:89] op_sel:[1,0,0] op_sel_hi:[1,1,1] neg_lo:[1,0,0] neg_hi:[1,0,0]
    v_pk_fma_f32 v[152:153], v[208:209], v[86:87], v[152:153] op_sel:[1,0,0] op_sel_hi:[1,1,1]
    v_pk_fma_f32 v[104:105], v[210:211], v[102:103], v[104:105] op_sel:[0,0,0] op_sel_hi:[0,1,1]
    v_pk_fma_f32 v[168:169], v[210:211], v[166:167], v[168:169] op_sel:[0,0,0] op_sel_hi:[0,1,1]
    v_pk_fma_f32 v[104:105], v[210:211], v[166:167], v[104:105] op_sel:[1,0,0] op_sel_hi:[1,1,1] neg_lo:[1,0,0] neg_hi:[1,0,0]
    v_pk_fma_f32 v[168:169], v[210:211], v[102:103], v[168:169] op_sel:[1,0,0] op_sel_hi:[1,1,1]
    v_pk_fma_f32 v[90:91], v[208:209], v[88:89], v[90:91] op_sel:[0,0,0] op_sel_hi:[0,1,1]
    v_pk_fma_f32 v[154:155], v[208:209], v[152:153], v[154:155] op_sel:[0,0,0] op_sel_hi:[0,1,1]
    v_pk_fma_f32 v[90:91], v[208:209], v[152:153], v[90:91] op_sel:[1,0,0] op_sel_hi:[1,1,1] neg_lo:[1,0,0] neg_hi:[1,0,0]
    v_pk_fma_f32 v[154:155], v[208:209], v[88:89], v[154:155] op_sel:[1,0,0] op_sel_hi:[1,1,1]
    v_pk_fma_f32 v[106:107], v[210:211], v[104:105], v[106:107] op_sel:[0,0,0] op_sel_hi:[0,1,1]
    v_pk_fma_f32 v[170:171], v[210:211], v[168:169], v[170:171] op_sel:[0,0,0] op_sel_hi:[0,1,1]
    v_pk_fma_f32 v[106:107], v[210:211], v[168:169], v[106:107] op_sel:[1,0,0] op_sel_hi:[1,1,1] neg_lo:[1,0,0] neg_hi:[1,0,0]
    v_pk_fma_f32 v[170:171], v[210:211], v[104:105], v[170:171] op_sel:[1,0,0] op_sel_hi:[1,1,1]
    v_pk_fma_f32 v[92:93], v[208:209], v[90:91], v[92:93] op_sel:[0,0,0] op_sel_hi:[0,1,1]
    v_pk_fma_f32 v[156:157], v[208:209], v[154:155], v[156:157] op_sel:[0,0,0] op_sel_hi:[0,1,1]
    v_pk_fma_f32 v[92:93], v[208:209], v[154:155], v[92:93] op_sel:[1,0,0] op_sel_hi:[1,1,1] neg_lo:[1,0,0] neg_hi:[1,0,0]
    v_pk_fma_f32 v[156:157], v[208:209], v[90:91], v[156:157] op_sel:[1,0,0] op_sel_hi:[1,1,1]
    v_pk_fma_f32 v[108:109], v[210:211], v[106:107], v[108:109] op_sel:[0,0,0] op_sel_hi:[0,1,1]
    v_pk_fma_f32 v[172:173], v[210:211], v[170:171], v[172:173] op_sel:[0,0,0] op_sel_hi:[0,1,1]
    v_pk_fma_f32 v[108:109], v[210:211], v[170:171], v[108:109] op_sel:[1,0,0] op_sel_hi:[1,1,1] neg_lo:[1,0,0] neg_hi:[1,0,0]
    v_pk_fma_f32 v[172:173], v[210:211], v[106:107], v[172:173] op_sel:[1,0,0] op_sel_hi:[1,1,1]
    v_pk_fma_f32 v[94:95], v[208:209], v[92:93], v[94:95] op_sel:[0,0,0] op_sel_hi:[0,1,1]
    v_pk_fma_f32 v[158:159], v[208:209], v[156:157], v[158:159] op_sel:[0,0,0] op_sel_hi:[0,1,1]
    v_pk_fma_f32 v[94:95], v[208:209], v[156:157], v[94:95] op_sel:[1,0,0] op_sel_hi:[1,1,1] neg_lo:[1,0,0] neg_hi:[1,0,0]
    v_pk_fma_f32 v[158:159], v[208:209], v[92:93], v[158:159] op_sel:[1,0,0] op_sel_hi:[1,1,1]
    v_pk_fma_f32 v[110:111], v[210:211], v[108:109], v[110:111] op_sel:[0,0,0] op_sel_hi:[0,1,1]
    v_pk_fma_f32 v[174:175], v[210:211], v[172:173], v[174:175] op_sel:[0,0,0] op_sel_hi:[0,1,1]
    v_pk_fma_f32 v[110:111], v[210:211], v[172:173], v[110:111] op_sel:[1,0,0] op_sel_hi:[1,1,1] neg_lo:[1,0,0] neg_hi:[1,0,0]
    v_pk_fma_f32 v[174:175], v[210:211], v[108:109], v[174:175] op_sel:[1,0,0] op_sel_hi:[1,1,1]
    v_cvt_pk_bf16_f32 v56, v80, v82
    v_cvt_pk_bf16_f32 v57, v84, v86
    v_cvt_pk_bf16_f32 v58, v88, v90
    v_cvt_pk_bf16_f32 v59, v92, v94
    ds_write_b128 v6, v[56:59] offset:0
    v_cvt_pk_bf16_f32 v60, v81, v83
    v_cvt_pk_bf16_f32 v61, v85, v87
    v_cvt_pk_bf16_f32 v62, v89, v91
    v_cvt_pk_bf16_f32 v63, v93, v95
    ds_write_b128 v6, v[60:63] offset:16
    v_cvt_pk_bf16_f32 v64, -v144, -v146
    v_cvt_pk_bf16_f32 v65, -v148, -v150
    v_cvt_pk_bf16_f32 v66, -v152, -v154
    v_cvt_pk_bf16_f32 v67, -v156, -v158
    ds_write_b128 v6, v[64:67] offset:4608
    v_cvt_pk_bf16_f32 v68, -v145, -v147
    v_cvt_pk_bf16_f32 v69, -v149, -v151
    v_cvt_pk_bf16_f32 v70, -v153, -v155
    v_cvt_pk_bf16_f32 v71, -v157, -v159
    ds_write_b128 v6, v[68:71] offset:4624
    v_cvt_pk_bf16_f32 v72, v96, v98
    v_cvt_pk_bf16_f32 v73, v100, v102
    v_cvt_pk_bf16_f32 v74, v104, v106
    v_cvt_pk_bf16_f32 v75, v108, v110
    ds_write_b128 v6, v[72:75] offset:2304
    s_waitcnt lgkmcnt(4)
    v_cvt_pk_bf16_f32 v76, v97, v99
    v_cvt_pk_bf16_f32 v77, v101, v103
    v_cvt_pk_bf16_f32 v78, v105, v107
    v_cvt_pk_bf16_f32 v79, v109, v111
    ds_write_b128 v6, v[76:79] offset:2320
    s_waitcnt lgkmcnt(4)
    v_cvt_pk_bf16_f32 v56, -v160, -v162
    v_cvt_pk_bf16_f32 v57, -v164, -v166
    v_cvt_pk_bf16_f32 v58, -v168, -v170
    v_cvt_pk_bf16_f32 v59, -v172, -v174
    ds_write_b128 v6, v[56:59] offset:6912
    s_waitcnt lgkmcnt(4)
    v_cvt_pk_bf16_f32 v60, -v161, -v163
    v_cvt_pk_bf16_f32 v61, -v165, -v167
    v_cvt_pk_bf16_f32 v62, -v169, -v171
    v_cvt_pk_bf16_f32 v63, -v173, -v175
    ds_write_b128 v6, v[60:63] offset:6928
    s_waitcnt lgkmcnt(4)
    v_pk_fma_f32 v[112:113], v[212:213], v[40:41], v[112:113] op_sel:[0,0,0] op_sel_hi:[0,1,1]
    v_pk_fma_f32 v[176:177], v[212:213], v[42:43], v[176:177] op_sel:[0,0,0] op_sel_hi:[0,1,1]
    v_pk_fma_f32 v[112:113], v[212:213], v[42:43], v[112:113] op_sel:[1,0,0] op_sel_hi:[1,1,1] neg_lo:[1,0,0] neg_hi:[1,0,0]
    v_pk_fma_f32 v[176:177], v[212:213], v[40:41], v[176:177] op_sel:[1,0,0] op_sel_hi:[1,1,1]
    v_pk_fma_f32 v[128:129], v[214:215], v[44:45], v[128:129] op_sel:[0,0,0] op_sel_hi:[0,1,1]
    v_pk_fma_f32 v[192:193], v[214:215], v[46:47], v[192:193] op_sel:[0,0,0] op_sel_hi:[0,1,1]
    v_pk_fma_f32 v[128:129], v[214:215], v[46:47], v[128:129] op_sel:[1,0,0] op_sel_hi:[1,1,1] neg_lo:[1,0,0] neg_hi:[1,0,0]
    v_pk_fma_f32 v[192:193], v[214:215], v[44:45], v[192:193] op_sel:[1,0,0] op_sel_hi:[1,1,1]
    v_pk_fma_f32 v[114:115], v[212:213], v[112:113], v[114:115] op_sel:[0,0,0] op_sel_hi:[0,1,1]
    v_pk_fma_f32 v[178:179], v[212:213], v[176:177], v[178:179] op_sel:[0,0,0] op_sel_hi:[0,1,1]
    v_pk_fma_f32 v[114:115], v[212:213], v[176:177], v[114:115] op_sel:[1,0,0] op_sel_hi:[1,1,1] neg_lo:[1,0,0] neg_hi:[1,0,0]
    v_pk_fma_f32 v[178:179], v[212:213], v[112:113], v[178:179] op_sel:[1,0,0] op_sel_hi:[1,1,1]
    v_pk_fma_f32 v[130:131], v[214:215], v[128:129], v[130:131] op_sel:[0,0,0] op_sel_hi:[0,1,1]
    v_pk_fma_f32 v[194:195], v[214:215], v[192:193], v[194:195] op_sel:[0,0,0] op_sel_hi:[0,1,1]
    v_pk_fma_f32 v[130:131], v[214:215], v[192:193], v[130:131] op_sel:[1,0,0] op_sel_hi:[1,1,1] neg_lo:[1,0,0] neg_hi:[1,0,0]
    v_pk_fma_f32 v[194:195], v[214:215], v[128:129], v[194:195] op_sel:[1,0,0] op_sel_hi:[1,1,1]
    v_pk_fma_f32 v[116:117], v[212:213], v[114:115], v[116:117] op_sel:[0,0,0] op_sel_hi:[0,1,1]
    v_pk_fma_f32 v[180:181], v[212:213], v[178:179], v[180:181] op_sel:[0,0,0] op_sel_hi:[0,1,1]
    v_pk_fma_f32 v[116:117], v[212:213], v[178:179], v[116:117] op_sel:[1,0,0] op_sel_hi:[1,1,1] neg_lo:[1,0,0] neg_hi:[1,0,0]
    v_pk_fma_f32 v[180:181], v[212:213], v[114:115], v[180:181] op_sel:[1,0,0] op_sel_hi:[1,1,1]
    v_pk_fma_f32 v[132:133], v[214:215], v[130:131], v[132:133] op_sel:[0,0,0] op_sel_hi:[0,1,1]
    v_pk_fma_f32 v[196:197], v[214:215], v[194:195], v[196:197] op_sel:[0,0,0] op_sel_hi:[0,1,1]
    v_pk_fma_f32 v[132:133], v[214:215], v[194:195], v[132:133] op_sel:[1,0,0] op_sel_hi:[1,1,1] neg_lo:[1,0,0] neg_hi:[1,0,0]
    v_pk_fma_f32 v[196:197], v[214:215], v[130:131], v[196:197] op_sel:[1,0,0] op_sel_hi:[1,1,1]
    v_pk_fma_f32 v[118:119], v[212:213], v[116:117], v[118:119] op_sel:[0,0,0] op_sel_hi:[0,1,1]
    v_pk_fma_f32 v[182:183], v[212:213], v[180:181], v[182:183] op_sel:[0,0,0] op_sel_hi:[0,1,1]
    v_pk_fma_f32 v[118:119], v[212:213], v[180:181], v[118:119] op_sel:[1,0,0] op_sel_hi:[1,1,1] neg_lo:[1,0,0] neg_hi:[1,0,0]
    v_pk_fma_f32 v[182:183], v[212:213], v[116:117], v[182:183] op_sel:[1,0,0] op_sel_hi:[1,1,1]
    v_pk_fma_f32 v[134:135], v[214:215], v[132:133], v[134:135] op_sel:[0,0,0] op_sel_hi:[0,1,1]
    v_pk_fma_f32 v[198:199], v[214:215], v[196:197], v[198:199] op_sel:[0,0,0] op_sel_hi:[0,1,1]
    v_pk_fma_f32 v[134:135], v[214:215], v[196:197], v[134:135] op_sel:[1,0,0] op_sel_hi:[1,1,1] neg_lo:[1,0,0] neg_hi:[1,0,0]
    v_pk_fma_f32 v[198:199], v[214:215], v[132:133], v[198:199] op_sel:[1,0,0] op_sel_hi:[1,1,1]
    v_pk_fma_f32 v[120:121], v[212:213], v[118:119], v[120:121] op_sel:[0,0,0] op_sel_hi:[0,1,1]
    v_pk_fma_f32 v[184:185], v[212:213], v[182:183], v[184:185] op_sel:[0,0,0] op_sel_hi:[0,1,1]
    v_pk_fma_f32 v[120:121], v[212:213], v[182:183], v[120:121] op_sel:[1,0,0] op_sel_hi:[1,1,1] neg_lo:[1,0,0] neg_hi:[1,0,0]
    v_pk_fma_f32 v[184:185], v[212:213], v[118:119], v[184:185] op_sel:[1,0,0] op_sel_hi:[1,1,1]
    v_pk_fma_f32 v[136:137], v[214:215], v[134:135], v[136:137] op_sel:[0,0,0] op_sel_hi:[0,1,1]
    v_pk_fma_f32 v[200:201], v[214:215], v[198:199], v[200:201] op_sel:[0,0,0] op_sel_hi:[0,1,1]
    v_pk_fma_f32 v[136:137], v[214:215], v[198:199], v[136:137] op_sel:[1,0,0] op_sel_hi:[1,1,1] neg_lo:[1,0,0] neg_hi:[1,0,0]
    v_pk_fma_f32 v[200:201], v[214:215], v[134:135], v[200:201] op_sel:[1,0,0] op_sel_hi:[1,1,1]
    v_pk_fma_f32 v[122:123], v[212:213], v[120:121], v[122:123] op_sel:[0,0,0] op_sel_hi:[0,1,1]
    v_pk_fma_f32 v[186:187], v[212:213], v[184:185], v[186:187] op_sel:[0,0,0] op_sel_hi:[0,1,1]
    v_pk_fma_f32 v[122:123], v[212:213], v[184:185], v[122:123] op_sel:[1,0,0] op_sel_hi:[1,1,1] neg_lo:[1,0,0] neg_hi:[1,0,0]
    v_pk_fma_f32 v[186:187], v[212:213], v[120:121], v[186:187] op_sel:[1,0,0] op_sel_hi:[1,1,1]
    v_pk_fma_f32 v[138:139], v[214:215], v[136:137], v[138:139] op_sel:[0,0,0] op_sel_hi:[0,1,1]
    v_pk_fma_f32 v[202:203], v[214:215], v[200:201], v[202:203] op_sel:[0,0,0] op_sel_hi:[0,1,1]
    v_pk_fma_f32 v[138:139], v[214:215], v[200:201], v[138:139] op_sel:[1,0,0] op_sel_hi:[1,1,1] neg_lo:[1,0,0] neg_hi:[1,0,0]
    v_pk_fma_f32 v[202:203], v[214:215], v[136:137], v[202:203] op_sel:[1,0,0] op_sel_hi:[1,1,1]
    v_pk_fma_f32 v[124:125], v[212:213], v[122:123], v[124:125] op_sel:[0,0,0] op_sel_hi:[0,1,1]
    v_pk_fma_f32 v[188:189], v[212:213], v[186:187], v[188:189] op_sel:[0,0,0] op_sel_hi:[0,1,1]
    v_pk_fma_f32 v[124:125], v[212:213], v[186:187], v[124:125] op_sel:[1,0,0] op_sel_hi:[1,1,1] neg_lo:[1,0,0] neg_hi:[1,0,0]
    v_pk_fma_f32 v[188:189], v[212:213], v[122:123], v[188:189] op_sel:[1,0,0] op_sel_hi:[1,1,1]
    v_pk_fma_f32 v[140:141], v[214:215], v[138:139], v[140:141] op_sel:[0,0,0] op_sel_hi:[0,1,1]
    v_pk_fma_f32 v[204:205], v[214:215], v[202:203], v[204:205] op_sel:[0,0,0] op_sel_hi:[0,1,1]
    v_pk_fma_f32 v[140:141], v[214:215], v[202:203], v[140:141] op_sel:[1,0,0] op_sel_hi:[1,1,1] neg_lo:[1,0,0] neg_hi:[1,0,0]
    v_pk_fma_f32 v[204:205], v[214:215], v[138:139], v[204:205] op_sel:[1,0,0] op_sel_hi:[1,1,1]
    v_pk_fma_f32 v[126:127], v[212:213], v[124:125], v[126:127] op_sel:[0,0,0] op_sel_hi:[0,1,1]
    v_pk_fma_f32 v[190:191], v[212:213], v[188:189], v[190:191] op_sel:[0,0,0] op_sel_hi:[0,1,1]
    v_pk_fma_f32 v[126:127], v[212:213], v[188:189], v[126:127] op_sel:[1,0,0] op_sel_hi:[1,1,1] neg_lo:[1,0,0] neg_hi:[1,0,0]
    v_pk_fma_f32 v[190:191], v[212:213], v[124:125], v[190:191] op_sel:[1,0,0] op_sel_hi:[1,1,1]
    v_pk_fma_f32 v[142:143], v[214:215], v[140:141], v[142:143] op_sel:[0,0,0] op_sel_hi:[0,1,1]
    v_pk_fma_f32 v[206:207], v[214:215], v[204:205], v[206:207] op_sel:[0,0,0] op_sel_hi:[0,1,1]
    v_pk_fma_f32 v[142:143], v[214:215], v[204:205], v[142:143] op_sel:[1,0,0] op_sel_hi:[1,1,1] neg_lo:[1,0,0] neg_hi:[1,0,0]
    v_pk_fma_f32 v[206:207], v[214:215], v[140:141], v[206:207] op_sel:[1,0,0] op_sel_hi:[1,1,1]
    s_waitcnt lgkmcnt(0)
    ds_read_b64_tr_b16 v[80:81], v7 offset:0
    ds_read_b64_tr_b16 v[82:83], v7 offset:576
    ds_read_b64_tr_b16 v[84:85], v7 offset:32
    ds_read_b64_tr_b16 v[86:87], v7 offset:608
    ds_read_b64_tr_b16 v[88:89], v7 offset:64
    ds_read_b64_tr_b16 v[90:91], v7 offset:640
    ds_read_b64_tr_b16 v[92:93], v7 offset:96
    ds_read_b64_tr_b16 v[94:95], v7 offset:672
    ds_read_b64_tr_b16 v[96:97], v7 offset:4608
    ds_read_b64_tr_b16 v[98:99], v7 offset:5184
    ds_read_b64_tr_b16 v[100:101], v7 offset:4640
    ds_read_b64_tr_b16 v[102:103], v7 offset:5216
    ds_read_b64_tr_b16 v[104:105], v7 offset:4672
    ds_read_b64_tr_b16 v[106:107], v7 offset:5248
    ds_read_b64_tr_b16 v[108:109], v7 offset:4704
    ds_read_b64_tr_b16 v[110:111], v7 offset:5280
    v_cvt_pk_bf16_f32 v56, v112, v114
    v_cvt_pk_bf16_f32 v57, v116, v118
    v_cvt_pk_bf16_f32 v58, v120, v122
    v_cvt_pk_bf16_f32 v59, v124, v126
    ds_write_b128 v6, v[56:59] offset:0
    v_cvt_pk_bf16_f32 v60, v113, v115
    v_cvt_pk_bf16_f32 v61, v117, v119
    v_cvt_pk_bf16_f32 v62, v121, v123
    v_cvt_pk_bf16_f32 v63, v125, v127
    ds_write_b128 v6, v[60:63] offset:16
    v_cvt_pk_bf16_f32 v64, -v176, -v178
    v_cvt_pk_bf16_f32 v65, -v180, -v182
    v_cvt_pk_bf16_f32 v66, -v184, -v186
    v_cvt_pk_bf16_f32 v67, -v188, -v190
    ds_write_b128 v6, v[64:67] offset:4608
    v_cvt_pk_bf16_f32 v68, -v177, -v179
    v_cvt_pk_bf16_f32 v69, -v181, -v183
    v_cvt_pk_bf16_f32 v70, -v185, -v187
    v_cvt_pk_bf16_f32 v71, -v189, -v191
    ds_write_b128 v6, v[68:71] offset:4624
    v_cvt_pk_bf16_f32 v72, v128, v130
    v_cvt_pk_bf16_f32 v73, v132, v134
    v_cvt_pk_bf16_f32 v74, v136, v138
    v_cvt_pk_bf16_f32 v75, v140, v142
    ds_write_b128 v6, v[72:75] offset:2304
    s_waitcnt lgkmcnt(4)
    v_cvt_pk_bf16_f32 v76, v129, v131
    v_cvt_pk_bf16_f32 v77, v133, v135
    v_cvt_pk_bf16_f32 v78, v137, v139
    v_cvt_pk_bf16_f32 v79, v141, v143
    ds_write_b128 v6, v[76:79] offset:2320
    s_waitcnt lgkmcnt(4)
    v_cvt_pk_bf16_f32 v56, -v192, -v194
    v_cvt_pk_bf16_f32 v57, -v196, -v198
    v_cvt_pk_bf16_f32 v58, -v200, -v202
    v_cvt_pk_bf16_f32 v59, -v204, -v206
    ds_write_b128 v6, v[56:59] offset:6912
    s_waitcnt lgkmcnt(4)
    v_cvt_pk_bf16_f32 v60, -v193, -v195
    v_cvt_pk_bf16_f32 v61, -v197, -v199
    v_cvt_pk_bf16_f32 v62, -v201, -v203
    v_cvt_pk_bf16_f32 v63, -v205, -v207
    ds_write_b128 v6, v[60:63] offset:6928
    s_waitcnt lgkmcnt(4)
    s_add_u32 s70, s69, 0
    buffer_store_dwordx4 v[80:83], v1, s[44:47], s70 offen offset:0 sc1
    buffer_store_dwordx4 v[84:87], v1, s[44:47], s70 offen offset:1024 sc1
    buffer_store_dwordx4 v[88:91], v1, s[44:47], s70 offen offset:2048 sc1
    buffer_store_dwordx4 v[92:95], v1, s[44:47], s70 offen offset:3072 sc1
    s_add_u32 s70, s69, 8192
    buffer_store_dwordx4 v[96:99], v1, s[44:47], s70 offen offset:0 sc1
    buffer_store_dwordx4 v[100:103], v1, s[44:47], s70 offen offset:1024 sc1
    buffer_store_dwordx4 v[104:107], v1, s[44:47], s70 offen offset:2048 sc1
    buffer_store_dwordx4 v[108:111], v1, s[44:47], s70 offen offset:3072 sc1
    s_waitcnt lgkmcnt(0)
    ds_read_b64_tr_b16 v[112:113], v7 offset:0
    ds_read_b64_tr_b16 v[114:115], v7 offset:576
    ds_read_b64_tr_b16 v[116:117], v7 offset:32
    ds_read_b64_tr_b16 v[118:119], v7 offset:608
    ds_read_b64_tr_b16 v[120:121], v7 offset:64
    ds_read_b64_tr_b16 v[122:123], v7 offset:640
    ds_read_b64_tr_b16 v[124:125], v7 offset:96
    ds_read_b64_tr_b16 v[126:127], v7 offset:672
    ds_read_b64_tr_b16 v[128:129], v7 offset:4608
    ds_read_b64_tr_b16 v[130:131], v7 offset:5184
    ds_read_b64_tr_b16 v[132:133], v7 offset:4640
    ds_read_b64_tr_b16 v[134:135], v7 offset:5216
    ds_read_b64_tr_b16 v[136:137], v7 offset:4672
    ds_read_b64_tr_b16 v[138:139], v7 offset:5248
    ds_read_b64_tr_b16 v[140:141], v7 offset:4704
    ds_read_b64_tr_b16 v[142:143], v7 offset:5280
    s_add_u32 s70, s69, 4096
    s_waitcnt lgkmcnt(14)
    buffer_store_dwordx4 v[112:115], v1, s[44:47], s70 offen offset:0 sc1
    s_waitcnt lgkmcnt(12)
    buffer_store_dwordx4 v[116:119], v1, s[44:47], s70 offen offset:1024 sc1
    s_waitcnt lgkmcnt(10)
    buffer_store_dwordx4 v[120:123], v1, s[44:47], s70 offen offset:2048 sc1
    s_waitcnt lgkmcnt(8)
    buffer_store_dwordx4 v[124:127], v1, s[44:47], s70 offen offset:3072 sc1
    s_add_u32 s70, s69, 12288
    s_waitcnt lgkmcnt(6)
    buffer_store_dwordx4 v[128:131], v1, s[44:47], s70 offen offset:0 sc1
    s_waitcnt lgkmcnt(4)
    buffer_store_dwordx4 v[132:135], v1, s[44:47], s70 offen offset:1024 sc1
    s_waitcnt lgkmcnt(2)
    buffer_store_dwordx4 v[136:139], v1, s[44:47], s70 offen offset:2048 sc1
    s_waitcnt lgkmcnt(0)
    buffer_store_dwordx4 v[140:143], v1, s[44:47], s70 offen offset:3072 sc1
    s_branch L_p2
L_ffn_s1a:
    ds_read_b128 v[8:11], v12 offset:32
    s_waitcnt lgkmcnt(0)
    v_min3_u32 v8, v8, v9, v10
    v_min_u32 v8, v8, v11
    v_cmp_gt_u32 vcc, 2, v8
    s_cbranch_vccz L_ffn_s1b
    s_add_u32 s67, s67, 1
    s_cmp_lt_u32 s67, 0x2000000
    s_cbranch_scc1 L_ffn_s1a
    s_branch L_ffn_s1b
L_ffn_s2a:
    ds_read_b128 v[8:11], v12 offset:32
    s_waitcnt lgkmcnt(0)
    v_min3_u32 v8, v8, v9, v10
    v_min_u32 v8, v8, v11
    v_cmp_gt_u32 vcc, 3, v8
    s_cbranch_vccz L_ffn_s2b
    s_add_u32 s67, s67, 1
    s_cmp_lt_u32 s67, 0x2000000
    s_cbranch_scc1 L_ffn_s2a
    s_branch L_ffn_s2b
L_ffn_s3a:
    ds_read_b128 v[8:11], v12 offset:32
    s_waitcnt lgkmcnt(0)
    v_min3_u32 v8, v8, v9, v10
    v_min_u32 v8, v8, v11
    v_cmp_gt_u32 vcc, 4, v8
    s_cbranch_vccz L_ffn_s3b
    s_add_u32 s67, s67, 1
    s_cmp_lt_u32 s67, 0x2000000
    s_cbranch_scc1 L_ffn_s3a
    s_branch L_ffn_s3b
L_ffn_s4a:
    ds_read_b128 v[8:11], v12 offset:32
    s_waitcnt lgkmcnt(0)
    v_min3_u32 v8, v8, v9, v10
    v_min_u32 v8, v8, v11
    v_cmp_gt_u32 vcc, 5, v8
    s_cbranch_vccz L_ffn_s4b
    s_add_u32 s67, s67, 1
    s_cmp_lt_u32 s67, 0x2000000
    s_cbranch_scc1 L_ffn_s4a
    s_branch L_ffn_s4b
L_ffn_s5a:
    ds_read_b128 v[8:11], v12 offset:32
    s_waitcnt lgkmcnt(0)
    v_min3_u32 v8, v8, v9, v10
    v_min_u32 v8, v8, v11
    v_cmp_gt_u32 vcc, 6, v8
    s_cbranch_vccz L_ffn_s5b
    s_add_u32 s67, s67, 1
    s_cmp_lt_u32 s67, 0x2000000
    s_cbranch_scc1 L_ffn_s5a
    s_branch L_ffn_s5b
L_ffn_s6a:
    ds_read_b128 v[8:11], v12 offset:32
    s_waitcnt lgkmcnt(0)
    v_min3_u32 v8, v8, v9, v10
    v_min_u32 v8, v8, v11
    v_cmp_gt_u32 vcc, 7, v8
    s_cbranch_vccz L_ffn_s6b
    s_add_u32 s67, s67, 1
    s_cmp_lt_u32 s67, 0x2000000
    s_cbranch_scc1 L_ffn_s6a
    s_branch L_ffn_s6b
L_ffn_s7a:
    ds_read_b128 v[8:11], v12 offset:32
    s_waitcnt lgkmcnt(0)
    v_min3_u32 v8, v8, v9, v10
    v_min_u32 v8, v8, v11
    v_cmp_gt_u32 vcc, 8, v8
    s_cbranch_vccz L_ffn_s7b
    s_add_u32 s67, s67, 1
    s_cmp_lt_u32 s67, 0x2000000
    s_cbranch_scc1 L_ffn_s7a
    s_branch L_ffn_s7b
L_ffn_s8a:
    ds_read_b128 v[8:11], v12 offset:32
    s_waitcnt lgkmcnt(0)
    v_min3_u32 v8, v8, v9, v10
    v_min_u32 v8, v8, v11
    v_cmp_gt_u32 vcc, 9, v8
    s_cbranch_vccz L_ffn_s8b
    s_add_u32 s67, s67, 1
    s_cmp_lt_u32 s67, 0x2000000
    s_cbranch_scc1 L_ffn_s8a
    s_branch L_ffn_s8b
L_ffn_s9a:
    ds_read_b128 v[8:11], v12 offset:32
    s_waitcnt lgkmcnt(0)
    v_min3_u32 v8, v8, v9, v10
    v_min_u32 v8, v8, v11
    v_cmp_gt_u32 vcc, 10, v8
    s_cbranch_vccz L_ffn_s9b
    s_add_u32 s67, s67, 1
    s_cmp_lt_u32 s67, 0x2000000
    s_cbranch_scc1 L_ffn_s9a
    s_branch L_ffn_s9b
L_ffn_s10a:
    ds_read_b128 v[8:11], v12 offset:32
    s_waitcnt lgkmcnt(0)
    v_min3_u32 v8, v8, v9, v10
    v_min_u32 v8, v8, v11
    v_cmp_gt_u32 vcc, 11, v8
    s_cbranch_vccz L_ffn_s10b
    s_add_u32 s67, s67, 1
    s_cmp_lt_u32 s67, 0x2000000
    s_cbranch_scc1 L_ffn_s10a
    s_branch L_ffn_s10b
L_ssm_s1a:
    ds_read_b128 v[8:11], v14 offset:32
    s_waitcnt lgkmcnt(0)
    v_min3_u32 v8, v8, v9, v10
    v_min_u32 v8, v8, v11
    v_cmp_gt_u32 vcc, 2, v8
    s_cbranch_vccz L_ssm_s1b
    s_add_u32 s67, s67, 1
    s_cmp_lt_u32 s67, 0x2000000
    s_cbranch_scc1 L_ssm_s1a
    s_branch L_ssm_s1b
L_ssm_s2a:
    ds_read_b128 v[8:11], v14 offset:32
    s_waitcnt lgkmcnt(0)
    v_min3_u32 v8, v8, v9, v10
    v_min_u32 v8, v8, v11
    v_cmp_gt_u32 vcc, 3, v8
    s_cbranch_vccz L_ssm_s2b
    s_add_u32 s67, s67, 1
    s_cmp_lt_u32 s67, 0x2000000
    s_cbranch_scc1 L_ssm_s2a
    s_branch L_ssm_s2b
L_ssm_s3a:
    ds_read_b128 v[8:11], v14 offset:32
    s_waitcnt lgkmcnt(0)
    v_min3_u32 v8, v8, v9, v10
    v_min_u32 v8, v8, v11
    v_cmp_gt_u32 vcc, 4, v8
    s_cbranch_vccz L_ssm_s3b
    s_add_u32 s67, s67, 1
    s_cmp_lt_u32 s67, 0x2000000
    s_cbranch_scc1 L_ssm_s3a
    s_branch L_ssm_s3b
L_ssm_s4a:
    ds_read_b128 v[8:11], v14 offset:32
    s_waitcnt lgkmcnt(0)
    v_min3_u32 v8, v8, v9, v10
    v_min_u32 v8, v8, v11
    v_cmp_gt_u32 vcc, 5, v8
    s_cbranch_vccz L_ssm_s4b
    s_add_u32 s67, s67, 1
    s_cmp_lt_u32 s67, 0x2000000
    s_cbranch_scc1 L_ssm_s4a
    s_branch L_ssm_s4b
L_ssm_s5a:
    ds_read_b128 v[8:11], v14 offset:32
    s_waitcnt lgkmcnt(0)
    v_min3_u32 v8, v8, v9, v10
    v_min_u32 v8, v8, v11
    v_cmp_gt_u32 vcc, 6, v8
    s_cbranch_vccz L_ssm_s5b
    s_add_u32 s67, s67, 1
    s_cmp_lt_u32 s67, 0x2000000
    s_cbranch_scc1 L_ssm_s5a
    s_branch L_ssm_s5b
L_ssm_s6a:
    ds_read_b128 v[8:11], v14 offset:32
    s_waitcnt lgkmcnt(0)
    v_min3_u32 v8, v8, v9, v10
    v_min_u32 v8, v8, v11
    v_cmp_gt_u32 vcc, 7, v8
    s_cbranch_vccz L_ssm_s6b
    s_add_u32 s67, s67, 1
    s_cmp_lt_u32 s67, 0x2000000
    s_cbranch_scc1 L_ssm_s6a
    s_branch L_ssm_s6b
L_ssm_s7a:
    ds_read_b128 v[8:11], v14 offset:32
    s_waitcnt lgkmcnt(0)
    v_min3_u32 v8, v8, v9, v10
    v_min_u32 v8, v8, v11
    v_cmp_gt_u32 vcc, 8, v8
    s_cbranch_vccz L_ssm_s7b
    s_add_u32 s67, s67, 1
    s_cmp_lt_u32 s67, 0x2000000
    s_cbranch_scc1 L_ssm_s7a
    s_branch L_ssm_s7b
L_ssm_s8a:
    ds_read_b128 v[8:11], v14 offset:32
    s_waitcnt lgkmcnt(0)
    v_min3_u32 v8, v8, v9, v10
    v_min_u32 v8, v8, v11
    v_cmp_gt_u32 vcc, 9, v8
    s_cbranch_vccz L_ssm_s8b
    s_add_u32 s67, s67, 1
    s_cmp_lt_u32 s67, 0x2000000
    s_cbranch_scc1 L_ssm_s8a
    s_branch L_ssm_s8b
L_ssm_s9a:
    ds_read_b128 v[8:11], v14 offset:32
    s_waitcnt lgkmcnt(0)
    v_min3_u32 v8, v8, v9, v10
    v_min_u32 v8, v8, v11
    v_cmp_gt_u32 vcc, 10, v8
    s_cbranch_vccz L_ssm_s9b
    s_add_u32 s67, s67, 1
    s_cmp_lt_u32 s67, 0x2000000
    s_cbranch_scc1 L_ssm_s9a
    s_branch L_ssm_s9b
L_ssm_s10a:
    ds_read_b128 v[8:11], v14 offset:32
    s_waitcnt lgkmcnt(0)
    v_min3_u32 v8, v8, v9, v10
    v_min_u32 v8, v8, v11
    v_cmp_gt_u32 vcc, 11, v8
    s_cbranch_vccz L_ssm_s10b
    s_add_u32 s67, s67, 1
    s_cmp_lt_u32 s67, 0x2000000
    s_cbranch_scc1 L_ssm_s10a
    s_branch L_ssm_s10b
L_helper:
    s_cmp_lt_u32 s61, 10
    s_cbranch_scc1 L_h_ssm
    s_mov_b32 s36, s4
    s_mov_b32 s37, s5
    s_mov_b32 s38, 2621440
    s_mov_b32 s39, 0x00020000
    v_lshrrev_b32 v2, 3, v0
    v_and_b32 v3, 7, v0
    v_lshrrev_b32 v4, 4, v0
    v_xor_b32 v3, v3, v4
    v_lshlrev_b32 v3, 4, v3
    v_xor_b32 v4, 64, v3
    v_mov_b32 v5, v2
    s_lshl_b32 s68, s60, 8
    s_lshl_b32 s69, s65, 6
    s_add_u32 s68, s68, s69
    v_add_u32 v5, s68, v5
    v_mul_u32_u24 v5, 1280, v5
    v_add_u32 v6, v5, v3
    v_add_u32 v7, v5, v4
    v_add_u32 v16, 0, v6
    v_add_u32 v17, 10240, v7
    v_add_u32 v18, 20480, v6
    v_add_u32 v19, 30720, v7
    v_add_u32 v20, 40960, v6
    v_add_u32 v21, 51200, v7
    v_add_u32 v22, 61440, v6
    v_add_u32 v23, 71680, v7
    s_cmp_ge_u32 s65, 2
    s_cselect_b32 s40, s26, s24
    s_cselect_b32 s41, s27, s25
    s_mov_b32 s42, 2211840
    s_mov_b32 s43, 0x00020000
    s_sub_u32 s62, s61, 10
    s_mul_i32 s68, s62, 160
    s_min_u32 s68, s68, 3296
    s_and_b32 s69, s65, 1
    s_mul_i32 s69, s69, 110592
    s_add_u32 s68, s68, s69
    v_add_u32 v8, 0, v0
    v_mul_u32_u24 v9, 6554, v8
    v_lshrrev_b32 v9, 16, v9
    v_mul_u32_u24 v10, 10, v9
    v_sub_u32 v10, v8, v10
    v_mul_u32_u24 v9, 3456, v9
    v_lshl_add_u32 v9, v10, 4, v9
    v_add_u32 v24, s68, v9
    v_add_u32 v8, 64, v0
    v_mul_u32_u24 v9, 6554, v8
    v_lshrrev_b32 v9, 16, v9
    v_mul_u32_u24 v10, 10, v9
    v_sub_u32 v10, v8, v10
    v_mul_u32_u24 v9, 3456, v9
    v_lshl_add_u32 v9, v10, 4, v9
    v_add_u32 v25, s68, v9
    v_add_u32 v8, 128, v0
    v_mul_u32_u24 v9, 6554, v8
    v_lshrrev_b32 v9, 16, v9
    v_mul_u32_u24 v10, 10, v9
    v_sub_u32 v10, v8, v10
    v_mul_u32_u24 v9, 3456, v9
    v_lshl_add_u32 v9, v10, 4, v9
    v_add_u32 v26, s68, v9
    v_add_u32 v8, 192, v0
    v_mul_u32_u24 v9, 6554, v8
    v_lshrrev_b32 v9, 16, v9
    v_mul_u32_u24 v10, 10, v9
    v_sub_u32 v10, v8, v10
    v_mul_u32_u24 v9, 3456, v9
    v_lshl_add_u32 v9, v10, 4, v9
    v_add_u32 v27, s68, v9
    v_add_u32 v8, 256, v0
    v_mul_u32_u24 v9, 6554, v8
    v_lshrrev_b32 v9, 16, v9
    v_mul_u32_u24 v10, 10, v9
    v_sub_u32 v10, v8, v10
    v_mul_u32_u24 v9, 3456, v9
    v_lshl_add_u32 v9, v10, 4, v9
    v_add_u32 v28, s68, v9
    s_mul_i32 s76, s65, 5120
    s_lshl_b32 s77, s65, 13
    s_movk_i32 s74, 0
    s_mov_b32 s75, 0
    s_add_u32 m0, s76, 32768
    s_nop 0
    buffer_load_dwordx4 v24, s[40:43], s75 offen lds
    s_add_u32 m0, s77, 0
    s_nop 0
    buffer_load_dwordx4 v16, s[36:39], s74 offen lds
    s_add_u32 m0, s76, 33792
    s_nop 0
    buffer_load_dwordx4 v25, s[40:43], s75 offen lds
    s_add_u32 m0, s77, 1024
    s_nop 0
    buffer_load_dwordx4 v17, s[36:39], s74 offen lds
    s_add_u32 m0, s76, 34816
    s_nop 0
    buffer_load_dwordx4 v26, s[40:43], s75 offen lds
    s_add_u32 m0, s77, 2048
    s_nop 0
    buffer_load_dwordx4 v18, s[36:39], s74 offen lds
    s_add_u32 m0, s76, 35840
    s_nop 0
    buffer_load_dwordx4 v27, s[40:43], s75 offen lds
    s_add_u32 m0, s77, 3072
    s_nop 0
    buffer_load_dwordx4 v19, s[36:39], s74 offen lds
    s_add_u32 m0, s76, 36864
    s_nop 0
    buffer_load_dwordx4 v28, s[40:43], s75 offen lds
    s_add_u32 m0, s77, 4096
    s_nop 0
    buffer_load_dwordx4 v20, s[36:39], s74 offen lds
    s_add_u32 m0, s77, 5120
    s_nop 0
    buffer_load_dwordx4 v21, s[36:39], s74 offen lds
    s_add_u32 m0, s77, 6144
    s_nop 0
    buffer_load_dwordx4 v22, s[36:39], s74 offen lds
    s_add_u32 m0, s77, 7168
    s_nop 0
    buffer_load_dwordx4 v23, s[36:39], s74 offen lds
    s_waitcnt lgkmcnt(0)
    s_add_u32 s66, s66, 0x9E3779B1
    s_movk_i32 s74, 128
    s_mov_b32 s75, 221184
    s_add_u32 m0, s76, 86016
    s_nop 0
    buffer_load_dwordx4 v24, s[40:43], s75 offen lds
    s_add_u32 m0, s77, 53248
    s_nop 0
    buffer_load_dwordx4 v16, s[36:39], s74 offen lds
    s_add_u32 m0, s76, 87040
    s_nop 0
    buffer_load_dwordx4 v25, s[40:43], s75 offen lds
    s_add_u32 m0, s77, 54272
    s_nop 0
    buffer_load_dwordx4 v17, s[36:39], s74 offen lds
    s_add_u32 m0, s76, 88064
    s_nop 0
    buffer_load_dwordx4 v26, s[40:43], s75 offen lds
    s_add_u32 m0, s77, 55296
    s_nop 0
    buffer_load_dwordx4 v18, s[36:39], s74 offen lds
    v_mov_b32 v36, 0x3f803f80
    v_mov_b32 v37, 0x3f803f80
    v_mov_b32 v38, 0x3f803f80
    v_mov_b32 v39, 0x3f803f80
    v_lshrrev_b32 v9, 4, v0
    v_bfe_u32 v8, v0, 2, 2
    v_lshl_add_u32 v8, v9, 2, v8
    v_mul_u32_u24 v8, 160, v8
    v_and_b32 v10, 3, v0
    v_lshl_add_u32 v8, v10, 3, v8
    s_add_u32 s68, s76, 32768
    v_add_u32 v8, s68, v8
    v_add_u32 v11, 106496, v8
    v_mov_b32 v64, 0
    v_mov_b32 v65, 0
    v_mov_b32 v66, 0
    v_mov_b32 v67, 0
    v_mov_b32 v68, 0
    v_mov_b32 v69, 0
    v_mov_b32 v70, 0
    v_mov_b32 v71, 0
    v_mov_b32 v72, 0
    v_mov_b32 v73, 0
    v_mov_b32 v74, 0
    v_mov_b32 v75, 0
    v_mov_b32 v76, 0
    v_mov_b32 v77, 0
    v_mov_b32 v78, 0
    v_mov_b32 v79, 0
    v_mov_b32 v80, 0
    v_mov_b32 v81, 0
    v_mov_b32 v82, 0
    v_mov_b32 v83, 0
    s_add_u32 s52, s34, 0x1000000
    s_addc_u32 s53, s35, 0
    s_mov_b32 s54, 1048576
    s_mov_b32 s55, 0x00020000
    s_lshl_b32 s70, s61, 15
    s_lshl_b32 s69, s60, 12
    s_add_u32 s70, s70, s69
    s_lshr_b32 s69, s65, 1
    s_lshl_b32 s69, s69, 10
    s_add_u32 s70, s70, s69
    s_and_b32 s69, s65, 1
    s_lshl_b32 s69, s69, 11
    s_add_u32 s78, s70, s69
    s_add_u32 s87, s60, 2
    s_mul_i32 s87, s87, 221184
    v_lshlrev_b32 v9, 2, v0
    v_lshlrev_b32 v12, 3, v0
    s_lshl_b32 s68, s65, 2
    s_add_u32 s68, s68, s91
    v_mov_b32 v15, s68
    v_mov_b32 v251, s91
    v_mov_b32 v252, v4
    v_mov_b32 v32, 0
    ds_write_b32 v15, v32 offset:0
    ds_write_b32 v15, v32 offset:16
    ds_write_b32 v15, v32 offset:32
    ds_write_b32 v15, v32 offset:48
    s_waitcnt vmcnt(6)
    s_waitcnt lgkmcnt(0)
    s_barrier
    s_movk_i32 s74, 128
    s_mov_b32 s75, 221184
    s_add_u32 m0, s76, 89088
    s_nop 0
    buffer_load_dwordx4 v27, s[40:43], s75 offen lds
    s_add_u32 m0, s77, 56320
    s_nop 0
    buffer_load_dwordx4 v19, s[36:39], s74 offen lds
    s_add_u32 m0, s76, 90112
    s_nop 0
    buffer_load_dwordx4 v28, s[40:43], s75 offen lds
    s_add_u32 m0, s77, 57344
    s_nop 0
    buffer_load_dwordx4 v20, s[36:39], s74 offen lds
    s_add_u32 m0, s77, 58368
    s_nop 0
    buffer_load_dwordx4 v21, s[36:39], s74 offen lds
    s_add_u32 m0, s77, 59392
    s_nop 0
    buffer_load_dwordx4 v22, s[36:39], s74 offen lds
    s_add_u32 m0, s77, 60416
    s_nop 0
    buffer_load_dwordx4 v23, s[36:39], s74 offen lds
    s_add_u32 m0, s76, 139264
    s_nop 0
    buffer_load_dwordx4 v24, s[40:43], s87 offen lds
    s_add_u32 m0, s76, 140288
    s_nop 0
    buffer_load_dwordx4 v25, s[40:43], s87 offen lds
    s_add_u32 m0, s76, 141312
    s_nop 0
    buffer_load_dwordx4 v26, s[40:43], s87 offen lds
    s_add_u32 m0, s76, 142336
    s_nop 0
    buffer_load_dwordx4 v27, s[40:43], s87 offen lds
    s_add_u32 m0, s76, 143360
    s_nop 0
    buffer_load_dwordx4 v28, s[40:43], s87 offen lds
    s_waitcnt vmcnt(5)
    v_mov_b32 v253, 2
    ds_write_b32 v15, v253 offset:32
    s_movk_i32 s74, 256
    s_mov_b32 s75, 442368
    s_add_u32 m0, s77, 106496
    s_nop 0
    buffer_load_dwordx4 v16, s[36:39], s74 offen lds
    s_add_u32 m0, s77, 107520
    s_nop 0
    buffer_load_dwordx4 v17, s[36:39], s74 offen lds
    s_add_u32 m0, s77, 108544
    s_nop 0
    buffer_load_dwordx4 v18, s[36:39], s74 offen lds
    s_add_u32 m0, s77, 109568
    s_nop 0
    buffer_load_dwordx4 v19, s[36:39], s74 offen lds
    s_add_u32 m0, s77, 110592
    s_nop 0
    buffer_load_dwordx4 v20, s[36:39], s74 offen lds
    s_add_u32 m0, s77, 111616
    s_nop 0
    buffer_load_dwordx4 v21, s[36:39], s74 offen lds
    s_add_u32 m0, s77, 112640
    s_nop 0
    buffer_load_dwordx4 v22, s[36:39], s74 offen lds
    s_add_u32 m0, s77, 113664
    s_nop 0
    buffer_load_dwordx4 v23, s[36:39], s74 offen lds
    s_cmp_lg_u32 s60, 0
    s_cbranch_scc1 L_hffn_cs0
    ds_read_b64_tr_b16 v[40:41], v8 offset:0
    ds_read_b64_tr_b16 v[42:43], v8 offset:2560
    ds_read_b64_tr_b16 v[44:45], v8 offset:32
    ds_read_b64_tr_b16 v[46:47], v8 offset:2592
    ds_read_b64_tr_b16 v[48:49], v8 offset:64
    ds_read_b64_tr_b16 v[50:51], v8 offset:2624
    ds_read_b64_tr_b16 v[52:53], v8 offset:96
    ds_read_b64_tr_b16 v[54:55], v8 offset:2656
    ds_read_b64_tr_b16 v[56:57], v8 offset:128
    ds_read_b64_tr_b16 v[58:59], v8 offset:2688
    s_waitcnt lgkmcnt(8)
    v_mfma_f32_16x16x32_bf16 v[64:67], v[36:39], v[40:43], v[64:67]
    s_waitcnt lgkmcnt(6)
    v_mfma_f32_16x16x32_bf16 v[68:71], v[36:39], v[44:47], v[68:71]
    s_waitcnt lgkmcnt(4)
    v_mfma_f32_16x16x32_bf16 v[72:75], v[36:39], v[48:51], v[72:75]
    s_waitcnt lgkmcnt(2)
    v_mfma_f32_16x16x32_bf16 v[76:79], v[36:39], v[52:55], v[76:79]
    s_waitcnt lgkmcnt(0)
    v_mfma_f32_16x16x32_bf16 v[80:83], v[36:39], v[56:59], v[80:83]
    ds_read_b64_tr_b16 v[40:41], v8 offset:53248
    ds_read_b64_tr_b16 v[42:43], v8 offset:55808
    ds_read_b64_tr_b16 v[44:45], v8 offset:53280
    ds_read_b64_tr_b16 v[46:47], v8 offset:55840
    ds_read_b64_tr_b16 v[48:49], v8 offset:53312
    ds_read_b64_tr_b16 v[50:51], v8 offset:55872
    ds_read_b64_tr_b16 v[52:53], v8 offset:53344
    ds_read_b64_tr_b16 v[54:55], v8 offset:55904
    ds_read_b64_tr_b16 v[56:57], v8 offset:53376
    ds_read_b64_tr_b16 v[58:59], v8 offset:55936
    s_waitcnt lgkmcnt(8)
    v_mfma_f32_16x16x32_bf16 v[64:67], v[36:39], v[40:43], v[64:67]
    s_waitcnt lgkmcnt(6)
    v_mfma_f32_16x16x32_bf16 v[68:71], v[36:39], v[44:47], v[68:71]
    s_waitcnt lgkmcnt(4)
    v_mfma_f32_16x16x32_bf16 v[72:75], v[36:39], v[48:51], v[72:75]
    s_waitcnt lgkmcnt(2)
    v_mfma_f32_16x16x32_bf16 v[76:79], v[36:39], v[52:55], v[76:79]
    s_waitcnt lgkmcnt(0)
    v_mfma_f32_16x16x32_bf16 v[80:83], v[36:39], v[56:59], v[80:83]
L_hffn_cs0:
    s_waitcnt vmcnt(8)
    ds_read_b64_tr_b16 v[40:41], v11 offset:0
    ds_read_b64_tr_b16 v[42:43], v11 offset:2560
    ds_read_b64_tr_b16 v[44:45], v11 offset:32
    ds_read_b64_tr_b16 v[46:47], v11 offset:2592
    ds_read_b64_tr_b16 v[48:49], v11 offset:64
    ds_read_b64_tr_b16 v[50:51], v11 offset:2624
    ds_read_b64_tr_b16 v[52:53], v11 offset:96
    ds_read_b64_tr_b16 v[54:55], v11 offset:2656
    ds_read_b64_tr_b16 v[56:57], v11 offset:128
    ds_read_b64_tr_b16 v[58:59], v11 offset:2688
    s_waitcnt lgkmcnt(8)
    v_mfma_f32_16x16x32_bf16 v[64:67], v[36:39], v[40:43], v[64:67]
    s_waitcnt lgkmcnt(6)
    v_mfma_f32_16x16x32_bf16 v[68:71], v[36:39], v[44:47], v[68:71]
    s_waitcnt lgkmcnt(4)
    v_mfma_f32_16x16x32_bf16 v[72:75], v[36:39], v[48:51], v[72:75]
    s_waitcnt lgkmcnt(2)
    v_mfma_f32_16x16x32_bf16 v[76:79], v[36:39], v[52:55], v[76:79]
    s_waitcnt lgkmcnt(0)
    v_mfma_f32_16x16x32_bf16 v[80:83], v[36:39], v[56:59], v[80:83]
    s_movk_i32 s74, 256
    s_mov_b32 s75, 442368
    s_add_u32 m0, s76, 139264
    s_nop 0
    buffer_load_dwordx4 v24, s[40:43], s75 offen lds
    s_add_u32 m0, s76, 140288
    s_nop 0
    buffer_load_dwordx4 v25, s[40:43], s75 offen lds
    s_add_u32 m0, s76, 141312
    s_nop 0
    buffer_load_dwordx4 v26, s[40:43], s75 offen lds
    s_add_u32 m0, s76, 142336
    s_nop 0
    buffer_load_dwordx4 v27, s[40:43], s75 offen lds
    s_add_u32 m0, s76, 143360
    s_nop 0
    buffer_load_dwordx4 v28, s[40:43], s75 offen lds
    s_mov_b32 exec_lo, 0xffff0000
    s_mov_b32 exec_hi, 0x0
    v_mov_b32 v64, v68
    s_mov_b32 exec_lo, 0x0
    s_mov_b32 exec_hi, 0xffff
    v_mov_b32 v64, v72
    s_mov_b32 exec_lo, 0x0
    s_mov_b32 exec_hi, 0xffff0000
    v_mov_b32 v64, v76
    s_mov_b64 exec, -1
    v_mov_b32 v65, s66
    v_mov_b32 v81, s66
    buffer_store_dwordx2 v[64:65], v12, s[52:55], s78 offen sc1
    s_mov_b64 exec, 0xffff
    buffer_store_dwordx2 v[80:81], v12, s[52:55], s78 offen offset:512 sc1
    s_mov_b64 exec, -1
    s_add_u32 s56, s34, 0xf00000
    s_addc_u32 s57, s35, 0
    s_mov_b32 s58, 65536
    s_mov_b32 s59, 0x00020000
    v_lshlrev_b32 v10, 5, v0
    s_lshl_b32 s18, s60, 13
    s_lshl_b32 s69, s65, 11
    s_add_u32 s18, s18, s69
    s_lshl_b32 s19, s61, 15
    s_lshl_b32 s69, s65, 9
    s_add_u32 s19, s19, s69
    s_bitcmp1_b32 s65, 0
    s_cselect_b32 s70, 0x78, -1
    v_and_b32 v13, s70, v12
L_hffn_f3:
    ds_read_b128 v[4:7], v251 offset:48
    s_waitcnt lgkmcnt(0)
    v_min3_u32 v4, v4, v5, v6
    v_min_u32 v4, v4, v7
    v_cmp_gt_u32 vcc, 1, v4
    s_cbranch_vccz L_hffn_f3x
    s_sleep 1
    s_add_u32 s67, s67, 1
    s_cmp_lt_u32 s67, 0x2000000
    s_cbranch_scc1 L_hffn_f3
L_hffn_f3x:
    s_movk_i32 s74, 384
    s_mov_b32 s75, 663552
    s_add_u32 m0, s76, 32768
    s_nop 0
    buffer_load_dwordx4 v24, s[40:43], s75 offen lds
    s_add_u32 m0, s77, 0
    s_nop 0
    buffer_load_dwordx4 v16, s[36:39], s74 offen lds
    s_add_u32 m0, s76, 33792
    s_nop 0
    buffer_load_dwordx4 v25, s[40:43], s75 offen lds
    s_add_u32 m0, s77, 1024
    s_nop 0
    buffer_load_dwordx4 v17, s[36:39], s74 offen lds
    s_add_u32 m0, s76, 34816
    s_nop 0
    buffer_load_dwordx4 v26, s[40:43], s75 offen lds
    s_add_u32 m0, s77, 2048
    s_nop 0
    buffer_load_dwordx4 v18, s[36:39], s74 offen lds
    s_waitcnt vmcnt(8)
    v_mov_b32 v253, 3
    ds_write_b32 v15, v253 offset:32
    s_movk_i32 s74, 384
    s_mov_b32 s75, 663552
    s_add_u32 m0, s76, 35840
    s_nop 0
    buffer_load_dwordx4 v27, s[40:43], s75 offen lds
    s_add_u32 m0, s77, 3072
    s_nop 0
    buffer_load_dwordx4 v19, s[36:39], s74 offen lds
    s_add_u32 m0, s76, 36864
    s_nop 0
    buffer_load_dwordx4 v28, s[40:43], s75 offen lds
    s_add_u32 m0, s77, 4096
    s_nop 0
    buffer_load_dwordx4 v20, s[36:39], s74 offen lds
    s_add_u32 m0, s77, 5120
    s_nop 0
    buffer_load_dwordx4 v21, s[36:39], s74 offen lds
    s_add_u32 m0, s77, 6144
    s_nop 0
    buffer_load_dwordx4 v22, s[36:39], s74 offen lds
    s_add_u32 m0, s77, 7168
    s_nop 0
    buffer_load_dwordx4 v23, s[36:39], s74 offen lds
L_hffn_f4:
    ds_read_b128 v[4:7], v251 offset:48
    s_waitcnt lgkmcnt(0)
    v_min3_u32 v4, v4, v5, v6
    v_min_u32 v4, v4, v7
    v_cmp_gt_u32 vcc, 2, v4
    s_cbranch_vccz L_hffn_f4x
    s_sleep 1
    s_add_u32 s67, s67, 1
    s_cmp_lt_u32 s67, 0x2000000
    s_cbranch_scc1 L_hffn_f4
L_hffn_f4x:
    s_movk_i32 s74, 512
    s_mov_b32 s75, 884736
    s_add_u32 m0, s76, 86016
    s_nop 0
    buffer_load_dwordx4 v24, s[40:43], s75 offen lds
    s_add_u32 m0, s77, 53248
    s_nop 0
    buffer_load_dwordx4 v16, s[36:39], s74 offen lds
    s_add_u32 m0, s76, 87040
    s_nop 0
    buffer_load_dwordx4 v25, s[40:43], s75 offen lds
    s_add_u32 m0, s77, 54272
    s_nop 0
    buffer_load_dwordx4 v17, s[36:39], s74 offen lds
    s_add_u32 m0, s76, 88064
    s_nop 0
    buffer_load_dwordx4 v26, s[40:43], s75 offen lds
    s_add_u32 m0, s77, 55296
    s_nop 0
    buffer_load_dwordx4 v18, s[36:39], s74 offen lds
    s_waitcnt vmcnt(6)
    v_mov_b32 v253, 4
    ds_write_b32 v15, v253 offset:32
    s_movk_i32 s74, 512
    s_mov_b32 s75, 884736
    s_add_u32 m0, s76, 89088
    s_nop 0
    buffer_load_dwordx4 v27, s[40:43], s75 offen lds
    s_add_u32 m0, s77, 56320
    s_nop 0
    buffer_load_dwordx4 v19, s[36:39], s74 offen lds
    s_add_u32 m0, s76, 90112
    s_nop 0
    buffer_load_dwordx4 v28, s[40:43], s75 offen lds
    s_add_u32 m0, s77, 57344
    s_nop 0
    buffer_load_dwordx4 v20, s[36:39], s74 offen lds
    s_add_u32 m0, s77, 58368
    s_nop 0
    buffer_load_dwordx4 v21, s[36:39], s74 offen lds
    s_add_u32 m0, s77, 59392
    s_nop 0
    buffer_load_dwordx4 v22, s[36:39], s74 offen lds
    s_add_u32 m0, s77, 60416
    s_nop 0
    buffer_load_dwordx4 v23, s[36:39], s74 offen lds
    s_add_u32 s44, s34, 0xf60000
    s_addc_u32 s45, s35, 0
    s_mov_b32 s46, 65536
    s_mov_b32 s47, 0x00020000
    s_lshl_b32 s70, s62, 3
    s_add_u32 s70, s70, s60
    s_cmp_lt_u32 s65, 3
    s_cbranch_scc1 L_rs_ffn
    s_mov_b32 s89, 0x7000000
    s_mov_b32 s80, s14
    s_mov_b32 s81, s15
    s_mov_b32 s82, 819200
    s_mov_b32 s83, 0x00020000
    s_mul_i32 s68, s70, 4736
    s_mov_b32 s68, 0x7000000
    v_min_u32 v5, 36, v0
    v_lshlrev_b32 v5, 7, v5
    buffer_load_dword v31, v5, s[80:83], s68 offen
    s_branch L_rs_ffnx
L_rs_ffn:
    s_mov_b32 s80, s28
    s_mov_b32 s81, s29
    s_mov_b32 s82, 2211840
    s_mov_b32 s83, 0x00020000
    s_lshl_b32 s68, s70, 1
    s_add_u32 s68, s68, s65
    s_add_u32 s69, s70, 352
    s_cmp_eq_u32 s65, 2
    s_cselect_b32 s69, s69, s68
    s_min_u32 s69, s69, 480
    s_cmp_ge_u32 s69, 432
    s_cselect_b32 s69, 480, s69
    s_lshr_b32 s68, s69, 3
    s_and_b32 s87, s69, 7
    s_lshr_b32 s88, s68, 1
    s_mul_i32 s88, s88, 10240
    s_and_b32 s69, s68, 1
    s_lshl_b32 s69, s69, 10
    s_add_u32 s88, s88, s69
    s_lshl_b32 s89, s87, 6
    s_add_u32 s89, s89, s68
    s_lshl_b32 s89, s89, 7
    s_mul_i32 s69, s68, 52
    s_lshr_b32 s69, s69, 8
    s_mul_i32 s70, s69, 5
    s_sub_u32 s70, s68, s70
    s_cmp_eq_u32 s68, 53
    s_cselect_b32 s70, 4, s70
    s_cselect_b32 s73, 48, 80
    s_lshl_b32 s71, s70, 5
    s_cmp_ge_u32 s70, 2
    s_cselect_b32 s72, 16, 0
    s_add_u32 s71, s71, s72
    s_cmp_eq_u32 s70, 4
    s_cselect_b32 s71, 64, s71
    s_cselect_b32 s72, s73, 16
    s_cselect_b32 s84, 3, 2
    s_cselect_b32 s85, 4, 16
    s_mul_i32 s69, s69, 160
    s_add_u32 s71, s71, s69
    s_sub_u32 s72, s72, 16
    s_mul_i32 s72, s72, 1280
    s_mul_i32 s86, s71, 1280
    s_mul_i32 s69, s87, 160
    s_add_u32 s86, s86, s69
    v_mov_b32 v30, s72
    v_add_u32 v5, 0, v0
    v_mul_u32_u24 v6, 6554, v5
    v_lshrrev_b32 v6, 16, v6
    v_mul_u32_u24 v7, 10, v6
    v_sub_u32 v7, v5, v7
    v_cmp_lt_u32 vcc, 15, v6
    v_mul_u32_u24 v6, 1280, v6
    v_lshl_add_u32 v6, v7, 4, v6
    v_cndmask_b32 v7, 0, v30, vcc
    v_add_u32 v6, v6, v7
    buffer_load_dwordx4 v[128:131], v6, s[80:83], s86 offen
    v_add_u32 v5, 64, v0
    v_mul_u32_u24 v6, 6554, v5
    v_lshrrev_b32 v6, 16, v6
    v_mul_u32_u24 v7, 10, v6
    v_sub_u32 v7, v5, v7
    v_cmp_lt_u32 vcc, 15, v6
    v_mul_u32_u24 v6, 1280, v6
    v_lshl_add_u32 v6, v7, 4, v6
    v_cndmask_b32 v7, 0, v30, vcc
    v_add_u32 v6, v6, v7
    buffer_load_dwordx4 v[132:135], v6, s[80:83], s86 offen
    v_add_u32 v5, 128, v0
    v_mul_u32_u24 v6, 6554, v5
    v_lshrrev_b32 v6, 16, v6
    v_mul_u32_u24 v7, 10, v6
    v_sub_u32 v7, v5, v7
    v_cmp_lt_u32 vcc, 15, v6
    v_mul_u32_u24 v6, 1280, v6
    v_lshl_add_u32 v6, v7, 4, v6
    v_cndmask_b32 v7, 0, v30, vcc
    v_add_u32 v6, v6, v7
    buffer_load_dwordx4 v[136:139], v6, s[80:83], s86 offen
    v_add_u32 v5, 192, v0
    v_mul_u32_u24 v6, 6554, v5
    v_lshrrev_b32 v6, 16, v6
    v_mul_u32_u24 v7, 10, v6
    v_sub_u32 v7, v5, v7
    v_cmp_lt_u32 vcc, 15, v6
    v_mul_u32_u24 v6, 1280, v6
    v_lshl_add_u32 v6, v7, 4, v6
    v_cndmask_b32 v7, 0, v30, vcc
    v_add_u32 v6, v6, v7
    buffer_load_dwordx4 v[140:143], v6, s[80:83], s86 offen
    v_add_u32 v5, 256, v0
    v_mul_u32_u24 v6, 6554, v5
    v_lshrrev_b32 v6, 16, v6
    v_mul_u32_u24 v7, 10, v6
    v_sub_u32 v7, v5, v7
    v_cmp_lt_u32 vcc, 15, v6
    v_mul_u32_u24 v6, 1280, v6
    v_lshl_add_u32 v6, v7, 4, v6
    v_cndmask_b32 v7, 0, v30, vcc
    v_add_u32 v6, v6, v7
    buffer_load_dwordx4 v[144:147], v6, s[80:83], s86 offen
L_rs_ffnx:
L_hffn_f5:
    ds_read_b128 v[4:7], v251 offset:48
    s_waitcnt lgkmcnt(0)
    v_min3_u32 v4, v4, v5, v6
    v_min_u32 v4, v4, v7
    v_cmp_gt_u32 vcc, 3, v4
    s_cbranch_vccz L_hffn_f5x
    s_sleep 1
    s_add_u32 s67, s67, 1
    s_cmp_lt_u32 s67, 0x2000000
    s_cbranch_scc1 L_hffn_f5
L_hffn_f5x:
    s_movk_i32 s74, 640
    s_mov_b32 s75, 1105920
    s_add_u32 m0, s76, 139264
    s_nop 0
    buffer_load_dwordx4 v24, s[40:43], s75 offen lds
    s_add_u32 m0, s77, 106496
    s_nop 0
    buffer_load_dwordx4 v16, s[36:39], s74 offen lds
    s_add_u32 m0, s76, 140288
    s_nop 0
    buffer_load_dwordx4 v25, s[40:43], s75 offen lds
    s_add_u32 m0, s77, 107520
    s_nop 0
    buffer_load_dwordx4 v17, s[36:39], s74 offen lds
    s_add_u32 m0, s76, 141312
    s_nop 0
    buffer_load_dwordx4 v26, s[40:43], s75 offen lds
    s_add_u32 m0, s77, 108544
    s_nop 0
    buffer_load_dwordx4 v18, s[36:39], s74 offen lds
    s_waitcnt vmcnt(7)
    v_mov_b32 v253, 5
    ds_write_b32 v15, v253 offset:32
    s_movk_i32 s74, 640
    s_mov_b32 s75, 1105920
    s_add_u32 m0, s76, 142336
    s_nop 0
    buffer_load_dwordx4 v27, s[40:43], s75 offen lds
    s_add_u32 m0, s77, 109568
    s_nop 0
    buffer_load_dwordx4 v19, s[36:39], s74 offen lds
    s_add_u32 m0, s76, 143360
    s_nop 0
    buffer_load_dwordx4 v28, s[40:43], s75 offen lds
    s_add_u32 m0, s77, 110592
    s_nop 0
    buffer_load_dwordx4 v20, s[36:39], s74 offen lds
    s_add_u32 m0, s77, 111616
    s_nop 0
    buffer_load_dwordx4 v21, s[36:39], s74 offen lds
    s_add_u32 m0, s77, 112640
    s_nop 0
    buffer_load_dwordx4 v22, s[36:39], s74 offen lds
    s_add_u32 m0, s77, 113664
    s_nop 0
    buffer_load_dwordx4 v23, s[36:39], s74 offen lds
L_hffn_f6:
    ds_read_b128 v[4:7], v251 offset:48
    s_waitcnt lgkmcnt(0)
    v_min3_u32 v4, v4, v5, v6
    v_min_u32 v4, v4, v7
    v_cmp_gt_u32 vcc, 4, v4
    s_cbranch_vccz L_hffn_f6x
    s_sleep 1
    s_add_u32 s67, s67, 1
    s_cmp_lt_u32 s67, 0x2000000
    s_cbranch_scc1 L_hffn_f6
L_hffn_f6x:
    s_movk_i32 s74, 768
    s_mov_b32 s75, 1327104
    s_add_u32 m0, s76, 32768
    s_nop 0
    buffer_load_dwordx4 v24, s[40:43], s75 offen lds
    s_add_u32 m0, s76, 33792
    s_nop 0
    buffer_load_dwordx4 v25, s[40:43], s75 offen lds
    s_add_u32 m0, s76, 34816
    s_nop 0
    buffer_load_dwordx4 v26, s[40:43], s75 offen lds
    s_add_u32 m0, s76, 35840
    s_nop 0
    buffer_load_dwordx4 v27, s[40:43], s75 offen lds
    s_add_u32 m0, s76, 36864
    s_nop 0
    buffer_load_dwordx4 v28, s[40:43], s75 offen lds
    s_add_u32 m0, s77, 5120
    s_nop 0
    buffer_load_dwordx4 v21, s[36:39], s74 offen lds
    s_add_u32 m0, s77, 6144
    s_nop 0
    buffer_load_dwordx4 v22, s[36:39], s74 offen lds
    s_add_u32 m0, s77, 7168
    s_nop 0
    buffer_load_dwordx4 v23, s[36:39], s74 offen lds
    s_waitcnt vmcnt(21)
    s_cmp_eq_u32 s65, 3
    s_cbranch_scc1 L_rf_ffn
    v_lshrrev_b32 v5, 4, v0
    v_lshlrev_b32 v5, s84, v5
    v_bfe_u32 v6, v0, 2, 2
    v_add_u32 v5, v5, v6
    v_add_u32 v6, s85, v5
    v_and_b32 v7, 3, v0
    v_lshlrev_b32 v7, 3, v7
    s_add_u32 s70, s77, 0
    v_add_u32 v4, s70, v1
    ds_write_b128 v4, v[128:131] offset:0
    ds_write_b128 v4, v[132:135] offset:1024
    ds_write_b128 v4, v[136:139] offset:2048
    ds_write_b128 v4, v[140:143] offset:3072
    ds_write_b128 v4, v[144:147] offset:4096
    v_add_u32 v7, s70, v7
    v_mul_u32_u24 v5, 160, v5
    v_mul_u32_u24 v6, 160, v6
    v_add_u32 v5, v5, v7
    v_add_u32 v6, v6, v7
    ds_read_b64_tr_b16 v[96:97], v5 offset:0
    ds_read_b64_tr_b16 v[98:99], v6 offset:0
    ds_read_b64_tr_b16 v[100:101], v5 offset:32
    ds_read_b64_tr_b16 v[102:103], v6 offset:32
    ds_read_b64_tr_b16 v[104:105], v5 offset:64
    ds_read_b64_tr_b16 v[106:107], v6 offset:64
    ds_read_b64_tr_b16 v[108:109], v5 offset:96
    ds_read_b64_tr_b16 v[110:111], v6 offset:96
    ds_read_b64_tr_b16 v[112:113], v5 offset:128
    ds_read_b64_tr_b16 v[114:115], v6 offset:128
    s_mul_i32 s72, s87, 276480
    s_add_u32 s72, s72, 0xc00000
    s_add_u32 s80, s34, s72
    s_addc_u32 s81, s35, 0
    s_mov_b32 s82, 276480
    s_mov_b32 s83, 0x00020000
    s_add_u32 s68, s88, 4096
    s_add_u32 s69, s88, 8192
L_rf_ffn:
    s_waitcnt vmcnt(8)
    v_mov_b32 v253, 6
    ds_write_b32 v15, v253 offset:32
    s_cmp_eq_u32 s65, 3
    s_cbranch_scc1 L_rg_ffn
    s_waitcnt lgkmcnt(0)
    buffer_store_dwordx4 v[96:99], v1, s[80:83], s88 offen offset:0 sc1
    buffer_store_dwordx4 v[100:103], v1, s[80:83], s88 offen offset:2048 sc1
    buffer_store_dwordx4 v[104:107], v1, s[80:83], s68 offen offset:0 sc1
    buffer_store_dwordx4 v[108:111], v1, s[80:83], s68 offen offset:2048 sc1
    buffer_store_dwordx4 v[112:115], v1, s[80:83], s69 offen offset:0 sc1
L_rg_ffn:
    s_add_u32 m0, s77, 0
    s_nop 0
    buffer_load_dwordx4 v16, s[36:39], s74 offen lds
    s_add_u32 m0, s77, 1024
    s_nop 0
    buffer_load_dwordx4 v17, s[36:39], s74 offen lds
    s_add_u32 m0, s77, 2048
    s_nop 0
    buffer_load_dwordx4 v18, s[36:39], s74 offen lds
    s_add_u32 m0, s77, 3072
    s_nop 0
    buffer_load_dwordx4 v19, s[36:39], s74 offen lds
    s_add_u32 m0, s77, 4096
    s_nop 0
    buffer_load_dwordx4 v20, s[36:39], s74 offen lds
L_hffn_f7:
    ds_read_b128 v[4:7], v251 offset:48
    s_waitcnt lgkmcnt(0)
    v_min3_u32 v4, v4, v5, v6
    v_min_u32 v4, v4, v7
    v_cmp_gt_u32 vcc, 5, v4
    s_cbranch_vccz L_hffn_f7x
    s_sleep 1
    s_add_u32 s67, s67, 1
    s_cmp_lt_u32 s67, 0x2000000
    s_cbranch_scc1 L_hffn_f7
L_hffn_f7x:
    s_movk_i32 s74, 896
    s_mov_b32 s75, 1548288
    s_add_u32 m0, s76, 86016
    s_nop 0
    buffer_load_dwordx4 v24, s[40:43], s75 offen lds
    s_add_u32 m0, s77, 53248
    s_nop 0
    buffer_load_dwordx4 v16, s[36:39], s74 offen lds
    s_add_u32 m0, s76, 87040
    s_nop 0
    buffer_load_dwordx4 v25, s[40:43], s75 offen lds
    s_add_u32 m0, s77, 54272
    s_nop 0
    buffer_load_dwordx4 v17, s[36:39], s74 offen lds
    s_add_u32 m0, s76, 88064
    s_nop 0
    buffer_load_dwordx4 v26, s[40:43], s75 offen lds
    s_add_u32 m0, s77, 55296
    s_nop 0
    buffer_load_dwordx4 v18, s[36:39], s74 offen lds
    s_waitcnt vmcnt(6)
    v_mov_b32 v253, 7
    ds_write_b32 v15, v253 offset:32
    s_movk_i32 s74, 896
    s_mov_b32 s75, 1548288
    s_add_u32 m0, s76, 89088
    s_nop 0
    buffer_load_dwordx4 v27, s[40:43], s75 offen lds
    s_add_u32 m0, s77, 56320
    s_nop 0
    buffer_load_dwordx4 v19, s[36:39], s74 offen lds
    s_add_u32 m0, s76, 90112
    s_nop 0
    buffer_load_dwordx4 v28, s[40:43], s75 offen lds
    s_add_u32 m0, s77, 57344
    s_nop 0
    buffer_load_dwordx4 v20, s[36:39], s74 offen lds
    s_add_u32 m0, s77, 58368
    s_nop 0
    buffer_load_dwordx4 v21, s[36:39], s74 offen lds
    s_add_u32 m0, s77, 59392
    s_nop 0
    buffer_load_dwordx4 v22, s[36:39], s74 offen lds
    s_add_u32 m0, s77, 60416
    s_nop 0
    buffer_load_dwordx4 v23, s[36:39], s74 offen lds
    v_mov_b32 v253, s66
    s_mov_b32 exec_hi, 0
    buffer_store_dword v253, v9, s[44:47], s89 offen sc1
    s_mov_b64 exec, -1
L_hffn_f8:
    ds_read_b128 v[4:7], v251 offset:48
    s_waitcnt lgkmcnt(0)
    v_min3_u32 v4, v4, v5, v6
    v_min_u32 v4, v4, v7
    v_cmp_gt_u32 vcc, 6, v4
    s_cbranch_vccz L_hffn_f8x
    s_sleep 1
    s_add_u32 s67, s67, 1
    s_cmp_lt_u32 s67, 0x2000000
    s_cbranch_scc1 L_hffn_f8
L_hffn_f8x:
    s_movk_i32 s74, 1024
    s_mov_b32 s75, 1769472
    s_add_u32 m0, s76, 139264
    s_nop 0
    buffer_load_dwordx4 v24, s[40:43], s75 offen lds
    s_add_u32 m0, s77, 106496
    s_nop 0
    buffer_load_dwordx4 v16, s[36:39], s74 offen lds
    s_add_u32 m0, s76, 140288
    s_nop 0
    buffer_load_dwordx4 v25, s[40:43], s75 offen lds
    s_add_u32 m0, s77, 107520
    s_nop 0
    buffer_load_dwordx4 v17, s[36:39], s74 offen lds
    s_add_u32 m0, s76, 141312
    s_nop 0
    buffer_load_dwordx4 v26, s[40:43], s75 offen lds
    s_add_u32 m0, s77, 108544
    s_nop 0
    buffer_load_dwordx4 v18, s[36:39], s74 offen lds
    s_waitcnt vmcnt(7)
    v_mov_b32 v253, 8
    ds_write_b32 v15, v253 offset:32
    s_movk_i32 s74, 1024
    s_mov_b32 s75, 1769472
    s_add_u32 m0, s76, 142336
    s_nop 0
    buffer_load_dwordx4 v27, s[40:43], s75 offen lds
    s_add_u32 m0, s77, 109568
    s_nop 0
    buffer_load_dwordx4 v19, s[36:39], s74 offen lds
    s_add_u32 m0, s76, 143360
    s_nop 0
    buffer_load_dwordx4 v28, s[40:43], s75 offen lds
    s_add_u32 m0, s77, 110592
    s_nop 0
    buffer_load_dwordx4 v20, s[36:39], s74 offen lds
    s_add_u32 m0, s77, 111616
    s_nop 0
    buffer_load_dwordx4 v21, s[36:39], s74 offen lds
    s_add_u32 m0, s77, 112640
    s_nop 0
    buffer_load_dwordx4 v22, s[36:39], s74 offen lds
    s_add_u32 m0, s77, 113664
    s_nop 0
    buffer_load_dwordx4 v23, s[36:39], s74 offen lds
L_hffn_f9:
    ds_read_b128 v[4:7], v251 offset:48
    s_waitcnt lgkmcnt(0)
    v_min3_u32 v4, v4, v5, v6
    v_min_u32 v4, v4, v7
    v_cmp_gt_u32 vcc, 7, v4
    s_cbranch_vccz L_hffn_f9x
    s_sleep 1
    s_add_u32 s67, s67, 1
    s_cmp_lt_u32 s67, 0x2000000
    s_cbranch_scc1 L_hffn_f9
L_hffn_f9x:
    s_movk_i32 s74, 1152
    s_mov_b32 s75, 1990656
    s_add_u32 m0, s76, 32768
    s_nop 0
    buffer_load_dwordx4 v24, s[40:43], s75 offen lds
    s_add_u32 m0, s77, 0
    s_nop 0
    buffer_load_dwordx4 v16, s[36:39], s74 offen lds
    s_add_u32 m0, s76, 33792
    s_nop 0
    buffer_load_dwordx4 v25, s[40:43], s75 offen lds
    s_add_u32 m0, s77, 1024
    s_nop 0
    buffer_load_dwordx4 v17, s[36:39], s74 offen lds
    s_add_u32 m0, s76, 34816
    s_nop 0
    buffer_load_dwordx4 v26, s[40:43], s75 offen lds
    s_add_u32 m0, s77, 2048
    s_nop 0
    buffer_load_dwordx4 v18, s[36:39], s74 offen lds
    s_waitcnt vmcnt(6)
    v_mov_b32 v253, 9
    ds_write_b32 v15, v253 offset:32
    s_movk_i32 s74, 1152
    s_mov_b32 s75, 1990656
    s_add_u32 m0, s76, 35840
    s_nop 0
    buffer_load_dwordx4 v27, s[40:43], s75 offen lds
    s_add_u32 m0, s77, 3072
    s_nop 0
    buffer_load_dwordx4 v19, s[36:39], s74 offen lds
    s_add_u32 m0, s76, 36864
    s_nop 0
    buffer_load_dwordx4 v28, s[40:43], s75 offen lds
    s_add_u32 m0, s77, 4096
    s_nop 0
    buffer_load_dwordx4 v20, s[36:39], s74 offen lds
    s_add_u32 m0, s77, 5120
    s_nop 0
    buffer_load_dwordx4 v21, s[36:39], s74 offen lds
    s_add_u32 m0, s77, 6144
    s_nop 0
    buffer_load_dwordx4 v22, s[36:39], s74 offen lds
    s_add_u32 m0, s77, 7168
    s_nop 0
    buffer_load_dwordx4 v23, s[36:39], s74 offen lds
    buffer_load_dwordx4 v[32:35], v10, s[56:59], s18 offen sc1
    s_add_u32 s68, s19, 0
    buffer_load_dwordx2 v[208:209], v13, s[52:55], s68 offen offset:0 sc1
    buffer_load_dwordx2 v[210:211], v13, s[52:55], s68 offen offset:2048 sc1
    s_add_u32 s68, s19, 4096
    buffer_load_dwordx2 v[212:213], v13, s[52:55], s68 offen offset:0 sc1
    buffer_load_dwordx2 v[214:215], v13, s[52:55], s68 offen offset:2048 sc1
    s_add_u32 s68, s19, 8192
    buffer_load_dwordx2 v[216:217], v13, s[52:55], s68 offen offset:0 sc1
    buffer_load_dwordx2 v[218:219], v13, s[52:55], s68 offen offset:2048 sc1
    s_add_u32 s68, s19, 12288
    buffer_load_dwordx2 v[220:221], v13, s[52:55], s68 offen offset:0 sc1
    buffer_load_dwordx2 v[222:223], v13, s[52:55], s68 offen offset:2048 sc1
    s_add_u32 s68, s19, 16384
    buffer_load_dwordx2 v[224:225], v13, s[52:55], s68 offen offset:0 sc1
    buffer_load_dwordx2 v[226:227], v13, s[52:55], s68 offen offset:2048 sc1
    s_add_u32 s68, s19, 20480
    buffer_load_dwordx2 v[228:229], v13, s[52:55], s68 offen offset:0 sc1
    buffer_load_dwordx2 v[230:231], v13, s[52:55], s68 offen offset:2048 sc1
    s_add_u32 s68, s19, 24576
    buffer_load_dwordx2 v[232:233], v13, s[52:55], s68 offen offset:0 sc1
    buffer_load_dwordx2 v[234:235], v13, s[52:55], s68 offen offset:2048 sc1
    s_add_u32 s68, s19, 28672
    buffer_load_dwordx2 v[236:237], v13, s[52:55], s68 offen offset:0 sc1
    buffer_load_dwordx2 v[238:239], v13, s[52:55], s68 offen offset:2048 sc1
    s_add_u32 s68, s64, s63
    s_and_b32 s68, s68, 3
    s_mov_b32 s68, 0
    s_lshl_b32 s68, s68, 2
    s_lshr_b32 s68, 0x2103210, s68
    s_and_b32 s68, s68, 0xffff
    s_mul_i32 s69, s68, 0x10001
    s_cmp_eq_u32 0, 1
    s_cselect_b32 s70, 0x44444444, 0
    s_cselect_b32 s71, 0, 0x8888
    s_cselect_b32 s72, 0x4444, 0
    s_add_u32 s92, s70, 0x44440000
    s_add_u32 s93, s71, s68
    s_xor_b32 s70, s70, 0x44440000
    s_cmp_eq_u32 s65, 1
    s_cselect_b32 s92, s70, s92
    s_cselect_b32 s93, 0xba98, s93
    s_add_u32 s92, s92, s69
    s_mov_b32 s27, 0x00020000
    s_mul_i32 s6, s65, 10240
    s_add_u32 s7, s6, s90
    s_add_u32 s8, s7, s90
    v_add_u32 v248, s6, v1
    v_add_u32 v249, s7, v1
    v_add_u32 v250, s8, v1
    s_mov_b32 s36, s14
    s_mov_b32 s37, s15
    s_mov_b32 s38, 819200
    s_mov_b32 s39, 0x00020000
    s_mov_b32 s40, s16
    s_mov_b32 s41, s17
    s_mov_b32 s42, 819200
    s_mov_b32 s43, 0x00020000
    s_mul_i32 s73, s64, 80
    v_add_u32 v5, s73, v2
    v_mul_u32_u24 v5, 1280, v5
    v_add_u32 v6, v5, v3
    v_add_u32 v7, v5, v252
    v_add_u32 v16, 0, v6
    v_add_u32 v17, 10240, v7
    v_add_u32 v18, 20480, v6
    v_add_u32 v19, 30720, v7
    v_add_u32 v20, 40960, v6
    v_add_u32 v21, 51200, v7
    v_add_u32 v22, 61440, v6
    v_add_u32 v23, 71680, v7
    v_add_u32 v24, 81920, v6
    v_add_u32 v25, 92160, v7
    s_mul_i32 s4, s65, 768
    s_movk_i32 s5, 128
    s_waitcnt vmcnt(17)
    v_mov_b32 v253, 10
    ds_write_b32 v15, v253 offset:32
    s_waitcnt vmcnt(0)
    s_mov_b32 s71, 0
L_hffn_g:
    v_xor_b32 v36, s66, v33
    v_xor_b32 v37, s66, v35
    v_or_b32 v36, v36, v37
    v_xor_b32 v37, s66, v209
    v_or_b32 v36, v36, v37
    v_xor_b32 v37, s66, v211
    v_or_b32 v36, v36, v37
    v_xor_b32 v37, s66, v213
    v_or_b32 v36, v36, v37
    v_xor_b32 v37, s66, v215
    v_or_b32 v36, v36, v37
    v_xor_b32 v37, s66, v217
    v_or_b32 v36, v36, v37
    v_xor_b32 v37, s66, v219
    v_or_b32 v36, v36, v37
    v_xor_b32 v37, s66, v221
    v_or_b32 v36, v36, v37
    v_xor_b32 v37, s66, v223
    v_or_b32 v36, v36, v37
    v_xor_b32 v37, s66, v225
    v_or_b32 v36, v36, v37
    v_xor_b32 v37, s66, v227
    v_or_b32 v36, v36, v37
    v_xor_b32 v37, s66, v229
    v_or_b32 v36, v36, v37
    v_xor_b32 v37, s66, v231
    v_or_b32 v36, v36, v37
    v_xor_b32 v37, s66, v233
    v_or_b32 v36, v36, v37
    v_xor_b32 v37, s66, v235
    v_or_b32 v36, v36, v37
    v_xor_b32 v37, s66, v237
    v_or_b32 v36, v36, v37
    v_xor_b32 v37, s66, v239
    v_or_b32 v36, v36, v37
    v_cmp_ne_u32 vcc, 0, v36
    s_cbranch_vccz L_hffn_gok
    s_sleep 4
    buffer_load_dwordx4 v[32:35], v10, s[56:59], s18 offen sc1
    s_add_u32 s68, s19, 0
    buffer_load_dwordx2 v[208:209], v13, s[52:55], s68 offen offset:0 sc1
    buffer_load_dwordx2 v[210:211], v13, s[52:55], s68 offen offset:2048 sc1
    s_add_u32 s68, s19, 4096
    buffer_load_dwordx2 v[212:213], v13, s[52:55], s68 offen offset:0 sc1
    buffer_load_dwordx2 v[214:215], v13, s[52:55], s68 offen offset:2048 sc1
    s_add_u32 s68, s19, 8192
    buffer_load_dwordx2 v[216:217], v13, s[52:55], s68 offen offset:0 sc1
    buffer_load_dwordx2 v[218:219], v13, s[52:55], s68 offen offset:2048 sc1
    s_add_u32 s68, s19, 12288
    buffer_load_dwordx2 v[220:221], v13, s[52:55], s68 offen offset:0 sc1
    buffer_load_dwordx2 v[222:223], v13, s[52:55], s68 offen offset:2048 sc1
    s_add_u32 s68, s19, 16384
    buffer_load_dwordx2 v[224:225], v13, s[52:55], s68 offen offset:0 sc1
    buffer_load_dwordx2 v[226:227], v13, s[52:55], s68 offen offset:2048 sc1
    s_add_u32 s68, s19, 20480
    buffer_load_dwordx2 v[228:229], v13, s[52:55], s68 offen offset:0 sc1
    buffer_load_dwordx2 v[230:231], v13, s[52:55], s68 offen offset:2048 sc1
    s_add_u32 s68, s19, 24576
    buffer_load_dwordx2 v[232:233], v13, s[52:55], s68 offen offset:0 sc1
    buffer_load_dwordx2 v[234:235], v13, s[52:55], s68 offen offset:2048 sc1
    s_add_u32 s68, s19, 28672
    buffer_load_dwordx2 v[236:237], v13, s[52:55], s68 offen offset:0 sc1
    buffer_load_dwordx2 v[238:239], v13, s[52:55], s68 offen offset:2048 sc1
    s_waitcnt vmcnt(0)
    s_add_u32 s71, s71, 1
    s_cmp_lt_u32 s71, 0x200000
    s_cbranch_scc1 L_hffn_g
L_hffn_gok:
    s_lshl_b32 s69, s65, 8
    s_lshl_b32 s68, s65, 9
    s_add_u32 s68, s68, 159744
    v_add_u32 v10, s68, v12
    v_mov_b32 v33, v34
    ds_write_b64 v10, v[32:33]
    v_add_f32 v208, v208, v210
    v_add_f32 v208, v208, v212
    v_add_f32 v208, v208, v214
    v_add_f32 v208, v208, v216
    v_add_f32 v208, v208, v218
    v_add_f32 v208, v208, v220
    v_add_f32 v208, v208, v222
    v_add_f32 v208, v208, v224
    v_add_f32 v208, v208, v226
    v_add_f32 v208, v208, v228
    v_add_f32 v208, v208, v230
    v_add_f32 v208, v208, v232
    v_add_f32 v208, v208, v234
    v_add_f32 v208, v208, v236
    v_add_f32 v208, v208, v238
    s_add_u32 s68, s69, 161792
    v_add_u32 v10, s68, v9
    ds_write_b32 v10, v208
    s_waitcnt lgkmcnt(0)
    v_mov_b32 v253, 11
    ds_write_b32 v15, v253 offset:32
    s_load_dwordx2 s[12:13], s[0:1], 0
    s_load_dwordx2 s[10:11], s[0:1], 64
    s_add_u32 s56, s34, 0xf00000
    s_addc_u32 s57, s35, 0
    s_mov_b32 s58, 65536
    s_mov_b32 s59, 0x00020000
    s_lshl_b32 s68, s63, 6
    s_lshl_b32 s69, s65, 4
    s_add_u32 s68, s68, s69
    s_mul_i32 s69, s68, 1280
    s_mul_i32 s70, s64, 160
    s_add_u32 s69, s69, s70
    s_lshl_b32 s77, s69, 1
    s_lshl_b32 s78, s68, 5
    v_and_b32 v5, 15, v0
    v_lshrrev_b32 v6, 4, v0
    v_mul_u32_u24 v14, 2560, v5
    v_lshl_add_u32 v14, v6, 4, v14
    v_lshlrev_b32 v13, 5, v5
    s_waitcnt lgkmcnt(0)
    s_mov_b32 s52, s12
    s_mov_b32 s53, s13
    s_mov_b32 s54, 2621440
    s_mov_b32 s55, 0x00020000
    v_add_u32 v5, 0, v0
    v_mul_u32_u24 v6, 6554, v5
    v_lshrrev_b32 v6, 16, v6
    v_mul_u32_u24 v6, 1120, v6
    v_lshl_add_u32 v6, v5, 4, v6
    buffer_load_dwordx4 v[28:31], v6, s[52:55], s69 offen
    v_add_u32 v5, 64, v0
    v_mul_u32_u24 v6, 6554, v5
    v_lshrrev_b32 v6, 16, v6
    v_mul_u32_u24 v6, 1120, v6
    v_lshl_add_u32 v6, v5, 4, v6
    buffer_load_dwordx4 v[32:35], v6, s[52:55], s69 offen
    v_add_u32 v5, 128, v0
    v_min_u32 v5, 159, v5
    v_mul_u32_u24 v6, 6554, v5
    v_lshrrev_b32 v6, 16, v6
    v_mul_u32_u24 v6, 1120, v6
    v_lshl_add_u32 v6, v5, 4, v6
    buffer_load_dwordx4 v[36:39], v6, s[52:55], s69 offen
    s_mov_b32 s52, s10
    s_mov_b32 s53, s11
    s_mov_b32 s54, 1280
    s_mov_b32 s55, 0x00020000
    v_min_u32 v5, 9, v0
    v_lshlrev_b32 v5, 4, v5
    buffer_load_dwordx4 v[40:43], v5, s[52:55], s70 offen
    buffer_load_dwordx4 v[44:47], v13, s[56:59], s78 offen sc1
    s_cmp_lt_u32 s65, 2
    s_cbranch_scc1 L_hffn_c
    s_add_u32 s44, s34, 0xf60000
    s_addc_u32 s45, s35, 0
    s_mov_b32 s46, 65536
    s_mov_b32 s47, 0x00020000
    s_mul_i32 s72, s64, 276480
    s_add_u32 s72, s72, 0xc00000
    s_add_u32 s36, s34, s72
    s_addc_u32 s37, s35, 0
    s_mov_b32 s38, 276480
    s_mov_b32 s39, 0x00020000
    s_add_u32 s72, s72, 10240
    s_add_u32 s40, s34, s72
    s_addc_u32 s41, s35, 0
    s_mov_b32 s42, 266240
    s_mov_b32 s43, 0x00020000
    v_add_u32 v16, 0, v1
    v_add_u32 v17, 1024, v1
    v_add_u32 v18, 2048, v1
    v_add_u32 v19, 3072, v1
    v_add_u32 v20, 4096, v1
    v_add_u32 v21, 5120, v1
    v_add_u32 v22, 6144, v1
    v_add_u32 v23, 7168, v1
    v_add_u32 v24, 8192, v1
    v_add_u32 v25, 9216, v1
    s_mul_i32 s4, s65, 122880
    s_sub_u32 s4, s4, 204800
    s_lshr_b32 s68, s65, 1
    s_mul_i32 s68, s68, 10240
    s_sub_u32 s4, s4, s68
    s_movk_i32 s5, 20480
    s_cmp_eq_u32 s65, 1
    s_cselect_b32 s70, 5, 23
    v_min_u32 v11, s70, v0
    v_lshlrev_b32 v11, 7, v11
    s_mul_i32 s70, s65, 3072
    s_sub_u32 s70, s70, 5376
    s_max_i32 s70, s70, 0
    s_lshl_b32 s68, s64, 13
    s_add_u32 s68, s68, s70
    s_mov_b32 s70, 0
L_f2ffn:
    buffer_load_dword v253, v11, s[44:47], s68 offen sc1
    s_waitcnt vmcnt(0)
    v_cmp_ne_u32 vcc, s66, v253
    s_cbranch_vccz L_f2okffn
    s_sleep 8
    s_add_u32 s70, s70, 1
    s_cmp_lt_u32 s70, 0x200000
    s_cbranch_scc1 L_f2ffn
L_f2okffn:
L_hffn_c:
L_hffn_e0:
    ds_read_b128 v[4:7], v251 offset:48
    s_waitcnt lgkmcnt(0)
    v_min3_u32 v4, v4, v5, v6
    v_min_u32 v4, v4, v7
    v_cmp_gt_u32 vcc, 8, v4
    s_cbranch_vccz L_hffn_e0x
    s_sleep 1
    s_add_u32 s67, s67, 1
    s_cmp_lt_u32 s67, 0x2000000
    s_cbranch_scc1 L_hffn_e0
L_hffn_e0x:
    s_bfe_u32 s73, s92, 0x40000
    s_bitcmp1_b32 s73, 0
    s_cselect_b64 s[24:25], s[40:41], s[36:37]
    s_cselect_b32 s26, s42, s38
    s_lshr_b32 s73, s73, 1
    s_mul_i32 s74, s5, s73
    s_add_u32 s74, s74, s4
    s_add_u32 m0, s7, 0
    s_nop 0
    buffer_load_dwordx4 v16, s[24:27], s74 offen sc1 lds
    s_add_u32 m0, s7, 1024
    s_nop 0
    buffer_load_dwordx4 v17, s[24:27], s74 offen sc1 lds
    s_add_u32 m0, s7, 2048
    s_nop 0
    buffer_load_dwordx4 v18, s[24:27], s74 offen sc1 lds
    s_add_u32 m0, s7, 3072
    s_nop 0
    buffer_load_dwordx4 v19, s[24:27], s74 offen sc1 lds
    s_add_u32 m0, s7, 4096
    s_nop 0
    buffer_load_dwordx4 v20, s[24:27], s74 offen sc1 lds
    s_add_u32 m0, s7, 5120
    s_nop 0
    buffer_load_dwordx4 v21, s[24:27], s74 offen sc1 lds
    s_add_u32 m0, s7, 6144
    s_nop 0
    buffer_load_dwordx4 v22, s[24:27], s74 offen sc1 lds
    s_add_u32 m0, s7, 7168
    s_nop 0
    buffer_load_dwordx4 v23, s[24:27], s74 offen sc1 lds
    s_add_u32 m0, s7, 8192
    s_nop 0
    buffer_load_dwordx4 v24, s[24:27], s74 offen sc1 lds
    s_add_u32 m0, s7, 9216
    s_nop 0
    buffer_load_dwordx4 v25, s[24:27], s74 offen sc1 lds
L_hffn_e1:
    ds_read_b128 v[4:7], v251 offset:48
    s_waitcnt lgkmcnt(0)
    v_min3_u32 v4, v4, v5, v6
    v_min_u32 v4, v4, v7
    v_cmp_gt_u32 vcc, 9, v4
    s_cbranch_vccz L_hffn_e1x
    s_sleep 1
    s_add_u32 s67, s67, 1
    s_cmp_lt_u32 s67, 0x2000000
    s_cbranch_scc1 L_hffn_e1
L_hffn_e1x:
    s_bfe_u32 s73, s92, 0x40004
    s_bitcmp1_b32 s73, 0
    s_cselect_b64 s[24:25], s[40:41], s[36:37]
    s_cselect_b32 s26, s42, s38
    s_lshr_b32 s73, s73, 1
    s_mul_i32 s74, s5, s73
    s_add_u32 s74, s74, s4
    s_add_u32 m0, s8, 0
    s_nop 0
    buffer_load_dwordx4 v16, s[24:27], s74 offen sc1 lds
    s_add_u32 m0, s8, 1024
    s_nop 0
    buffer_load_dwordx4 v17, s[24:27], s74 offen sc1 lds
    s_add_u32 m0, s8, 2048
    s_nop 0
    buffer_load_dwordx4 v18, s[24:27], s74 offen sc1 lds
    s_add_u32 m0, s8, 3072
    s_nop 0
    buffer_load_dwordx4 v19, s[24:27], s74 offen sc1 lds
    s_add_u32 m0, s8, 4096
    s_nop 0
    buffer_load_dwordx4 v20, s[24:27], s74 offen sc1 lds
    s_add_u32 m0, s8, 5120
    s_nop 0
    buffer_load_dwordx4 v21, s[24:27], s74 offen sc1 lds
    s_add_u32 m0, s8, 6144
    s_nop 0
    buffer_load_dwordx4 v22, s[24:27], s74 offen sc1 lds
    s_add_u32 m0, s8, 7168
    s_nop 0
    buffer_load_dwordx4 v23, s[24:27], s74 offen sc1 lds
    s_add_u32 m0, s8, 8192
    s_nop 0
    buffer_load_dwordx4 v24, s[24:27], s74 offen sc1 lds
    s_add_u32 m0, s8, 9216
    s_nop 0
    buffer_load_dwordx4 v25, s[24:27], s74 offen sc1 lds
    s_bfe_u32 s73, s92, 0x40008
    s_bitcmp1_b32 s73, 0
    s_cselect_b64 s[24:25], s[40:41], s[36:37]
    s_cselect_b32 s26, s42, s38
    s_lshr_b32 s73, s73, 1
    s_mul_i32 s74, s5, s73
    s_add_u32 s74, s74, s4
    buffer_load_dwordx4 v[48:51], v16, s[24:27], s74 offen sc1
    buffer_load_dwordx4 v[52:55], v17, s[24:27], s74 offen sc1
    buffer_load_dwordx4 v[56:59], v18, s[24:27], s74 offen sc1
    buffer_load_dwordx4 v[60:63], v19, s[24:27], s74 offen sc1
    buffer_load_dwordx4 v[64:67], v20, s[24:27], s74 offen sc1
    buffer_load_dwordx4 v[68:71], v21, s[24:27], s74 offen sc1
    buffer_load_dwordx4 v[72:75], v22, s[24:27], s74 offen sc1
    buffer_load_dwordx4 v[76:79], v23, s[24:27], s74 offen sc1
    buffer_load_dwordx4 v[80:83], v24, s[24:27], s74 offen sc1
    buffer_load_dwordx4 v[84:87], v25, s[24:27], s74 offen sc1
    s_bfe_u32 s73, s92, 0x4000c
    s_bitcmp1_b32 s73, 0
    s_cselect_b64 s[24:25], s[40:41], s[36:37]
    s_cselect_b32 s26, s42, s38
    s_lshr_b32 s73, s73, 1
    s_mul_i32 s74, s5, s73
    s_add_u32 s74, s74, s4
    buffer_load_dwordx4 v[88:91], v16, s[24:27], s74 offen sc1
    buffer_load_dwordx4 v[92:95], v17, s[24:27], s74 offen sc1
    buffer_load_dwordx4 v[96:99], v18, s[24:27], s74 offen sc1
    buffer_load_dwordx4 v[100:103], v19, s[24:27], s74 offen sc1
    buffer_load_dwordx4 v[104:107], v20, s[24:27], s74 offen sc1
    buffer_load_dwordx4 v[108:111], v21, s[24:27], s74 offen sc1
    buffer_load_dwordx4 v[112:115], v22, s[24:27], s74 offen sc1
    buffer_load_dwordx4 v[116:119], v23, s[24:27], s74 offen sc1
    buffer_load_dwordx4 v[120:123], v24, s[24:27], s74 offen sc1
    buffer_load_dwordx4 v[124:127], v25, s[24:27], s74 offen sc1
    s_bfe_u32 s73, s92, 0x40010
    s_bitcmp1_b32 s73, 0
    s_cselect_b64 s[24:25], s[40:41], s[36:37]
    s_cselect_b32 s26, s42, s38
    s_lshr_b32 s73, s73, 1
    s_mul_i32 s74, s5, s73
    s_add_u32 s74, s74, s4
    buffer_load_dwordx4 v[128:131], v16, s[24:27], s74 offen sc1
    buffer_load_dwordx4 v[132:135], v17, s[24:27], s74 offen sc1
    buffer_load_dwordx4 v[136:139], v18, s[24:27], s74 offen sc1
    buffer_load_dwordx4 v[140:143], v19, s[24:27], s74 offen sc1
    buffer_load_dwordx4 v[144:147], v20, s[24:27], s74 offen sc1
    buffer_load_dwordx4 v[148:151], v21, s[24:27], s74 offen sc1
    buffer_load_dwordx4 v[152:155], v22, s[24:27], s74 offen sc1
    buffer_load_dwordx4 v[156:159], v23, s[24:27], s74 offen sc1
    buffer_load_dwordx4 v[160:163], v24, s[24:27], s74 offen sc1
    buffer_load_dwordx4 v[164:167], v25, s[24:27], s74 offen sc1
    s_waitcnt vmcnt(30)
    v_mov_b32 v253, 2
    ds_write_b32 v15, v253
    s_bfe_u32 s73, s92, 0x40014
    s_bitcmp1_b32 s73, 0
    s_cselect_b64 s[24:25], s[40:41], s[36:37]
    s_cselect_b32 s26, s42, s38
    s_lshr_b32 s73, s73, 1
    s_mul_i32 s74, s5, s73
    s_add_u32 s74, s74, s4
    buffer_load_dwordx4 v[168:171], v16, s[24:27], s74 offen sc1
    buffer_load_dwordx4 v[172:175], v17, s[24:27], s74 offen sc1
    buffer_load_dwordx4 v[176:179], v18, s[24:27], s74 offen sc1
    buffer_load_dwordx4 v[180:183], v19, s[24:27], s74 offen sc1
    buffer_load_dwordx4 v[184:187], v20, s[24:27], s74 offen sc1
    buffer_load_dwordx4 v[188:191], v21, s[24:27], s74 offen sc1
    buffer_load_dwordx4 v[192:195], v22, s[24:27], s74 offen sc1
    buffer_load_dwordx4 v[196:199], v23, s[24:27], s74 offen sc1
    buffer_load_dwordx4 v[200:203], v24, s[24:27], s74 offen sc1
    buffer_load_dwordx4 v[204:207], v25, s[24:27], s74 offen sc1
    s_bfe_u32 s73, s92, 0x40018
    s_bitcmp1_b32 s73, 0
    s_cselect_b64 s[24:25], s[40:41], s[36:37]
    s_cselect_b32 s26, s42, s38
    s_lshr_b32 s73, s73, 1
    s_mul_i32 s74, s5, s73
    s_add_u32 s74, s74, s4
    buffer_load_dwordx4 v[208:211], v16, s[24:27], s74 offen sc1
    buffer_load_dwordx4 v[212:215], v17, s[24:27], s74 offen sc1
    buffer_load_dwordx4 v[216:219], v18, s[24:27], s74 offen sc1
    buffer_load_dwordx4 v[220:223], v19, s[24:27], s74 offen sc1
    buffer_load_dwordx4 v[224:227], v20, s[24:27], s74 offen sc1
    buffer_load_dwordx4 v[228:231], v21, s[24:27], s74 offen sc1
    buffer_load_dwordx4 v[232:235], v22, s[24:27], s74 offen sc1
    buffer_load_dwordx4 v[236:239], v23, s[24:27], s74 offen sc1
    buffer_load_dwordx4 v[240:243], v24, s[24:27], s74 offen sc1
    buffer_load_dwordx4 v[244:247], v25, s[24:27], s74 offen sc1
    s_branch L_h_p2
L_h_ssm:
    s_mov_b32 s36, s4
    s_mov_b32 s37, s5
    s_mov_b32 s38, 2621440
    s_mov_b32 s39, 0x00020000
    v_lshrrev_b32 v2, 3, v0
    v_and_b32 v3, 7, v0
    v_lshrrev_b32 v4, 4, v0
    v_xor_b32 v3, v3, v4
    v_lshlrev_b32 v3, 4, v3
    v_xor_b32 v4, 64, v3
    v_lshrrev_b32 v5, 2, v2
    v_lshlrev_b32 v5, 4, v5
    v_and_b32 v6, 1, v2
    v_lshl_add_u32 v5, v6, 3, v5
    v_bfe_u32 v6, v2, 1, 1
    v_add_u32 v5, v5, v6
    s_lshl_b32 s68, s60, 8
    s_lshl_b32 s69, s65, 6
    s_add_u32 s68, s68, s69
    v_add_u32 v5, s68, v5
    v_mul_u32_u24 v5, 1280, v5
    v_add_u32 v6, v5, v3
    v_add_u32 v7, v5, v4
    v_add_u32 v16, 0, v6
    v_add_u32 v17, 40960, v7
    v_add_u32 v18, 2560, v6
    v_add_u32 v19, 43520, v7
    v_add_u32 v20, 5120, v6
    v_add_u32 v21, 46080, v7
    v_add_u32 v22, 7680, v6
    v_add_u32 v23, 48640, v7
    s_cmp_ge_u32 s65, 2
    s_cselect_b32 s40, s12, s10
    s_cselect_b32 s41, s13, s11
    s_mov_b32 s42, 819200
    s_mov_b32 s43, 0x00020000
    s_mov_b32 s62, s61
    s_lshl_b32 s68, s62, 6
    s_and_b32 s69, s65, 1
    s_lshl_b32 s69, s69, 5
    s_add_u32 s68, s68, s69
    v_add_u32 v5, s68, v2
    v_mul_u32_u24 v5, 1280, v5
    v_add_u32 v6, v5, v3
    v_add_u32 v7, v5, v4
    v_add_u32 v24, 0, v6
    v_add_u32 v25, 10240, v7
    v_add_u32 v26, 20480, v6
    v_add_u32 v27, 30720, v7
    s_lshl_b32 s76, s65, 12
    s_lshl_b32 s77, s65, 13
    s_movk_i32 s74, 0
    s_mov_b32 s75, 0
    s_add_u32 m0, s76, 32768
    s_nop 0
    buffer_load_dwordx4 v24, s[40:43], s75 offen lds
    s_add_u32 m0, s77, 0
    s_nop 0
    buffer_load_dwordx4 v16, s[36:39], s74 offen lds
    s_add_u32 m0, s76, 33792
    s_nop 0
    buffer_load_dwordx4 v25, s[40:43], s75 offen lds
    s_add_u32 m0, s77, 1024
    s_nop 0
    buffer_load_dwordx4 v17, s[36:39], s74 offen lds
    s_add_u32 m0, s76, 34816
    s_nop 0
    buffer_load_dwordx4 v26, s[40:43], s75 offen lds
    s_add_u32 m0, s77, 2048
    s_nop 0
    buffer_load_dwordx4 v18, s[36:39], s74 offen lds
    s_add_u32 m0, s76, 35840
    s_nop 0
    buffer_load_dwordx4 v27, s[40:43], s75 offen lds
    s_add_u32 m0, s77, 3072
    s_nop 0
    buffer_load_dwordx4 v19, s[36:39], s74 offen lds
    s_add_u32 m0, s77, 4096
    s_nop 0
    buffer_load_dwordx4 v20, s[36:39], s74 offen lds
    s_add_u32 m0, s77, 5120
    s_nop 0
    buffer_load_dwordx4 v21, s[36:39], s74 offen lds
    s_add_u32 m0, s77, 6144
    s_nop 0
    buffer_load_dwordx4 v22, s[36:39], s74 offen lds
    s_add_u32 m0, s77, 7168
    s_nop 0
    buffer_load_dwordx4 v23, s[36:39], s74 offen lds
    s_lshl_b32 s68, s62, 13
    s_add_u32 s68, s68, 0xf20000
    s_add_u32 s48, s34, s68
    s_addc_u32 s49, s35, 0
    s_mov_b32 s50, 8192
    s_mov_b32 s51, 0x00020000
    s_lshl_b32 s79, s60, 10
    s_waitcnt lgkmcnt(0)
    s_add_u32 s66, s66, 0x9E3779B1
    s_movk_i32 s74, 128
    s_mov_b32 s75, 128
    s_add_u32 m0, s76, 81920
    s_nop 0
    buffer_load_dwordx4 v24, s[40:43], s75 offen lds
    s_add_u32 m0, s77, 49152
    s_nop 0
    buffer_load_dwordx4 v16, s[36:39], s74 offen lds
    s_add_u32 m0, s76, 82944
    s_nop 0
    buffer_load_dwordx4 v25, s[40:43], s75 offen lds
    s_add_u32 m0, s77, 50176
    s_nop 0
    buffer_load_dwordx4 v17, s[36:39], s74 offen lds
    s_add_u32 m0, s76, 83968
    s_nop 0
    buffer_load_dwordx4 v26, s[40:43], s75 offen lds
    s_add_u32 m0, s77, 51200
    s_nop 0
    buffer_load_dwordx4 v18, s[36:39], s74 offen lds
    v_mov_b32 v36, 0x3f803f80
    v_mov_b32 v37, 0x3f803f80
    v_mov_b32 v38, 0x3f803f80
    v_mov_b32 v39, 0x3f803f80
    v_lshrrev_b32 v9, 4, v0
    v_and_b32 v10, 15, v0
    v_lshlrev_b32 v8, 7, v10
    v_bfe_u32 v10, v0, 1, 3
    v_xor_b32 v10, v10, v9
    v_lshl_add_u32 v8, v10, 4, v8
    s_add_u32 s68, s76, 32768
    v_add_u32 v8, s68, v8
    v_add_u32 v11, 98304, v8
    v_xor_b32 v13, 64, v8
    v_xor_b32 v14, 64, v11
    v_mov_b32 v64, 0
    v_mov_b32 v65, 0
    v_mov_b32 v66, 0
    v_mov_b32 v67, 0
    v_mov_b32 v68, 0
    v_mov_b32 v69, 0
    v_mov_b32 v70, 0
    v_mov_b32 v71, 0
    v_mov_b32 v72, 0
    v_mov_b32 v73, 0
    v_mov_b32 v74, 0
    v_mov_b32 v75, 0
    v_mov_b32 v76, 0
    v_mov_b32 v77, 0
    v_mov_b32 v78, 0
    v_mov_b32 v79, 0
    v_mov_b32 v80, 0
    v_mov_b32 v81, 0
    v_mov_b32 v82, 0
    v_mov_b32 v83, 0
    s_add_u32 s52, s34, 0x1000000
    s_addc_u32 s53, s35, 0
    s_mov_b32 s54, 1048576
    s_mov_b32 s55, 0x00020000
    s_lshl_b32 s70, s61, 15
    s_lshl_b32 s69, s60, 11
    s_add_u32 s70, s70, s69
    s_lshr_b32 s69, s65, 1
    s_lshl_b32 s69, s69, 10
    s_add_u32 s70, s70, s69
    s_and_b32 s69, s65, 1
    s_lshl_b32 s69, s69, 8
    s_add_u32 s78, s70, s69
    s_add_u32 s87, s60, 2
    s_mul_i32 s87, s87, 128
    v_lshlrev_b32 v9, 2, v0
    v_lshlrev_b32 v12, 3, v0
    s_lshl_b32 s68, s65, 2
    s_add_u32 s68, s68, s91
    v_mov_b32 v15, s68
    v_mov_b32 v251, s91
    v_mov_b32 v252, v4
    v_mov_b32 v32, 0
    ds_write_b32 v15, v32 offset:0
    ds_write_b32 v15, v32 offset:16
    ds_write_b32 v15, v32 offset:32
    ds_write_b32 v15, v32 offset:48
    s_waitcnt vmcnt(6)
    s_waitcnt lgkmcnt(0)
    s_barrier
    s_movk_i32 s74, 128
    s_mov_b32 s75, 128
    s_add_u32 m0, s76, 84992
    s_nop 0
    buffer_load_dwordx4 v27, s[40:43], s75 offen lds
    s_add_u32 m0, s77, 52224
    s_nop 0
    buffer_load_dwordx4 v19, s[36:39], s74 offen lds
    s_add_u32 m0, s77, 53248
    s_nop 0
    buffer_load_dwordx4 v20, s[36:39], s74 offen lds
    s_add_u32 m0, s77, 54272
    s_nop 0
    buffer_load_dwordx4 v21, s[36:39], s74 offen lds
    s_add_u32 m0, s77, 55296
    s_nop 0
    buffer_load_dwordx4 v22, s[36:39], s74 offen lds
    s_add_u32 m0, s77, 56320
    s_nop 0
    buffer_load_dwordx4 v23, s[36:39], s74 offen lds
    s_add_u32 m0, s76, 131072
    s_nop 0
    buffer_load_dwordx4 v24, s[40:43], s87 offen lds
    s_add_u32 m0, s76, 132096
    s_nop 0
    buffer_load_dwordx4 v25, s[40:43], s87 offen lds
    s_add_u32 m0, s76, 133120
    s_nop 0
    buffer_load_dwordx4 v26, s[40:43], s87 offen lds
    s_add_u32 m0, s76, 134144
    s_nop 0
    buffer_load_dwordx4 v27, s[40:43], s87 offen lds
    s_waitcnt vmcnt(4)
    v_mov_b32 v253, 2
    ds_write_b32 v15, v253 offset:32
    s_movk_i32 s74, 256
    s_mov_b32 s75, 256
    s_add_u32 m0, s77, 98304
    s_nop 0
    buffer_load_dwordx4 v16, s[36:39], s74 offen lds
    s_add_u32 m0, s77, 99328
    s_nop 0
    buffer_load_dwordx4 v17, s[36:39], s74 offen lds
    s_add_u32 m0, s77, 100352
    s_nop 0
    buffer_load_dwordx4 v18, s[36:39], s74 offen lds
    s_add_u32 m0, s77, 101376
    s_nop 0
    buffer_load_dwordx4 v19, s[36:39], s74 offen lds
    s_add_u32 m0, s77, 102400
    s_nop 0
    buffer_load_dwordx4 v20, s[36:39], s74 offen lds
    s_add_u32 m0, s77, 103424
    s_nop 0
    buffer_load_dwordx4 v21, s[36:39], s74 offen lds
    s_add_u32 m0, s77, 104448
    s_nop 0
    buffer_load_dwordx4 v22, s[36:39], s74 offen lds
    s_add_u32 m0, s77, 105472
    s_nop 0
    buffer_load_dwordx4 v23, s[36:39], s74 offen lds
    s_cmp_lg_u32 s60, 0
    s_cbranch_scc1 L_hssm_cs0
    ds_read_b128 v[40:43], v8 offset:0
    ds_read_b128 v[44:47], v8 offset:2048
    ds_read_b128 v[48:51], v13 offset:0
    ds_read_b128 v[52:55], v13 offset:2048
    s_waitcnt lgkmcnt(3)
    v_mfma_f32_16x16x32_bf16 v[64:67], v[36:39], v[40:43], v[64:67]
    s_waitcnt lgkmcnt(2)
    v_mfma_f32_16x16x32_bf16 v[68:71], v[36:39], v[44:47], v[68:71]
    s_waitcnt lgkmcnt(1)
    v_mfma_f32_16x16x32_bf16 v[64:67], v[36:39], v[48:51], v[64:67]
    s_waitcnt lgkmcnt(0)
    v_mfma_f32_16x16x32_bf16 v[68:71], v[36:39], v[52:55], v[68:71]
    ds_read_b128 v[40:43], v8 offset:49152
    ds_read_b128 v[44:47], v8 offset:51200
    ds_read_b128 v[48:51], v13 offset:49152
    ds_read_b128 v[52:55], v13 offset:51200
    s_waitcnt lgkmcnt(3)
    v_mfma_f32_16x16x32_bf16 v[64:67], v[36:39], v[40:43], v[64:67]
    s_waitcnt lgkmcnt(2)
    v_mfma_f32_16x16x32_bf16 v[68:71], v[36:39], v[44:47], v[68:71]
    s_waitcnt lgkmcnt(1)
    v_mfma_f32_16x16x32_bf16 v[64:67], v[36:39], v[48:51], v[64:67]
    s_waitcnt lgkmcnt(0)
    v_mfma_f32_16x16x32_bf16 v[68:71], v[36:39], v[52:55], v[68:71]
L_hssm_cs0:
    s_waitcnt vmcnt(8)
    ds_read_b128 v[40:43], v11 offset:0
    ds_read_b128 v[44:47], v11 offset:2048
    ds_read_b128 v[48:51], v14 offset:0
    ds_read_b128 v[52:55], v14 offset:2048
    s_waitcnt lgkmcnt(3)
    v_mfma_f32_16x16x32_bf16 v[64:67], v[36:39], v[40:43], v[64:67]
    s_waitcnt lgkmcnt(2)
    v_mfma_f32_16x16x32_bf16 v[68:71], v[36:39], v[44:47], v[68:71]
    s_waitcnt lgkmcnt(1)
    v_mfma_f32_16x16x32_bf16 v[64:67], v[36:39], v[48:51], v[64:67]
    s_waitcnt lgkmcnt(0)
    v_mfma_f32_16x16x32_bf16 v[68:71], v[36:39], v[52:55], v[68:71]
    s_movk_i32 s74, 256
    s_mov_b32 s75, 256
    s_add_u32 m0, s76, 131072
    s_nop 0
    buffer_load_dwordx4 v24, s[40:43], s75 offen lds
    s_add_u32 m0, s76, 132096
    s_nop 0
    buffer_load_dwordx4 v25, s[40:43], s75 offen lds
    s_add_u32 m0, s76, 133120
    s_nop 0
    buffer_load_dwordx4 v26, s[40:43], s75 offen lds
    s_add_u32 m0, s76, 134144
    s_nop 0
    buffer_load_dwordx4 v27, s[40:43], s75 offen lds
    s_mov_b32 exec_lo, 0xffff0000
    s_mov_b32 exec_hi, 0x0
    v_mov_b32 v64, v68
    s_mov_b64 exec, -1
    v_mov_b32 v65, s66
    v_mov_b32 v81, s66
    s_mov_b32 exec_hi, 0
    buffer_store_dwordx2 v[64:65], v12, s[52:55], s78 offen sc1
    s_mov_b64 exec, -1
    s_add_u32 s56, s34, 0xf00000
    s_addc_u32 s57, s35, 0
    s_mov_b32 s58, 65536
    s_mov_b32 s59, 0x00020000
    v_bfe_u32 v10, v0, 2, 2
    v_lshlrev_b32 v10, 4, v10
    v_and_b32 v30, 1, v0
    v_lshl_add_u32 v10, v30, 3, v10
    v_lshrrev_b32 v30, 4, v0
    v_lshl_add_u32 v10, v30, 1, v10
    v_bfe_u32 v30, v0, 1, 1
    v_add_u32 v10, v10, v30
    v_lshlrev_b32 v10, 5, v10
    s_lshl_b32 s18, s60, 13
    s_lshl_b32 s69, s65, 11
    s_add_u32 s18, s18, s69
    s_lshl_b32 s19, s61, 15
    s_lshl_b32 s69, s65, 9
    s_and_b32 s70, s69, 0x400
    s_add_u32 s19, s19, s70
    v_mov_b32 v13, v12
L_hssm_f3:
    ds_read_b128 v[4:7], v251 offset:48
    s_waitcnt lgkmcnt(0)
    v_min3_u32 v4, v4, v5, v6
    v_min_u32 v4, v4, v7
    v_cmp_gt_u32 vcc, 1, v4
    s_cbranch_vccz L_hssm_f3x
    s_sleep 1
    s_add_u32 s67, s67, 1
    s_cmp_lt_u32 s67, 0x2000000
    s_cbranch_scc1 L_hssm_f3
L_hssm_f3x:
    s_movk_i32 s74, 384
    s_mov_b32 s75, 384
    s_add_u32 m0, s76, 32768
    s_nop 0
    buffer_load_dwordx4 v24, s[40:43], s75 offen lds
    s_add_u32 m0, s77, 0
    s_nop 0
    buffer_load_dwordx4 v16, s[36:39], s74 offen lds
    s_add_u32 m0, s76, 33792
    s_nop 0
    buffer_load_dwordx4 v25, s[40:43], s75 offen lds
    s_add_u32 m0, s77, 1024
    s_nop 0
    buffer_load_dwordx4 v17, s[36:39], s74 offen lds
    s_add_u32 m0, s76, 34816
    s_nop 0
    buffer_load_dwordx4 v26, s[40:43], s75 offen lds
    s_add_u32 m0, s77, 2048
    s_nop 0
    buffer_load_dwordx4 v18, s[36:39], s74 offen lds
    s_waitcnt vmcnt(7)
    v_mov_b32 v253, 3
    ds_write_b32 v15, v253 offset:32
    s_movk_i32 s74, 384
    s_mov_b32 s75, 384
    s_add_u32 m0, s76, 35840
    s_nop 0
    buffer_load_dwordx4 v27, s[40:43], s75 offen lds
    s_add_u32 m0, s77, 3072
    s_nop 0
    buffer_load_dwordx4 v19, s[36:39], s74 offen lds
    s_add_u32 m0, s77, 4096
    s_nop 0
    buffer_load_dwordx4 v20, s[36:39], s74 offen lds
    s_add_u32 m0, s77, 5120
    s_nop 0
    buffer_load_dwordx4 v21, s[36:39], s74 offen lds
    s_add_u32 m0, s77, 6144
    s_nop 0
    buffer_load_dwordx4 v22, s[36:39], s74 offen lds
    s_add_u32 m0, s77, 7168
    s_nop 0
    buffer_load_dwordx4 v23, s[36:39], s74 offen lds
L_hssm_f4:
    ds_read_b128 v[4:7], v251 offset:48
    s_waitcnt lgkmcnt(0)
    v_min3_u32 v4, v4, v5, v6
    v_min_u32 v4, v4, v7
    v_cmp_gt_u32 vcc, 2, v4
    s_cbranch_vccz L_hssm_f4x
    s_sleep 1
    s_add_u32 s67, s67, 1
    s_cmp_lt_u32 s67, 0x2000000
    s_cbranch_scc1 L_hssm_f4
L_hssm_f4x:
    s_movk_i32 s74, 512
    s_mov_b32 s75, 512
    s_add_u32 m0, s76, 81920
    s_nop 0
    buffer_load_dwordx4 v24, s[40:43], s75 offen lds
    s_add_u32 m0, s77, 49152
    s_nop 0
    buffer_load_dwordx4 v16, s[36:39], s74 offen lds
    s_add_u32 m0, s76, 82944
    s_nop 0
    buffer_load_dwordx4 v25, s[40:43], s75 offen lds
    s_add_u32 m0, s77, 50176
    s_nop 0
    buffer_load_dwordx4 v17, s[36:39], s74 offen lds
    s_add_u32 m0, s76, 83968
    s_nop 0
    buffer_load_dwordx4 v26, s[40:43], s75 offen lds
    s_add_u32 m0, s77, 51200
    s_nop 0
    buffer_load_dwordx4 v18, s[36:39], s74 offen lds
    s_waitcnt vmcnt(6)
    v_mov_b32 v253, 4
    ds_write_b32 v15, v253 offset:32
    s_movk_i32 s74, 512
    s_mov_b32 s75, 512
    s_add_u32 m0, s76, 84992
    s_nop 0
    buffer_load_dwordx4 v27, s[40:43], s75 offen lds
    s_add_u32 m0, s77, 52224
    s_nop 0
    buffer_load_dwordx4 v19, s[36:39], s74 offen lds
    s_add_u32 m0, s77, 53248
    s_nop 0
    buffer_load_dwordx4 v20, s[36:39], s74 offen lds
    s_add_u32 m0, s77, 54272
    s_nop 0
    buffer_load_dwordx4 v21, s[36:39], s74 offen lds
    s_add_u32 m0, s77, 55296
    s_nop 0
    buffer_load_dwordx4 v22, s[36:39], s74 offen lds
    s_add_u32 m0, s77, 56320
    s_nop 0
    buffer_load_dwordx4 v23, s[36:39], s74 offen lds
L_hssm_f5:
    ds_read_b128 v[4:7], v251 offset:48
    s_waitcnt lgkmcnt(0)
    v_min3_u32 v4, v4, v5, v6
    v_min_u32 v4, v4, v7
    v_cmp_gt_u32 vcc, 3, v4
    s_cbranch_vccz L_hssm_f5x
    s_sleep 1
    s_add_u32 s67, s67, 1
    s_cmp_lt_u32 s67, 0x2000000
    s_cbranch_scc1 L_hssm_f5
L_hssm_f5x:
    s_movk_i32 s74, 640
    s_mov_b32 s75, 640
    s_add_u32 m0, s76, 131072
    s_nop 0
    buffer_load_dwordx4 v24, s[40:43], s75 offen lds
    s_add_u32 m0, s77, 98304
    s_nop 0
    buffer_load_dwordx4 v16, s[36:39], s74 offen lds
    s_add_u32 m0, s76, 132096
    s_nop 0
    buffer_load_dwordx4 v25, s[40:43], s75 offen lds
    s_add_u32 m0, s77, 99328
    s_nop 0
    buffer_load_dwordx4 v17, s[36:39], s74 offen lds
    s_add_u32 m0, s76, 133120
    s_nop 0
    buffer_load_dwordx4 v26, s[40:43], s75 offen lds
    s_add_u32 m0, s77, 100352
    s_nop 0
    buffer_load_dwordx4 v18, s[36:39], s74 offen lds
    s_waitcnt vmcnt(6)
    v_mov_b32 v253, 5
    ds_write_b32 v15, v253 offset:32
    s_movk_i32 s74, 640
    s_mov_b32 s75, 640
    s_add_u32 m0, s76, 134144
    s_nop 0
    buffer_load_dwordx4 v27, s[40:43], s75 offen lds
    s_add_u32 m0, s77, 101376
    s_nop 0
    buffer_load_dwordx4 v19, s[36:39], s74 offen lds
    s_add_u32 m0, s77, 102400
    s_nop 0
    buffer_load_dwordx4 v20, s[36:39], s74 offen lds
    s_add_u32 m0, s77, 103424
    s_nop 0
    buffer_load_dwordx4 v21, s[36:39], s74 offen lds
    s_add_u32 m0, s77, 104448
    s_nop 0
    buffer_load_dwordx4 v22, s[36:39], s74 offen lds
    s_add_u32 m0, s77, 105472
    s_nop 0
    buffer_load_dwordx4 v23, s[36:39], s74 offen lds
L_hssm_f6:
    ds_read_b128 v[4:7], v251 offset:48
    s_waitcnt lgkmcnt(0)
    v_min3_u32 v4, v4, v5, v6
    v_min_u32 v4, v4, v7
    v_cmp_gt_u32 vcc, 4, v4
    s_cbranch_vccz L_hssm_f6x
    s_sleep 1
    s_add_u32 s67, s67, 1
    s_cmp_lt_u32 s67, 0x2000000
    s_cbranch_scc1 L_hssm_f6
L_hssm_f6x:
    s_movk_i32 s74, 768
    s_mov_b32 s75, 768
    s_add_u32 m0, s76, 32768
    s_nop 0
    buffer_load_dwordx4 v24, s[40:43], s75 offen lds
    s_add_u32 m0, s77, 0
    s_nop 0
    buffer_load_dwordx4 v16, s[36:39], s74 offen lds
    s_add_u32 m0, s76, 33792
    s_nop 0
    buffer_load_dwordx4 v25, s[40:43], s75 offen lds
    s_add_u32 m0, s77, 1024
    s_nop 0
    buffer_load_dwordx4 v17, s[36:39], s74 offen lds
    s_add_u32 m0, s76, 34816
    s_nop 0
    buffer_load_dwordx4 v26, s[40:43], s75 offen lds
    s_add_u32 m0, s77, 2048
    s_nop 0
    buffer_load_dwordx4 v18, s[36:39], s74 offen lds
    s_waitcnt vmcnt(6)
    v_mov_b32 v253, 6
    ds_write_b32 v15, v253 offset:32
    s_movk_i32 s74, 768
    s_mov_b32 s75, 768
    s_add_u32 m0, s76, 35840
    s_nop 0
    buffer_load_dwordx4 v27, s[40:43], s75 offen lds
    s_add_u32 m0, s77, 3072
    s_nop 0
    buffer_load_dwordx4 v19, s[36:39], s74 offen lds
    s_add_u32 m0, s77, 4096
    s_nop 0
    buffer_load_dwordx4 v20, s[36:39], s74 offen lds
    s_add_u32 m0, s77, 5120
    s_nop 0
    buffer_load_dwordx4 v21, s[36:39], s74 offen lds
    s_add_u32 m0, s77, 6144
    s_nop 0
    buffer_load_dwordx4 v22, s[36:39], s74 offen lds
    s_add_u32 m0, s77, 7168
    s_nop 0
    buffer_load_dwordx4 v23, s[36:39], s74 offen lds
    s_lshl_b32 s70, s62, 3
    s_add_u32 s70, s70, s60
    s_lshl_b32 s70, s70, 1
    s_and_b32 s69, s65, 1
    s_add_u32 s70, s70, s69
    s_mul_i32 s68, s70, 5120
    s_cmp_lt_u32 s65, 2
    s_cselect_b32 s80, s14, s16
    s_cselect_b32 s81, s15, s17
    s_mov_b32 s82, 819200
    s_mov_b32 s83, 0x00020000
    v_min_u32 v5, 39, v0
    v_lshlrev_b32 v5, 7, v5
    buffer_load_dword v31, v5, s[80:83], s68 offen
L_hssm_f7:
    ds_read_b128 v[4:7], v251 offset:48
    s_waitcnt lgkmcnt(0)
    v_min3_u32 v4, v4, v5, v6
    v_min_u32 v4, v4, v7
    v_cmp_gt_u32 vcc, 5, v4
    s_cbranch_vccz L_hssm_f7x
    s_sleep 1
    s_add_u32 s67, s67, 1
    s_cmp_lt_u32 s67, 0x2000000
    s_cbranch_scc1 L_hssm_f7
L_hssm_f7x:
    s_movk_i32 s74, 896
    s_mov_b32 s75, 896
    s_add_u32 m0, s76, 81920
    s_nop 0
    buffer_load_dwordx4 v24, s[40:43], s75 offen lds
    s_add_u32 m0, s77, 49152
    s_nop 0
    buffer_load_dwordx4 v16, s[36:39], s74 offen lds
    s_add_u32 m0, s76, 82944
    s_nop 0
    buffer_load_dwordx4 v25, s[40:43], s75 offen lds
    s_add_u32 m0, s77, 50176
    s_nop 0
    buffer_load_dwordx4 v17, s[36:39], s74 offen lds
    s_add_u32 m0, s76, 83968
    s_nop 0
    buffer_load_dwordx4 v26, s[40:43], s75 offen lds
    s_add_u32 m0, s77, 51200
    s_nop 0
    buffer_load_dwordx4 v18, s[36:39], s74 offen lds
    s_waitcnt vmcnt(7)
    v_mov_b32 v253, 7
    ds_write_b32 v15, v253 offset:32
    s_movk_i32 s74, 896
    s_mov_b32 s75, 896
    s_add_u32 m0, s76, 84992
    s_nop 0
    buffer_load_dwordx4 v27, s[40:43], s75 offen lds
    s_add_u32 m0, s77, 52224
    s_nop 0
    buffer_load_dwordx4 v19, s[36:39], s74 offen lds
    s_add_u32 m0, s77, 53248
    s_nop 0
    buffer_load_dwordx4 v20, s[36:39], s74 offen lds
    s_add_u32 m0, s77, 54272
    s_nop 0
    buffer_load_dwordx4 v21, s[36:39], s74 offen lds
    s_add_u32 m0, s77, 55296
    s_nop 0
    buffer_load_dwordx4 v22, s[36:39], s74 offen lds
    s_add_u32 m0, s77, 56320
    s_nop 0
    buffer_load_dwordx4 v23, s[36:39], s74 offen lds
L_hssm_f8:
    ds_read_b128 v[4:7], v251 offset:48
    s_waitcnt lgkmcnt(0)
    v_min3_u32 v4, v4, v5, v6
    v_min_u32 v4, v4, v7
    v_cmp_gt_u32 vcc, 6, v4
    s_cbranch_vccz L_hssm_f8x
    s_sleep 1
    s_add_u32 s67, s67, 1
    s_cmp_lt_u32 s67, 0x2000000
    s_cbranch_scc1 L_hssm_f8
L_hssm_f8x:
    s_movk_i32 s74, 1024
    s_mov_b32 s75, 1024
    s_add_u32 m0, s76, 131072
    s_nop 0
    buffer_load_dwordx4 v24, s[40:43], s75 offen lds
    s_add_u32 m0, s77, 98304
    s_nop 0
    buffer_load_dwordx4 v16, s[36:39], s74 offen lds
    s_add_u32 m0, s76, 132096
    s_nop 0
    buffer_load_dwordx4 v25, s[40:43], s75 offen lds
    s_add_u32 m0, s77, 99328
    s_nop 0
    buffer_load_dwordx4 v17, s[36:39], s74 offen lds
    s_add_u32 m0, s76, 133120
    s_nop 0
    buffer_load_dwordx4 v26, s[40:43], s75 offen lds
    s_add_u32 m0, s77, 100352
    s_nop 0
    buffer_load_dwordx4 v18, s[36:39], s74 offen lds
    s_waitcnt vmcnt(6)
    v_mov_b32 v253, 8
    ds_write_b32 v15, v253 offset:32
    s_movk_i32 s74, 1024
    s_mov_b32 s75, 1024
    s_add_u32 m0, s76, 134144
    s_nop 0
    buffer_load_dwordx4 v27, s[40:43], s75 offen lds
    s_add_u32 m0, s77, 101376
    s_nop 0
    buffer_load_dwordx4 v19, s[36:39], s74 offen lds
    s_add_u32 m0, s77, 102400
    s_nop 0
    buffer_load_dwordx4 v20, s[36:39], s74 offen lds
    s_add_u32 m0, s77, 103424
    s_nop 0
    buffer_load_dwordx4 v21, s[36:39], s74 offen lds
    s_add_u32 m0, s77, 104448
    s_nop 0
    buffer_load_dwordx4 v22, s[36:39], s74 offen lds
    s_add_u32 m0, s77, 105472
    s_nop 0
    buffer_load_dwordx4 v23, s[36:39], s74 offen lds
L_hssm_f9:
    ds_read_b128 v[4:7], v251 offset:48
    s_waitcnt lgkmcnt(0)
    v_min3_u32 v4, v4, v5, v6
    v_min_u32 v4, v4, v7
    v_cmp_gt_u32 vcc, 7, v4
    s_cbranch_vccz L_hssm_f9x
    s_sleep 1
    s_add_u32 s67, s67, 1
    s_cmp_lt_u32 s67, 0x2000000
    s_cbranch_scc1 L_hssm_f9
L_hssm_f9x:
    s_movk_i32 s74, 1152
    s_mov_b32 s75, 1152
    s_add_u32 m0, s76, 32768
    s_nop 0
    buffer_load_dwordx4 v24, s[40:43], s75 offen lds
    s_add_u32 m0, s77, 0
    s_nop 0
    buffer_load_dwordx4 v16, s[36:39], s74 offen lds
    s_add_u32 m0, s76, 33792
    s_nop 0
    buffer_load_dwordx4 v25, s[40:43], s75 offen lds
    s_add_u32 m0, s77, 1024
    s_nop 0
    buffer_load_dwordx4 v17, s[36:39], s74 offen lds
    s_add_u32 m0, s76, 34816
    s_nop 0
    buffer_load_dwordx4 v26, s[40:43], s75 offen lds
    s_add_u32 m0, s77, 2048
    s_nop 0
    buffer_load_dwordx4 v18, s[36:39], s74 offen lds
    s_waitcnt vmcnt(6)
    v_mov_b32 v253, 9
    ds_write_b32 v15, v253 offset:32
    s_movk_i32 s74, 1152
    s_mov_b32 s75, 1152
    s_add_u32 m0, s76, 35840
    s_nop 0
    buffer_load_dwordx4 v27, s[40:43], s75 offen lds
    s_add_u32 m0, s77, 3072
    s_nop 0
    buffer_load_dwordx4 v19, s[36:39], s74 offen lds
    s_add_u32 m0, s77, 4096
    s_nop 0
    buffer_load_dwordx4 v20, s[36:39], s74 offen lds
    s_add_u32 m0, s77, 5120
    s_nop 0
    buffer_load_dwordx4 v21, s[36:39], s74 offen lds
    s_add_u32 m0, s77, 6144
    s_nop 0
    buffer_load_dwordx4 v22, s[36:39], s74 offen lds
    s_add_u32 m0, s77, 7168
    s_nop 0
    buffer_load_dwordx4 v23, s[36:39], s74 offen lds
    buffer_load_dwordx4 v[32:35], v10, s[56:59], s18 offen sc1
    s_add_u32 s68, s19, 0
    buffer_load_dwordx2 v[208:209], v13, s[52:55], s68 offen offset:0 sc1
    buffer_load_dwordx2 v[210:211], v13, s[52:55], s68 offen offset:2048 sc1
    s_add_u32 s68, s19, 4096
    buffer_load_dwordx2 v[212:213], v13, s[52:55], s68 offen offset:0 sc1
    buffer_load_dwordx2 v[214:215], v13, s[52:55], s68 offen offset:2048 sc1
    s_add_u32 s68, s19, 8192
    buffer_load_dwordx2 v[216:217], v13, s[52:55], s68 offen offset:0 sc1
    buffer_load_dwordx2 v[218:219], v13, s[52:55], s68 offen offset:2048 sc1
    s_add_u32 s68, s19, 12288
    buffer_load_dwordx2 v[220:221], v13, s[52:55], s68 offen offset:0 sc1
    buffer_load_dwordx2 v[222:223], v13, s[52:55], s68 offen offset:2048 sc1
    s_add_u32 s68, s64, s63
    s_and_b32 s68, s68, 3
    s_mov_b32 s68, 0
    s_lshl_b32 s68, s68, 2
    s_lshr_b32 s68, 0x2103210, s68
    s_and_b32 s68, s68, 0xffff
    s_mul_i32 s69, s68, 0x10001
    s_cmp_eq_u32 0, 1
    s_cselect_b32 s70, 0x44444444, 0
    s_cselect_b32 s71, 0, 0x8888
    s_cselect_b32 s72, 0x4444, 0
    s_add_u32 s92, s70, 0x44440000
    s_add_u32 s93, s71, s68
    s_xor_b32 s70, s70, 0x44440000
    s_cmp_eq_u32 s65, 1
    s_cselect_b32 s92, s70, s92
    s_cselect_b32 s93, 0xba98, s93
    s_add_u32 s92, s92, s69
    s_mov_b32 s27, 0x00020000
    s_mul_i32 s6, s65, 10240
    s_add_u32 s7, s6, s90
    s_add_u32 s8, s7, s90
    v_add_u32 v248, s6, v1
    v_add_u32 v249, s7, v1
    v_add_u32 v250, s8, v1
    s_mov_b32 s36, s14
    s_mov_b32 s37, s15
    s_mov_b32 s38, 819200
    s_mov_b32 s39, 0x00020000
    s_mov_b32 s40, s16
    s_mov_b32 s41, s17
    s_mov_b32 s42, 819200
    s_mov_b32 s43, 0x00020000
    s_mul_i32 s73, s64, 80
    v_add_u32 v5, s73, v2
    v_mul_u32_u24 v5, 1280, v5
    v_add_u32 v6, v5, v3
    v_add_u32 v7, v5, v252
    v_add_u32 v16, 0, v6
    v_add_u32 v17, 10240, v7
    v_add_u32 v18, 20480, v6
    v_add_u32 v19, 30720, v7
    v_add_u32 v20, 40960, v6
    v_add_u32 v21, 51200, v7
    v_add_u32 v22, 61440, v6
    v_add_u32 v23, 71680, v7
    v_add_u32 v24, 81920, v6
    v_add_u32 v25, 92160, v7
    s_mul_i32 s4, s65, 768
    s_movk_i32 s5, 128
    s_waitcnt vmcnt(9)
    v_mov_b32 v253, 10
    ds_write_b32 v15, v253 offset:32
    s_waitcnt vmcnt(0)
    s_mov_b32 s71, 0
L_hssm_g:
    v_xor_b32 v36, s66, v33
    v_xor_b32 v37, s66, v35
    v_or_b32 v36, v36, v37
    v_xor_b32 v37, s66, v209
    v_or_b32 v36, v36, v37
    v_xor_b32 v37, s66, v211
    v_or_b32 v36, v36, v37
    v_xor_b32 v37, s66, v213
    v_or_b32 v36, v36, v37
    v_xor_b32 v37, s66, v215
    v_or_b32 v36, v36, v37
    v_xor_b32 v37, s66, v217
    v_or_b32 v36, v36, v37
    v_xor_b32 v37, s66, v219
    v_or_b32 v36, v36, v37
    v_xor_b32 v37, s66, v221
    v_or_b32 v36, v36, v37
    v_xor_b32 v37, s66, v223
    v_or_b32 v36, v36, v37
    v_cmp_ne_u32 vcc, 0, v36
    s_cbranch_vccz L_hssm_gok
    s_sleep 4
    buffer_load_dwordx4 v[32:35], v10, s[56:59], s18 offen sc1
    s_add_u32 s68, s19, 0
    buffer_load_dwordx2 v[208:209], v13, s[52:55], s68 offen offset:0 sc1
    buffer_load_dwordx2 v[210:211], v13, s[52:55], s68 offen offset:2048 sc1
    s_add_u32 s68, s19, 4096
    buffer_load_dwordx2 v[212:213], v13, s[52:55], s68 offen offset:0 sc1
    buffer_load_dwordx2 v[214:215], v13, s[52:55], s68 offen offset:2048 sc1
    s_add_u32 s68, s19, 8192
    buffer_load_dwordx2 v[216:217], v13, s[52:55], s68 offen offset:0 sc1
    buffer_load_dwordx2 v[218:219], v13, s[52:55], s68 offen offset:2048 sc1
    s_add_u32 s68, s19, 12288
    buffer_load_dwordx2 v[220:221], v13, s[52:55], s68 offen offset:0 sc1
    buffer_load_dwordx2 v[222:223], v13, s[52:55], s68 offen offset:2048 sc1
    s_waitcnt vmcnt(0)
    s_add_u32 s71, s71, 1
    s_cmp_lt_u32 s71, 0x200000
    s_cbranch_scc1 L_hssm_g
L_hssm_gok:
    s_lshl_b32 s69, s65, 8
    v_rcp_f32 v33, v34
    s_add_u32 s68, s69, 161792
    v_add_u32 v10, s68, v9
    v_mul_f32 v32, v32, v33
    ds_write_b32 v10, v33
    ds_write_b32 v10, v32 offset:1024
    v_add_f32 v208, v208, v210
    v_add_f32 v208, v208, v212
    v_add_f32 v208, v208, v214
    v_add_f32 v208, v208, v216
    v_add_f32 v208, v208, v218
    v_add_f32 v208, v208, v220
    v_add_f32 v208, v208, v222
    s_add_u32 s68, s69, 156160
    v_add_u32 v10, s68, v9
    ds_write_b32 v10, v208
    s_waitcnt lgkmcnt(0)
    v_mov_b32 v253, 11
    ds_write_b32 v15, v253 offset:32
    s_load_dwordx2 s[12:13], s[0:1], 0
    s_load_dwordx2 s[10:11], s[0:1], 64
    s_add_u32 s56, s34, 0xf00000
    s_addc_u32 s57, s35, 0
    s_mov_b32 s58, 65536
    s_mov_b32 s59, 0x00020000
    s_lshl_b32 s68, s63, 6
    s_lshl_b32 s69, s65, 4
    s_add_u32 s68, s68, s69
    s_mul_i32 s69, s68, 1280
    s_mul_i32 s70, s64, 160
    s_add_u32 s69, s69, s70
    s_lshl_b32 s77, s69, 1
    s_lshl_b32 s78, s68, 5
    v_and_b32 v5, 15, v0
    v_lshrrev_b32 v6, 4, v0
    v_mul_u32_u24 v14, 2560, v5
    v_lshl_add_u32 v14, v6, 4, v14
    v_lshlrev_b32 v13, 5, v5
    s_waitcnt lgkmcnt(0)
    s_mov_b32 s52, s12
    s_mov_b32 s53, s13
    s_mov_b32 s54, 2621440
    s_mov_b32 s55, 0x00020000
    v_add_u32 v5, 0, v0
    v_mul_u32_u24 v6, 6554, v5
    v_lshrrev_b32 v6, 16, v6
    v_mul_u32_u24 v6, 1120, v6
    v_lshl_add_u32 v6, v5, 4, v6
    buffer_load_dwordx4 v[28:31], v6, s[52:55], s69 offen
    v_add_u32 v5, 64, v0
    v_mul_u32_u24 v6, 6554, v5
    v_lshrrev_b32 v6, 16, v6
    v_mul_u32_u24 v6, 1120, v6
    v_lshl_add_u32 v6, v5, 4, v6
    buffer_load_dwordx4 v[32:35], v6, s[52:55], s69 offen
    v_add_u32 v5, 128, v0
    v_min_u32 v5, 159, v5
    v_mul_u32_u24 v6, 6554, v5
    v_lshrrev_b32 v6, 16, v6
    v_mul_u32_u24 v6, 1120, v6
    v_lshl_add_u32 v6, v5, 4, v6
    buffer_load_dwordx4 v[36:39], v6, s[52:55], s69 offen
    s_mov_b32 s52, s10
    s_mov_b32 s53, s11
    s_mov_b32 s54, 1280
    s_mov_b32 s55, 0x00020000
    v_min_u32 v5, 9, v0
    v_lshlrev_b32 v5, 4, v5
    buffer_load_dwordx4 v[40:43], v5, s[52:55], s70 offen
    buffer_load_dwordx4 v[44:47], v13, s[56:59], s78 offen sc1
    s_cmp_lt_u32 s65, 2
    s_cbranch_scc1 L_hssm_c
    s_setprio 2
    v_lshlrev_b32 v3, 3, v0
    v_add_u32 v3, 147456, v3
    s_cmp_eq_u32 s65, 3
    s_cbranch_scc1 L_x_gather
    ds_read_b64 v[60:61], v3 offset:9728
    v_mov_b32 v97, s66
    v_mov_b32 v99, s66
L_x_s1:
    ds_read_b128 v[4:7], v251 offset:48
    s_waitcnt lgkmcnt(0)
    v_min3_u32 v4, v4, v5, v6
    v_min_u32 v4, v4, v7
    v_cmp_gt_u32 vcc, 11, v4
    s_cbranch_vccz L_x_s1x
    s_sleep 1
    s_add_u32 s67, s67, 1
    s_cmp_lt_u32 s67, 0x2000000
    s_cbranch_scc1 L_x_s1
L_x_s1x:
    ds_read_b64 v[64:65], v3 offset:0
    ds_read_b64 v[66:67], v3 offset:512
    ds_read_b64 v[68:69], v3 offset:1024
    ds_read_b64 v[70:71], v3 offset:1536
    ds_read_b64 v[72:73], v3 offset:2048
    ds_read_b64 v[74:75], v3 offset:2560
    ds_read_b64 v[76:77], v3 offset:3072
    ds_read_b64 v[78:79], v3 offset:3584
    ds_read_b64 v[80:81], v3 offset:4096
    ds_read_b64 v[82:83], v3 offset:4608
    ds_read_b64 v[84:85], v3 offset:5120
    ds_read_b64 v[86:87], v3 offset:5632
    ds_read_b64 v[88:89], v3 offset:6144
    ds_read_b64 v[90:91], v3 offset:6656
    ds_read_b64 v[92:93], v3 offset:7168
    ds_read_b64 v[94:95], v3 offset:7680
    s_waitcnt lgkmcnt(14)
    v_pk_fma_f32 v[58:59], v[60:61], v[64:65], v[66:67] op_sel:[0,0,0] op_sel_hi:[0,1,1]
    s_nop 0
    v_pk_fma_f32 v[66:67], v[60:61], v[64:65], v[58:59] op_sel:[1,1,0] op_sel_hi:[1,0,1] neg_lo:[1,0,0]
    s_waitcnt lgkmcnt(13)
    v_pk_fma_f32 v[58:59], v[60:61], v[66:67], v[68:69] op_sel:[0,0,0] op_sel_hi:[0,1,1]
    s_nop 0
    v_pk_fma_f32 v[68:69], v[60:61], v[66:67], v[58:59] op_sel:[1,1,0] op_sel_hi:[1,0,1] neg_lo:[1,0,0]
    s_waitcnt lgkmcnt(12)
    v_pk_fma_f32 v[58:59], v[60:61], v[68:69], v[70:71] op_sel:[0,0,0] op_sel_hi:[0,1,1]
    s_nop 0
    v_pk_fma_f32 v[70:71], v[60:61], v[68:69], v[58:59] op_sel:[1,1,0] op_sel_hi:[1,0,1] neg_lo:[1,0,0]
    s_waitcnt lgkmcnt(11)
    v_pk_fma_f32 v[58:59], v[60:61], v[70:71], v[72:73] op_sel:[0,0,0] op_sel_hi:[0,1,1]
    s_nop 0
    v_pk_fma_f32 v[72:73], v[60:61], v[70:71], v[58:59] op_sel:[1,1,0] op_sel_hi:[1,0,1] neg_lo:[1,0,0]
    s_waitcnt lgkmcnt(10)
    v_pk_fma_f32 v[58:59], v[60:61], v[72:73], v[74:75] op_sel:[0,0,0] op_sel_hi:[0,1,1]
    s_nop 0
    v_pk_fma_f32 v[74:75], v[60:61], v[72:73], v[58:59] op_sel:[1,1,0] op_sel_hi:[1,0,1] neg_lo:[1,0,0]
    s_waitcnt lgkmcnt(9)
    v_pk_fma_f32 v[58:59], v[60:61], v[74:75], v[76:77] op_sel:[0,0,0] op_sel_hi:[0,1,1]
    s_nop 0
    v_pk_fma_f32 v[76:77], v[60:61], v[74:75], v[58:59] op_sel:[1,1,0] op_sel_hi:[1,0,1] neg_lo:[1,0,0]
    s_waitcnt lgkmcnt(8)
    v_pk_fma_f32 v[58:59], v[60:61], v[76:77], v[78:79] op_sel:[0,0,0] op_sel_hi:[0,1,1]
    s_nop 0
    v_pk_fma_f32 v[78:79], v[60:61], v[76:77], v[58:59] op_sel:[1,1,0] op_sel_hi:[1,0,1] neg_lo:[1,0,0]
    s_waitcnt lgkmcnt(7)
    v_pk_fma_f32 v[58:59], v[60:61], v[78:79], v[80:81] op_sel:[0,0,0] op_sel_hi:[0,1,1]
    s_nop 0
    v_pk_fma_f32 v[80:81], v[60:61], v[78:79], v[58:59] op_sel:[1,1,0] op_sel_hi:[1,0,1] neg_lo:[1,0,0]
    s_waitcnt lgkmcnt(6)
    v_pk_fma_f32 v[58:59], v[60:61], v[80:81], v[82:83] op_sel:[0,0,0] op_sel_hi:[0,1,1]
    s_nop 0
    v_pk_fma_f32 v[82:83], v[60:61], v[80:81], v[58:59] op_sel:[1,1,0] op_sel_hi:[1,0,1] neg_lo:[1,0,0]
    s_waitcnt lgkmcnt(5)
    v_pk_fma_f32 v[58:59], v[60:61], v[82:83], v[84:85] op_sel:[0,0,0] op_sel_hi:[0,1,1]
    s_nop 0
    v_pk_fma_f32 v[84:85], v[60:61], v[82:83], v[58:59] op_sel:[1,1,0] op_sel_hi:[1,0,1] neg_lo:[1,0,0]
    s_waitcnt lgkmcnt(4)
    v_pk_fma_f32 v[58:59], v[60:61], v[84:85], v[86:87] op_sel:[0,0,0] op_sel_hi:[0,1,1]
    s_nop 0
    v_pk_fma_f32 v[86:87], v[60:61], v[84:85], v[58:59] op_sel:[1,1,0] op_sel_hi:[1,0,1] neg_lo:[1,0,0]
    s_waitcnt lgkmcnt(3)
    v_pk_fma_f32 v[58:59], v[60:61], v[86:87], v[88:89] op_sel:[0,0,0] op_sel_hi:[0,1,1]
    s_nop 0
    v_pk_fma_f32 v[88:89], v[60:61], v[86:87], v[58:59] op_sel:[1,1,0] op_sel_hi:[1,0,1] neg_lo:[1,0,0]
    s_waitcnt lgkmcnt(2)
    v_pk_fma_f32 v[58:59], v[60:61], v[88:89], v[90:91] op_sel:[0,0,0] op_sel_hi:[0,1,1]
    s_nop 0
    v_pk_fma_f32 v[90:91], v[60:61], v[88:89], v[58:59] op_sel:[1,1,0] op_sel_hi:[1,0,1] neg_lo:[1,0,0]
    s_waitcnt lgkmcnt(1)
    v_pk_fma_f32 v[58:59], v[60:61], v[90:91], v[92:93] op_sel:[0,0,0] op_sel_hi:[0,1,1]
    s_nop 0
    v_pk_fma_f32 v[92:93], v[60:61], v[90:91], v[58:59] op_sel:[1,1,0] op_sel_hi:[1,0,1] neg_lo:[1,0,0]
    s_waitcnt lgkmcnt(0)
    v_pk_fma_f32 v[58:59], v[60:61], v[92:93], v[94:95] op_sel:[0,0,0] op_sel_hi:[0,1,1]
    s_nop 0
    v_pk_fma_f32 v[94:95], v[60:61], v[92:93], v[58:59] op_sel:[1,1,0] op_sel_hi:[1,0,1] neg_lo:[1,0,0]
    s_nop 0
    v_mov_b32 v96, v94
    v_mov_b32 v98, v95
    buffer_store_dwordx4 v[96:99], v1, s[48:51], s79 offen sc1
    v_mov_b32 v58, 0
    v_mov_b32 v59, 0
    ds_write_b64 v3, v[58:59]
    ds_write_b64 v3, v[64:65] offset:512
    ds_write_b64 v3, v[66:67] offset:1024
    ds_write_b64 v3, v[68:69] offset:1536
    ds_write_b64 v3, v[70:71] offset:2048
    ds_write_b64 v3, v[72:73] offset:2560
    ds_write_b64 v3, v[74:75] offset:3072
    ds_write_b64 v3, v[76:77] offset:3584
    ds_write_b64 v3, v[78:79] offset:4096
    ds_write_b64 v3, v[80:81] offset:4608
    ds_write_b64 v3, v[82:83] offset:5120
    ds_write_b64 v3, v[84:85] offset:5632
    ds_write_b64 v3, v[86:87] offset:6144
    ds_write_b64 v3, v[88:89] offset:6656
    ds_write_b64 v3, v[90:91] offset:7168
    ds_write_b64 v3, v[92:93] offset:7680
    s_branch L_x_done
L_x_gather:
    ds_read_b64 v[60:61], v3 offset:10240
    s_sub_u32 s69, s79, 1024
    s_cmp_ge_u32 s60, 1
    s_cselect_b32 s80, s66, 0
    s_cselect_b32 s18, s69, 0x10000
    s_sub_u32 s69, s79, 2048
    s_cmp_ge_u32 s60, 2
    s_cselect_b32 s81, s66, 0
    s_cselect_b32 s19, s69, 0x10000
    s_sub_u32 s69, s79, 3072
    s_cmp_ge_u32 s60, 3
    s_cselect_b32 s82, s66, 0
    s_cselect_b32 s20, s69, 0x10000
    s_sub_u32 s69, s79, 4096
    s_cmp_ge_u32 s60, 4
    s_cselect_b32 s83, s66, 0
    s_cselect_b32 s21, s69, 0x10000
    s_sub_u32 s69, s79, 5120
    s_cmp_ge_u32 s60, 5
    s_cselect_b32 s84, s66, 0
    s_cselect_b32 s22, s69, 0x10000
    s_sub_u32 s69, s79, 6144
    s_cmp_ge_u32 s60, 6
    s_cselect_b32 s85, s66, 0
    s_cselect_b32 s23, s69, 0x10000
    s_sub_u32 s69, s79, 7168
    s_cmp_ge_u32 s60, 7
    s_cselect_b32 s86, s66, 0
    s_cselect_b32 s24, s69, 0x10000
    s_mov_b32 s69, 0
L_x_s0:
    ds_read_b128 v[4:7], v251 offset:48
    s_waitcnt lgkmcnt(0)
    v_min3_u32 v4, v4, v5, v6
    v_min_u32 v4, v4, v7
    v_cmp_gt_u32 vcc, 10, v4
    s_cbranch_vccz L_x_s0x
    s_sleep 1
    s_add_u32 s67, s67, 1
    s_cmp_lt_u32 s67, 0x2000000
    s_cbranch_scc1 L_x_s0
L_x_s0x:
L_x_poll:
    buffer_load_dwordx4 v[100:103], v1, s[48:51], s18 offen sc1
    buffer_load_dwordx4 v[104:107], v1, s[48:51], s19 offen sc1
    buffer_load_dwordx4 v[108:111], v1, s[48:51], s20 offen sc1
    buffer_load_dwordx4 v[112:115], v1, s[48:51], s21 offen sc1
    buffer_load_dwordx4 v[116:119], v1, s[48:51], s22 offen sc1
    buffer_load_dwordx4 v[120:123], v1, s[48:51], s23 offen sc1
    buffer_load_dwordx4 v[124:127], v1, s[48:51], s24 offen sc1
    s_waitcnt vmcnt(0)
    v_mov_b32 v58, 0
    v_xor_b32 v59, s80, v101
    v_xor_b32 v57, s80, v103
    v_or3_b32 v58, v58, v59, v57
    v_xor_b32 v59, s81, v105
    v_xor_b32 v57, s81, v107
    v_or3_b32 v58, v58, v59, v57
    v_xor_b32 v59, s82, v109
    v_xor_b32 v57, s82, v111
    v_or3_b32 v58, v58, v59, v57
    v_xor_b32 v59, s83, v113
    v_xor_b32 v57, s83, v115
    v_or3_b32 v58, v58, v59, v57
    v_xor_b32 v59, s84, v117
    v_xor_b32 v57, s84, v119
    v_or3_b32 v58, v58, v59, v57
    v_xor_b32 v59, s85, v121
    v_xor_b32 v57, s85, v123
    v_or3_b32 v58, v58, v59, v57
    v_xor_b32 v59, s86, v125
    v_xor_b32 v57, s86, v127
    v_or3_b32 v58, v58, v59, v57
    v_cmp_ne_u32 vcc, 0, v58
    s_cbranch_vccz L_x_ok
    s_sleep 3
    s_add_u32 s69, s69, 1
    s_cmp_lt_u32 s69, 0x200000
    s_cbranch_scc1 L_x_poll
L_x_ok:
    v_mov_b32 v101, v102
    v_mov_b32 v105, v106
    v_mov_b32 v109, v110
    v_mov_b32 v113, v114
    v_mov_b32 v117, v118
    v_mov_b32 v121, v122
    v_mov_b32 v125, v126
    v_pk_fma_f32 v[58:59], v[60:61], v[124:125], v[120:121] op_sel:[0,0,0] op_sel_hi:[0,1,1]
    s_nop 0
    v_pk_fma_f32 v[120:121], v[60:61], v[124:125], v[58:59] op_sel:[1,1,0] op_sel_hi:[1,0,1] neg_lo:[1,0,0]
    s_nop 0
    v_pk_fma_f32 v[58:59], v[60:61], v[120:121], v[116:117] op_sel:[0,0,0] op_sel_hi:[0,1,1]
    s_nop 0
    v_pk_fma_f32 v[116:117], v[60:61], v[120:121], v[58:59] op_sel:[1,1,0] op_sel_hi:[1,0,1] neg_lo:[1,0,0]
    s_nop 0
    v_pk_fma_f32 v[58:59], v[60:61], v[116:117], v[112:113] op_sel:[0,0,0] op_sel_hi:[0,1,1]
    s_nop 0
    v_pk_fma_f32 v[112:113], v[60:61], v[116:117], v[58:59] op_sel:[1,1,0] op_sel_hi:[1,0,1] neg_lo:[1,0,0]
    s_nop 0
    v_pk_fma_f32 v[58:59], v[60:61], v[112:113], v[108:109] op_sel:[0,0,0] op_sel_hi:[0,1,1]
    s_nop 0
    v_pk_fma_f32 v[108:109], v[60:61], v[112:113], v[58:59] op_sel:[1,1,0] op_sel_hi:[1,0,1] neg_lo:[1,0,0]
    s_nop 0
    v_pk_fma_f32 v[58:59], v[60:61], v[108:109], v[104:105] op_sel:[0,0,0] op_sel_hi:[0,1,1]
    s_nop 0
    v_pk_fma_f32 v[104:105], v[60:61], v[108:109], v[58:59] op_sel:[1,1,0] op_sel_hi:[1,0,1] neg_lo:[1,0,0]
    s_nop 0
    v_pk_fma_f32 v[58:59], v[60:61], v[104:105], v[100:101] op_sel:[0,0,0] op_sel_hi:[0,1,1]
    s_nop 0
    v_pk_fma_f32 v[100:101], v[60:61], v[104:105], v[58:59] op_sel:[1,1,0] op_sel_hi:[1,0,1] neg_lo:[1,0,0]
    ds_write_b64 v3, v[100:101] offset:8192
L_x_done:
    v_mov_b32 v253, 12
    ds_write_b32 v15, v253 offset:32
    s_setprio 0
    s_waitcnt lgkmcnt(0)
L_hssm_pause:
    ds_read_b32 v253, v251 offset:40
    s_waitcnt lgkmcnt(0)
    v_readfirstlane_b32 s73, v253
    s_nop 0
    s_cmp_ge_u32 s73, 12
    s_cbranch_scc1 L_hssm_pausex
    s_sleep 3
    s_add_u32 s67, s67, 1
    s_cmp_lt_u32 s67, 0x2000000
    s_cbranch_scc1 L_hssm_pause
L_hssm_pausex:
L_hssm_pause2:
    ds_read_b32 v253, v251 offset:44
    s_waitcnt lgkmcnt(0)
    v_readfirstlane_b32 s73, v253
    s_nop 0
    s_cmp_ge_u32 s73, 12
    s_cbranch_scc1 L_hssm_pause2x
    s_sleep 3
    s_add_u32 s67, s67, 1
    s_cmp_lt_u32 s67, 0x2000000
    s_cbranch_scc1 L_hssm_pause2
L_hssm_pause2x:
    s_add_u32 s44, s34, 0xf60000
    s_addc_u32 s45, s35, 0
    s_mov_b32 s46, 65536
    s_mov_b32 s47, 0x00020000
    s_mul_i32 s72, s64, 276480
    s_add_u32 s72, s72, 0xc00000
    s_add_u32 s36, s34, s72
    s_addc_u32 s37, s35, 0
    s_mov_b32 s38, 276480
    s_mov_b32 s39, 0x00020000
    s_add_u32 s72, s72, 10240
    s_add_u32 s40, s34, s72
    s_addc_u32 s41, s35, 0
    s_mov_b32 s42, 266240
    s_mov_b32 s43, 0x00020000
    v_add_u32 v16, 0, v1
    v_add_u32 v17, 1024, v1
    v_add_u32 v18, 2048, v1
    v_add_u32 v19, 3072, v1
    v_add_u32 v20, 4096, v1
    v_add_u32 v21, 5120, v1
    v_add_u32 v22, 6144, v1
    v_add_u32 v23, 7168, v1
    v_add_u32 v24, 8192, v1
    v_add_u32 v25, 9216, v1
    s_mul_i32 s4, s65, 122880
    s_sub_u32 s4, s4, 204800
    s_lshr_b32 s68, s65, 1
    s_mul_i32 s68, s68, 10240
    s_sub_u32 s4, s4, s68
    s_movk_i32 s5, 20480
    s_cmp_eq_u32 s65, 1
    s_cselect_b32 s70, 5, 23
    v_min_u32 v11, s70, v0
    v_lshlrev_b32 v11, 7, v11
    s_mul_i32 s70, s65, 3072
    s_sub_u32 s70, s70, 5376
    s_max_i32 s70, s70, 0
    s_lshl_b32 s68, s64, 13
    s_add_u32 s68, s68, s70
    s_mov_b32 s70, 0
L_f2ssm:
    buffer_load_dword v253, v11, s[44:47], s68 offen sc1
    s_waitcnt vmcnt(0)
    v_cmp_ne_u32 vcc, s66, v253
    s_cbranch_vccz L_f2okssm
    s_sleep 8
    s_add_u32 s70, s70, 1
    s_cmp_lt_u32 s70, 0x200000
    s_cbranch_scc1 L_f2ssm
L_f2okssm:
L_hssm_c:
    s_bfe_u32 s73, s92, 0x40008
    s_bitcmp1_b32 s73, 0
    s_cselect_b64 s[24:25], s[40:41], s[36:37]
    s_cselect_b32 s26, s42, s38
    s_lshr_b32 s73, s73, 1
    s_mul_i32 s74, s5, s73
    s_add_u32 s74, s74, s4
    buffer_load_dwordx4 v[48:51], v16, s[24:27], s74 offen sc1
    buffer_load_dwordx4 v[52:55], v17, s[24:27], s74 offen sc1
    buffer_load_dwordx4 v[56:59], v18, s[24:27], s74 offen sc1
    buffer_load_dwordx4 v[60:63], v19, s[24:27], s74 offen sc1
    buffer_load_dwordx4 v[64:67], v20, s[24:27], s74 offen sc1
    buffer_load_dwordx4 v[68:71], v21, s[24:27], s74 offen sc1
    buffer_load_dwordx4 v[72:75], v22, s[24:27], s74 offen sc1
    buffer_load_dwordx4 v[76:79], v23, s[24:27], s74 offen sc1
    buffer_load_dwordx4 v[80:83], v24, s[24:27], s74 offen sc1
    buffer_load_dwordx4 v[84:87], v25, s[24:27], s74 offen sc1
L_hssm_e0:
    ds_read_b128 v[4:7], v251 offset:48
    s_waitcnt lgkmcnt(0)
    v_min3_u32 v4, v4, v5, v6
    v_min_u32 v4, v4, v7
    v_cmp_gt_u32 vcc, 8, v4
    s_cbranch_vccz L_hssm_e0x
    s_sleep 1
    s_add_u32 s67, s67, 1
    s_cmp_lt_u32 s67, 0x2000000
    s_cbranch_scc1 L_hssm_e0
L_hssm_e0x:
    s_bfe_u32 s73, s92, 0x40000
    s_bitcmp1_b32 s73, 0
    s_cselect_b64 s[24:25], s[40:41], s[36:37]
    s_cselect_b32 s26, s42, s38
    s_lshr_b32 s73, s73, 1
    s_mul_i32 s74, s5, s73
    s_add_u32 s74, s74, s4
    s_add_u32 m0, s7, 0
    s_nop 0
    buffer_load_dwordx4 v16, s[24:27], s74 offen sc1 lds
    s_add_u32 m0, s7, 1024
    s_nop 0
    buffer_load_dwordx4 v17, s[24:27], s74 offen sc1 lds
    s_add_u32 m0, s7, 2048
    s_nop 0
    buffer_load_dwordx4 v18, s[24:27], s74 offen sc1 lds
    s_add_u32 m0, s7, 3072
    s_nop 0
    buffer_load_dwordx4 v19, s[24:27], s74 offen sc1 lds
    s_add_u32 m0, s7, 4096
    s_nop 0
    buffer_load_dwordx4 v20, s[24:27], s74 offen sc1 lds
    s_add_u32 m0, s7, 5120
    s_nop 0
    buffer_load_dwordx4 v21, s[24:27], s74 offen sc1 lds
    s_add_u32 m0, s7, 6144
    s_nop 0
    buffer_load_dwordx4 v22, s[24:27], s74 offen sc1 lds
    s_add_u32 m0, s7, 7168
    s_nop 0
    buffer_load_dwordx4 v23, s[24:27], s74 offen sc1 lds
    s_add_u32 m0, s7, 8192
    s_nop 0
    buffer_load_dwordx4 v24, s[24:27], s74 offen sc1 lds
    s_add_u32 m0, s7, 9216
    s_nop 0
    buffer_load_dwordx4 v25, s[24:27], s74 offen sc1 lds
    s_bfe_u32 s73, s92, 0x4000c
    s_bitcmp1_b32 s73, 0
    s_cselect_b64 s[24:25], s[40:41], s[36:37]
    s_cselect_b32 s26, s42, s38
    s_lshr_b32 s73, s73, 1
    s_mul_i32 s74, s5, s73
    s_add_u32 s74, s74, s4
    buffer_load_dwordx4 v[88:91], v16, s[24:27], s74 offen sc1
    buffer_load_dwordx4 v[92:95], v17, s[24:27], s74 offen sc1
    buffer_load_dwordx4 v[96:99], v18, s[24:27], s74 offen sc1
    buffer_load_dwordx4 v[100:103], v19, s[24:27], s74 offen sc1
    buffer_load_dwordx4 v[104:107], v20, s[24:27], s74 offen sc1
    buffer_load_dwordx4 v[108:111], v21, s[24:27], s74 offen sc1
    buffer_load_dwordx4 v[112:115], v22, s[24:27], s74 offen sc1
    buffer_load_dwordx4 v[116:119], v23, s[24:27], s74 offen sc1
    buffer_load_dwordx4 v[120:123], v24, s[24:27], s74 offen sc1
    buffer_load_dwordx4 v[124:127], v25, s[24:27], s74 offen sc1
L_hssm_e1:
    ds_read_b128 v[4:7], v251 offset:48
    s_waitcnt lgkmcnt(0)
    v_min3_u32 v4, v4, v5, v6
    v_min_u32 v4, v4, v7
    v_cmp_gt_u32 vcc, 9, v4
    s_cbranch_vccz L_hssm_e1x
    s_sleep 1
    s_add_u32 s67, s67, 1
    s_cmp_lt_u32 s67, 0x2000000
    s_cbranch_scc1 L_hssm_e1
L_hssm_e1x:
    s_bfe_u32 s73, s92, 0x40004
    s_bitcmp1_b32 s73, 0
    s_cselect_b64 s[24:25], s[40:41], s[36:37]
    s_cselect_b32 s26, s42, s38
    s_lshr_b32 s73, s73, 1
    s_mul_i32 s74, s5, s73
    s_add_u32 s74, s74, s4
    s_add_u32 m0, s8, 0
    s_nop 0
    buffer_load_dwordx4 v16, s[24:27], s74 offen sc1 lds
    s_add_u32 m0, s8, 1024
    s_nop 0
    buffer_load_dwordx4 v17, s[24:27], s74 offen sc1 lds
    s_add_u32 m0, s8, 2048
    s_nop 0
    buffer_load_dwordx4 v18, s[24:27], s74 offen sc1 lds
    s_add_u32 m0, s8, 3072
    s_nop 0
    buffer_load_dwordx4 v19, s[24:27], s74 offen sc1 lds
    s_add_u32 m0, s8, 4096
    s_nop 0
    buffer_load_dwordx4 v20, s[24:27], s74 offen sc1 lds
    s_add_u32 m0, s8, 5120
    s_nop 0
    buffer_load_dwordx4 v21, s[24:27], s74 offen sc1 lds
    s_add_u32 m0, s8, 6144
    s_nop 0
    buffer_load_dwordx4 v22, s[24:27], s74 offen sc1 lds
    s_add_u32 m0, s8, 7168
    s_nop 0
    buffer_load_dwordx4 v23, s[24:27], s74 offen sc1 lds
    s_add_u32 m0, s8, 8192
    s_nop 0
    buffer_load_dwordx4 v24, s[24:27], s74 offen sc1 lds
    s_add_u32 m0, s8, 9216
    s_nop 0
    buffer_load_dwordx4 v25, s[24:27], s74 offen sc1 lds
    s_bfe_u32 s73, s92, 0x40010
    s_bitcmp1_b32 s73, 0
    s_cselect_b64 s[24:25], s[40:41], s[36:37]
    s_cselect_b32 s26, s42, s38
    s_lshr_b32 s73, s73, 1
    s_mul_i32 s74, s5, s73
    s_add_u32 s74, s74, s4
    buffer_load_dwordx4 v[128:131], v16, s[24:27], s74 offen sc1
    buffer_load_dwordx4 v[132:135], v17, s[24:27], s74 offen sc1
    buffer_load_dwordx4 v[136:139], v18, s[24:27], s74 offen sc1
    buffer_load_dwordx4 v[140:143], v19, s[24:27], s74 offen sc1
    buffer_load_dwordx4 v[144:147], v20, s[24:27], s74 offen sc1
    buffer_load_dwordx4 v[148:151], v21, s[24:27], s74 offen sc1
    buffer_load_dwordx4 v[152:155], v22, s[24:27], s74 offen sc1
    buffer_load_dwordx4 v[156:159], v23, s[24:27], s74 offen sc1
    buffer_load_dwordx4 v[160:163], v24, s[24:27], s74 offen sc1
    buffer_load_dwordx4 v[164:167], v25, s[24:27], s74 offen sc1
    s_waitcnt vmcnt(10)
    v_mov_b32 v253, 2
    ds_write_b32 v15, v253
    s_bfe_u32 s73, s92, 0x40014
    s_bitcmp1_b32 s73, 0
    s_cselect_b64 s[24:25], s[40:41], s[36:37]
    s_cselect_b32 s26, s42, s38
    s_lshr_b32 s73, s73, 1
    s_mul_i32 s74, s5, s73
    s_add_u32 s74, s74, s4
    buffer_load_dwordx4 v[168:171], v16, s[24:27], s74 offen sc1
    buffer_load_dwordx4 v[172:175], v17, s[24:27], s74 offen sc1
    buffer_load_dwordx4 v[176:179], v18, s[24:27], s74 offen sc1
    buffer_load_dwordx4 v[180:183], v19, s[24:27], s74 offen sc1
    buffer_load_dwordx4 v[184:187], v20, s[24:27], s74 offen sc1
    buffer_load_dwordx4 v[188:191], v21, s[24:27], s74 offen sc1
    buffer_load_dwordx4 v[192:195], v22, s[24:27], s74 offen sc1
    buffer_load_dwordx4 v[196:199], v23, s[24:27], s74 offen sc1
    buffer_load_dwordx4 v[200:203], v24, s[24:27], s74 offen sc1
    buffer_load_dwordx4 v[204:207], v25, s[24:27], s74 offen sc1
    s_bfe_u32 s73, s92, 0x40018
    s_bitcmp1_b32 s73, 0
    s_cselect_b64 s[24:25], s[40:41], s[36:37]
    s_cselect_b32 s26, s42, s38
    s_lshr_b32 s73, s73, 1
    s_mul_i32 s74, s5, s73
    s_add_u32 s74, s74, s4
    buffer_load_dwordx4 v[208:211], v16, s[24:27], s74 offen sc1
    buffer_load_dwordx4 v[212:215], v17, s[24:27], s74 offen sc1
    buffer_load_dwordx4 v[216:219], v18, s[24:27], s74 offen sc1
    buffer_load_dwordx4 v[220:223], v19, s[24:27], s74 offen sc1
    buffer_load_dwordx4 v[224:227], v20, s[24:27], s74 offen sc1
    buffer_load_dwordx4 v[228:231], v21, s[24:27], s74 offen sc1
    buffer_load_dwordx4 v[232:235], v22, s[24:27], s74 offen sc1
    buffer_load_dwordx4 v[236:239], v23, s[24:27], s74 offen sc1
    buffer_load_dwordx4 v[240:243], v24, s[24:27], s74 offen sc1
    buffer_load_dwordx4 v[244:247], v25, s[24:27], s74 offen sc1
    s_branch L_h_p2
L_h_p2:
L_h_e4:
    ds_read_b128 v[4:7], v251 offset:48
    s_waitcnt lgkmcnt(0)
    v_min3_u32 v4, v4, v5, v6
    v_min_u32 v4, v4, v7
    v_cmp_gt_u32 vcc, 10, v4
    s_cbranch_vccz L_h_e4x
    s_sleep 1
    s_add_u32 s67, s67, 1
    s_cmp_lt_u32 s67, 0x2000000
    s_cbranch_scc1 L_h_e4
L_h_e4x:
L_h_fre2:
    ds_read_b32 v253, v15 offset:16
    s_waitcnt lgkmcnt(0)
    v_readfirstlane_b32 s73, v253
    s_nop 0
    s_cmp_ge_u32 s73, 1
    s_cbranch_scc1 L_h_fre2x
    s_sleep 3
    s_add_u32 s67, s67, 1
    s_cmp_lt_u32 s67, 0x2000000
    s_cbranch_scc1 L_h_fre2
L_h_fre2x:
    ds_write_b128 v248, v[28:31] offset:0
    ds_write_b128 v248, v[32:35] offset:1024
    ds_write_b128 v248, v[36:39] offset:2048
    ds_write_b128 v248, v[40:43] offset:3072
    v_and_b32 v5, 15, v0
    v_lshrrev_b32 v6, 4, v0
    v_lshlrev_b32 v6, 3, v6
    v_add_u32 v6, s6, v6
    v_mul_u32_u24 v5, 160, v5
    v_add_u32 v5, v5, v6
L_xr_st:
    v_xor_b32 v8, s66, v45
    v_xor_b32 v9, s66, v47
    v_or_b32 v8, v8, v9
    v_cmp_ne_u32 vcc, 0, v8
    s_cbranch_vccz L_xr_ok
    buffer_load_dwordx4 v[44:47], v13, s[56:59], s78 offen sc1
    s_waitcnt vmcnt(0)
    s_add_u32 s67, s67, 16
    s_cmp_lt_u32 s67, 0x2000000
    s_cbranch_scc1 L_xr_st
L_xr_ok:
    v_mov_b32 v8, v44
    v_rcp_f32 v9, v46
    s_waitcnt lgkmcnt(0)
    ds_read_b64 v[26:27], v5 offset:0
    ds_read_b64 v[36:37], v6 offset:3072
    ds_read_b64 v[28:29], v5 offset:32
    ds_read_b64 v[38:39], v6 offset:3104
    ds_read_b64 v[30:31], v5 offset:64
    ds_read_b64 v[40:41], v6 offset:3136
    ds_read_b64 v[32:33], v5 offset:96
    ds_read_b64 v[42:43], v6 offset:3168
    ds_read_b64 v[34:35], v5 offset:128
    ds_read_b64 v[44:45], v6 offset:3200
    s_mov_b32 s70, 0xffff0000
    s_waitcnt lgkmcnt(0)
    s_waitcnt vmcnt(40)
    ds_write_b128 v248, v[48:51] offset:0
    ds_write_b128 v248, v[52:55] offset:1024
    ds_write_b128 v248, v[56:59] offset:2048
    ds_write_b128 v248, v[60:63] offset:3072
    ds_write_b128 v248, v[64:67] offset:4096
    ds_write_b128 v248, v[68:71] offset:5120
    ds_write_b128 v248, v[72:75] offset:6144
    ds_write_b128 v248, v[76:79] offset:7168
    ds_write_b128 v248, v[80:83] offset:8192
    ds_write_b128 v248, v[84:87] offset:9216
    v_mov_b32 v253, 3
    ds_write_b32 v15, v253
    s_waitcnt lgkmcnt(0)
    s_bfe_u32 s73, s92, 0x4001c
    s_bitcmp1_b32 s73, 0
    s_cselect_b64 s[24:25], s[40:41], s[36:37]
    s_cselect_b32 s26, s42, s38
    s_lshr_b32 s73, s73, 1
    s_mul_i32 s74, s5, s73
    s_add_u32 s74, s74, s4
    buffer_load_dwordx4 v[48:51], v16, s[24:27], s74 offen sc1
    buffer_load_dwordx4 v[52:55], v17, s[24:27], s74 offen sc1
    buffer_load_dwordx4 v[56:59], v18, s[24:27], s74 offen sc1
    buffer_load_dwordx4 v[60:63], v19, s[24:27], s74 offen sc1
    buffer_load_dwordx4 v[64:67], v20, s[24:27], s74 offen sc1
    buffer_load_dwordx4 v[68:71], v21, s[24:27], s74 offen sc1
    buffer_load_dwordx4 v[72:75], v22, s[24:27], s74 offen sc1
    buffer_load_dwordx4 v[76:79], v23, s[24:27], s74 offen sc1
    buffer_load_dwordx4 v[80:83], v24, s[24:27], s74 offen sc1
    buffer_load_dwordx4 v[84:87], v25, s[24:27], s74 offen sc1
L_h_fre3:
    ds_read_b32 v253, v15 offset:16
    s_waitcnt lgkmcnt(0)
    v_readfirstlane_b32 s73, v253
    s_nop 0
    s_cmp_ge_u32 s73, 1
    s_cbranch_scc1 L_h_fre3x
    s_sleep 3
    s_add_u32 s67, s67, 1
    s_cmp_lt_u32 s67, 0x2000000
    s_cbranch_scc1 L_h_fre3
L_h_fre3x:
    s_waitcnt vmcnt(40)
    ds_write_b128 v249, v[88:91] offset:0
    ds_write_b128 v249, v[92:95] offset:1024
    ds_write_b128 v249, v[96:99] offset:2048
    ds_write_b128 v249, v[100:103] offset:3072
    ds_write_b128 v249, v[104:107] offset:4096
    ds_write_b128 v249, v[108:111] offset:5120
    ds_write_b128 v249, v[112:115] offset:6144
    ds_write_b128 v249, v[116:119] offset:7168
    ds_write_b128 v249, v[120:123] offset:8192
    ds_write_b128 v249, v[124:127] offset:9216
    v_mov_b32 v253, 4
    ds_write_b32 v15, v253
    s_cmp_lg_u32 s65, 1
    s_cbranch_scc1 L_h_nosw
    s_add_u32 s44, s34, 0xf60000
    s_addc_u32 s45, s35, 0
    s_mov_b32 s46, 65536
    s_mov_b32 s47, 0x00020000
    s_mul_i32 s72, s64, 276480
    s_add_u32 s72, s72, 0xc00000
    s_add_u32 s36, s34, s72
    s_addc_u32 s37, s35, 0
    s_mov_b32 s38, 276480
    s_mov_b32 s39, 0x00020000
    s_add_u32 s72, s72, 10240
    s_add_u32 s40, s34, s72
    s_addc_u32 s41, s35, 0
    s_mov_b32 s42, 266240
    s_mov_b32 s43, 0x00020000
    v_add_u32 v16, 0, v1
    v_add_u32 v17, 1024, v1
    v_add_u32 v18, 2048, v1
    v_add_u32 v19, 3072, v1
    v_add_u32 v20, 4096, v1
    v_add_u32 v21, 5120, v1
    v_add_u32 v22, 6144, v1
    v_add_u32 v23, 7168, v1
    v_add_u32 v24, 8192, v1
    v_add_u32 v25, 9216, v1
    s_mul_i32 s4, s65, 122880
    s_sub_u32 s4, s4, 204800
    s_lshr_b32 s68, s65, 1
    s_mul_i32 s68, s68, 10240
    s_sub_u32 s4, s4, s68
    s_movk_i32 s5, 20480
    s_cmp_eq_u32 s65, 1
    s_cselect_b32 s70, 5, 23
    v_min_u32 v11, s70, v0
    v_lshlrev_b32 v11, 7, v11
    s_mul_i32 s70, s65, 3072
    s_sub_u32 s70, s70, 5376
    s_max_i32 s70, s70, 0
    s_lshl_b32 s68, s64, 13
    s_add_u32 s68, s68, s70
    s_mov_b32 s70, 0
L_f2b:
    buffer_load_dword v253, v11, s[44:47], s68 offen sc1
    s_waitcnt vmcnt(0)
    v_cmp_ne_u32 vcc, s66, v253
    s_cbranch_vccz L_f2okb
    s_sleep 8
    s_add_u32 s70, s70, 1
    s_cmp_lt_u32 s70, 0x200000
    s_cbranch_scc1 L_f2b
L_f2okb:
L_h_nosw:
    s_waitcnt lgkmcnt(0)
    s_bfe_u32 s73, s93, 0x40000
    s_bitcmp1_b32 s73, 0
    s_cselect_b64 s[24:25], s[40:41], s[36:37]
    s_cselect_b32 s26, s42, s38
    s_lshr_b32 s73, s73, 1
    s_mul_i32 s74, s5, s73
    s_add_u32 s74, s74, s4
    buffer_load_dwordx4 v[88:91], v16, s[24:27], s74 offen sc1
    buffer_load_dwordx4 v[92:95], v17, s[24:27], s74 offen sc1
    buffer_load_dwordx4 v[96:99], v18, s[24:27], s74 offen sc1
    buffer_load_dwordx4 v[100:103], v19, s[24:27], s74 offen sc1
    buffer_load_dwordx4 v[104:107], v20, s[24:27], s74 offen sc1
    buffer_load_dwordx4 v[108:111], v21, s[24:27], s74 offen sc1
    buffer_load_dwordx4 v[112:115], v22, s[24:27], s74 offen sc1
    buffer_load_dwordx4 v[116:119], v23, s[24:27], s74 offen sc1
    buffer_load_dwordx4 v[120:123], v24, s[24:27], s74 offen sc1
    buffer_load_dwordx4 v[124:127], v25, s[24:27], s74 offen sc1
L_h_fre4:
    ds_read_b32 v253, v15 offset:16
    s_waitcnt lgkmcnt(0)
    v_readfirstlane_b32 s73, v253
    s_nop 0
    s_cmp_ge_u32 s73, 2
    s_cbranch_scc1 L_h_fre4x
    s_sleep 3
    s_add_u32 s67, s67, 1
    s_cmp_lt_u32 s67, 0x2000000
    s_cbranch_scc1 L_h_fre4
L_h_fre4x:
    s_waitcnt vmcnt(40)
    ds_write_b128 v250, v[128:131] offset:0
    ds_write_b128 v250, v[132:135] offset:1024
    ds_write_b128 v250, v[136:139] offset:2048
    ds_write_b128 v250, v[140:143] offset:3072
    ds_write_b128 v250, v[144:147] offset:4096
    ds_write_b128 v250, v[148:151] offset:5120
    ds_write_b128 v250, v[152:155] offset:6144
    ds_write_b128 v250, v[156:159] offset:7168
    ds_write_b128 v250, v[160:163] offset:8192
    ds_write_b128 v250, v[164:167] offset:9216
    v_mov_b32 v253, 5
    ds_write_b32 v15, v253
    s_waitcnt lgkmcnt(0)
    s_bfe_u32 s73, s93, 0x40004
    s_bitcmp1_b32 s73, 0
    s_cselect_b64 s[24:25], s[40:41], s[36:37]
    s_cselect_b32 s26, s42, s38
    s_lshr_b32 s73, s73, 1
    s_mul_i32 s74, s5, s73
    s_add_u32 s74, s74, s4
    buffer_load_dwordx4 v[128:131], v16, s[24:27], s74 offen sc1
    buffer_load_dwordx4 v[132:135], v17, s[24:27], s74 offen sc1
    buffer_load_dwordx4 v[136:139], v18, s[24:27], s74 offen sc1
    buffer_load_dwordx4 v[140:143], v19, s[24:27], s74 offen sc1
    buffer_load_dwordx4 v[144:147], v20, s[24:27], s74 offen sc1
    buffer_load_dwordx4 v[148:151], v21, s[24:27], s74 offen sc1
    buffer_load_dwordx4 v[152:155], v22, s[24:27], s74 offen sc1
    buffer_load_dwordx4 v[156:159], v23, s[24:27], s74 offen sc1
    buffer_load_dwordx4 v[160:163], v24, s[24:27], s74 offen sc1
    buffer_load_dwordx4 v[164:167], v25, s[24:27], s74 offen sc1
L_h_fre5:
    ds_read_b32 v253, v15 offset:16
    s_waitcnt lgkmcnt(0)
    v_readfirstlane_b32 s73, v253
    s_nop 0
    s_cmp_ge_u32 s73, 3
    s_cbranch_scc1 L_h_fre5x
    s_sleep 3
    s_add_u32 s67, s67, 1
    s_cmp_lt_u32 s67, 0x2000000
    s_cbranch_scc1 L_h_fre5
L_h_fre5x:
    s_waitcnt vmcnt(40)
    ds_write_b128 v248, v[168:171] offset:0
    ds_write_b128 v248, v[172:175] offset:1024
    ds_write_b128 v248, v[176:179] offset:2048
    ds_write_b128 v248, v[180:183] offset:3072
    ds_write_b128 v248, v[184:187] offset:4096
    ds_write_b128 v248, v[188:191] offset:5120
    ds_write_b128 v248, v[192:195] offset:6144
    ds_write_b128 v248, v[196:199] offset:7168
    ds_write_b128 v248, v[200:203] offset:8192
    ds_write_b128 v248, v[204:207] offset:9216
    v_mov_b32 v253, 6
    ds_write_b32 v15, v253
L_h_fre6:
    ds_read_b32 v253, v15 offset:16
    s_waitcnt lgkmcnt(0)
    v_readfirstlane_b32 s73, v253
    s_nop 0
    s_cmp_ge_u32 s73, 4
    s_cbranch_scc1 L_h_fre6x
    s_sleep 3
    s_add_u32 s67, s67, 1
    s_cmp_lt_u32 s67, 0x2000000
    s_cbranch_scc1 L_h_fre6
L_h_fre6x:
    s_waitcnt vmcnt(30)
    ds_write_b128 v249, v[208:211] offset:0
    ds_write_b128 v249, v[212:215] offset:1024
    ds_write_b128 v249, v[216:219] offset:2048
    ds_write_b128 v249, v[220:223] offset:3072
    ds_write_b128 v249, v[224:227] offset:4096
    ds_write_b128 v249, v[228:231] offset:5120
    ds_write_b128 v249, v[232:235] offset:6144
    ds_write_b128 v249, v[236:239] offset:7168
    ds_write_b128 v249, v[240:243] offset:8192
    ds_write_b128 v249, v[244:247] offset:9216
    v_mov_b32 v253, 7
    ds_write_b32 v15, v253
L_h_fre7:
    ds_read_b32 v253, v15 offset:16
    s_waitcnt lgkmcnt(0)
    v_readfirstlane_b32 s73, v253
    s_nop 0
    s_cmp_ge_u32 s73, 5
    s_cbranch_scc1 L_h_fre7x
    s_sleep 3
    s_add_u32 s67, s67, 1
    s_cmp_lt_u32 s67, 0x2000000
    s_cbranch_scc1 L_h_fre7
L_h_fre7x:
    s_waitcnt vmcnt(20)
    ds_write_b128 v250, v[48:51] offset:0
    ds_write_b128 v250, v[52:55] offset:1024
    ds_write_b128 v250, v[56:59] offset:2048
    ds_write_b128 v250, v[60:63] offset:3072
    ds_write_b128 v250, v[64:67] offset:4096
    ds_write_b128 v250, v[68:71] offset:5120
    ds_write_b128 v250, v[72:75] offset:6144
    ds_write_b128 v250, v[76:79] offset:7168
    ds_write_b128 v250, v[80:83] offset:8192
    ds_write_b128 v250, v[84:87] offset:9216
    v_mov_b32 v253, 8
    ds_write_b32 v15, v253
L_h_fre8:
    ds_read_b32 v253, v15 offset:16
    s_waitcnt lgkmcnt(0)
    v_readfirstlane_b32 s73, v253
    s_nop 0
    s_cmp_ge_u32 s73, 6
    s_cbranch_scc1 L_h_fre8x
    s_sleep 3
    s_add_u32 s67, s67, 1
    s_cmp_lt_u32 s67, 0x2000000
    s_cbranch_scc1 L_h_fre8
L_h_fre8x:
    s_waitcnt vmcnt(10)
    ds_write_b128 v248, v[88:91] offset:0
    ds_write_b128 v248, v[92:95] offset:1024
    ds_write_b128 v248, v[96:99] offset:2048
    ds_write_b128 v248, v[100:103] offset:3072
    ds_write_b128 v248, v[104:107] offset:4096
    ds_write_b128 v248, v[108:111] offset:5120
    ds_write_b128 v248, v[112:115] offset:6144
    ds_write_b128 v248, v[116:119] offset:7168
    ds_write_b128 v248, v[120:123] offset:8192
    ds_write_b128 v248, v[124:127] offset:9216
    v_mov_b32 v253, 9
    ds_write_b32 v15, v253
L_h_fre9:
    ds_read_b32 v253, v15 offset:16
    s_waitcnt lgkmcnt(0)
    v_readfirstlane_b32 s73, v253
    s_nop 0
    s_cmp_ge_u32 s73, 7
    s_cbranch_scc1 L_h_fre9x
    s_sleep 3
    s_add_u32 s67, s67, 1
    s_cmp_lt_u32 s67, 0x2000000
    s_cbranch_scc1 L_h_fre9
L_h_fre9x:
    s_waitcnt vmcnt(0)
    ds_write_b128 v249, v[128:131] offset:0
    ds_write_b128 v249, v[132:135] offset:1024
    ds_write_b128 v249, v[136:139] offset:2048
    ds_write_b128 v249, v[140:143] offset:3072
    ds_write_b128 v249, v[144:147] offset:4096
    ds_write_b128 v249, v[148:151] offset:5120
    ds_write_b128 v249, v[152:155] offset:6144
    ds_write_b128 v249, v[156:159] offset:7168
    ds_write_b128 v249, v[160:163] offset:8192
    ds_write_b128 v249, v[164:167] offset:9216
    v_mov_b32 v253, 10
    ds_write_b32 v15, v253
L_h_fre10:
    ds_read_b32 v253, v15 offset:16
    s_waitcnt lgkmcnt(0)
    v_readfirstlane_b32 s73, v253
    s_nop 0
    s_cmp_ge_u32 s73, 8
    s_cbranch_scc1 L_h_fre10x
    s_sleep 3
    s_add_u32 s67, s67, 1
    s_cmp_lt_u32 s67, 0x2000000
    s_cbranch_scc1 L_h_fre10
L_h_fre10x:
    s_bfe_u32 s73, s93, 0x40008
    s_bitcmp1_b32 s73, 0
    s_cselect_b64 s[24:25], s[40:41], s[36:37]
    s_cselect_b32 s26, s42, s38
    s_lshr_b32 s73, s73, 1
    s_mul_i32 s74, s5, s73
    s_add_u32 s74, s74, s4
    s_add_u32 m0, s8, 0
    s_nop 0
    buffer_load_dwordx4 v16, s[24:27], s74 offen sc1 lds
    s_add_u32 m0, s8, 1024
    s_nop 0
    buffer_load_dwordx4 v17, s[24:27], s74 offen sc1 lds
    s_add_u32 m0, s8, 2048
    s_nop 0
    buffer_load_dwordx4 v18, s[24:27], s74 offen sc1 lds
    s_add_u32 m0, s8, 3072
    s_nop 0
    buffer_load_dwordx4 v19, s[24:27], s74 offen sc1 lds
    s_add_u32 m0, s8, 4096
    s_nop 0
    buffer_load_dwordx4 v20, s[24:27], s74 offen sc1 lds
    s_add_u32 m0, s8, 5120
    s_nop 0
    buffer_load_dwordx4 v21, s[24:27], s74 offen sc1 lds
    s_add_u32 m0, s8, 6144
    s_nop 0
    buffer_load_dwordx4 v22, s[24:27], s74 offen sc1 lds
    s_add_u32 m0, s8, 7168
    s_nop 0
    buffer_load_dwordx4 v23, s[24:27], s74 offen sc1 lds
    s_add_u32 m0, s8, 8192
    s_nop 0
    buffer_load_dwordx4 v24, s[24:27], s74 offen sc1 lds
    s_add_u32 m0, s8, 9216
    s_nop 0
    buffer_load_dwordx4 v25, s[24:27], s74 offen sc1 lds
    s_waitcnt vmcnt(0)
    v_mov_b32 v253, 11
    ds_write_b32 v15, v253
    s_cmp_eq_u32 s65, 1
    s_cbranch_scc1 L_h_fin
L_h_fre11:
    ds_read_b32 v253, v15 offset:16
    s_waitcnt lgkmcnt(0)
    v_readfirstlane_b32 s73, v253
    s_nop 0
    s_cmp_ge_u32 s73, 9
    s_cbranch_scc1 L_h_fre11x
    s_sleep 3
    s_add_u32 s67, s67, 1
    s_cmp_lt_u32 s67, 0x2000000
    s_cbranch_scc1 L_h_fre11
L_h_fre11x:
    s_bfe_u32 s73, s93, 0x4000c
    s_bitcmp1_b32 s73, 0
    s_cselect_b64 s[24:25], s[40:41], s[36:37]
    s_cselect_b32 s26, s42, s38
    s_lshr_b32 s73, s73, 1
    s_mul_i32 s74, s5, s73
    s_add_u32 s74, s74, s4
    s_cmp_eq_u32 s65, 1
    s_cselect_b32 s74, 0x7000000, s74
    s_add_u32 m0, s6, 0
    s_nop 0
    buffer_load_dwordx4 v16, s[24:27], s74 offen sc1 lds
    s_add_u32 m0, s6, 1024
    s_nop 0
    buffer_load_dwordx4 v17, s[24:27], s74 offen sc1 lds
    s_add_u32 m0, s6, 2048
    s_nop 0
    buffer_load_dwordx4 v18, s[24:27], s74 offen sc1 lds
    s_add_u32 m0, s6, 3072
    s_nop 0
    buffer_load_dwordx4 v19, s[24:27], s74 offen sc1 lds
    s_add_u32 m0, s6, 4096
    s_nop 0
    buffer_load_dwordx4 v20, s[24:27], s74 offen sc1 lds
    s_add_u32 m0, s6, 5120
    s_nop 0
    buffer_load_dwordx4 v21, s[24:27], s74 offen sc1 lds
    s_add_u32 m0, s6, 6144
    s_nop 0
    buffer_load_dwordx4 v22, s[24:27], s74 offen sc1 lds
    s_add_u32 m0, s6, 7168
    s_nop 0
    buffer_load_dwordx4 v23, s[24:27], s74 offen sc1 lds
    s_add_u32 m0, s6, 8192
    s_nop 0
    buffer_load_dwordx4 v24, s[24:27], s74 offen sc1 lds
    s_add_u32 m0, s6, 9216
    s_nop 0
    buffer_load_dwordx4 v25, s[24:27], s74 offen sc1 lds
    s_waitcnt vmcnt(0)
    v_mov_b32 v253, 12
    ds_write_b32 v15, v253
L_h_fin:
    s_mov_b32 s56, s30
    s_mov_b32 s57, s31
    s_mov_b32 s58, 5242880
    s_mov_b32 s59, 0x00020000
    s_or_b32 s72, s2, s65
    s_cmp_lg_u32 s72, 0
    s_cbranch_scc1 L_h_nonce
    s_add_u32 s44, s34, 0xf40000
    s_addc_u32 s45, s35, 0
    s_mov_b32 s46, 131072
    s_mov_b32 s47, 0x00020000
    v_and_b32 v5, 31, v0
    v_lshlrev_b32 v5, 7, v5
    v_lshrrev_b32 v6, 5, v0
    v_lshl_add_u32 v5, v6, 14, v5
    s_mov_b32 s70, 0
L_h_np:
    s_mov_b32 s71, 0
    buffer_load_dword v16, v5, s[44:47], s71 offen sc1
    s_mov_b32 s71, 32768
    buffer_load_dword v17, v5, s[44:47], s71 offen sc1
    s_mov_b32 s71, 65536
    buffer_load_dword v18, v5, s[44:47], s71 offen sc1
    s_mov_b32 s71, 98304
    buffer_load_dword v19, v5, s[44:47], s71 offen sc1
    s_waitcnt vmcnt(0)
    v_xor_b32 v16, s66, v16
    v_xor_b32 v17, s66, v17
    v_xor_b32 v18, s66, v18
    v_xor_b32 v19, s66, v19
    v_or3_b32 v16, v16, v17, v18
    v_or_b32 v16, v16, v19
    v_cmp_ne_u32 vcc, 0, v16
    s_cbranch_vccz L_h_npok
    s_add_u32 s70, s70, 1
    s_cmp_lt_u32 s70, 0x200000
    s_cbranch_scc1 L_h_np
L_h_npok:
    s_add_u32 s44, s34, 0xf80000
    s_addc_u32 s45, s35, 0
    s_mov_b32 s46, 128
    s_mov_b32 s47, 0x00020000
    v_mov_b32 v16, s66
    v_lshlrev_b32 v5, 2, v0
    buffer_store_dword v16, v5, s[44:47], 0 offen sc1
L_h_nonce:
    s_lshr_b32 s68, s65, 1
    s_mul_i32 s68, s68, s90
    s_and_b32 s69, s65, 1
    s_mul_i32 s69, s69, 5120
    s_add_u32 s68, s68, s69
    v_add_u32 v5, s68, v1
    s_mul_i32 s68, s65, s90
    s_cmp_lt_u32 s61, 10
    s_cselect_b32 s69, 101376, 0
    s_add_u32 s69, s69, 5120
    s_cmp_eq_u32 s65, 3
    s_cselect_b32 s68, s69, s68
    s_add_u32 s68, s68, 40960
    v_add_u32 v6, s68, v1
    s_mov_b32 s70, 0xffff0000
    s_mov_b32 s68, 0xbfb8aa3b
    s_waitcnt vmcnt(0) lgkmcnt(0)
    v_lshlrev_b32 v56, 16, v26
    v_and_b32 v57, s70, v26
    v_sub_f32 v76, v56, v8
    v_sub_f32 v77, v57, v8
    v_cvt_pk_bf16_f32 v77, v76, v77
    v_lshlrev_b32 v76, 16, v77
    v_and_b32 v77, s70, v77
    v_mul_f32 v76, v76, v9
    v_mul_f32 v77, v77, v9
    v_cvt_pk_bf16_f32 v77, v76, v77
    v_lshlrev_b32 v76, 16, v77
    v_and_b32 v77, s70, v77
    v_lshlrev_b32 v52, 16, v36
    v_and_b32 v53, s70, v36
    v_mul_f32 v76, v76, v52
    v_mul_f32 v77, v77, v53
    v_cvt_pk_bf16_f32 v77, v76, v77
    v_lshlrev_b32 v76, 16, v77
    v_and_b32 v77, s70, v77
    v_lshlrev_b32 v58, 16, v27
    v_and_b32 v59, s70, v27
    v_sub_f32 v78, v58, v8
    v_sub_f32 v79, v59, v8
    v_cvt_pk_bf16_f32 v79, v78, v79
    v_lshlrev_b32 v78, 16, v79
    v_and_b32 v79, s70, v79
    v_mul_f32 v78, v78, v9
    v_mul_f32 v79, v79, v9
    v_cvt_pk_bf16_f32 v79, v78, v79
    v_lshlrev_b32 v78, 16, v79
    v_and_b32 v79, s70, v79
    v_lshlrev_b32 v52, 16, v37
    v_and_b32 v53, s70, v37
    v_mul_f32 v78, v78, v52
    v_mul_f32 v79, v79, v53
    v_cvt_pk_bf16_f32 v79, v78, v79
    v_lshlrev_b32 v78, 16, v79
    v_and_b32 v79, s70, v79
    v_lshlrev_b32 v60, 16, v28
    v_and_b32 v61, s70, v28
    v_sub_f32 v80, v60, v8
    v_sub_f32 v81, v61, v8
    v_cvt_pk_bf16_f32 v81, v80, v81
    v_lshlrev_b32 v80, 16, v81
    v_and_b32 v81, s70, v81
    v_mul_f32 v80, v80, v9
    v_mul_f32 v81, v81, v9
    v_cvt_pk_bf16_f32 v81, v80, v81
    v_lshlrev_b32 v80, 16, v81
    v_and_b32 v81, s70, v81
    v_lshlrev_b32 v52, 16, v38
    v_and_b32 v53, s70, v38
    v_mul_f32 v80, v80, v52
    v_mul_f32 v81, v81, v53
    v_cvt_pk_bf16_f32 v81, v80, v81
    v_lshlrev_b32 v80, 16, v81
    v_and_b32 v81, s70, v81
    v_lshlrev_b32 v62, 16, v29
    v_and_b32 v63, s70, v29
    v_sub_f32 v82, v62, v8
    v_sub_f32 v83, v63, v8
    v_cvt_pk_bf16_f32 v83, v82, v83
    v_lshlrev_b32 v82, 16, v83
    v_and_b32 v83, s70, v83
    v_mul_f32 v82, v82, v9
    v_mul_f32 v83, v83, v9
    v_cvt_pk_bf16_f32 v83, v82, v83
    v_lshlrev_b32 v82, 16, v83
    v_and_b32 v83, s70, v83
    v_lshlrev_b32 v52, 16, v39
    v_and_b32 v53, s70, v39
    v_mul_f32 v82, v82, v52
    v_mul_f32 v83, v83, v53
    v_cvt_pk_bf16_f32 v83, v82, v83
    v_lshlrev_b32 v82, 16, v83
    v_and_b32 v83, s70, v83
    v_lshlrev_b32 v64, 16, v30
    v_and_b32 v65, s70, v30
    v_sub_f32 v84, v64, v8
    v_sub_f32 v85, v65, v8
    v_cvt_pk_bf16_f32 v85, v84, v85
    v_lshlrev_b32 v84, 16, v85
    v_and_b32 v85, s70, v85
    v_mul_f32 v84, v84, v9
    v_mul_f32 v85, v85, v9
    v_cvt_pk_bf16_f32 v85, v84, v85
    v_lshlrev_b32 v84, 16, v85
    v_and_b32 v85, s70, v85
    v_lshlrev_b32 v52, 16, v40
    v_and_b32 v53, s70, v40
    v_mul_f32 v84, v84, v52
    v_mul_f32 v85, v85, v53
    v_cvt_pk_bf16_f32 v85, v84, v85
    v_lshlrev_b32 v84, 16, v85
    v_and_b32 v85, s70, v85
    v_lshlrev_b32 v66, 16, v31
    v_and_b32 v67, s70, v31
    v_sub_f32 v86, v66, v8
    v_sub_f32 v87, v67, v8
    v_cvt_pk_bf16_f32 v87, v86, v87
    v_lshlrev_b32 v86, 16, v87
    v_and_b32 v87, s70, v87
    v_mul_f32 v86, v86, v9
    v_mul_f32 v87, v87, v9
    v_cvt_pk_bf16_f32 v87, v86, v87
    v_lshlrev_b32 v86, 16, v87
    v_and_b32 v87, s70, v87
    v_lshlrev_b32 v52, 16, v41
    v_and_b32 v53, s70, v41
    v_mul_f32 v86, v86, v52
    v_mul_f32 v87, v87, v53
    v_cvt_pk_bf16_f32 v87, v86, v87
    v_lshlrev_b32 v86, 16, v87
    v_and_b32 v87, s70, v87
    v_lshlrev_b32 v68, 16, v32
    v_and_b32 v69, s70, v32
    v_sub_f32 v88, v68, v8
    v_sub_f32 v89, v69, v8
    v_cvt_pk_bf16_f32 v89, v88, v89
    v_lshlrev_b32 v88, 16, v89
    v_and_b32 v89, s70, v89
    v_mul_f32 v88, v88, v9
    v_mul_f32 v89, v89, v9
    v_cvt_pk_bf16_f32 v89, v88, v89
    v_lshlrev_b32 v88, 16, v89
    v_and_b32 v89, s70, v89
    v_lshlrev_b32 v52, 16, v42
    v_and_b32 v53, s70, v42
    v_mul_f32 v88, v88, v52
    v_mul_f32 v89, v89, v53
    v_cvt_pk_bf16_f32 v89, v88, v89
    v_lshlrev_b32 v88, 16, v89
    v_and_b32 v89, s70, v89
    v_lshlrev_b32 v70, 16, v33
    v_and_b32 v71, s70, v33
    v_sub_f32 v90, v70, v8
    v_sub_f32 v91, v71, v8
    v_cvt_pk_bf16_f32 v91, v90, v91
    v_lshlrev_b32 v90, 16, v91
    v_and_b32 v91, s70, v91
    v_mul_f32 v90, v90, v9
    v_mul_f32 v91, v91, v9
    v_cvt_pk_bf16_f32 v91, v90, v91
    v_lshlrev_b32 v90, 16, v91
    v_and_b32 v91, s70, v91
    v_lshlrev_b32 v52, 16, v43
    v_and_b32 v53, s70, v43
    v_mul_f32 v90, v90, v52
    v_mul_f32 v91, v91, v53
    v_cvt_pk_bf16_f32 v91, v90, v91
    v_lshlrev_b32 v90, 16, v91
    v_and_b32 v91, s70, v91
    v_lshlrev_b32 v72, 16, v34
    v_and_b32 v73, s70, v34
    v_sub_f32 v92, v72, v8
    v_sub_f32 v93, v73, v8
    v_cvt_pk_bf16_f32 v93, v92, v93
    v_lshlrev_b32 v92, 16, v93
    v_and_b32 v93, s70, v93
    v_mul_f32 v92, v92, v9
    v_mul_f32 v93, v93, v9
    v_cvt_pk_bf16_f32 v93, v92, v93
    v_lshlrev_b32 v92, 16, v93
    v_and_b32 v93, s70, v93
    v_lshlrev_b32 v52, 16, v44
    v_and_b32 v53, s70, v44
    v_mul_f32 v92, v92, v52
    v_mul_f32 v93, v93, v53
    v_cvt_pk_bf16_f32 v93, v92, v93
    v_lshlrev_b32 v92, 16, v93
    v_and_b32 v93, s70, v93
    v_lshlrev_b32 v74, 16, v35
    v_and_b32 v75, s70, v35
    v_sub_f32 v94, v74, v8
    v_sub_f32 v95, v75, v8
    v_cvt_pk_bf16_f32 v95, v94, v95
    v_lshlrev_b32 v94, 16, v95
    v_and_b32 v95, s70, v95
    v_mul_f32 v94, v94, v9
    v_mul_f32 v95, v95, v9
    v_cvt_pk_bf16_f32 v95, v94, v95
    v_lshlrev_b32 v94, 16, v95
    v_and_b32 v95, s70, v95
    v_lshlrev_b32 v52, 16, v45
    v_and_b32 v53, s70, v45
    v_mul_f32 v94, v94, v52
    v_mul_f32 v95, v95, v53
    v_cvt_pk_bf16_f32 v95, v94, v95
    v_lshlrev_b32 v94, 16, v95
    v_and_b32 v95, s70, v95
    s_barrier
    ds_read_b128 v[100:103], v5 offset:10240
    ds_read_b128 v[104:107], v5 offset:20480
    ds_read_b128 v[108:111], v5 offset:30720
    ds_read_b128 v[96:99], v5 offset:0
    ds_read_b128 v[112:115], v6 offset:0
    ds_read_b128 v[120:123], v5 offset:11264
    ds_read_b128 v[124:127], v5 offset:21504
    ds_read_b128 v[128:131], v5 offset:31744
    ds_read_b128 v[116:119], v5 offset:1024
    ds_read_b128 v[132:135], v6 offset:1024
    ds_read_b128 v[140:143], v5 offset:12288
    ds_read_b128 v[144:147], v5 offset:22528
    ds_read_b128 v[148:151], v5 offset:32768
    ds_read_b128 v[136:139], v5 offset:2048
    ds_read_b128 v[152:155], v6 offset:2048
    ds_read_b128 v[160:163], v5 offset:13312
    ds_read_b128 v[164:167], v5 offset:23552
    ds_read_b128 v[168:171], v5 offset:33792
    ds_read_b128 v[156:159], v5 offset:3072
    ds_read_b128 v[172:175], v6 offset:3072
    ds_read_b128 v[180:183], v5 offset:14336
    ds_read_b128 v[184:187], v5 offset:24576
    ds_read_b128 v[188:191], v5 offset:34816
    ds_read_b128 v[176:179], v5 offset:4096
    ds_read_b128 v[192:195], v6 offset:4096
    s_waitcnt lgkmcnt(15)
    v_pk_add_f32 v[100:101], v[100:101], v[104:105]
    v_pk_add_f32 v[96:97], v[96:97], v[112:113]
    v_pk_add_f32 v[102:103], v[102:103], v[106:107]
    v_pk_add_f32 v[98:99], v[98:99], v[114:115]
    v_pk_add_f32 v[100:101], v[100:101], v[108:109]
    v_pk_add_f32 v[96:97], v[96:97], v[76:77]
    v_pk_add_f32 v[102:103], v[102:103], v[110:111]
    v_pk_add_f32 v[98:99], v[98:99], v[78:79]
    v_pk_mul_f32 v[104:105], v[100:101], s[68:69] op_sel_hi:[1,0]
    v_pk_mul_f32 v[106:107], v[102:103], s[68:69] op_sel_hi:[1,0]
    v_exp_f32 v104, v104
    v_exp_f32 v105, v105
    v_exp_f32 v106, v106
    v_exp_f32 v107, v107
    v_pk_mul_f32 v[96:97], v[96:97], v[100:101]
    v_pk_mul_f32 v[98:99], v[98:99], v[102:103]
    v_pk_add_f32 v[104:105], v[104:105], 1.0 op_sel_hi:[1,0]
    v_pk_add_f32 v[106:107], v[106:107], 1.0 op_sel_hi:[1,0]
    v_rcp_f32 v104, v104
    v_rcp_f32 v105, v105
    v_rcp_f32 v106, v106
    v_rcp_f32 v107, v107
    s_nop 0
    v_pk_fma_f32 v[96:97], v[96:97], v[104:105], v[56:57]
    v_pk_fma_f32 v[98:99], v[98:99], v[106:107], v[58:59]
    buffer_store_dwordx4 v[96:99], v14, s[56:59], s77 offen offset:0 sc1
    v_pk_add_f32 v[120:121], v[120:121], v[124:125]
    v_pk_add_f32 v[116:117], v[116:117], v[132:133]
    v_pk_add_f32 v[122:123], v[122:123], v[126:127]
    v_pk_add_f32 v[118:119], v[118:119], v[134:135]
    v_pk_add_f32 v[120:121], v[120:121], v[128:129]
    v_pk_add_f32 v[116:117], v[116:117], v[80:81]
    v_pk_add_f32 v[122:123], v[122:123], v[130:131]
    v_pk_add_f32 v[118:119], v[118:119], v[82:83]
    v_pk_mul_f32 v[124:125], v[120:121], s[68:69] op_sel_hi:[1,0]
    v_pk_mul_f32 v[126:127], v[122:123], s[68:69] op_sel_hi:[1,0]
    v_exp_f32 v124, v124
    v_exp_f32 v125, v125
    v_exp_f32 v126, v126
    v_exp_f32 v127, v127
    v_pk_mul_f32 v[116:117], v[116:117], v[120:121]
    v_pk_mul_f32 v[118:119], v[118:119], v[122:123]
    v_pk_add_f32 v[124:125], v[124:125], 1.0 op_sel_hi:[1,0]
    v_pk_add_f32 v[126:127], v[126:127], 1.0 op_sel_hi:[1,0]
    v_rcp_f32 v124, v124
    v_rcp_f32 v125, v125
    v_rcp_f32 v126, v126
    v_rcp_f32 v127, v127
    s_nop 0
    v_pk_fma_f32 v[116:117], v[116:117], v[124:125], v[60:61]
    v_pk_fma_f32 v[118:119], v[118:119], v[126:127], v[62:63]
    buffer_store_dwordx4 v[116:119], v14, s[56:59], s77 offen offset:64 sc1
    s_waitcnt lgkmcnt(10)
    v_pk_add_f32 v[140:141], v[140:141], v[144:145]
    v_pk_add_f32 v[136:137], v[136:137], v[152:153]
    v_pk_add_f32 v[142:143], v[142:143], v[146:147]
    v_pk_add_f32 v[138:139], v[138:139], v[154:155]
    v_pk_add_f32 v[140:141], v[140:141], v[148:149]
    v_pk_add_f32 v[136:137], v[136:137], v[84:85]
    v_pk_add_f32 v[142:143], v[142:143], v[150:151]
    v_pk_add_f32 v[138:139], v[138:139], v[86:87]
    v_pk_mul_f32 v[144:145], v[140:141], s[68:69] op_sel_hi:[1,0]
    v_pk_mul_f32 v[146:147], v[142:143], s[68:69] op_sel_hi:[1,0]
    v_exp_f32 v144, v144
    v_exp_f32 v145, v145
    v_exp_f32 v146, v146
    v_exp_f32 v147, v147
    v_pk_mul_f32 v[136:137], v[136:137], v[140:141]
    v_pk_mul_f32 v[138:139], v[138:139], v[142:143]
    v_pk_add_f32 v[144:145], v[144:145], 1.0 op_sel_hi:[1,0]
    v_pk_add_f32 v[146:147], v[146:147], 1.0 op_sel_hi:[1,0]
    v_rcp_f32 v144, v144
    v_rcp_f32 v145, v145
    v_rcp_f32 v146, v146
    v_rcp_f32 v147, v147
    s_nop 0
    v_pk_fma_f32 v[136:137], v[136:137], v[144:145], v[64:65]
    v_pk_fma_f32 v[138:139], v[138:139], v[146:147], v[66:67]
    buffer_store_dwordx4 v[136:139], v14, s[56:59], s77 offen offset:128 sc1
    s_waitcnt lgkmcnt(5)
    v_pk_add_f32 v[160:161], v[160:161], v[164:165]
    v_pk_add_f32 v[156:157], v[156:157], v[172:173]
    v_pk_add_f32 v[162:163], v[162:163], v[166:167]
    v_pk_add_f32 v[158:159], v[158:159], v[174:175]
    v_pk_add_f32 v[160:161], v[160:161], v[168:169]
    v_pk_add_f32 v[156:157], v[156:157], v[88:89]
    v_pk_add_f32 v[162:163], v[162:163], v[170:171]
    v_pk_add_f32 v[158:159], v[158:159], v[90:91]
    v_pk_mul_f32 v[164:165], v[160:161], s[68:69] op_sel_hi:[1,0]
    v_pk_mul_f32 v[166:167], v[162:163], s[68:69] op_sel_hi:[1,0]
    v_exp_f32 v164, v164
    v_exp_f32 v165, v165
    v_exp_f32 v166, v166
    v_exp_f32 v167, v167
    v_pk_mul_f32 v[156:157], v[156:157], v[160:161]
    v_pk_mul_f32 v[158:159], v[158:159], v[162:163]
    v_pk_add_f32 v[164:165], v[164:165], 1.0 op_sel_hi:[1,0]
    v_pk_add_f32 v[166:167], v[166:167], 1.0 op_sel_hi:[1,0]
    v_rcp_f32 v164, v164
    v_rcp_f32 v165, v165
    v_rcp_f32 v166, v166
    v_rcp_f32 v167, v167
    s_nop 0
    v_pk_fma_f32 v[156:157], v[156:157], v[164:165], v[68:69]
    v_pk_fma_f32 v[158:159], v[158:159], v[166:167], v[70:71]
    buffer_store_dwordx4 v[156:159], v14, s[56:59], s77 offen offset:192 sc1
    s_waitcnt lgkmcnt(0)
    v_pk_add_f32 v[180:181], v[180:181], v[184:185]
    v_pk_add_f32 v[176:177], v[176:177], v[192:193]
    v_pk_add_f32 v[182:183], v[182:183], v[186:187]
    v_pk_add_f32 v[178:179], v[178:179], v[194:195]
    v_pk_add_f32 v[180:181], v[180:181], v[188:189]
    v_pk_add_f32 v[176:177], v[176:177], v[92:93]
    v_pk_add_f32 v[182:183], v[182:183], v[190:191]
    v_pk_add_f32 v[178:179], v[178:179], v[94:95]
    v_pk_mul_f32 v[184:185], v[180:181], s[68:69] op_sel_hi:[1,0]
    v_pk_mul_f32 v[186:187], v[182:183], s[68:69] op_sel_hi:[1,0]
    v_exp_f32 v184, v184
    v_exp_f32 v185, v185
    v_exp_f32 v186, v186
    v_exp_f32 v187, v187
    v_pk_mul_f32 v[176:177], v[176:177], v[180:181]
    v_pk_mul_f32 v[178:179], v[178:179], v[182:183]
    v_pk_add_f32 v[184:185], v[184:185], 1.0 op_sel_hi:[1,0]
    v_pk_add_f32 v[186:187], v[186:187], 1.0 op_sel_hi:[1,0]
    v_rcp_f32 v184, v184
    v_rcp_f32 v185, v185
    v_rcp_f32 v186, v186
    v_rcp_f32 v187, v187
    s_nop 0
    v_pk_fma_f32 v[176:177], v[176:177], v[184:185], v[72:73]
    v_pk_fma_f32 v[178:179], v[178:179], v[186:187], v[74:75]
    buffer_store_dwordx4 v[176:179], v14, s[56:59], s77 offen offset:256 sc1
L_done:
    s_endpgm
L_end:
.section .rodata,"a"
.p2align 6
.amdhsa_kernel recurrent_scan__ssm_conv_s5__glu_gated_swiglu__prompt_kernel
  .amdhsa_next_free_vgpr 256
  .amdhsa_next_free_sgpr 100
  .amdhsa_accum_offset 256
  .amdhsa_group_segment_fixed_size 0
  .amdhsa_kernarg_size 128
  .amdhsa_user_sgpr_count 2
  .amdhsa_user_sgpr_kernarg_segment_ptr 1
  .amdhsa_system_sgpr_workgroup_id_x 1
  .amdhsa_float_denorm_mode_32 3
.end_amdhsa_kernel
```
